```python
import torch

def _softmax(x, axis=-1):
    return torch.softmax(x, dim=axis)

def _gelu(x):
    return torch.nn.functional.gelu(x, approximate='tanh')

def _silu(x):
    return torch.nn.functional.silu(x)

def _sigmoid(x):
    return torch.sigmoid(x)

def _layernorm(x, axis=-1, eps=1e-05):
    m = x.mean(dim=axis, keepdim=True)
    v = x.var(dim=axis, keepdim=True, unbiased=False)
    return (x - m) / torch.sqrt(v + eps)

def _scatter_add(tgt, idx, src, axis=0):
    return tgt.clone().index_add_(axis, idx, src)

def _segment_sum(src, seg, n):
    out = torch.zeros((n,) + src.shape[1:], dtype=src.dtype)
    return out.index_add_(0, seg, src)

def _pad(x, pw):
    flat = tuple((v for pair in reversed(pw) for v in pair))
    return torch.nn.functional.pad(x, flat)
kernel_name = 'adaLN_cond__sliding_block_cached__swiglu_ffn__prompt'

def setup_inputs():

    _w = lambda a: (lambda t: t.to(torch.bfloat16) if t.is_floating_point() else t)(torch.as_tensor(a))

    def _A_setup():
        B, Sq, D = (1, 2048, 576)
        Hq, Hkv, Sk, Dh = (32, 16, 2048, 128)
        assert Hq % Hkv == 0, (Hq, Hkv)
        return {'x': _w((lambda *s: torch.randn(*s, dtype=torch.bfloat16) * 0.05)(B, Sq, D)), 'k_cache': _w((lambda *s: torch.randn(*s, dtype=torch.bfloat16) * 3.2)(B, Hkv, Sk, Dh)), 'v_cache': _w((lambda *s: torch.randn(*s, dtype=torch.bfloat16) * 0.4)(B, Hkv, Sk, Dh)), 'wq': _w((lambda *s: torch.randn(*s, dtype=torch.bfloat16) * 3.2)(D, Hq * Dh) * D ** (-0.5)), 'wo': _w((lambda *s: torch.randn(*s, dtype=torch.bfloat16) * 0.4)(Hq * Dh, D) * (Hq * Dh) ** (-0.5))}
    _A_in = _A_setup()

    def _B_setup():
        B, S, D, F = (1, 2048, 576, 4608)
        return {'x': _w((lambda *s: torch.randn(*s, dtype=torch.bfloat16) * 0.05)(B, S, D)), 'w_gate': _w((lambda *s: torch.randn(*s, dtype=torch.bfloat16) * 0.05)(D, F)), 'w_up': _w((lambda *s: torch.randn(*s, dtype=torch.bfloat16) * 0.05)(D, F)), 'w_down': _w((lambda *s: torch.randn(*s, dtype=torch.bfloat16) * 0.05)(F, D))}
    _B_in = _B_setup()
    return {'A_x': _A_in['x'], 'A_k_cache': _A_in['k_cache'], 'A_v_cache': _A_in['v_cache'], 'A_wq': _A_in['wq'], 'A_wo': _A_in['wo'], 'B_x': _B_in['x'], 'B_w_gate': _B_in['w_gate'], 'B_w_up': _B_in['w_up'], 'B_w_down': _B_in['w_down'], 'c': _w((lambda *s: torch.randn(*s, dtype=torch.bfloat16) * 0.1)(1, 576) * 8.0), 'w_mod': _w((lambda *s: torch.randn(*s, dtype=torch.bfloat16) * 0.1)(576, 6 * 576) * 576 ** (-0.5) * 8.0)}

def reference(A_x, A_k_cache, A_v_cache, A_wq, A_wo, B_x, B_w_gate, B_w_up, B_w_down, c, w_mod):

    def _A_ref(x, k_cache, v_cache, wq, wo):
        B, Sq, D = x.shape
        Hq, Dh = (32, 128)
        Hkv, Sk = (k_cache.shape[1], k_cache.shape[2])
        W = min(4096, max(256, Sk // 4))
        rep = Hq // Hkv
        q = (lambda x, *d: x.permute(*d))((x @ wq).reshape(B, Sq, Hq, Dh), 0, 2, 1, 3)
        k = (lambda x, n, axis: torch.repeat_interleave(x, n, dim=axis))(k_cache[:, :, Sk - W:, :], rep, axis=1)
        v = (lambda x, n, axis: torch.repeat_interleave(x, n, dim=axis))(v_cache[:, :, Sk - W:, :], rep, axis=1)
        scores = torch.einsum('bhqd,bhkd->bhqk', q, k) * Dh ** (-0.5)
        p = _softmax(scores, axis=-1)
        o = torch.einsum('bhqk,bhkd->bhqd', p, v)
        return (lambda x, *d: x.permute(*d))(o, 0, 2, 1, 3).reshape(B, Sq, Hq * Dh) @ wo

    def _B_ref(x, w_gate, w_up, w_down):
        g = _silu(x @ w_gate)
        u = x @ w_up
        return g * u @ w_down
    x = A_x
    mod = (_silu(c) @ w_mod).reshape(c.shape[0], 6, 1, -1)
    sa, ca, ga, sb, cb, gb = (mod[:, 0].clone(), mod[:, 1].clone(), mod[:, 2].clone(), mod[:, 3].clone(), mod[:, 4].clone(), mod[:, 5].clone())
    h = _layernorm(x, axis=-1) * (1 + ca) + sa
    x = x + ga * _A_ref(h, A_k_cache, A_v_cache, A_wq, A_wo)
    h = _layernorm(x, axis=-1) * (1 + cb) + sb
    x = x + gb * _B_ref(h, B_w_gate, B_w_up, B_w_down)
    return x
```

```asm
; @launch kernel=pre_kernel grid=(264,1,1) block=(256,1,1) lds=9216
; @launch kernel=main_kernel grid=(256,1,1) block=(256,1,1) lds=163840
.amdgcn_target "amdgcn-amd-amdhsa--gfx950"
.text
.globl pre_kernel
.p2align 8
.type pre_kernel,@function
pre_kernel:
 s_cmp_ge_u32 s2, 0xe8
 s_cbranch_scc1 pre_kernel_pf
 s_cmp_ge_u32 s2, 0xa8
 s_cbranch_scc1 pre_kernel_y
 s_cmp_ge_u32 s2, 0xa2
 s_cbranch_scc1 pre_kernel_m_end
 s_load_dwordx2 s[8:9], s[0:1], 0x50
 s_load_dwordx2 s[12:13], s[0:1], 0x48
 s_load_dwordx2 s[16:17], s[0:1], 0x68
 s_mov_b32 s10, 0x3cc000
 s_mov_b32 s11, 0x20000
 s_mov_b32 s14, 0x480
 s_mov_b32 s15, 0x20000
 s_mov_b32 s18, 0xa200
 s_mov_b32 s19, 0x20000
 s_mov_b32 s3, 0x55555556
 s_mul_hi_u32 s4, s2, s3
 s_mul_i32 s5, s4, 3
 s_sub_u32 s5, s2, s5
 s_mul_i32 s6, s5, 0xc0
 v_and_b32 v1, 7, v0
 v_lshrrev_b32 v2, 3, v0
 v_add_u32 v3, s6, v2
 v_lshlrev_b32 v4, 1, v3
 s_mov_b32 s7, 0x1b00
 v_mul_lo_u32 v5, v3, s7
 v_lshl_add_u32 v5, v1, 4, v5
 s_lshl_b32 s20, s4, 7
 s_waitcnt lgkmcnt(0)
 buffer_load_ushort v8, v4, s[12:15], 0 offen
 buffer_load_ushort v9, v4, s[12:15], 0 offen offset:64
 buffer_load_ushort v10, v4, s[12:15], 0 offen offset:128
 buffer_load_ushort v11, v4, s[12:15], 0 offen offset:192
 buffer_load_ushort v12, v4, s[12:15], 0 offen offset:256
 buffer_load_ushort v13, v4, s[12:15], 0 offen offset:320
 buffer_load_dwordx4 v[16:19], v5, s[8:11], s20 offen nt
 s_add_u32 s20, s20, 0x36000
 buffer_load_dwordx4 v[20:23], v5, s[8:11], s20 offen nt
 s_add_u32 s20, s20, 0x36000
 buffer_load_dwordx4 v[24:27], v5, s[8:11], s20 offen nt
 s_add_u32 s20, s20, 0x36000
 buffer_load_dwordx4 v[28:31], v5, s[8:11], s20 offen nt
 s_add_u32 s20, s20, 0x36000
 buffer_load_dwordx4 v[32:35], v5, s[8:11], s20 offen nt
 s_add_u32 s20, s20, 0x36000
 buffer_load_dwordx4 v[36:39], v5, s[8:11], s20 offen nt
 s_waitcnt vmcnt(11)
 v_lshlrev_b32 v8, 16, v8
 v_mul_f32 v40, 0xbfb8aa3b, v8
 v_exp_f32 v40, v40
 s_nop 0
 v_add_f32 v40, 1.0, v40
 v_rcp_f32 v40, v40
 s_nop 0
 v_mul_f32 v8, v8, v40
 v_cvt_pk_bf16_f32 v8, v8, v8
 v_and_b32 v8, 0xffff0000, v8
 s_waitcnt vmcnt(10)
 v_lshlrev_b32 v9, 16, v9
 v_mul_f32 v40, 0xbfb8aa3b, v9
 v_exp_f32 v40, v40
 s_nop 0
 v_add_f32 v40, 1.0, v40
 v_rcp_f32 v40, v40
 s_nop 0
 v_mul_f32 v9, v9, v40
 v_cvt_pk_bf16_f32 v9, v9, v9
 v_and_b32 v9, 0xffff0000, v9
 s_waitcnt vmcnt(9)
 v_lshlrev_b32 v10, 16, v10
 v_mul_f32 v40, 0xbfb8aa3b, v10
 v_exp_f32 v40, v40
 s_nop 0
 v_add_f32 v40, 1.0, v40
 v_rcp_f32 v40, v40
 s_nop 0
 v_mul_f32 v10, v10, v40
 v_cvt_pk_bf16_f32 v10, v10, v10
 v_and_b32 v10, 0xffff0000, v10
 s_waitcnt vmcnt(8)
 v_lshlrev_b32 v11, 16, v11
 v_mul_f32 v40, 0xbfb8aa3b, v11
 v_exp_f32 v40, v40
 s_nop 0
 v_add_f32 v40, 1.0, v40
 v_rcp_f32 v40, v40
 s_nop 0
 v_mul_f32 v11, v11, v40
 v_cvt_pk_bf16_f32 v11, v11, v11
 v_and_b32 v11, 0xffff0000, v11
 s_waitcnt vmcnt(7)
 v_lshlrev_b32 v12, 16, v12
 v_mul_f32 v40, 0xbfb8aa3b, v12
 v_exp_f32 v40, v40
 s_nop 0
 v_add_f32 v40, 1.0, v40
 v_rcp_f32 v40, v40
 s_nop 0
 v_mul_f32 v12, v12, v40
 v_cvt_pk_bf16_f32 v12, v12, v12
 v_and_b32 v12, 0xffff0000, v12
 s_waitcnt vmcnt(6)
 v_lshlrev_b32 v13, 16, v13
 v_mul_f32 v40, 0xbfb8aa3b, v13
 v_exp_f32 v40, v40
 s_nop 0
 v_add_f32 v40, 1.0, v40
 v_rcp_f32 v40, v40
 s_nop 0
 v_mul_f32 v13, v13, v40
 v_cvt_pk_bf16_f32 v13, v13, v13
 v_and_b32 v13, 0xffff0000, v13
 s_waitcnt vmcnt(5)
 v_lshlrev_b32 v41, 16, v16
 v_and_b32 v42, 0xffff0000, v16
 v_mul_f32 v44, v8, v41
 v_mul_f32 v45, v8, v42
 v_lshlrev_b32 v41, 16, v17
 v_and_b32 v42, 0xffff0000, v17
 v_mul_f32 v46, v8, v41
 v_mul_f32 v47, v8, v42
 v_lshlrev_b32 v41, 16, v18
 v_and_b32 v42, 0xffff0000, v18
 v_mul_f32 v48, v8, v41
 v_mul_f32 v49, v8, v42
 v_lshlrev_b32 v41, 16, v19
 v_and_b32 v42, 0xffff0000, v19
 v_mul_f32 v50, v8, v41
 v_mul_f32 v51, v8, v42
 s_waitcnt vmcnt(4)
 v_lshlrev_b32 v41, 16, v20
 v_and_b32 v42, 0xffff0000, v20
 v_fmac_f32 v44, v9, v41
 v_fmac_f32 v45, v9, v42
 v_lshlrev_b32 v41, 16, v21
 v_and_b32 v42, 0xffff0000, v21
 v_fmac_f32 v46, v9, v41
 v_fmac_f32 v47, v9, v42
 v_lshlrev_b32 v41, 16, v22
 v_and_b32 v42, 0xffff0000, v22
 v_fmac_f32 v48, v9, v41
 v_fmac_f32 v49, v9, v42
 v_lshlrev_b32 v41, 16, v23
 v_and_b32 v42, 0xffff0000, v23
 v_fmac_f32 v50, v9, v41
 v_fmac_f32 v51, v9, v42
 s_waitcnt vmcnt(3)
 v_lshlrev_b32 v41, 16, v24
 v_and_b32 v42, 0xffff0000, v24
 v_fmac_f32 v44, v10, v41
 v_fmac_f32 v45, v10, v42
 v_lshlrev_b32 v41, 16, v25
 v_and_b32 v42, 0xffff0000, v25
 v_fmac_f32 v46, v10, v41
 v_fmac_f32 v47, v10, v42
 v_lshlrev_b32 v41, 16, v26
 v_and_b32 v42, 0xffff0000, v26
 v_fmac_f32 v48, v10, v41
 v_fmac_f32 v49, v10, v42
 v_lshlrev_b32 v41, 16, v27
 v_and_b32 v42, 0xffff0000, v27
 v_fmac_f32 v50, v10, v41
 v_fmac_f32 v51, v10, v42
 s_waitcnt vmcnt(2)
 v_lshlrev_b32 v41, 16, v28
 v_and_b32 v42, 0xffff0000, v28
 v_fmac_f32 v44, v11, v41
 v_fmac_f32 v45, v11, v42
 v_lshlrev_b32 v41, 16, v29
 v_and_b32 v42, 0xffff0000, v29
 v_fmac_f32 v46, v11, v41
 v_fmac_f32 v47, v11, v42
 v_lshlrev_b32 v41, 16, v30
 v_and_b32 v42, 0xffff0000, v30
 v_fmac_f32 v48, v11, v41
 v_fmac_f32 v49, v11, v42
 v_lshlrev_b32 v41, 16, v31
 v_and_b32 v42, 0xffff0000, v31
 v_fmac_f32 v50, v11, v41
 v_fmac_f32 v51, v11, v42
 s_waitcnt vmcnt(1)
 v_lshlrev_b32 v41, 16, v32
 v_and_b32 v42, 0xffff0000, v32
 v_fmac_f32 v44, v12, v41
 v_fmac_f32 v45, v12, v42
 v_lshlrev_b32 v41, 16, v33
 v_and_b32 v42, 0xffff0000, v33
 v_fmac_f32 v46, v12, v41
 v_fmac_f32 v47, v12, v42
 v_lshlrev_b32 v41, 16, v34
 v_and_b32 v42, 0xffff0000, v34
 v_fmac_f32 v48, v12, v41
 v_fmac_f32 v49, v12, v42
 v_lshlrev_b32 v41, 16, v35
 v_and_b32 v42, 0xffff0000, v35
 v_fmac_f32 v50, v12, v41
 v_fmac_f32 v51, v12, v42
 s_waitcnt vmcnt(0)
 v_lshlrev_b32 v41, 16, v36
 v_and_b32 v42, 0xffff0000, v36
 v_fmac_f32 v44, v13, v41
 v_fmac_f32 v45, v13, v42
 v_lshlrev_b32 v41, 16, v37
 v_and_b32 v42, 0xffff0000, v37
 v_fmac_f32 v46, v13, v41
 v_fmac_f32 v47, v13, v42
 v_lshlrev_b32 v41, 16, v38
 v_and_b32 v42, 0xffff0000, v38
 v_fmac_f32 v48, v13, v41
 v_fmac_f32 v49, v13, v42
 v_lshlrev_b32 v41, 16, v39
 v_and_b32 v42, 0xffff0000, v39
 v_fmac_f32 v50, v13, v41
 v_fmac_f32 v51, v13, v42
 v_lshlrev_b32 v6, 8, v2
 v_lshl_add_u32 v6, v1, 5, v6
 ds_write_b128 v6, v[44:47]
 ds_write_b128 v6, v[48:51] offset:16
 s_waitcnt lgkmcnt(0)
 s_barrier
 v_and_b32 v1, 63, v0
 v_lshrrev_b32 v2, 6, v0
 v_lshlrev_b32 v6, 11, v2
 v_lshl_add_u32 v6, v1, 2, v6
 ds_read_b32 v16, v6
 ds_read_b32 v17, v6 offset:256
 ds_read_b32 v18, v6 offset:512
 ds_read_b32 v19, v6 offset:768
 ds_read_b32 v20, v6 offset:1024
 ds_read_b32 v21, v6 offset:1280
 ds_read_b32 v22, v6 offset:1536
 ds_read_b32 v23, v6 offset:1792
 s_waitcnt lgkmcnt(6)
 v_add_f32 v16, v16, v17
 s_waitcnt lgkmcnt(5)
 v_add_f32 v16, v16, v18
 s_waitcnt lgkmcnt(4)
 v_add_f32 v16, v16, v19
 s_waitcnt lgkmcnt(3)
 v_add_f32 v16, v16, v20
 s_waitcnt lgkmcnt(2)
 v_add_f32 v16, v16, v21
 s_waitcnt lgkmcnt(1)
 v_add_f32 v16, v16, v22
 s_waitcnt lgkmcnt(0)
 v_add_f32 v16, v16, v23
 v_lshlrev_b32 v7, 2, v0
 ds_write_b32 v7, v16 offset:8192
 s_waitcnt lgkmcnt(0)
 s_barrier
 v_readfirstlane_b32 s21, v2
 s_nop 0
 s_cmp_lg_u32 s21, 0
 s_cbranch_scc1 pre_kernel_m_end
 ds_read_b32 v16, v7 offset:8192
 ds_read_b32 v17, v7 offset:8448
 ds_read_b32 v18, v7 offset:8704
 ds_read_b32 v19, v7 offset:8960
 s_waitcnt lgkmcnt(2)
 v_add_f32 v16, v16, v17
 s_waitcnt lgkmcnt(0)
 v_add_f32 v18, v18, v19
 v_add_f32 v16, v16, v18
 s_mul_i32 s22, s5, 0x3600
 s_lshl_b32 s23, s4, 8
 s_add_u32 s22, s22, s23
 buffer_store_dword v16, v7, s[16:19], s22 offen sc1
 s_waitcnt vmcnt(0)
pre_kernel_m_end:
 s_endpgm
pre_kernel_y:
 s_load_dwordx2 s[8:9], s[0:1], 0
 s_load_dwordx2 s[16:17], s[0:1], 0x68
 s_mov_b32 s10, 0x240000
 s_mov_b32 s11, 0x20000
 s_waitcnt lgkmcnt(0)
 s_add_u32 s16, s16, 0x40000
 s_addc_u32 s17, s17, 0
 s_mov_b32 s18, 0x240000
 s_mov_b32 s19, 0x20000
 s_sub_u32 s2, s2, 0xa8
 v_and_b32 v1, 7, v0
 v_lshrrev_b32 v2, 3, v0
 s_lshl_b32 s3, s2, 5
 v_add_u32 v3, s3, v2
 s_movk_i32 s4, 0x480
 v_mul_lo_u32 v3, v3, s4
 v_lshl_add_u32 v3, v1, 4, v3
 buffer_load_dwordx4 v[100:103], v3, s[8:11], 0 offen
 buffer_load_dwordx4 v[104:107], v3, s[8:11], 0 offen offset:128
 buffer_load_dwordx4 v[108:111], v3, s[8:11], 0 offen offset:256
 buffer_load_dwordx4 v[112:115], v3, s[8:11], 0 offen offset:384
 buffer_load_dwordx4 v[116:119], v3, s[8:11], 0 offen offset:512
 buffer_load_dwordx4 v[120:123], v3, s[8:11], 0 offen offset:640
 buffer_load_dwordx4 v[124:127], v3, s[8:11], 0 offen offset:768
 buffer_load_dwordx4 v[128:131], v3, s[8:11], 0 offen offset:896
 buffer_load_dwordx4 v[132:135], v3, s[8:11], 0 offen offset:1024
 v_lshrrev_b32 v3, 1, v1
 v_lshlrev_b32 v3, 10, v3
 v_and_b32 v27, 1, v1
 v_lshl_add_u32 v27, v27, 5, v2
 v_lshl_add_u32 v3, v27, 4, v3
 s_mul_i32 s6, s2, 0x9000
 s_waitcnt vmcnt(8)
 v_lshlrev_b32 v28, 16, v100
 v_and_b32 v29, 0xffff0000, v100
 v_lshlrev_b32 v30, 16, v101
 v_and_b32 v31, 0xffff0000, v101
 v_pk_add_f32 v[8:9], v[28:29], v[30:31]
 v_lshlrev_b32 v32, 16, v102
 v_and_b32 v33, 0xffff0000, v102
 v_pk_add_f32 v[8:9], v[8:9], v[32:33]
 v_lshlrev_b32 v34, 16, v103
 v_and_b32 v35, 0xffff0000, v103
 v_pk_add_f32 v[8:9], v[8:9], v[34:35]
 s_waitcnt vmcnt(7)
 v_lshlrev_b32 v36, 16, v104
 v_and_b32 v37, 0xffff0000, v104
 v_pk_add_f32 v[8:9], v[8:9], v[36:37]
 v_lshlrev_b32 v38, 16, v105
 v_and_b32 v39, 0xffff0000, v105
 v_pk_add_f32 v[8:9], v[8:9], v[38:39]
 v_lshlrev_b32 v40, 16, v106
 v_and_b32 v41, 0xffff0000, v106
 v_pk_add_f32 v[8:9], v[8:9], v[40:41]
 v_lshlrev_b32 v42, 16, v107
 v_and_b32 v43, 0xffff0000, v107
 v_pk_add_f32 v[8:9], v[8:9], v[42:43]
 s_waitcnt vmcnt(6)
 v_lshlrev_b32 v44, 16, v108
 v_and_b32 v45, 0xffff0000, v108
 v_pk_add_f32 v[8:9], v[8:9], v[44:45]
 v_lshlrev_b32 v46, 16, v109
 v_and_b32 v47, 0xffff0000, v109
 v_pk_add_f32 v[8:9], v[8:9], v[46:47]
 v_lshlrev_b32 v48, 16, v110
 v_and_b32 v49, 0xffff0000, v110
 v_pk_add_f32 v[8:9], v[8:9], v[48:49]
 v_lshlrev_b32 v50, 16, v111
 v_and_b32 v51, 0xffff0000, v111
 v_pk_add_f32 v[8:9], v[8:9], v[50:51]
 s_waitcnt vmcnt(5)
 v_lshlrev_b32 v52, 16, v112
 v_and_b32 v53, 0xffff0000, v112
 v_pk_add_f32 v[8:9], v[8:9], v[52:53]
 v_lshlrev_b32 v54, 16, v113
 v_and_b32 v55, 0xffff0000, v113
 v_pk_add_f32 v[8:9], v[8:9], v[54:55]
 v_lshlrev_b32 v56, 16, v114
 v_and_b32 v57, 0xffff0000, v114
 v_pk_add_f32 v[8:9], v[8:9], v[56:57]
 v_lshlrev_b32 v58, 16, v115
 v_and_b32 v59, 0xffff0000, v115
 v_pk_add_f32 v[8:9], v[8:9], v[58:59]
 s_waitcnt vmcnt(4)
 v_lshlrev_b32 v60, 16, v116
 v_and_b32 v61, 0xffff0000, v116
 v_pk_add_f32 v[8:9], v[8:9], v[60:61]
 v_lshlrev_b32 v62, 16, v117
 v_and_b32 v63, 0xffff0000, v117
 v_pk_add_f32 v[8:9], v[8:9], v[62:63]
 v_lshlrev_b32 v64, 16, v118
 v_and_b32 v65, 0xffff0000, v118
 v_pk_add_f32 v[8:9], v[8:9], v[64:65]
 v_lshlrev_b32 v66, 16, v119
 v_and_b32 v67, 0xffff0000, v119
 v_pk_add_f32 v[8:9], v[8:9], v[66:67]
 s_waitcnt vmcnt(3)
 v_lshlrev_b32 v68, 16, v120
 v_and_b32 v69, 0xffff0000, v120
 v_pk_add_f32 v[8:9], v[8:9], v[68:69]
 v_lshlrev_b32 v70, 16, v121
 v_and_b32 v71, 0xffff0000, v121
 v_pk_add_f32 v[8:9], v[8:9], v[70:71]
 v_lshlrev_b32 v72, 16, v122
 v_and_b32 v73, 0xffff0000, v122
 v_pk_add_f32 v[8:9], v[8:9], v[72:73]
 v_lshlrev_b32 v74, 16, v123
 v_and_b32 v75, 0xffff0000, v123
 v_pk_add_f32 v[8:9], v[8:9], v[74:75]
 s_waitcnt vmcnt(2)
 v_lshlrev_b32 v76, 16, v124
 v_and_b32 v77, 0xffff0000, v124
 v_pk_add_f32 v[8:9], v[8:9], v[76:77]
 v_lshlrev_b32 v78, 16, v125
 v_and_b32 v79, 0xffff0000, v125
 v_pk_add_f32 v[8:9], v[8:9], v[78:79]
 v_lshlrev_b32 v80, 16, v126
 v_and_b32 v81, 0xffff0000, v126
 v_pk_add_f32 v[8:9], v[8:9], v[80:81]
 v_lshlrev_b32 v82, 16, v127
 v_and_b32 v83, 0xffff0000, v127
 v_pk_add_f32 v[8:9], v[8:9], v[82:83]
 s_waitcnt vmcnt(1)
 v_lshlrev_b32 v84, 16, v128
 v_and_b32 v85, 0xffff0000, v128
 v_pk_add_f32 v[8:9], v[8:9], v[84:85]
 v_lshlrev_b32 v86, 16, v129
 v_and_b32 v87, 0xffff0000, v129
 v_pk_add_f32 v[8:9], v[8:9], v[86:87]
 v_lshlrev_b32 v88, 16, v130
 v_and_b32 v89, 0xffff0000, v130
 v_pk_add_f32 v[8:9], v[8:9], v[88:89]
 v_lshlrev_b32 v90, 16, v131
 v_and_b32 v91, 0xffff0000, v131
 v_pk_add_f32 v[8:9], v[8:9], v[90:91]
 s_waitcnt vmcnt(0)
 v_lshlrev_b32 v92, 16, v132
 v_and_b32 v93, 0xffff0000, v132
 v_pk_add_f32 v[8:9], v[8:9], v[92:93]
 v_lshlrev_b32 v94, 16, v133
 v_and_b32 v95, 0xffff0000, v133
 v_pk_add_f32 v[8:9], v[8:9], v[94:95]
 v_lshlrev_b32 v96, 16, v134
 v_and_b32 v97, 0xffff0000, v134
 v_pk_add_f32 v[8:9], v[8:9], v[96:97]
 v_lshlrev_b32 v98, 16, v135
 v_and_b32 v99, 0xffff0000, v135
 v_pk_add_f32 v[8:9], v[8:9], v[98:99]
 v_add_f32 v5, v8, v9
 s_nop 1
 v_add_f32_dpp v6, v5, v5 quad_perm:[1,0,3,2] row_mask:0xf bank_mask:0xf
 s_nop 1
 v_add_f32_dpp v5, v6, v6 quad_perm:[2,3,0,1] row_mask:0xf bank_mask:0xf
 s_nop 1
 v_add_f32_dpp v6, v5, v5 row_half_mirror row_mask:0xf bank_mask:0xf
 v_mov_b32 v5, v6
 v_mul_f32 v10, 0xbae38e39, v5
 v_mul_f32 v11, 0xbae38e39, v5
 v_pk_add_f32 v[28:29], v[28:29], v[10:11]
 v_pk_mul_f32 v[8:9], v[28:29], v[28:29]
 v_pk_add_f32 v[30:31], v[30:31], v[10:11]
 v_pk_fma_f32 v[8:9], v[30:31], v[30:31], v[8:9]
 v_pk_add_f32 v[32:33], v[32:33], v[10:11]
 v_pk_fma_f32 v[8:9], v[32:33], v[32:33], v[8:9]
 v_pk_add_f32 v[34:35], v[34:35], v[10:11]
 v_pk_fma_f32 v[8:9], v[34:35], v[34:35], v[8:9]
 v_pk_add_f32 v[36:37], v[36:37], v[10:11]
 v_pk_fma_f32 v[8:9], v[36:37], v[36:37], v[8:9]
 v_pk_add_f32 v[38:39], v[38:39], v[10:11]
 v_pk_fma_f32 v[8:9], v[38:39], v[38:39], v[8:9]
 v_pk_add_f32 v[40:41], v[40:41], v[10:11]
 v_pk_fma_f32 v[8:9], v[40:41], v[40:41], v[8:9]
 v_pk_add_f32 v[42:43], v[42:43], v[10:11]
 v_pk_fma_f32 v[8:9], v[42:43], v[42:43], v[8:9]
 v_pk_add_f32 v[44:45], v[44:45], v[10:11]
 v_pk_fma_f32 v[8:9], v[44:45], v[44:45], v[8:9]
 v_pk_add_f32 v[46:47], v[46:47], v[10:11]
 v_pk_fma_f32 v[8:9], v[46:47], v[46:47], v[8:9]
 v_pk_add_f32 v[48:49], v[48:49], v[10:11]
 v_pk_fma_f32 v[8:9], v[48:49], v[48:49], v[8:9]
 v_pk_add_f32 v[50:51], v[50:51], v[10:11]
 v_pk_fma_f32 v[8:9], v[50:51], v[50:51], v[8:9]
 v_pk_add_f32 v[52:53], v[52:53], v[10:11]
 v_pk_fma_f32 v[8:9], v[52:53], v[52:53], v[8:9]
 v_pk_add_f32 v[54:55], v[54:55], v[10:11]
 v_pk_fma_f32 v[8:9], v[54:55], v[54:55], v[8:9]
 v_pk_add_f32 v[56:57], v[56:57], v[10:11]
 v_pk_fma_f32 v[8:9], v[56:57], v[56:57], v[8:9]
 v_pk_add_f32 v[58:59], v[58:59], v[10:11]
 v_pk_fma_f32 v[8:9], v[58:59], v[58:59], v[8:9]
 v_pk_add_f32 v[60:61], v[60:61], v[10:11]
 v_pk_fma_f32 v[8:9], v[60:61], v[60:61], v[8:9]
 v_pk_add_f32 v[62:63], v[62:63], v[10:11]
 v_pk_fma_f32 v[8:9], v[62:63], v[62:63], v[8:9]
 v_pk_add_f32 v[64:65], v[64:65], v[10:11]
 v_pk_fma_f32 v[8:9], v[64:65], v[64:65], v[8:9]
 v_pk_add_f32 v[66:67], v[66:67], v[10:11]
 v_pk_fma_f32 v[8:9], v[66:67], v[66:67], v[8:9]
 v_pk_add_f32 v[68:69], v[68:69], v[10:11]
 v_pk_fma_f32 v[8:9], v[68:69], v[68:69], v[8:9]
 v_pk_add_f32 v[70:71], v[70:71], v[10:11]
 v_pk_fma_f32 v[8:9], v[70:71], v[70:71], v[8:9]
 v_pk_add_f32 v[72:73], v[72:73], v[10:11]
 v_pk_fma_f32 v[8:9], v[72:73], v[72:73], v[8:9]
 v_pk_add_f32 v[74:75], v[74:75], v[10:11]
 v_pk_fma_f32 v[8:9], v[74:75], v[74:75], v[8:9]
 v_pk_add_f32 v[76:77], v[76:77], v[10:11]
 v_pk_fma_f32 v[8:9], v[76:77], v[76:77], v[8:9]
 v_pk_add_f32 v[78:79], v[78:79], v[10:11]
 v_pk_fma_f32 v[8:9], v[78:79], v[78:79], v[8:9]
 v_pk_add_f32 v[80:81], v[80:81], v[10:11]
 v_pk_fma_f32 v[8:9], v[80:81], v[80:81], v[8:9]
 v_pk_add_f32 v[82:83], v[82:83], v[10:11]
 v_pk_fma_f32 v[8:9], v[82:83], v[82:83], v[8:9]
 v_pk_add_f32 v[84:85], v[84:85], v[10:11]
 v_pk_fma_f32 v[8:9], v[84:85], v[84:85], v[8:9]
 v_pk_add_f32 v[86:87], v[86:87], v[10:11]
 v_pk_fma_f32 v[8:9], v[86:87], v[86:87], v[8:9]
 v_pk_add_f32 v[88:89], v[88:89], v[10:11]
 v_pk_fma_f32 v[8:9], v[88:89], v[88:89], v[8:9]
 v_pk_add_f32 v[90:91], v[90:91], v[10:11]
 v_pk_fma_f32 v[8:9], v[90:91], v[90:91], v[8:9]
 v_pk_add_f32 v[92:93], v[92:93], v[10:11]
 v_pk_fma_f32 v[8:9], v[92:93], v[92:93], v[8:9]
 v_pk_add_f32 v[94:95], v[94:95], v[10:11]
 v_pk_fma_f32 v[8:9], v[94:95], v[94:95], v[8:9]
 v_pk_add_f32 v[96:97], v[96:97], v[10:11]
 v_pk_fma_f32 v[8:9], v[96:97], v[96:97], v[8:9]
 v_pk_add_f32 v[98:99], v[98:99], v[10:11]
 v_pk_fma_f32 v[8:9], v[98:99], v[98:99], v[8:9]
 v_add_f32 v6, v8, v9
 s_nop 1
 v_add_f32_dpp v7, v6, v6 quad_perm:[1,0,3,2] row_mask:0xf bank_mask:0xf
 s_nop 1
 v_add_f32_dpp v6, v7, v7 quad_perm:[2,3,0,1] row_mask:0xf bank_mask:0xf
 s_nop 1
 v_add_f32_dpp v7, v6, v6 row_half_mirror row_mask:0xf bank_mask:0xf
 v_mov_b32 v6, v7
 v_mov_b32 v7, 0x3727c5ac
 v_fmac_f32 v7, 0x3ae38e39, v6
 v_rsq_f32 v10, v7
 v_rsq_f32 v11, v7
 s_nop 0
 v_pk_mul_f32 v[28:29], v[28:29], v[10:11]
 v_pk_mul_f32 v[30:31], v[30:31], v[10:11]
 v_pk_mul_f32 v[32:33], v[32:33], v[10:11]
 v_pk_mul_f32 v[34:35], v[34:35], v[10:11]
 v_cvt_pk_f16_f32 v100, v28, v29
 v_cvt_pk_f16_f32 v101, v30, v31
 v_cvt_pk_f16_f32 v102, v32, v33
 v_cvt_pk_f16_f32 v103, v34, v35
 buffer_store_dwordx4 v[100:103], v3, s[16:19], s6 offen sc1
 s_add_u32 s6, s6, 0x1000
 v_pk_mul_f32 v[36:37], v[36:37], v[10:11]
 v_pk_mul_f32 v[38:39], v[38:39], v[10:11]
 v_pk_mul_f32 v[40:41], v[40:41], v[10:11]
 v_pk_mul_f32 v[42:43], v[42:43], v[10:11]
 v_cvt_pk_f16_f32 v104, v36, v37
 v_cvt_pk_f16_f32 v105, v38, v39
 v_cvt_pk_f16_f32 v106, v40, v41
 v_cvt_pk_f16_f32 v107, v42, v43
 buffer_store_dwordx4 v[104:107], v3, s[16:19], s6 offen sc1
 s_add_u32 s6, s6, 0x1000
 v_pk_mul_f32 v[44:45], v[44:45], v[10:11]
 v_pk_mul_f32 v[46:47], v[46:47], v[10:11]
 v_pk_mul_f32 v[48:49], v[48:49], v[10:11]
 v_pk_mul_f32 v[50:51], v[50:51], v[10:11]
 v_cvt_pk_f16_f32 v108, v44, v45
 v_cvt_pk_f16_f32 v109, v46, v47
 v_cvt_pk_f16_f32 v110, v48, v49
 v_cvt_pk_f16_f32 v111, v50, v51
 buffer_store_dwordx4 v[108:111], v3, s[16:19], s6 offen sc1
 s_add_u32 s6, s6, 0x1000
 v_pk_mul_f32 v[52:53], v[52:53], v[10:11]
 v_pk_mul_f32 v[54:55], v[54:55], v[10:11]
 v_pk_mul_f32 v[56:57], v[56:57], v[10:11]
 v_pk_mul_f32 v[58:59], v[58:59], v[10:11]
 v_cvt_pk_f16_f32 v112, v52, v53
 v_cvt_pk_f16_f32 v113, v54, v55
 v_cvt_pk_f16_f32 v114, v56, v57
 v_cvt_pk_f16_f32 v115, v58, v59
 buffer_store_dwordx4 v[112:115], v3, s[16:19], s6 offen sc1
 s_add_u32 s6, s6, 0x1000
 v_pk_mul_f32 v[60:61], v[60:61], v[10:11]
 v_pk_mul_f32 v[62:63], v[62:63], v[10:11]
 v_pk_mul_f32 v[64:65], v[64:65], v[10:11]
 v_pk_mul_f32 v[66:67], v[66:67], v[10:11]
 v_cvt_pk_f16_f32 v116, v60, v61
 v_cvt_pk_f16_f32 v117, v62, v63
 v_cvt_pk_f16_f32 v118, v64, v65
 v_cvt_pk_f16_f32 v119, v66, v67
 buffer_store_dwordx4 v[116:119], v3, s[16:19], s6 offen sc1
 s_add_u32 s6, s6, 0x1000
 v_pk_mul_f32 v[68:69], v[68:69], v[10:11]
 v_pk_mul_f32 v[70:71], v[70:71], v[10:11]
 v_pk_mul_f32 v[72:73], v[72:73], v[10:11]
 v_pk_mul_f32 v[74:75], v[74:75], v[10:11]
 v_cvt_pk_f16_f32 v120, v68, v69
 v_cvt_pk_f16_f32 v121, v70, v71
 v_cvt_pk_f16_f32 v122, v72, v73
 v_cvt_pk_f16_f32 v123, v74, v75
 buffer_store_dwordx4 v[120:123], v3, s[16:19], s6 offen sc1
 s_add_u32 s6, s6, 0x1000
 v_pk_mul_f32 v[76:77], v[76:77], v[10:11]
 v_pk_mul_f32 v[78:79], v[78:79], v[10:11]
 v_pk_mul_f32 v[80:81], v[80:81], v[10:11]
 v_pk_mul_f32 v[82:83], v[82:83], v[10:11]
 v_cvt_pk_f16_f32 v124, v76, v77
 v_cvt_pk_f16_f32 v125, v78, v79
 v_cvt_pk_f16_f32 v126, v80, v81
 v_cvt_pk_f16_f32 v127, v82, v83
 buffer_store_dwordx4 v[124:127], v3, s[16:19], s6 offen sc1
 s_add_u32 s6, s6, 0x1000
 v_pk_mul_f32 v[84:85], v[84:85], v[10:11]
 v_pk_mul_f32 v[86:87], v[86:87], v[10:11]
 v_pk_mul_f32 v[88:89], v[88:89], v[10:11]
 v_pk_mul_f32 v[90:91], v[90:91], v[10:11]
 v_cvt_pk_f16_f32 v128, v84, v85
 v_cvt_pk_f16_f32 v129, v86, v87
 v_cvt_pk_f16_f32 v130, v88, v89
 v_cvt_pk_f16_f32 v131, v90, v91
 buffer_store_dwordx4 v[128:131], v3, s[16:19], s6 offen sc1
 s_add_u32 s6, s6, 0x1000
 v_pk_mul_f32 v[92:93], v[92:93], v[10:11]
 v_pk_mul_f32 v[94:95], v[94:95], v[10:11]
 v_pk_mul_f32 v[96:97], v[96:97], v[10:11]
 v_pk_mul_f32 v[98:99], v[98:99], v[10:11]
 v_cvt_pk_f16_f32 v132, v92, v93
 v_cvt_pk_f16_f32 v133, v94, v95
 v_cvt_pk_f16_f32 v134, v96, v97
 v_cvt_pk_f16_f32 v135, v98, v99
 buffer_store_dwordx4 v[132:135], v3, s[16:19], s6 offen sc1
 s_endpgm
 s_waitcnt vmcnt(0)
pre_kernel_pf:
 s_cmp_ge_u32 s2, 0x108
 s_cbranch_scc1 pre_kernel_end2
 s_load_dwordx2 s[16:17], s[0:1], 0x68
 s_waitcnt lgkmcnt(0)
 s_add_u32 s16, s16, 0x2a00000
 s_addc_u32 s17, s17, 0
 s_mov_b32 s18, 0x40000
 s_mov_b32 s19, 0x20000
 s_sub_u32 s2, s2, 0xe8
 s_lshl_b32 s3, s2, 15
 v_lshlrev_b32 v14, 7, v0
 v_mov_b32 v16, 0
 buffer_store_dword v16, v14, s[16:19], s3 offen sc1
 s_getpc_b64 s[12:13]
 pre_kernel_pc_main_kernel:
 s_add_u32 s12, s12, main_kernel-pre_kernel_pc_main_kernel
 s_addc_u32 s13, s13, 0
 s_lshr_b32 s14, s2, 3
 s_lshl_b32 s14, s14, 15
 v_lshl_add_u32 v12, v0, 7, s14
 v_min_u32 v12, code_end-main_kernel-4, v12
 global_load_dword v13, v12, s[12:13]
 s_waitcnt vmcnt(0)
pre_kernel_end2:
 s_endpgm
.globl main_kernel
.p2align 8
.type main_kernel,@function
main_kernel:
 s_cmp_ge_u32 s2, 0x100
 s_cbranch_scc1 main_kernel_end
 s_load_dwordx2 s[4:5], s[0:1], 0x68
 s_load_dwordx2 s[8:9], s[0:1], 0x68
 s_load_dwordx2 s[12:13], s[0:1], 24
 s_load_dwordx2 s[16:17], s[0:1], 8
 s_load_dwordx2 s[20:21], s[0:1], 16
 s_load_dwordx2 s[24:25], s[0:1], 0x68
 s_load_dwordx2 s[96:97], s[0:1], 32
 s_load_dwordx2 s[80:81], s[0:1], 48
 s_load_dwordx2 s[84:85], s[0:1], 56
 s_load_dwordx2 s[88:89], s[0:1], 64
 v_lshlrev_b32 v57, 4, v0
 v_lshrrev_b32 v56, 1, v0
 v_lshlrev_b32 v56, 6, v56
 v_and_b32 v3, 1, v0
 v_lshl_add_u32 v56, v3, 4, v56
 v_add_u32 v56, 0x10000, v56
 v_lshrrev_b32 v1, 6, v0
 s_nop 0
 v_readfirstlane_b32 s28, v1
 v_readfirstlane_b32 s100, v1
 v_and_b32 v0, 63, v0
 v_lshlrev_b32 v1, 4, v0
 s_and_b32 s40, s2, 7
 s_lshl_b32 s40, s40, 2
 s_lshr_b32 s41, s2, 3
 s_and_b32 s42, s41, 3
 s_add_u32 s29, s40, s42
 s_lshr_b32 s40, s41, 2
 s_lshl_b32 s40, s40, 3
 s_lshl_b32 s41, s28, 1
 s_add_u32 s30, s40, s41
 s_lshl_b32 s40, s28, 17
 s_lshl_b32 s41, s29, 8
 s_add_u32 s31, s40, s41
 s_lshr_b32 s40, s29, 1
 s_lshl_b32 s40, s40, 19
 s_lshl_b32 s41, s28, 12
 s_add_u32 s32, s40, s41
 s_add_u32 s32, s32, 0x60000
 s_mul_i32 s33, s30, 0x9000
 s_add_u32 s34, s33, 0x9000
 s_lshl_b32 s35, s28, 12
 s_mul_i32 s40, s30, 0x48000
 s_lshl_b32 s41, s29, 13
 s_add_u32 s40, s40, s41
 s_lshr_b32 s41, s29, 2
 s_lshl_b32 s41, s41, 12
 s_add_u32 s36, s40, s41
 s_add_u32 s37, s36, 0x48000
 v_lshrrev_b32 v17, 4, v0
 v_and_b32 v18, 15, v0
 v_lshlrev_b32 v19, 2, v17
 v_xor_b32 v19, v18, v19
 v_lshlrev_b32 v19, 4, v19
 v_lshl_add_u32 v10, v17, 8, v19
 v_lshl_add_u32 v2, v17, 13, v19
 v_add_u32 v3, 0x7c00, v2
 v_add_u32 v4, 0xf800, v2
 v_add_u32 v5, 0x17400, v2
 v_add_u32 v19, 0, v17
 v_xor_b32 v19, v18, v19
 v_lshlrev_b32 v19, 4, v19
 v_lshl_add_u32 v6, v17, 8, v19
 v_add_u32 v19, 4, v17
 v_xor_b32 v19, v18, v19
 v_lshlrev_b32 v19, 4, v19
 v_lshl_add_u32 v7, v17, 8, v19
 v_add_u32 v19, 8, v17
 v_xor_b32 v19, v18, v19
 v_lshlrev_b32 v19, 4, v19
 v_lshl_add_u32 v8, v17, 8, v19
 v_add_u32 v19, 12, v17
 v_xor_b32 v19, v18, v19
 v_lshlrev_b32 v19, 4, v19
 v_lshl_add_u32 v9, v17, 8, v19
 s_mov_b32 s6, 0xa200
 s_mov_b32 s7, 0x20000
 s_waitcnt lgkmcnt(0)
 s_add_u32 s8, s8, 0x40000
 s_addc_u32 s9, s9, 0
 s_mov_b32 s10, 0x240000
 s_mov_b32 s11, 0x20000
 s_mov_b32 s14, 0x480000
 s_mov_b32 s15, 0x20000
 s_mov_b32 s3, 0x900
 buffer_load_dwordx4 v[32:35], v57, s[4:7], s3 offen
 s_mov_b32 s3, 0x3f00
 buffer_load_dwordx4 v[36:39], v57, s[4:7], s3 offen
 s_mov_b32 s3, 0x7500
 buffer_load_dwordx4 v[40:43], v57, s[4:7], s3 offen
 s_mov_b32 s3, 0
 buffer_load_dwordx4 v[44:47], v57, s[4:7], s3 offen
 s_mov_b32 s3, 0x3600
 buffer_load_dwordx4 v[48:51], v57, s[4:7], s3 offen
 s_mov_b32 s3, 0x6c00
 buffer_load_dwordx4 v[52:55], v57, s[4:7], s3 offen
 s_add_u32 m0, s35, 0
 s_add_u32 s43, s31, 0
 buffer_load_dwordx4 v2, s[12:15], s43 offen nt lds
 buffer_load_dwordx4 v3, s[12:15], s43 offen offset:1024 nt lds
 buffer_load_dwordx4 v4, s[12:15], s43 offen offset:2048 nt lds
 buffer_load_dwordx4 v5, s[12:15], s43 offen offset:3072 nt lds
 s_add_u32 s45, s33, 0
 s_add_u32 s46, s34, 0
 buffer_load_dwordx4 v[128:131], v1, s[8:11], s45 offen
 buffer_load_dwordx4 v[132:135], v1, s[8:11], s46 offen
 buffer_load_dwordx4 v[136:139], v1, s[8:11], s45 offen offset:1024
 buffer_load_dwordx4 v[140:143], v1, s[8:11], s46 offen offset:1024
 buffer_load_dwordx4 v[144:147], v1, s[8:11], s45 offen offset:2048
 buffer_load_dwordx4 v[148:151], v1, s[8:11], s46 offen offset:2048
 buffer_load_dwordx4 v[152:155], v1, s[8:11], s45 offen offset:3072
 buffer_load_dwordx4 v[156:159], v1, s[8:11], s46 offen offset:3072
 s_mov_b32 s18, 0x800000
 s_mov_b32 s19, 0x20000
 s_mov_b32 s22, 0x800000
 s_mov_b32 s23, 0x20000
 s_add_u32 s24, s24, 0x5800000
 s_addc_u32 s25, s25, 0
 s_mov_b32 s26, 0x1200000
 s_mov_b32 s27, 0x20000
 s_mov_b32 s98, 0x480000
 s_mov_b32 s99, 0x20000
 s_mov_b32 s82, 0x510000
 s_mov_b32 s83, 0x20000
 s_mov_b32 s86, 0x510000
 s_mov_b32 s87, 0x20000
 s_mov_b32 s90, 0x510000
 s_mov_b32 s91, 0x20000
 v_lshrrev_b32 v17, 5, v0
 v_bfe_u32 v18, v0, 2, 2
 v_bfe_u32 v19, v0, 4, 1
 v_lshl_add_u32 v21, v17, 3, v18
 v_lshlrev_b32 v21, 8, v21
 v_lshl_add_u32 v21, v19, 5, v21
 v_and_b32 v20, 1, v0
 v_lshl_add_u32 v21, v20, 4, v21
 v_bfe_u32 v20, v0, 1, 1
 v_lshl_add_u32 v21, v20, 3, v21
 v_xor_b32 v20, 0, v18
 v_lshl_add_u32 v64, v20, 6, v21
 v_add_u32 v68, 0x14000, v64
 v_add_u32 v72, 0x24000, v64
 v_xor_b32 v20, 1, v18
 v_lshl_add_u32 v65, v20, 6, v21
 v_add_u32 v69, 0x14000, v65
 v_add_u32 v73, 0x24000, v65
 v_xor_b32 v20, 2, v18
 v_lshl_add_u32 v66, v20, 6, v21
 v_add_u32 v70, 0x14000, v66
 v_add_u32 v74, 0x24000, v66
 v_xor_b32 v20, 3, v18
 v_lshl_add_u32 v67, v20, 6, v21
 v_add_u32 v71, 0x14000, v67
 v_add_u32 v75, 0x24000, v67
 v_and_b32 v18, 19, v0
 v_bfe_u32 v19, v0, 2, 1
 v_bfe_u32 v20, v0, 3, 1
 v_lshl_or_b32 v18, v19, 3, v18
 v_lshl_or_b32 v18, v20, 2, v18
 v_and_b32 v19, 15, v18
 v_xor_b32 v19, v19, v17
 v_lshlrev_b32 v18, 8, v18
 v_add_u32 v18, 0x14000, v18
 v_xor_b32 v20, 0, v19
 v_lshl_add_u32 v76, v20, 4, v18
 v_add_u32 v84, 0x10000, v76
 v_xor_b32 v20, 2, v19
 v_lshl_add_u32 v77, v20, 4, v18
 v_add_u32 v85, 0x10000, v77
 v_xor_b32 v20, 4, v19
 v_lshl_add_u32 v78, v20, 4, v18
 v_add_u32 v86, 0x10000, v78
 v_xor_b32 v20, 6, v19
 v_lshl_add_u32 v79, v20, 4, v18
 v_add_u32 v87, 0x10000, v79
 v_xor_b32 v20, 8, v19
 v_lshl_add_u32 v80, v20, 4, v18
 v_add_u32 v88, 0x10000, v80
 v_xor_b32 v20, 10, v19
 v_lshl_add_u32 v81, v20, 4, v18
 v_add_u32 v89, 0x10000, v81
 v_xor_b32 v20, 12, v19
 v_lshl_add_u32 v82, v20, 4, v18
 v_add_u32 v90, 0x10000, v82
 v_xor_b32 v20, 14, v19
 v_lshl_add_u32 v83, v20, 4, v18
 v_add_u32 v91, 0x10000, v83
 v_mov_b32 v11, 0
 v_mov_b32 v12, 0
 v_lshlrev_b32 v23, 6, v17
 v_add_u32 v23, 0x10000, v23
 v_min_u32 v123, 20, v0
 v_lshlrev_b32 v123, 7, v123
 s_lshl_b32 s40, s2, 2
 s_add_u32 s40, s40, s28
 s_mul_i32 s39, s40, 0x1480
 s_add_u32 m0, s35, 0x4000
 s_add_u32 s44, s31, 0x80000
 buffer_load_dwordx4 v2, s[12:15], s44 offen nt lds
 buffer_load_dwordx4 v3, s[12:15], s44 offen offset:1024 nt lds
 buffer_load_dwordx4 v4, s[12:15], s44 offen offset:2048 nt lds
 buffer_load_dwordx4 v5, s[12:15], s44 offen offset:3072 nt lds
 s_add_u32 s45, s33, 0x1000
 s_add_u32 s46, s34, 0x1000
 buffer_load_dwordx4 v[160:163], v1, s[8:11], s45 offen
 buffer_load_dwordx4 v[164:167], v1, s[8:11], s46 offen
 buffer_load_dwordx4 v[168:171], v1, s[8:11], s45 offen offset:1024
 buffer_load_dwordx4 v[172:175], v1, s[8:11], s46 offen offset:1024
 buffer_load_dwordx4 v[176:179], v1, s[8:11], s45 offen offset:2048
 buffer_load_dwordx4 v[180:183], v1, s[8:11], s46 offen offset:2048
 buffer_load_dwordx4 v[184:187], v1, s[8:11], s45 offen offset:3072
 buffer_load_dwordx4 v[188:191], v1, s[8:11], s46 offen offset:3072
 s_waitcnt vmcnt(28)
 v_add_f32 v32, v32, v36
 s_waitcnt vmcnt(27)
 v_add_f32 v32, v32, v40
 v_cvt_pk_bf16_f32 v32, v32, v32
 v_and_b32 v32, 0xffff0000, v32
 v_add_f32 v32, 1.0, v32
 v_cvt_pk_bf16_f32 v32, v32, v32
 v_and_b32 v32, 0xffff0000, v32
 v_mul_f32 v32, 0x3e0293ee, v32
 v_add_f32 v33, v33, v37
 v_add_f32 v33, v33, v41
 v_cvt_pk_bf16_f32 v33, v33, v33
 v_and_b32 v33, 0xffff0000, v33
 v_add_f32 v33, 1.0, v33
 v_cvt_pk_bf16_f32 v33, v33, v33
 v_and_b32 v33, 0xffff0000, v33
 v_mul_f32 v33, 0x3e0293ee, v33
 v_add_f32 v34, v34, v38
 v_add_f32 v34, v34, v42
 v_cvt_pk_bf16_f32 v34, v34, v34
 v_and_b32 v34, 0xffff0000, v34
 v_add_f32 v34, 1.0, v34
 v_cvt_pk_bf16_f32 v34, v34, v34
 v_and_b32 v34, 0xffff0000, v34
 v_mul_f32 v34, 0x3e0293ee, v34
 v_add_f32 v35, v35, v39
 v_add_f32 v35, v35, v43
 v_cvt_pk_bf16_f32 v35, v35, v35
 v_and_b32 v35, 0xffff0000, v35
 v_add_f32 v35, 1.0, v35
 v_cvt_pk_bf16_f32 v35, v35, v35
 v_and_b32 v35, 0xffff0000, v35
 v_mul_f32 v35, 0x3e0293ee, v35
 ds_write_b128 v56, v[32:35]
 s_waitcnt vmcnt(25)
 v_add_f32 v44, v44, v48
 s_waitcnt vmcnt(24)
 v_add_f32 v44, v44, v52
 v_cvt_pk_bf16_f32 v44, v44, v44
 v_and_b32 v44, 0xffff0000, v44
 v_mul_f32 v44, 0x3e0293ee, v44
 v_add_f32 v45, v45, v49
 v_add_f32 v45, v45, v53
 v_cvt_pk_bf16_f32 v45, v45, v45
 v_and_b32 v45, 0xffff0000, v45
 v_mul_f32 v45, 0x3e0293ee, v45
 v_add_f32 v46, v46, v50
 v_add_f32 v46, v46, v54
 v_cvt_pk_bf16_f32 v46, v46, v46
 v_and_b32 v46, 0xffff0000, v46
 v_mul_f32 v46, 0x3e0293ee, v46
 v_add_f32 v47, v47, v51
 v_add_f32 v47, v47, v55
 v_cvt_pk_bf16_f32 v47, v47, v47
 v_and_b32 v47, 0xffff0000, v47
 v_mul_f32 v47, 0x3e0293ee, v47
 ds_write_b128 v56, v[44:47] offset:32
 s_waitcnt lgkmcnt(0)
 s_waitcnt vmcnt(12)
 s_barrier
 ds_read_b64_tr_b16 a[192:193], v64
 ds_read_b64_tr_b16 a[194:195], v64 offset:1024
 ds_read_b64_tr_b16 a[196:197], v65
 ds_read_b64_tr_b16 a[198:199], v65 offset:1024
 ds_read_b64_tr_b16 a[200:201], v66
 ds_read_b64_tr_b16 a[202:203], v66 offset:1024
 ds_read_b128 v[32:35], v23
 ds_read_b128 v[36:39], v23 offset:16
 ds_read_b128 v[40:43], v23 offset:32
 ds_read_b128 v[44:47], v23 offset:48
 ds_read_b128 v[48:51], v23 offset:128
 ds_read_b128 v[52:55], v23 offset:144
 ds_read_b128 v[56:59], v23 offset:160
 ds_read_b128 v[60:63], v23 offset:176
 s_waitcnt lgkmcnt(5)
 v_fma_mix_f32 v100, v128, v32, v40 op_sel_hi:[1,0,0]
 v_fma_mix_f32 v101, v128, v33, v41 op_sel:[1,0,0] op_sel_hi:[1,0,0]
 v_fma_mix_f32 v102, v129, v34, v42 op_sel_hi:[1,0,0]
 v_fma_mix_f32 v103, v129, v35, v43 op_sel:[1,0,0] op_sel_hi:[1,0,0]
 v_cvt_pk_bf16_f32 v128, v100, v101
 v_cvt_pk_bf16_f32 v129, v102, v103
 s_waitcnt lgkmcnt(4)
 v_fma_mix_f32 v104, v130, v36, v44 op_sel_hi:[1,0,0]
 v_fma_mix_f32 v105, v130, v37, v45 op_sel:[1,0,0] op_sel_hi:[1,0,0]
 v_fma_mix_f32 v106, v131, v38, v46 op_sel_hi:[1,0,0]
 v_fma_mix_f32 v107, v131, v39, v47 op_sel:[1,0,0] op_sel_hi:[1,0,0]
 v_cvt_pk_bf16_f32 v130, v104, v105
 v_cvt_pk_bf16_f32 v131, v106, v107
 v_fma_mix_f32 v100, v132, v32, v40 op_sel_hi:[1,0,0]
 v_fma_mix_f32 v101, v132, v33, v41 op_sel:[1,0,0] op_sel_hi:[1,0,0]
 v_fma_mix_f32 v102, v133, v34, v42 op_sel_hi:[1,0,0]
 v_fma_mix_f32 v103, v133, v35, v43 op_sel:[1,0,0] op_sel_hi:[1,0,0]
 v_cvt_pk_bf16_f32 v132, v100, v101
 v_cvt_pk_bf16_f32 v133, v102, v103
 v_fma_mix_f32 v104, v134, v36, v44 op_sel_hi:[1,0,0]
 v_fma_mix_f32 v105, v134, v37, v45 op_sel:[1,0,0] op_sel_hi:[1,0,0]
 v_fma_mix_f32 v106, v135, v38, v46 op_sel_hi:[1,0,0]
 v_fma_mix_f32 v107, v135, v39, v47 op_sel:[1,0,0] op_sel_hi:[1,0,0]
 v_cvt_pk_bf16_f32 v134, v104, v105
 v_cvt_pk_bf16_f32 v135, v106, v107
 v_mfma_f32_32x32x16_bf16 a[0:15], a[192:195], v[128:131], 0
 s_add_u32 m0, s35, 0x8000
 s_add_u32 s43, s31, 0x100000
 buffer_load_dwordx4 v2, s[12:15], s43 offen nt lds
 buffer_load_dwordx4 v3, s[12:15], s43 offen offset:1024 nt lds
 v_mfma_f32_32x32x16_bf16 a[16:31], a[192:195], v[132:135], 0
 buffer_load_dwordx4 v4, s[12:15], s43 offen offset:2048 nt lds
 buffer_load_dwordx4 v5, s[12:15], s43 offen offset:3072 nt lds
 ds_read_b64_tr_b16 a[204:205], v67
 ds_read_b64_tr_b16 a[206:207], v67 offset:1024
 v_mfma_f32_32x32x16_bf16 a[32:47], a[196:199], v[128:131], 0
 s_add_u32 s45, s33, 0x2000
 s_add_u32 s46, s34, 0x2000
 buffer_load_dwordx4 v[192:195], v1, s[8:11], s45 offen
 buffer_load_dwordx4 v[196:199], v1, s[8:11], s46 offen
 v_mfma_f32_32x32x16_bf16 a[48:63], a[196:199], v[132:135], 0
 buffer_load_dwordx4 v[200:203], v1, s[8:11], s45 offen offset:1024
 ds_read_b64_tr_b16 a[208:209], v64 offset:4096
 ds_read_b64_tr_b16 a[210:211], v64 offset:5120
 buffer_load_dwordx4 v[204:207], v1, s[8:11], s46 offen offset:1024
 v_mfma_f32_32x32x16_bf16 a[64:79], a[200:203], v[128:131], 0
 buffer_load_dwordx4 v[208:211], v1, s[8:11], s45 offen offset:2048
 buffer_load_dwordx4 v[212:215], v1, s[8:11], s46 offen offset:2048
 buffer_load_dwordx4 v[216:219], v1, s[8:11], s45 offen offset:3072
 v_mfma_f32_32x32x16_bf16 a[80:95], a[200:203], v[132:135], 0
 buffer_load_dwordx4 v[220:223], v1, s[8:11], s46 offen offset:3072
 ds_read_b64_tr_b16 a[212:213], v65 offset:4096
 ds_read_b64_tr_b16 a[214:215], v65 offset:5120
 ds_read_b128 v[32:35], v23 offset:256
 ds_read_b128 v[36:39], v23 offset:272
 s_waitcnt lgkmcnt(6)
 v_mfma_f32_32x32x16_bf16 a[96:111], a[204:207], v[128:131], 0
 ds_read_b128 v[40:43], v23 offset:288
 ds_read_b128 v[44:47], v23 offset:304
 v_fma_mix_f32 v100, v136, v48, v56 op_sel_hi:[1,0,0]
 v_fma_mix_f32 v101, v136, v49, v57 op_sel:[1,0,0] op_sel_hi:[1,0,0]
 v_fma_mix_f32 v102, v137, v50, v58 op_sel_hi:[1,0,0]
 v_fma_mix_f32 v103, v137, v51, v59 op_sel:[1,0,0] op_sel_hi:[1,0,0]
 v_cvt_pk_bf16_f32 v136, v100, v101
 v_cvt_pk_bf16_f32 v137, v102, v103
 v_fma_mix_f32 v104, v138, v52, v60 op_sel_hi:[1,0,0]
 v_fma_mix_f32 v105, v138, v53, v61 op_sel:[1,0,0] op_sel_hi:[1,0,0]
 v_fma_mix_f32 v106, v139, v54, v62 op_sel_hi:[1,0,0]
 v_fma_mix_f32 v107, v139, v55, v63 op_sel:[1,0,0] op_sel_hi:[1,0,0]
 v_cvt_pk_bf16_f32 v138, v104, v105
 v_cvt_pk_bf16_f32 v139, v106, v107
 v_fma_mix_f32 v100, v140, v48, v56 op_sel_hi:[1,0,0]
 v_fma_mix_f32 v101, v140, v49, v57 op_sel:[1,0,0] op_sel_hi:[1,0,0]
 v_fma_mix_f32 v102, v141, v50, v58 op_sel_hi:[1,0,0]
 v_fma_mix_f32 v103, v141, v51, v59 op_sel:[1,0,0] op_sel_hi:[1,0,0]
 v_cvt_pk_bf16_f32 v140, v100, v101
 v_cvt_pk_bf16_f32 v141, v102, v103
 v_fma_mix_f32 v104, v142, v52, v60 op_sel_hi:[1,0,0]
 v_fma_mix_f32 v105, v142, v53, v61 op_sel:[1,0,0] op_sel_hi:[1,0,0]
 v_fma_mix_f32 v106, v143, v54, v62 op_sel_hi:[1,0,0]
 v_fma_mix_f32 v107, v143, v55, v63 op_sel:[1,0,0] op_sel_hi:[1,0,0]
 v_cvt_pk_bf16_f32 v142, v104, v105
 v_cvt_pk_bf16_f32 v143, v106, v107
 v_mfma_f32_32x32x16_bf16 a[112:127], a[204:207], v[132:135], 0
 s_waitcnt vmcnt(12)
 s_barrier
 ds_read_b64_tr_b16 a[216:217], v66 offset:4096
 ds_read_b64_tr_b16 a[218:219], v66 offset:5120
 s_add_u32 m0, s35, 0xc000
 ds_read_b64_tr_b16 a[220:221], v67 offset:4096
 s_waitcnt lgkmcnt(9)
 v_mfma_f32_32x32x16_bf16 a[0:15], a[208:211], v[136:139], a[0:15]
 s_add_u32 s44, s31, 0x180000
 ds_read_b64_tr_b16 a[222:223], v67 offset:5120
 ds_read_b64_tr_b16 a[224:225], v64 offset:8192
 ds_read_b64_tr_b16 a[226:227], v64 offset:9216
 ds_read_b64_tr_b16 a[228:229], v65 offset:8192
 ds_read_b64_tr_b16 a[230:231], v65 offset:9216
 v_mfma_f32_32x32x16_bf16 a[16:31], a[208:211], v[140:143], a[16:31]
 ds_read_b128 v[48:51], v23 offset:384
 s_waitcnt lgkmcnt(14)
 ds_read_b128 v[52:55], v23 offset:400
 s_waitcnt lgkmcnt(14)
 ds_read_b128 v[56:59], v23 offset:416
 s_waitcnt lgkmcnt(14)
 ds_read_b128 v[60:63], v23 offset:432
 s_waitcnt lgkmcnt(13)
 v_fma_mix_f32 v100, v144, v32, v40 op_sel_hi:[1,0,0]
 v_fma_mix_f32 v101, v144, v33, v41 op_sel:[1,0,0] op_sel_hi:[1,0,0]
 v_mfma_f32_32x32x16_bf16 a[32:47], a[212:215], v[136:139], a[32:47]
 buffer_load_dwordx4 v2, s[12:15], s44 offen nt lds
 v_fma_mix_f32 v102, v145, v34, v42 op_sel_hi:[1,0,0]
 v_fma_mix_f32 v103, v145, v35, v43 op_sel:[1,0,0] op_sel_hi:[1,0,0]
 v_cvt_pk_bf16_f32 v144, v100, v101
 v_cvt_pk_bf16_f32 v145, v102, v103
 v_mfma_f32_32x32x16_bf16 a[48:63], a[212:215], v[140:143], a[48:63]
 s_waitcnt lgkmcnt(12)
 v_fma_mix_f32 v104, v146, v36, v44 op_sel_hi:[1,0,0]
 v_fma_mix_f32 v105, v146, v37, v45 op_sel:[1,0,0] op_sel_hi:[1,0,0]
 v_fma_mix_f32 v106, v147, v38, v46 op_sel_hi:[1,0,0]
 v_fma_mix_f32 v107, v147, v39, v47 op_sel:[1,0,0] op_sel_hi:[1,0,0]
 v_cvt_pk_bf16_f32 v146, v104, v105
 v_cvt_pk_bf16_f32 v147, v106, v107
 s_waitcnt lgkmcnt(9)
 v_mfma_f32_32x32x16_bf16 a[64:79], a[216:219], v[136:139], a[64:79]
 buffer_load_dwordx4 v3, s[12:15], s44 offen offset:1024 nt lds
 v_fma_mix_f32 v100, v148, v32, v40 op_sel_hi:[1,0,0]
 v_fma_mix_f32 v101, v148, v33, v41 op_sel:[1,0,0] op_sel_hi:[1,0,0]
 v_fma_mix_f32 v102, v149, v34, v42 op_sel_hi:[1,0,0]
 v_fma_mix_f32 v103, v149, v35, v43 op_sel:[1,0,0] op_sel_hi:[1,0,0]
 v_mfma_f32_32x32x16_bf16 a[80:95], a[216:219], v[140:143], a[80:95]
 v_cvt_pk_bf16_f32 v148, v100, v101
 v_cvt_pk_bf16_f32 v149, v102, v103
 v_fma_mix_f32 v104, v150, v36, v44 op_sel_hi:[1,0,0]
 v_fma_mix_f32 v105, v150, v37, v45 op_sel:[1,0,0] op_sel_hi:[1,0,0]
 v_fma_mix_f32 v106, v151, v38, v46 op_sel_hi:[1,0,0]
 v_fma_mix_f32 v107, v151, v39, v47 op_sel:[1,0,0] op_sel_hi:[1,0,0]
 s_waitcnt lgkmcnt(0)
 v_mfma_f32_32x32x16_bf16 a[96:111], a[220:223], v[136:139], a[96:111]
 v_cvt_pk_bf16_f32 v150, v104, v105
 v_cvt_pk_bf16_f32 v151, v106, v107
 buffer_load_dwordx4 v4, s[12:15], s44 offen offset:2048 nt lds
 ds_read_b64_tr_b16 a[232:233], v66 offset:8192
 ds_read_b64_tr_b16 a[234:235], v66 offset:9216
 v_mfma_f32_32x32x16_bf16 a[112:127], a[220:223], v[140:143], a[112:127]
 ds_read_b64_tr_b16 a[236:237], v67 offset:8192
 ds_read_b64_tr_b16 a[238:239], v67 offset:9216
 ds_read_b64_tr_b16 a[240:241], v64 offset:12288
 ds_read_b64_tr_b16 a[242:243], v64 offset:13312
 ds_read_b64_tr_b16 a[244:245], v65 offset:12288
 ds_read_b64_tr_b16 a[246:247], v65 offset:13312
 v_mfma_f32_32x32x16_bf16 a[0:15], a[224:227], v[144:147], a[0:15]
 buffer_load_dwordx4 v5, s[12:15], s44 offen offset:3072 nt lds
 ds_read_b128 v[32:35], v23 offset:512
 ds_read_b128 v[36:39], v23 offset:528
 ds_read_b128 v[40:43], v23 offset:544
 ds_read_b128 v[44:47], v23 offset:560
 v_mfma_f32_32x32x16_bf16 a[16:31], a[224:227], v[148:151], a[16:31]
 v_fma_mix_f32 v100, v152, v48, v56 op_sel_hi:[1,0,0]
 v_fma_mix_f32 v101, v152, v49, v57 op_sel:[1,0,0] op_sel_hi:[1,0,0]
 v_fma_mix_f32 v102, v153, v50, v58 op_sel_hi:[1,0,0]
 v_fma_mix_f32 v103, v153, v51, v59 op_sel:[1,0,0] op_sel_hi:[1,0,0]
 v_cvt_pk_bf16_f32 v152, v100, v101
 v_cvt_pk_bf16_f32 v153, v102, v103
 v_mfma_f32_32x32x16_bf16 a[32:47], a[228:231], v[144:147], a[32:47]
 s_add_u32 s45, s33, 0x3000
 v_fma_mix_f32 v104, v154, v52, v60 op_sel_hi:[1,0,0]
 v_fma_mix_f32 v105, v154, v53, v61 op_sel:[1,0,0] op_sel_hi:[1,0,0]
 v_fma_mix_f32 v106, v155, v54, v62 op_sel_hi:[1,0,0]
 v_fma_mix_f32 v107, v155, v55, v63 op_sel:[1,0,0] op_sel_hi:[1,0,0]
 v_cvt_pk_bf16_f32 v154, v104, v105
 v_mfma_f32_32x32x16_bf16 a[48:63], a[228:231], v[148:151], a[48:63]
 v_cvt_pk_bf16_f32 v155, v106, v107
 v_fma_mix_f32 v100, v156, v48, v56 op_sel_hi:[1,0,0]
 v_fma_mix_f32 v101, v156, v49, v57 op_sel:[1,0,0] op_sel_hi:[1,0,0]
 v_fma_mix_f32 v102, v157, v50, v58 op_sel_hi:[1,0,0]
 v_fma_mix_f32 v103, v157, v51, v59 op_sel:[1,0,0] op_sel_hi:[1,0,0]
 v_cvt_pk_bf16_f32 v156, v100, v101
 s_waitcnt lgkmcnt(4)
 v_mfma_f32_32x32x16_bf16 a[64:79], a[232:235], v[144:147], a[64:79]
 s_add_u32 s46, s34, 0x3000
 v_cvt_pk_bf16_f32 v157, v102, v103
 v_fma_mix_f32 v104, v158, v52, v60 op_sel_hi:[1,0,0]
 v_fma_mix_f32 v105, v158, v53, v61 op_sel:[1,0,0] op_sel_hi:[1,0,0]
 v_fma_mix_f32 v106, v159, v54, v62 op_sel_hi:[1,0,0]
 v_fma_mix_f32 v107, v159, v55, v63 op_sel:[1,0,0] op_sel_hi:[1,0,0]
 v_mfma_f32_32x32x16_bf16 a[80:95], a[232:235], v[148:151], a[80:95]
 v_cvt_pk_bf16_f32 v158, v104, v105
 v_cvt_pk_bf16_f32 v159, v106, v107
 ds_read_b64_tr_b16 a[248:249], v66 offset:12288
 ds_read_b64_tr_b16 a[250:251], v66 offset:13312
 ds_read_b64_tr_b16 a[252:253], v67 offset:12288
 ds_read_b64_tr_b16 a[254:255], v67 offset:13312
 v_mfma_f32_32x32x16_bf16 a[96:111], a[236:239], v[144:147], a[96:111]
 buffer_load_dwordx4 v[224:227], v1, s[8:11], s45 offen
 ds_read_b64_tr_b16 a[192:193], v64 offset:16384
 ds_read_b64_tr_b16 a[194:195], v64 offset:17408
 ds_read_b64_tr_b16 a[196:197], v65 offset:16384
 ds_read_b64_tr_b16 a[198:199], v65 offset:17408
 v_mfma_f32_32x32x16_bf16 a[112:127], a[236:239], v[148:151], a[112:127]
 buffer_load_dwordx4 v[228:231], v1, s[8:11], s46 offen
 ds_read_b128 v[48:51], v23 offset:640
 ds_read_b128 v[52:55], v23 offset:656
 ds_read_b128 v[56:59], v23 offset:672
 s_waitcnt lgkmcnt(14)
 ds_read_b128 v[60:63], v23 offset:688
 v_mfma_f32_32x32x16_bf16 a[0:15], a[240:243], v[152:155], a[0:15]
 s_waitcnt lgkmcnt(12)
 v_fma_mix_f32 v100, v160, v32, v40 op_sel_hi:[1,0,0]
 v_fma_mix_f32 v101, v160, v33, v41 op_sel:[1,0,0] op_sel_hi:[1,0,0]
 v_fma_mix_f32 v102, v161, v34, v42 op_sel_hi:[1,0,0]
 v_fma_mix_f32 v103, v161, v35, v43 op_sel:[1,0,0] op_sel_hi:[1,0,0]
 v_cvt_pk_bf16_f32 v160, v100, v101
 v_cvt_pk_bf16_f32 v161, v102, v103
 v_mfma_f32_32x32x16_bf16 a[16:31], a[240:243], v[156:159], a[16:31]
 buffer_load_dwordx4 v[232:235], v1, s[8:11], s45 offen offset:1024
 v_fma_mix_f32 v104, v162, v36, v44 op_sel_hi:[1,0,0]
 v_fma_mix_f32 v105, v162, v37, v45 op_sel:[1,0,0] op_sel_hi:[1,0,0]
 v_fma_mix_f32 v106, v163, v38, v46 op_sel_hi:[1,0,0]
 v_fma_mix_f32 v107, v163, v39, v47 op_sel:[1,0,0] op_sel_hi:[1,0,0]
 v_mfma_f32_32x32x16_bf16 a[32:47], a[244:247], v[152:155], a[32:47]
 v_cvt_pk_bf16_f32 v162, v104, v105
 v_cvt_pk_bf16_f32 v163, v106, v107
 v_fma_mix_f32 v100, v164, v32, v40 op_sel_hi:[1,0,0]
 v_fma_mix_f32 v101, v164, v33, v41 op_sel:[1,0,0] op_sel_hi:[1,0,0]
 v_fma_mix_f32 v102, v165, v34, v42 op_sel_hi:[1,0,0]
 v_fma_mix_f32 v103, v165, v35, v43 op_sel:[1,0,0] op_sel_hi:[1,0,0]
 v_mfma_f32_32x32x16_bf16 a[48:63], a[244:247], v[156:159], a[48:63]
 buffer_load_dwordx4 v[236:239], v1, s[8:11], s46 offen offset:1024
 v_cvt_pk_bf16_f32 v164, v100, v101
 v_cvt_pk_bf16_f32 v165, v102, v103
 v_fma_mix_f32 v104, v166, v36, v44 op_sel_hi:[1,0,0]
 v_fma_mix_f32 v105, v166, v37, v45 op_sel:[1,0,0] op_sel_hi:[1,0,0]
 s_waitcnt lgkmcnt(0)
 v_mfma_f32_32x32x16_bf16 a[64:79], a[248:251], v[152:155], a[64:79]
 v_fma_mix_f32 v106, v167, v38, v46 op_sel_hi:[1,0,0]
 v_fma_mix_f32 v107, v167, v39, v47 op_sel:[1,0,0] op_sel_hi:[1,0,0]
 v_cvt_pk_bf16_f32 v166, v104, v105
 v_cvt_pk_bf16_f32 v167, v106, v107
 ds_read_b64_tr_b16 a[200:201], v66 offset:16384
 ds_read_b64_tr_b16 a[202:203], v66 offset:17408
 v_mfma_f32_32x32x16_bf16 a[80:95], a[248:251], v[156:159], a[80:95]
 buffer_load_dwordx4 v[240:243], v1, s[8:11], s45 offen offset:2048
 ds_read_b64_tr_b16 a[204:205], v67 offset:16384
 ds_read_b64_tr_b16 a[206:207], v67 offset:17408
 ds_read_b64_tr_b16 a[208:209], v64 offset:20480
 ds_read_b64_tr_b16 a[210:211], v64 offset:21504
 v_mfma_f32_32x32x16_bf16 a[96:111], a[252:255], v[152:155], a[96:111]
 ds_read_b64_tr_b16 a[212:213], v65 offset:20480
 ds_read_b64_tr_b16 a[214:215], v65 offset:21504
 ds_read_b128 v[32:35], v23 offset:768
 ds_read_b128 v[36:39], v23 offset:784
 ds_read_b128 v[40:43], v23 offset:800
 ds_read_b128 v[44:47], v23 offset:816
 v_mfma_f32_32x32x16_bf16 a[112:127], a[252:255], v[156:159], a[112:127]
 buffer_load_dwordx4 v[244:247], v1, s[8:11], s46 offen offset:2048
 v_fma_mix_f32 v100, v168, v48, v56 op_sel_hi:[1,0,0]
 v_fma_mix_f32 v101, v168, v49, v57 op_sel:[1,0,0] op_sel_hi:[1,0,0]
 v_fma_mix_f32 v102, v169, v50, v58 op_sel_hi:[1,0,0]
 v_fma_mix_f32 v103, v169, v51, v59 op_sel:[1,0,0] op_sel_hi:[1,0,0]
 v_mfma_f32_32x32x16_bf16 a[0:15], a[192:195], v[160:163], a[0:15]
 v_cvt_pk_bf16_f32 v168, v100, v101
 v_cvt_pk_bf16_f32 v169, v102, v103
 v_fma_mix_f32 v104, v170, v52, v60 op_sel_hi:[1,0,0]
 v_fma_mix_f32 v105, v170, v53, v61 op_sel:[1,0,0] op_sel_hi:[1,0,0]
 v_fma_mix_f32 v106, v171, v54, v62 op_sel_hi:[1,0,0]
 v_fma_mix_f32 v107, v171, v55, v63 op_sel:[1,0,0] op_sel_hi:[1,0,0]
 v_mfma_f32_32x32x16_bf16 a[16:31], a[192:195], v[164:167], a[16:31]
 buffer_load_dwordx4 v[248:251], v1, s[8:11], s45 offen offset:3072
 v_cvt_pk_bf16_f32 v170, v104, v105
 v_cvt_pk_bf16_f32 v171, v106, v107
 v_fma_mix_f32 v100, v172, v48, v56 op_sel_hi:[1,0,0]
 v_fma_mix_f32 v101, v172, v49, v57 op_sel:[1,0,0] op_sel_hi:[1,0,0]
 v_mfma_f32_32x32x16_bf16 a[32:47], a[196:199], v[160:163], a[32:47]
 v_fma_mix_f32 v102, v173, v50, v58 op_sel_hi:[1,0,0]
 v_fma_mix_f32 v103, v173, v51, v59 op_sel:[1,0,0] op_sel_hi:[1,0,0]
 v_cvt_pk_bf16_f32 v172, v100, v101
 v_cvt_pk_bf16_f32 v173, v102, v103
 v_fma_mix_f32 v104, v174, v52, v60 op_sel_hi:[1,0,0]
 v_fma_mix_f32 v105, v174, v53, v61 op_sel:[1,0,0] op_sel_hi:[1,0,0]
 v_mfma_f32_32x32x16_bf16 a[48:63], a[196:199], v[164:167], a[48:63]
 buffer_load_dwordx4 v[252:255], v1, s[8:11], s46 offen offset:3072
 v_fma_mix_f32 v106, v175, v54, v62 op_sel_hi:[1,0,0]
 v_fma_mix_f32 v107, v175, v55, v63 op_sel:[1,0,0] op_sel_hi:[1,0,0]
 v_cvt_pk_bf16_f32 v174, v104, v105
 v_cvt_pk_bf16_f32 v175, v106, v107
 s_waitcnt lgkmcnt(0)
 v_mfma_f32_32x32x16_bf16 a[64:79], a[200:203], v[160:163], a[64:79]
 ds_read_b64_tr_b16 a[216:217], v66 offset:20480
 ds_read_b64_tr_b16 a[218:219], v66 offset:21504
 ds_read_b64_tr_b16 a[220:221], v67 offset:20480
 ds_read_b64_tr_b16 a[222:223], v67 offset:21504
 ds_read_b64_tr_b16 a[224:225], v64 offset:24576
 ds_read_b64_tr_b16 a[226:227], v64 offset:25600
 v_mfma_f32_32x32x16_bf16 a[80:95], a[200:203], v[164:167], a[80:95]
 ds_read_b64_tr_b16 a[228:229], v65 offset:24576
 ds_read_b64_tr_b16 a[230:231], v65 offset:25600
 ds_read_b128 v[48:51], v23 offset:896
 ds_read_b128 v[52:55], v23 offset:912
 ds_read_b128 v[56:59], v23 offset:928
 ds_read_b128 v[60:63], v23 offset:944
 v_mfma_f32_32x32x16_bf16 a[96:111], a[204:207], v[160:163], a[96:111]
 v_fma_mix_f32 v100, v176, v32, v40 op_sel_hi:[1,0,0]
 v_fma_mix_f32 v101, v176, v33, v41 op_sel:[1,0,0] op_sel_hi:[1,0,0]
 v_fma_mix_f32 v102, v177, v34, v42 op_sel_hi:[1,0,0]
 v_fma_mix_f32 v103, v177, v35, v43 op_sel:[1,0,0] op_sel_hi:[1,0,0]
 v_cvt_pk_bf16_f32 v176, v100, v101
 v_cvt_pk_bf16_f32 v177, v102, v103
 v_mfma_f32_32x32x16_bf16 a[112:127], a[204:207], v[164:167], a[112:127]
 s_waitcnt vmcnt(12)
 s_barrier
 s_add_u32 m0, s35, 0
 v_fma_mix_f32 v104, v178, v36, v44 op_sel_hi:[1,0,0]
 v_fma_mix_f32 v105, v178, v37, v45 op_sel:[1,0,0] op_sel_hi:[1,0,0]
 v_fma_mix_f32 v106, v179, v38, v46 op_sel_hi:[1,0,0]
 v_mfma_f32_32x32x16_bf16 a[0:15], a[208:211], v[168:171], a[0:15]
 s_add_u32 s43, s31, 0x200000
 v_fma_mix_f32 v107, v179, v39, v47 op_sel:[1,0,0] op_sel_hi:[1,0,0]
 v_cvt_pk_bf16_f32 v178, v104, v105
 v_cvt_pk_bf16_f32 v179, v106, v107
 v_fma_mix_f32 v100, v180, v32, v40 op_sel_hi:[1,0,0]
 v_fma_mix_f32 v101, v180, v33, v41 op_sel:[1,0,0] op_sel_hi:[1,0,0]
 v_mfma_f32_32x32x16_bf16 a[16:31], a[208:211], v[172:175], a[16:31]
 v_fma_mix_f32 v102, v181, v34, v42 op_sel_hi:[1,0,0]
 v_fma_mix_f32 v103, v181, v35, v43 op_sel:[1,0,0] op_sel_hi:[1,0,0]
 v_cvt_pk_bf16_f32 v180, v100, v101
 v_cvt_pk_bf16_f32 v181, v102, v103
 v_fma_mix_f32 v104, v182, v36, v44 op_sel_hi:[1,0,0]
 v_fma_mix_f32 v105, v182, v37, v45 op_sel:[1,0,0] op_sel_hi:[1,0,0]
 v_mfma_f32_32x32x16_bf16 a[32:47], a[212:215], v[168:171], a[32:47]
 buffer_load_dwordx4 v2, s[12:15], s43 offen nt lds
 v_fma_mix_f32 v106, v183, v38, v46 op_sel_hi:[1,0,0]
 v_fma_mix_f32 v107, v183, v39, v47 op_sel:[1,0,0] op_sel_hi:[1,0,0]
 v_cvt_pk_bf16_f32 v182, v104, v105
 v_cvt_pk_bf16_f32 v183, v106, v107
 v_mfma_f32_32x32x16_bf16 a[48:63], a[212:215], v[172:175], a[48:63]
 ds_read_b64_tr_b16 a[232:233], v66 offset:24576
 ds_read_b64_tr_b16 a[234:235], v66 offset:25600
 ds_read_b64_tr_b16 a[236:237], v67 offset:24576
 s_waitcnt lgkmcnt(14)
 ds_read_b64_tr_b16 a[238:239], v67 offset:25600
 s_waitcnt lgkmcnt(14)
 ds_read_b64_tr_b16 a[240:241], v64 offset:28672
 s_waitcnt lgkmcnt(14)
 ds_read_b64_tr_b16 a[242:243], v64 offset:29696
 v_mfma_f32_32x32x16_bf16 a[64:79], a[216:219], v[168:171], a[64:79]
 buffer_load_dwordx4 v3, s[12:15], s43 offen offset:1024 nt lds
 s_waitcnt lgkmcnt(14)
 ds_read_b128 v[32:35], v23 offset:1024
 s_waitcnt lgkmcnt(14)
 ds_read_b128 v[36:39], v23 offset:1040
 s_waitcnt lgkmcnt(14)
 ds_read_b128 v[40:43], v23 offset:1056
 s_waitcnt lgkmcnt(14)
 ds_read_b128 v[44:47], v23 offset:1072
 v_mfma_f32_32x32x16_bf16 a[80:95], a[216:219], v[172:175], a[80:95]
 s_waitcnt lgkmcnt(14)
 ds_read_b64_tr_b16 a[244:245], v65 offset:28672
 s_waitcnt lgkmcnt(14)
 ds_read_b64_tr_b16 a[246:247], v65 offset:29696
 s_waitcnt lgkmcnt(12)
 v_fma_mix_f32 v100, v184, v48, v56 op_sel_hi:[1,0,0]
 v_fma_mix_f32 v101, v184, v49, v57 op_sel:[1,0,0] op_sel_hi:[1,0,0]
 v_fma_mix_f32 v102, v185, v50, v58 op_sel_hi:[1,0,0]
 v_fma_mix_f32 v103, v185, v51, v59 op_sel:[1,0,0] op_sel_hi:[1,0,0]
 v_mfma_f32_32x32x16_bf16 a[96:111], a[220:223], v[168:171], a[96:111]
 buffer_load_dwordx4 v4, s[12:15], s43 offen offset:2048 nt lds
 v_cvt_pk_bf16_f32 v184, v100, v101
 v_cvt_pk_bf16_f32 v185, v102, v103
 v_fma_mix_f32 v104, v186, v52, v60 op_sel_hi:[1,0,0]
 v_fma_mix_f32 v105, v186, v53, v61 op_sel:[1,0,0] op_sel_hi:[1,0,0]
 v_mfma_f32_32x32x16_bf16 a[112:127], a[220:223], v[172:175], a[112:127]
 v_fma_mix_f32 v106, v187, v54, v62 op_sel_hi:[1,0,0]
 v_fma_mix_f32 v107, v187, v55, v63 op_sel:[1,0,0] op_sel_hi:[1,0,0]
 v_cvt_pk_bf16_f32 v186, v104, v105
 v_cvt_pk_bf16_f32 v187, v106, v107
 v_fma_mix_f32 v100, v188, v48, v56 op_sel_hi:[1,0,0]
 v_fma_mix_f32 v101, v188, v49, v57 op_sel:[1,0,0] op_sel_hi:[1,0,0]
 v_mfma_f32_32x32x16_bf16 a[0:15], a[224:227], v[176:179], a[0:15]
 buffer_load_dwordx4 v5, s[12:15], s43 offen offset:3072 nt lds
 v_fma_mix_f32 v102, v189, v50, v58 op_sel_hi:[1,0,0]
 v_fma_mix_f32 v103, v189, v51, v59 op_sel:[1,0,0] op_sel_hi:[1,0,0]
 v_cvt_pk_bf16_f32 v188, v100, v101
 v_cvt_pk_bf16_f32 v189, v102, v103
 v_mfma_f32_32x32x16_bf16 a[16:31], a[224:227], v[180:183], a[16:31]
 v_fma_mix_f32 v104, v190, v52, v60 op_sel_hi:[1,0,0]
 v_fma_mix_f32 v105, v190, v53, v61 op_sel:[1,0,0] op_sel_hi:[1,0,0]
 v_fma_mix_f32 v106, v191, v54, v62 op_sel_hi:[1,0,0]
 v_fma_mix_f32 v107, v191, v55, v63 op_sel:[1,0,0] op_sel_hi:[1,0,0]
 v_cvt_pk_bf16_f32 v190, v104, v105
 v_cvt_pk_bf16_f32 v191, v106, v107
 v_mfma_f32_32x32x16_bf16 a[32:47], a[228:231], v[176:179], a[32:47]
 s_add_u32 s45, s33, 0x4000
 ds_read_b64_tr_b16 a[248:249], v66 offset:28672
 ds_read_b64_tr_b16 a[250:251], v66 offset:29696
 ds_read_b64_tr_b16 a[252:253], v67 offset:28672
 s_waitcnt lgkmcnt(14)
 ds_read_b64_tr_b16 a[254:255], v67 offset:29696
 s_waitcnt lgkmcnt(14)
 ds_read_b128 v[48:51], v23 offset:1152
 v_mfma_f32_32x32x16_bf16 a[48:63], a[228:231], v[180:183], a[48:63]
 s_waitcnt lgkmcnt(14)
 ds_read_b64_tr_b16 a[192:193], v64 offset:32768
 s_waitcnt lgkmcnt(14)
 ds_read_b64_tr_b16 a[194:195], v64 offset:33792
 s_waitcnt lgkmcnt(14)
 ds_read_b128 v[52:55], v23 offset:1168
 s_waitcnt lgkmcnt(14)
 ds_read_b128 v[56:59], v23 offset:1184
 s_waitcnt lgkmcnt(14)
 ds_read_b128 v[60:63], v23 offset:1200
 s_waitcnt lgkmcnt(10)
 v_fma_mix_f32 v100, v192, v32, v40 op_sel_hi:[1,0,0]
 v_mfma_f32_32x32x16_bf16 a[64:79], a[232:235], v[176:179], a[64:79]
 s_add_u32 s46, s34, 0x4000
 v_fma_mix_f32 v101, v192, v33, v41 op_sel:[1,0,0] op_sel_hi:[1,0,0]
 v_fma_mix_f32 v102, v193, v34, v42 op_sel_hi:[1,0,0]
 v_fma_mix_f32 v103, v193, v35, v43 op_sel:[1,0,0] op_sel_hi:[1,0,0]
 v_cvt_pk_bf16_f32 v192, v100, v101
 v_cvt_pk_bf16_f32 v193, v102, v103
 v_mfma_f32_32x32x16_bf16 a[80:95], a[232:235], v[180:183], a[80:95]
 ds_read_b64_tr_b16 a[196:197], v65 offset:32768
 ds_read_b64_tr_b16 a[198:199], v65 offset:33792
 v_fma_mix_f32 v104, v194, v36, v44 op_sel_hi:[1,0,0]
 v_fma_mix_f32 v105, v194, v37, v45 op_sel:[1,0,0] op_sel_hi:[1,0,0]
 v_fma_mix_f32 v106, v195, v38, v46 op_sel_hi:[1,0,0]
 v_fma_mix_f32 v107, v195, v39, v47 op_sel:[1,0,0] op_sel_hi:[1,0,0]
 v_mfma_f32_32x32x16_bf16 a[96:111], a[236:239], v[176:179], a[96:111]
 buffer_load_dwordx4 v[128:131], v1, s[8:11], s45 offen
 v_cvt_pk_bf16_f32 v194, v104, v105
 v_cvt_pk_bf16_f32 v195, v106, v107
 v_fma_mix_f32 v100, v196, v32, v40 op_sel_hi:[1,0,0]
 v_fma_mix_f32 v101, v196, v33, v41 op_sel:[1,0,0] op_sel_hi:[1,0,0]
 v_mfma_f32_32x32x16_bf16 a[112:127], a[236:239], v[180:183], a[112:127]
 buffer_load_dwordx4 v[132:135], v1, s[8:11], s46 offen
 v_fma_mix_f32 v102, v197, v34, v42 op_sel_hi:[1,0,0]
 v_fma_mix_f32 v103, v197, v35, v43 op_sel:[1,0,0] op_sel_hi:[1,0,0]
 v_cvt_pk_bf16_f32 v196, v100, v101
 v_cvt_pk_bf16_f32 v197, v102, v103
 v_mfma_f32_32x32x16_bf16 a[0:15], a[240:243], v[184:187], a[0:15]
 v_fma_mix_f32 v104, v198, v36, v44 op_sel_hi:[1,0,0]
 v_fma_mix_f32 v105, v198, v37, v45 op_sel:[1,0,0] op_sel_hi:[1,0,0]
 v_fma_mix_f32 v106, v199, v38, v46 op_sel_hi:[1,0,0]
 v_fma_mix_f32 v107, v199, v39, v47 op_sel:[1,0,0] op_sel_hi:[1,0,0]
 v_cvt_pk_bf16_f32 v198, v104, v105
 v_cvt_pk_bf16_f32 v199, v106, v107
 v_mfma_f32_32x32x16_bf16 a[16:31], a[240:243], v[188:191], a[16:31]
 buffer_load_dwordx4 v[136:139], v1, s[8:11], s45 offen offset:1024
 ds_read_b64_tr_b16 a[200:201], v66 offset:32768
 ds_read_b64_tr_b16 a[202:203], v66 offset:33792
 ds_read_b64_tr_b16 a[204:205], v67 offset:32768
 s_waitcnt lgkmcnt(14)
 ds_read_b64_tr_b16 a[206:207], v67 offset:33792
 v_mfma_f32_32x32x16_bf16 a[32:47], a[244:247], v[184:187], a[32:47]
 s_waitcnt lgkmcnt(14)
 ds_read_b128 v[32:35], v23 offset:1280
 s_waitcnt lgkmcnt(14)
 ds_read_b128 v[36:39], v23 offset:1296
 s_waitcnt lgkmcnt(14)
 ds_read_b128 v[40:43], v23 offset:1312
 s_waitcnt lgkmcnt(14)
 ds_read_b128 v[44:47], v23 offset:1328
 s_waitcnt lgkmcnt(8)
 v_fma_mix_f32 v100, v200, v48, v56 op_sel_hi:[1,0,0]
 v_fma_mix_f32 v101, v200, v49, v57 op_sel:[1,0,0] op_sel_hi:[1,0,0]
 v_mfma_f32_32x32x16_bf16 a[48:63], a[244:247], v[188:191], a[48:63]
 buffer_load_dwordx4 v[140:143], v1, s[8:11], s46 offen offset:1024
 ds_read_b64_tr_b16 a[208:209], v64 offset:36864
 ds_read_b64_tr_b16 a[210:211], v64 offset:37888
 v_fma_mix_f32 v102, v201, v50, v58 op_sel_hi:[1,0,0]
 v_fma_mix_f32 v103, v201, v51, v59 op_sel:[1,0,0] op_sel_hi:[1,0,0]
 v_mfma_f32_32x32x16_bf16 a[64:79], a[248:251], v[184:187], a[64:79]
 v_cvt_pk_bf16_f32 v200, v100, v101
 v_cvt_pk_bf16_f32 v201, v102, v103
 v_fma_mix_f32 v104, v202, v52, v60 op_sel_hi:[1,0,0]
 v_fma_mix_f32 v105, v202, v53, v61 op_sel:[1,0,0] op_sel_hi:[1,0,0]
 v_fma_mix_f32 v106, v203, v54, v62 op_sel_hi:[1,0,0]
 v_fma_mix_f32 v107, v203, v55, v63 op_sel:[1,0,0] op_sel_hi:[1,0,0]
 v_mfma_f32_32x32x16_bf16 a[80:95], a[248:251], v[188:191], a[80:95]
 buffer_load_dwordx4 v[144:147], v1, s[8:11], s45 offen offset:2048
 ds_read_b64_tr_b16 a[212:213], v65 offset:36864
 ds_read_b64_tr_b16 a[214:215], v65 offset:37888
 v_cvt_pk_bf16_f32 v202, v104, v105
 v_cvt_pk_bf16_f32 v203, v106, v107
 v_mfma_f32_32x32x16_bf16 a[96:111], a[252:255], v[184:187], a[96:111]
 v_fma_mix_f32 v100, v204, v48, v56 op_sel_hi:[1,0,0]
 v_fma_mix_f32 v101, v204, v49, v57 op_sel:[1,0,0] op_sel_hi:[1,0,0]
 v_fma_mix_f32 v102, v205, v50, v58 op_sel_hi:[1,0,0]
 v_fma_mix_f32 v103, v205, v51, v59 op_sel:[1,0,0] op_sel_hi:[1,0,0]
 v_cvt_pk_bf16_f32 v204, v100, v101
 v_cvt_pk_bf16_f32 v205, v102, v103
 v_mfma_f32_32x32x16_bf16 a[112:127], a[252:255], v[188:191], a[112:127]
 buffer_load_dwordx4 v[148:151], v1, s[8:11], s46 offen offset:2048
 v_fma_mix_f32 v104, v206, v52, v60 op_sel_hi:[1,0,0]
 v_fma_mix_f32 v105, v206, v53, v61 op_sel:[1,0,0] op_sel_hi:[1,0,0]
 v_fma_mix_f32 v106, v207, v54, v62 op_sel_hi:[1,0,0]
 v_fma_mix_f32 v107, v207, v55, v63 op_sel:[1,0,0] op_sel_hi:[1,0,0]
 v_mfma_f32_32x32x16_bf16 a[0:15], a[192:195], v[192:195], a[0:15]
 v_cvt_pk_bf16_f32 v206, v104, v105
 v_cvt_pk_bf16_f32 v207, v106, v107
 ds_read_b64_tr_b16 a[216:217], v66 offset:36864
 ds_read_b64_tr_b16 a[218:219], v66 offset:37888
 ds_read_b128 v[48:51], v23 offset:1408
 s_waitcnt lgkmcnt(14)
 ds_read_b128 v[52:55], v23 offset:1424
 v_mfma_f32_32x32x16_bf16 a[16:31], a[192:195], v[196:199], a[16:31]
 buffer_load_dwordx4 v[152:155], v1, s[8:11], s45 offen offset:3072
 s_waitcnt lgkmcnt(14)
 ds_read_b64_tr_b16 a[220:221], v67 offset:36864
 s_waitcnt lgkmcnt(14)
 ds_read_b64_tr_b16 a[222:223], v67 offset:37888
 s_waitcnt lgkmcnt(14)
 ds_read_b128 v[56:59], v23 offset:1440
 s_waitcnt lgkmcnt(14)
 ds_read_b128 v[60:63], v23 offset:1456
 v_mfma_f32_32x32x16_bf16 a[32:47], a[196:199], v[192:195], a[32:47]
 s_waitcnt lgkmcnt(8)
 v_fma_mix_f32 v100, v208, v32, v40 op_sel_hi:[1,0,0]
 v_fma_mix_f32 v101, v208, v33, v41 op_sel:[1,0,0] op_sel_hi:[1,0,0]
 v_fma_mix_f32 v102, v209, v34, v42 op_sel_hi:[1,0,0]
 v_fma_mix_f32 v103, v209, v35, v43 op_sel:[1,0,0] op_sel_hi:[1,0,0]
 v_cvt_pk_bf16_f32 v208, v100, v101
 v_cvt_pk_bf16_f32 v209, v102, v103
 v_mfma_f32_32x32x16_bf16 a[48:63], a[196:199], v[196:199], a[48:63]
 buffer_load_dwordx4 v[156:159], v1, s[8:11], s46 offen offset:3072
 ds_read_b64_tr_b16 a[224:225], v64 offset:40960
 ds_read_b64_tr_b16 a[226:227], v64 offset:41984
 v_fma_mix_f32 v104, v210, v36, v44 op_sel_hi:[1,0,0]
 v_fma_mix_f32 v105, v210, v37, v45 op_sel:[1,0,0] op_sel_hi:[1,0,0]
 v_mfma_f32_32x32x16_bf16 a[64:79], a[200:203], v[192:195], a[64:79]
 v_fma_mix_f32 v106, v211, v38, v46 op_sel_hi:[1,0,0]
 v_fma_mix_f32 v107, v211, v39, v47 op_sel:[1,0,0] op_sel_hi:[1,0,0]
 v_cvt_pk_bf16_f32 v210, v104, v105
 v_cvt_pk_bf16_f32 v211, v106, v107
 v_fma_mix_f32 v100, v212, v32, v40 op_sel_hi:[1,0,0]
 v_fma_mix_f32 v101, v212, v33, v41 op_sel:[1,0,0] op_sel_hi:[1,0,0]
 v_mfma_f32_32x32x16_bf16 a[80:95], a[200:203], v[196:199], a[80:95]
 ds_read_b64_tr_b16 a[228:229], v65 offset:40960
 ds_read_b64_tr_b16 a[230:231], v65 offset:41984
 v_fma_mix_f32 v102, v213, v34, v42 op_sel_hi:[1,0,0]
 v_fma_mix_f32 v103, v213, v35, v43 op_sel:[1,0,0] op_sel_hi:[1,0,0]
 v_cvt_pk_bf16_f32 v212, v100, v101
 v_cvt_pk_bf16_f32 v213, v102, v103
 v_mfma_f32_32x32x16_bf16 a[96:111], a[204:207], v[192:195], a[96:111]
 v_fma_mix_f32 v104, v214, v36, v44 op_sel_hi:[1,0,0]
 v_fma_mix_f32 v105, v214, v37, v45 op_sel:[1,0,0] op_sel_hi:[1,0,0]
 v_fma_mix_f32 v106, v215, v38, v46 op_sel_hi:[1,0,0]
 v_fma_mix_f32 v107, v215, v39, v47 op_sel:[1,0,0] op_sel_hi:[1,0,0]
 v_cvt_pk_bf16_f32 v214, v104, v105
 v_cvt_pk_bf16_f32 v215, v106, v107
 v_mfma_f32_32x32x16_bf16 a[112:127], a[204:207], v[196:199], a[112:127]
 s_waitcnt vmcnt(12)
 s_barrier
 s_add_u32 m0, s35, 0x4000
 ds_read_b64_tr_b16 a[232:233], v66 offset:40960
 ds_read_b64_tr_b16 a[234:235], v66 offset:41984
 ds_read_b128 v[32:35], v23 offset:1536
 v_mfma_f32_32x32x16_bf16 a[0:15], a[208:211], v[200:203], a[0:15]
 s_add_u32 s44, s31, 0x280000
 s_waitcnt lgkmcnt(14)
 ds_read_b128 v[36:39], v23 offset:1552
 s_waitcnt lgkmcnt(14)
 ds_read_b128 v[40:43], v23 offset:1568
 s_waitcnt lgkmcnt(14)
 ds_read_b128 v[44:47], v23 offset:1584
 s_waitcnt lgkmcnt(8)
 v_fma_mix_f32 v100, v216, v48, v56 op_sel_hi:[1,0,0]
 v_fma_mix_f32 v101, v216, v49, v57 op_sel:[1,0,0] op_sel_hi:[1,0,0]
 v_mfma_f32_32x32x16_bf16 a[16:31], a[208:211], v[204:207], a[16:31]
 ds_read_b64_tr_b16 a[236:237], v67 offset:40960
 ds_read_b64_tr_b16 a[238:239], v67 offset:41984
 v_fma_mix_f32 v102, v217, v50, v58 op_sel_hi:[1,0,0]
 v_fma_mix_f32 v103, v217, v51, v59 op_sel:[1,0,0] op_sel_hi:[1,0,0]
 v_cvt_pk_bf16_f32 v216, v100, v101
 v_cvt_pk_bf16_f32 v217, v102, v103
 v_mfma_f32_32x32x16_bf16 a[32:47], a[212:215], v[200:203], a[32:47]
 buffer_load_dwordx4 v2, s[12:15], s44 offen nt lds
 v_fma_mix_f32 v104, v218, v52, v60 op_sel_hi:[1,0,0]
 v_fma_mix_f32 v105, v218, v53, v61 op_sel:[1,0,0] op_sel_hi:[1,0,0]
 v_fma_mix_f32 v106, v219, v54, v62 op_sel_hi:[1,0,0]
 v_fma_mix_f32 v107, v219, v55, v63 op_sel:[1,0,0] op_sel_hi:[1,0,0]
 v_mfma_f32_32x32x16_bf16 a[48:63], a[212:215], v[204:207], a[48:63]
 ds_read_b64_tr_b16 a[240:241], v64 offset:45056
 ds_read_b64_tr_b16 a[242:243], v64 offset:46080
 v_cvt_pk_bf16_f32 v218, v104, v105
 v_cvt_pk_bf16_f32 v219, v106, v107
 v_fma_mix_f32 v100, v220, v48, v56 op_sel_hi:[1,0,0]
 v_fma_mix_f32 v101, v220, v49, v57 op_sel:[1,0,0] op_sel_hi:[1,0,0]
 v_mfma_f32_32x32x16_bf16 a[64:79], a[216:219], v[200:203], a[64:79]
 buffer_load_dwordx4 v3, s[12:15], s44 offen offset:1024 nt lds
 v_fma_mix_f32 v102, v221, v50, v58 op_sel_hi:[1,0,0]
 v_fma_mix_f32 v103, v221, v51, v59 op_sel:[1,0,0] op_sel_hi:[1,0,0]
 v_cvt_pk_bf16_f32 v220, v100, v101
 v_cvt_pk_bf16_f32 v221, v102, v103
 v_mfma_f32_32x32x16_bf16 a[80:95], a[216:219], v[204:207], a[80:95]
 ds_read_b64_tr_b16 a[244:245], v65 offset:45056
 ds_read_b64_tr_b16 a[246:247], v65 offset:46080
 v_fma_mix_f32 v104, v222, v52, v60 op_sel_hi:[1,0,0]
 v_fma_mix_f32 v105, v222, v53, v61 op_sel:[1,0,0] op_sel_hi:[1,0,0]
 v_fma_mix_f32 v106, v223, v54, v62 op_sel_hi:[1,0,0]
 v_fma_mix_f32 v107, v223, v55, v63 op_sel:[1,0,0] op_sel_hi:[1,0,0]
 v_mfma_f32_32x32x16_bf16 a[96:111], a[220:223], v[200:203], a[96:111]
 buffer_load_dwordx4 v4, s[12:15], s44 offen offset:2048 nt lds
 v_cvt_pk_bf16_f32 v222, v104, v105
 v_cvt_pk_bf16_f32 v223, v106, v107
 ds_read_b128 v[48:51], v23 offset:1664
 s_waitcnt lgkmcnt(14)
 ds_read_b128 v[52:55], v23 offset:1680
 v_mfma_f32_32x32x16_bf16 a[112:127], a[220:223], v[204:207], a[112:127]
 s_waitcnt lgkmcnt(14)
 ds_read_b64_tr_b16 a[248:249], v66 offset:45056
 s_waitcnt lgkmcnt(14)
 ds_read_b64_tr_b16 a[250:251], v66 offset:46080
 s_waitcnt lgkmcnt(14)
 ds_read_b128 v[56:59], v23 offset:1696
 s_waitcnt lgkmcnt(14)
 ds_read_b128 v[60:63], v23 offset:1712
 s_waitcnt lgkmcnt(10)
 v_fma_mix_f32 v100, v224, v32, v40 op_sel_hi:[1,0,0]
 v_fma_mix_f32 v101, v224, v33, v41 op_sel:[1,0,0] op_sel_hi:[1,0,0]
 v_mfma_f32_32x32x16_bf16 a[0:15], a[224:227], v[208:211], a[0:15]
 buffer_load_dwordx4 v5, s[12:15], s44 offen offset:3072 nt lds
 v_fma_mix_f32 v102, v225, v34, v42 op_sel_hi:[1,0,0]
 v_fma_mix_f32 v103, v225, v35, v43 op_sel:[1,0,0] op_sel_hi:[1,0,0]
 v_cvt_pk_bf16_f32 v224, v100, v101
 v_cvt_pk_bf16_f32 v225, v102, v103
 v_mfma_f32_32x32x16_bf16 a[16:31], a[224:227], v[212:215], a[16:31]
 ds_read_b64_tr_b16 a[252:253], v67 offset:45056
 ds_read_b64_tr_b16 a[254:255], v67 offset:46080
 v_fma_mix_f32 v104, v226, v36, v44 op_sel_hi:[1,0,0]
 v_fma_mix_f32 v105, v226, v37, v45 op_sel:[1,0,0] op_sel_hi:[1,0,0]
 v_fma_mix_f32 v106, v227, v38, v46 op_sel_hi:[1,0,0]
 v_fma_mix_f32 v107, v227, v39, v47 op_sel:[1,0,0] op_sel_hi:[1,0,0]
 v_mfma_f32_32x32x16_bf16 a[32:47], a[228:231], v[208:211], a[32:47]
 s_add_u32 s45, s33, 0x5000
 v_cvt_pk_bf16_f32 v226, v104, v105
 v_cvt_pk_bf16_f32 v227, v106, v107
 v_fma_mix_f32 v100, v228, v32, v40 op_sel_hi:[1,0,0]
 v_fma_mix_f32 v101, v228, v33, v41 op_sel:[1,0,0] op_sel_hi:[1,0,0]
 v_fma_mix_f32 v102, v229, v34, v42 op_sel_hi:[1,0,0]
 v_mfma_f32_32x32x16_bf16 a[48:63], a[228:231], v[212:215], a[48:63]
 ds_read_b64_tr_b16 a[192:193], v64 offset:49152
 ds_read_b64_tr_b16 a[194:195], v64 offset:50176
 v_fma_mix_f32 v103, v229, v35, v43 op_sel:[1,0,0] op_sel_hi:[1,0,0]
 v_cvt_pk_bf16_f32 v228, v100, v101
 v_cvt_pk_bf16_f32 v229, v102, v103
 v_fma_mix_f32 v104, v230, v36, v44 op_sel_hi:[1,0,0]
 v_mfma_f32_32x32x16_bf16 a[64:79], a[232:235], v[208:211], a[64:79]
 s_add_u32 s46, s34, 0x5000
 v_fma_mix_f32 v105, v230, v37, v45 op_sel:[1,0,0] op_sel_hi:[1,0,0]
 v_fma_mix_f32 v106, v231, v38, v46 op_sel_hi:[1,0,0]
 v_fma_mix_f32 v107, v231, v39, v47 op_sel:[1,0,0] op_sel_hi:[1,0,0]
 v_cvt_pk_bf16_f32 v230, v104, v105
 v_cvt_pk_bf16_f32 v231, v106, v107
 v_mfma_f32_32x32x16_bf16 a[80:95], a[232:235], v[212:215], a[80:95]
 ds_read_b64_tr_b16 a[196:197], v65 offset:49152
 s_waitcnt lgkmcnt(14)
 ds_read_b64_tr_b16 a[198:199], v65 offset:50176
 s_waitcnt lgkmcnt(14)
 ds_read_b128 v[32:35], v23 offset:1792
 s_waitcnt lgkmcnt(14)
 ds_read_b128 v[36:39], v23 offset:1808
 s_waitcnt lgkmcnt(14)
 ds_read_b128 v[40:43], v23 offset:1824
 s_waitcnt lgkmcnt(14)
 ds_read_b128 v[44:47], v23 offset:1840
 v_mfma_f32_32x32x16_bf16 a[96:111], a[236:239], v[208:211], a[96:111]
 buffer_load_dwordx4 v[160:163], v1, s[8:11], s45 offen
 s_waitcnt lgkmcnt(8)
 v_fma_mix_f32 v100, v232, v48, v56 op_sel_hi:[1,0,0]
 v_fma_mix_f32 v101, v232, v49, v57 op_sel:[1,0,0] op_sel_hi:[1,0,0]
 v_fma_mix_f32 v102, v233, v50, v58 op_sel_hi:[1,0,0]
 v_fma_mix_f32 v103, v233, v51, v59 op_sel:[1,0,0] op_sel_hi:[1,0,0]
 v_mfma_f32_32x32x16_bf16 a[112:127], a[236:239], v[212:215], a[112:127]
 buffer_load_dwordx4 v[164:167], v1, s[8:11], s46 offen
 ds_read_b64_tr_b16 a[200:201], v66 offset:49152
 ds_read_b64_tr_b16 a[202:203], v66 offset:50176
 v_cvt_pk_bf16_f32 v232, v100, v101
 v_cvt_pk_bf16_f32 v233, v102, v103
 v_mfma_f32_32x32x16_bf16 a[0:15], a[240:243], v[216:219], a[0:15]
 v_fma_mix_f32 v104, v234, v52, v60 op_sel_hi:[1,0,0]
 v_fma_mix_f32 v105, v234, v53, v61 op_sel:[1,0,0] op_sel_hi:[1,0,0]
 v_fma_mix_f32 v106, v235, v54, v62 op_sel_hi:[1,0,0]
 v_fma_mix_f32 v107, v235, v55, v63 op_sel:[1,0,0] op_sel_hi:[1,0,0]
 v_cvt_pk_bf16_f32 v234, v104, v105
 v_cvt_pk_bf16_f32 v235, v106, v107
 v_mfma_f32_32x32x16_bf16 a[16:31], a[240:243], v[220:223], a[16:31]
 buffer_load_dwordx4 v[168:171], v1, s[8:11], s45 offen offset:1024
 ds_read_b64_tr_b16 a[204:205], v67 offset:49152
 ds_read_b64_tr_b16 a[206:207], v67 offset:50176
 v_fma_mix_f32 v100, v236, v48, v56 op_sel_hi:[1,0,0]
 v_fma_mix_f32 v101, v236, v49, v57 op_sel:[1,0,0] op_sel_hi:[1,0,0]
 v_mfma_f32_32x32x16_bf16 a[32:47], a[244:247], v[216:219], a[32:47]
 v_fma_mix_f32 v102, v237, v50, v58 op_sel_hi:[1,0,0]
 v_fma_mix_f32 v103, v237, v51, v59 op_sel:[1,0,0] op_sel_hi:[1,0,0]
 v_cvt_pk_bf16_f32 v236, v100, v101
 v_cvt_pk_bf16_f32 v237, v102, v103
 v_fma_mix_f32 v104, v238, v52, v60 op_sel_hi:[1,0,0]
 v_fma_mix_f32 v105, v238, v53, v61 op_sel:[1,0,0] op_sel_hi:[1,0,0]
 v_mfma_f32_32x32x16_bf16 a[48:63], a[244:247], v[220:223], a[48:63]
 buffer_load_dwordx4 v[172:175], v1, s[8:11], s46 offen offset:1024
 ds_read_b64_tr_b16 a[208:209], v64 offset:53248
 ds_read_b64_tr_b16 a[210:211], v64 offset:54272
 v_fma_mix_f32 v106, v239, v54, v62 op_sel_hi:[1,0,0]
 v_fma_mix_f32 v107, v239, v55, v63 op_sel:[1,0,0] op_sel_hi:[1,0,0]
 v_mfma_f32_32x32x16_bf16 a[64:79], a[248:251], v[216:219], a[64:79]
 v_cvt_pk_bf16_f32 v238, v104, v105
 v_cvt_pk_bf16_f32 v239, v106, v107
 ds_read_b128 v[48:51], v23 offset:1920
 s_waitcnt lgkmcnt(14)
 ds_read_b128 v[52:55], v23 offset:1936
 s_waitcnt lgkmcnt(14)
 ds_read_b128 v[56:59], v23 offset:1952
 s_waitcnt lgkmcnt(14)
 ds_read_b128 v[60:63], v23 offset:1968
 v_mfma_f32_32x32x16_bf16 a[80:95], a[248:251], v[220:223], a[80:95]
 buffer_load_dwordx4 v[176:179], v1, s[8:11], s45 offen offset:2048
 s_waitcnt lgkmcnt(14)
 ds_read_b64_tr_b16 a[212:213], v65 offset:53248
 s_waitcnt lgkmcnt(14)
 ds_read_b64_tr_b16 a[214:215], v65 offset:54272
 s_waitcnt lgkmcnt(10)
 v_fma_mix_f32 v100, v240, v32, v40 op_sel_hi:[1,0,0]
 v_fma_mix_f32 v101, v240, v33, v41 op_sel:[1,0,0] op_sel_hi:[1,0,0]
 v_mfma_f32_32x32x16_bf16 a[96:111], a[252:255], v[216:219], a[96:111]
 v_fma_mix_f32 v102, v241, v34, v42 op_sel_hi:[1,0,0]
 v_fma_mix_f32 v103, v241, v35, v43 op_sel:[1,0,0] op_sel_hi:[1,0,0]
 v_cvt_pk_bf16_f32 v240, v100, v101
 v_cvt_pk_bf16_f32 v241, v102, v103
 v_fma_mix_f32 v104, v242, v36, v44 op_sel_hi:[1,0,0]
 v_fma_mix_f32 v105, v242, v37, v45 op_sel:[1,0,0] op_sel_hi:[1,0,0]
 v_mfma_f32_32x32x16_bf16 a[112:127], a[252:255], v[220:223], a[112:127]
 buffer_load_dwordx4 v[180:183], v1, s[8:11], s46 offen offset:2048
 ds_read_b64_tr_b16 a[216:217], v66 offset:53248
 ds_read_b64_tr_b16 a[218:219], v66 offset:54272
 v_fma_mix_f32 v106, v243, v38, v46 op_sel_hi:[1,0,0]
 v_fma_mix_f32 v107, v243, v39, v47 op_sel:[1,0,0] op_sel_hi:[1,0,0]
 v_mfma_f32_32x32x16_bf16 a[0:15], a[192:195], v[224:227], a[0:15]
 v_cvt_pk_bf16_f32 v242, v104, v105
 v_cvt_pk_bf16_f32 v243, v106, v107
 v_fma_mix_f32 v100, v244, v32, v40 op_sel_hi:[1,0,0]
 v_fma_mix_f32 v101, v244, v33, v41 op_sel:[1,0,0] op_sel_hi:[1,0,0]
 v_fma_mix_f32 v102, v245, v34, v42 op_sel_hi:[1,0,0]
 v_fma_mix_f32 v103, v245, v35, v43 op_sel:[1,0,0] op_sel_hi:[1,0,0]
 v_mfma_f32_32x32x16_bf16 a[16:31], a[192:195], v[228:231], a[16:31]
 buffer_load_dwordx4 v[184:187], v1, s[8:11], s45 offen offset:3072
 ds_read_b64_tr_b16 a[220:221], v67 offset:53248
 ds_read_b64_tr_b16 a[222:223], v67 offset:54272
 v_cvt_pk_bf16_f32 v244, v100, v101
 v_cvt_pk_bf16_f32 v245, v102, v103
 v_mfma_f32_32x32x16_bf16 a[32:47], a[196:199], v[224:227], a[32:47]
 v_fma_mix_f32 v104, v246, v36, v44 op_sel_hi:[1,0,0]
 v_fma_mix_f32 v105, v246, v37, v45 op_sel:[1,0,0] op_sel_hi:[1,0,0]
 v_fma_mix_f32 v106, v247, v38, v46 op_sel_hi:[1,0,0]
 v_fma_mix_f32 v107, v247, v39, v47 op_sel:[1,0,0] op_sel_hi:[1,0,0]
 v_cvt_pk_bf16_f32 v246, v104, v105
 v_cvt_pk_bf16_f32 v247, v106, v107
 v_mfma_f32_32x32x16_bf16 a[48:63], a[196:199], v[228:231], a[48:63]
 buffer_load_dwordx4 v[188:191], v1, s[8:11], s46 offen offset:3072
 ds_read_b64_tr_b16 a[224:225], v64 offset:57344
 s_waitcnt lgkmcnt(14)
 ds_read_b64_tr_b16 a[226:227], v64 offset:58368
 s_waitcnt lgkmcnt(14)
 ds_read_b128 v[32:35], v23 offset:2048
 s_waitcnt lgkmcnt(14)
 ds_read_b128 v[36:39], v23 offset:2064
 v_mfma_f32_32x32x16_bf16 a[64:79], a[200:203], v[224:227], a[64:79]
 s_waitcnt lgkmcnt(14)
 ds_read_b128 v[40:43], v23 offset:2080
 s_waitcnt lgkmcnt(14)
 ds_read_b128 v[44:47], v23 offset:2096
 s_waitcnt lgkmcnt(8)
 v_fma_mix_f32 v100, v248, v48, v56 op_sel_hi:[1,0,0]
 v_fma_mix_f32 v101, v248, v49, v57 op_sel:[1,0,0] op_sel_hi:[1,0,0]
 v_fma_mix_f32 v102, v249, v50, v58 op_sel_hi:[1,0,0]
 v_fma_mix_f32 v103, v249, v51, v59 op_sel:[1,0,0] op_sel_hi:[1,0,0]
 v_mfma_f32_32x32x16_bf16 a[80:95], a[200:203], v[228:231], a[80:95]
 ds_read_b64_tr_b16 a[228:229], v65 offset:57344
 ds_read_b64_tr_b16 a[230:231], v65 offset:58368
 v_cvt_pk_bf16_f32 v248, v100, v101
 v_cvt_pk_bf16_f32 v249, v102, v103
 v_fma_mix_f32 v104, v250, v52, v60 op_sel_hi:[1,0,0]
 v_fma_mix_f32 v105, v250, v53, v61 op_sel:[1,0,0] op_sel_hi:[1,0,0]
 v_mfma_f32_32x32x16_bf16 a[96:111], a[204:207], v[224:227], a[96:111]
 v_fma_mix_f32 v106, v251, v54, v62 op_sel_hi:[1,0,0]
 v_fma_mix_f32 v107, v251, v55, v63 op_sel:[1,0,0] op_sel_hi:[1,0,0]
 v_cvt_pk_bf16_f32 v250, v104, v105
 v_cvt_pk_bf16_f32 v251, v106, v107
 v_fma_mix_f32 v100, v252, v48, v56 op_sel_hi:[1,0,0]
 v_fma_mix_f32 v101, v252, v49, v57 op_sel:[1,0,0] op_sel_hi:[1,0,0]
 v_mfma_f32_32x32x16_bf16 a[112:127], a[204:207], v[228:231], a[112:127]
 s_waitcnt vmcnt(12)
 s_barrier
 s_add_u32 m0, s35, 0x8000
 ds_read_b64_tr_b16 a[232:233], v66 offset:57344
 ds_read_b64_tr_b16 a[234:235], v66 offset:58368
 v_fma_mix_f32 v102, v253, v50, v58 op_sel_hi:[1,0,0]
 v_mfma_f32_32x32x16_bf16 a[0:15], a[208:211], v[232:235], a[0:15]
 s_add_u32 s43, s31, 0x300000
 v_fma_mix_f32 v103, v253, v51, v59 op_sel:[1,0,0] op_sel_hi:[1,0,0]
 v_cvt_pk_bf16_f32 v252, v100, v101
 v_cvt_pk_bf16_f32 v253, v102, v103
 v_fma_mix_f32 v104, v254, v52, v60 op_sel_hi:[1,0,0]
 v_fma_mix_f32 v105, v254, v53, v61 op_sel:[1,0,0] op_sel_hi:[1,0,0]
 v_mfma_f32_32x32x16_bf16 a[16:31], a[208:211], v[236:239], a[16:31]
 ds_read_b64_tr_b16 a[236:237], v67 offset:57344
 ds_read_b64_tr_b16 a[238:239], v67 offset:58368
 v_fma_mix_f32 v106, v255, v54, v62 op_sel_hi:[1,0,0]
 v_fma_mix_f32 v107, v255, v55, v63 op_sel:[1,0,0] op_sel_hi:[1,0,0]
 v_cvt_pk_bf16_f32 v254, v104, v105
 v_cvt_pk_bf16_f32 v255, v106, v107
 v_mfma_f32_32x32x16_bf16 a[32:47], a[212:215], v[232:235], a[32:47]
 buffer_load_dwordx4 v2, s[12:15], s43 offen nt lds
 ds_read_b128 v[48:51], v23 offset:2176
 s_waitcnt lgkmcnt(14)
 ds_read_b128 v[52:55], v23 offset:2192
 s_waitcnt lgkmcnt(14)
 ds_read_b128 v[56:59], v23 offset:2208
 s_waitcnt lgkmcnt(14)
 ds_read_b128 v[60:63], v23 offset:2224
 v_mfma_f32_32x32x16_bf16 a[48:63], a[212:215], v[236:239], a[48:63]
 s_waitcnt lgkmcnt(14)
 ds_read_b64_tr_b16 a[240:241], v64 offset:61440
 s_waitcnt lgkmcnt(14)
 ds_read_b64_tr_b16 a[242:243], v64 offset:62464
 s_waitcnt lgkmcnt(10)
 v_fma_mix_f32 v100, v128, v32, v40 op_sel_hi:[1,0,0]
 v_fma_mix_f32 v101, v128, v33, v41 op_sel:[1,0,0] op_sel_hi:[1,0,0]
 v_fma_mix_f32 v102, v129, v34, v42 op_sel_hi:[1,0,0]
 v_fma_mix_f32 v103, v129, v35, v43 op_sel:[1,0,0] op_sel_hi:[1,0,0]
 v_mfma_f32_32x32x16_bf16 a[64:79], a[216:219], v[232:235], a[64:79]
 buffer_load_dwordx4 v3, s[12:15], s43 offen offset:1024 nt lds
 v_cvt_pk_bf16_f32 v128, v100, v101
 v_cvt_pk_bf16_f32 v129, v102, v103
 v_fma_mix_f32 v104, v130, v36, v44 op_sel_hi:[1,0,0]
 v_fma_mix_f32 v105, v130, v37, v45 op_sel:[1,0,0] op_sel_hi:[1,0,0]
 v_mfma_f32_32x32x16_bf16 a[80:95], a[216:219], v[236:239], a[80:95]
 ds_read_b64_tr_b16 a[244:245], v65 offset:61440
 ds_read_b64_tr_b16 a[246:247], v65 offset:62464
 v_fma_mix_f32 v106, v131, v38, v46 op_sel_hi:[1,0,0]
 v_fma_mix_f32 v107, v131, v39, v47 op_sel:[1,0,0] op_sel_hi:[1,0,0]
 v_cvt_pk_bf16_f32 v130, v104, v105
 v_cvt_pk_bf16_f32 v131, v106, v107
 v_mfma_f32_32x32x16_bf16 a[96:111], a[220:223], v[232:235], a[96:111]
 buffer_load_dwordx4 v4, s[12:15], s43 offen offset:2048 nt lds
 v_fma_mix_f32 v100, v132, v32, v40 op_sel_hi:[1,0,0]
 v_fma_mix_f32 v101, v132, v33, v41 op_sel:[1,0,0] op_sel_hi:[1,0,0]
 v_fma_mix_f32 v102, v133, v34, v42 op_sel_hi:[1,0,0]
 v_fma_mix_f32 v103, v133, v35, v43 op_sel:[1,0,0] op_sel_hi:[1,0,0]
 v_mfma_f32_32x32x16_bf16 a[112:127], a[220:223], v[236:239], a[112:127]
 ds_read_b64_tr_b16 a[248:249], v66 offset:61440
 ds_read_b64_tr_b16 a[250:251], v66 offset:62464
 v_cvt_pk_bf16_f32 v132, v100, v101
 v_cvt_pk_bf16_f32 v133, v102, v103
 v_fma_mix_f32 v104, v134, v36, v44 op_sel_hi:[1,0,0]
 v_fma_mix_f32 v105, v134, v37, v45 op_sel:[1,0,0] op_sel_hi:[1,0,0]
 v_mfma_f32_32x32x16_bf16 a[0:15], a[224:227], v[240:243], a[0:15]
 buffer_load_dwordx4 v5, s[12:15], s43 offen offset:3072 nt lds
 v_fma_mix_f32 v106, v135, v38, v46 op_sel_hi:[1,0,0]
 v_fma_mix_f32 v107, v135, v39, v47 op_sel:[1,0,0] op_sel_hi:[1,0,0]
 v_cvt_pk_bf16_f32 v134, v104, v105
 v_cvt_pk_bf16_f32 v135, v106, v107
 v_mfma_f32_32x32x16_bf16 a[16:31], a[224:227], v[244:247], a[16:31]
 ds_read_b64_tr_b16 a[252:253], v67 offset:61440
 s_waitcnt lgkmcnt(14)
 ds_read_b64_tr_b16 a[254:255], v67 offset:62464
 s_waitcnt lgkmcnt(14)
 ds_read_b128 v[32:35], v23 offset:2304
 s_waitcnt lgkmcnt(14)
 ds_read_b128 v[36:39], v23 offset:2320
 s_waitcnt lgkmcnt(14)
 ds_read_b128 v[40:43], v23 offset:2336
 s_waitcnt lgkmcnt(14)
 ds_read_b128 v[44:47], v23 offset:2352
 v_mfma_f32_32x32x16_bf16 a[32:47], a[228:231], v[240:243], a[32:47]
 s_add_u32 s45, s33, 0x6000
 s_waitcnt lgkmcnt(8)
 v_fma_mix_f32 v100, v136, v48, v56 op_sel_hi:[1,0,0]
 v_fma_mix_f32 v101, v136, v49, v57 op_sel:[1,0,0] op_sel_hi:[1,0,0]
 v_fma_mix_f32 v102, v137, v50, v58 op_sel_hi:[1,0,0]
 v_fma_mix_f32 v103, v137, v51, v59 op_sel:[1,0,0] op_sel_hi:[1,0,0]
 v_cvt_pk_bf16_f32 v136, v100, v101
 v_mfma_f32_32x32x16_bf16 a[48:63], a[228:231], v[244:247], a[48:63]
 ds_read_b64_tr_b16 a[192:193], v64
 ds_read_b64_tr_b16 a[194:195], v64 offset:1024
 v_cvt_pk_bf16_f32 v137, v102, v103
 v_fma_mix_f32 v104, v138, v52, v60 op_sel_hi:[1,0,0]
 v_fma_mix_f32 v105, v138, v53, v61 op_sel:[1,0,0] op_sel_hi:[1,0,0]
 v_fma_mix_f32 v106, v139, v54, v62 op_sel_hi:[1,0,0]
 v_mfma_f32_32x32x16_bf16 a[64:79], a[232:235], v[240:243], a[64:79]
 s_add_u32 s46, s34, 0x6000
 v_fma_mix_f32 v107, v139, v55, v63 op_sel:[1,0,0] op_sel_hi:[1,0,0]
 v_cvt_pk_bf16_f32 v138, v104, v105
 v_cvt_pk_bf16_f32 v139, v106, v107
 v_fma_mix_f32 v100, v140, v48, v56 op_sel_hi:[1,0,0]
 v_fma_mix_f32 v101, v140, v49, v57 op_sel:[1,0,0] op_sel_hi:[1,0,0]
 v_mfma_f32_32x32x16_bf16 a[80:95], a[232:235], v[244:247], a[80:95]
 ds_read_b64_tr_b16 a[196:197], v65
 ds_read_b64_tr_b16 a[198:199], v65 offset:1024
 v_fma_mix_f32 v102, v141, v50, v58 op_sel_hi:[1,0,0]
 v_fma_mix_f32 v103, v141, v51, v59 op_sel:[1,0,0] op_sel_hi:[1,0,0]
 v_cvt_pk_bf16_f32 v140, v100, v101
 v_cvt_pk_bf16_f32 v141, v102, v103
 v_mfma_f32_32x32x16_bf16 a[96:111], a[236:239], v[240:243], a[96:111]
 buffer_load_dwordx4 v[192:195], v1, s[8:11], s45 offen
 v_fma_mix_f32 v104, v142, v52, v60 op_sel_hi:[1,0,0]
 v_fma_mix_f32 v105, v142, v53, v61 op_sel:[1,0,0] op_sel_hi:[1,0,0]
 v_fma_mix_f32 v106, v143, v54, v62 op_sel_hi:[1,0,0]
 v_fma_mix_f32 v107, v143, v55, v63 op_sel:[1,0,0] op_sel_hi:[1,0,0]
 v_mfma_f32_32x32x16_bf16 a[112:127], a[236:239], v[244:247], a[112:127]
 buffer_load_dwordx4 v[196:199], v1, s[8:11], s46 offen
 ds_read_b64_tr_b16 a[200:201], v66
 ds_read_b64_tr_b16 a[202:203], v66 offset:1024
 v_cvt_pk_bf16_f32 v142, v104, v105
 v_cvt_pk_bf16_f32 v143, v106, v107
 v_mfma_f32_32x32x16_bf16 a[0:15], a[240:243], v[248:251], a[0:15]
 ds_read_b128 v[48:51], v23 offset:2432
 s_waitcnt lgkmcnt(14)
 ds_read_b128 v[52:55], v23 offset:2448
 s_waitcnt lgkmcnt(14)
 ds_read_b128 v[56:59], v23 offset:2464
 s_waitcnt lgkmcnt(14)
 ds_read_b128 v[60:63], v23 offset:2480
 s_waitcnt lgkmcnt(8)
 v_fma_mix_f32 v100, v144, v32, v40 op_sel_hi:[1,0,0]
 v_fma_mix_f32 v101, v144, v33, v41 op_sel:[1,0,0] op_sel_hi:[1,0,0]
 v_mfma_f32_32x32x16_bf16 a[16:31], a[240:243], v[252:255], a[16:31]
 buffer_load_dwordx4 v[200:203], v1, s[8:11], s45 offen offset:1024
 ds_read_b64_tr_b16 a[204:205], v67
 ds_read_b64_tr_b16 a[206:207], v67 offset:1024
 v_fma_mix_f32 v102, v145, v34, v42 op_sel_hi:[1,0,0]
 v_fma_mix_f32 v103, v145, v35, v43 op_sel:[1,0,0] op_sel_hi:[1,0,0]
 v_mfma_f32_32x32x16_bf16 a[32:47], a[244:247], v[248:251], a[32:47]
 v_cvt_pk_bf16_f32 v144, v100, v101
 v_cvt_pk_bf16_f32 v145, v102, v103
 v_fma_mix_f32 v104, v146, v36, v44 op_sel_hi:[1,0,0]
 v_fma_mix_f32 v105, v146, v37, v45 op_sel:[1,0,0] op_sel_hi:[1,0,0]
 v_fma_mix_f32 v106, v147, v38, v46 op_sel_hi:[1,0,0]
 v_fma_mix_f32 v107, v147, v39, v47 op_sel:[1,0,0] op_sel_hi:[1,0,0]
 v_mfma_f32_32x32x16_bf16 a[48:63], a[244:247], v[252:255], a[48:63]
 buffer_load_dwordx4 v[204:207], v1, s[8:11], s46 offen offset:1024
 ds_read_b64_tr_b16 a[208:209], v64 offset:4096
 ds_read_b64_tr_b16 a[210:211], v64 offset:5120
 v_cvt_pk_bf16_f32 v146, v104, v105
 v_cvt_pk_bf16_f32 v147, v106, v107
 v_mfma_f32_32x32x16_bf16 a[64:79], a[248:251], v[248:251], a[64:79]
 v_fma_mix_f32 v100, v148, v32, v40 op_sel_hi:[1,0,0]
 v_fma_mix_f32 v101, v148, v33, v41 op_sel:[1,0,0] op_sel_hi:[1,0,0]
 v_fma_mix_f32 v102, v149, v34, v42 op_sel_hi:[1,0,0]
 v_fma_mix_f32 v103, v149, v35, v43 op_sel:[1,0,0] op_sel_hi:[1,0,0]
 v_cvt_pk_bf16_f32 v148, v100, v101
 v_mfma_f32_32x32x16_bf16 a[80:95], a[248:251], v[252:255], a[80:95]
 buffer_load_dwordx4 v[208:211], v1, s[8:11], s45 offen offset:2048
 ds_read_b64_tr_b16 a[212:213], v65 offset:4096
 ds_read_b64_tr_b16 a[214:215], v65 offset:5120
 v_cvt_pk_bf16_f32 v149, v102, v103
 v_fma_mix_f32 v104, v150, v36, v44 op_sel_hi:[1,0,0]
 v_mfma_f32_32x32x16_bf16 a[96:111], a[252:255], v[248:251], a[96:111]
 v_fma_mix_f32 v105, v150, v37, v45 op_sel:[1,0,0] op_sel_hi:[1,0,0]
 v_fma_mix_f32 v106, v151, v38, v46 op_sel_hi:[1,0,0]
 v_fma_mix_f32 v107, v151, v39, v47 op_sel:[1,0,0] op_sel_hi:[1,0,0]
 v_cvt_pk_bf16_f32 v150, v104, v105
 v_cvt_pk_bf16_f32 v151, v106, v107
 v_mfma_f32_32x32x16_bf16 a[112:127], a[252:255], v[252:255], a[112:127]
 buffer_load_dwordx4 v[212:215], v1, s[8:11], s46 offen offset:2048
 ds_read_b64_tr_b16 a[216:217], v66 offset:4096
 s_waitcnt lgkmcnt(14)
 ds_read_b64_tr_b16 a[218:219], v66 offset:5120
 s_waitcnt lgkmcnt(14)
 ds_read_b128 v[32:35], v23 offset:2560
 s_waitcnt lgkmcnt(14)
 ds_read_b128 v[36:39], v23 offset:2576
 v_mfma_f32_32x32x16_bf16 a[0:15], a[192:195], v[128:131], a[0:15]
 s_waitcnt lgkmcnt(14)
 ds_read_b128 v[40:43], v23 offset:2592
 s_waitcnt lgkmcnt(14)
 ds_read_b128 v[44:47], v23 offset:2608
 s_waitcnt lgkmcnt(8)
 v_fma_mix_f32 v100, v152, v48, v56 op_sel_hi:[1,0,0]
 v_fma_mix_f32 v101, v152, v49, v57 op_sel:[1,0,0] op_sel_hi:[1,0,0]
 v_fma_mix_f32 v102, v153, v50, v58 op_sel_hi:[1,0,0]
 v_mfma_f32_32x32x16_bf16 a[16:31], a[192:195], v[132:135], a[16:31]
 buffer_load_dwordx4 v[216:219], v1, s[8:11], s45 offen offset:3072
 ds_read_b64_tr_b16 a[220:221], v67 offset:4096
 ds_read_b64_tr_b16 a[222:223], v67 offset:5120
 v_fma_mix_f32 v103, v153, v51, v59 op_sel:[1,0,0] op_sel_hi:[1,0,0]
 v_cvt_pk_bf16_f32 v152, v100, v101
 v_mfma_f32_32x32x16_bf16 a[32:47], a[196:199], v[128:131], a[32:47]
 v_cvt_pk_bf16_f32 v153, v102, v103
 v_fma_mix_f32 v104, v154, v52, v60 op_sel_hi:[1,0,0]
 v_fma_mix_f32 v105, v154, v53, v61 op_sel:[1,0,0] op_sel_hi:[1,0,0]
 v_fma_mix_f32 v106, v155, v54, v62 op_sel_hi:[1,0,0]
 v_fma_mix_f32 v107, v155, v55, v63 op_sel:[1,0,0] op_sel_hi:[1,0,0]
 v_mfma_f32_32x32x16_bf16 a[48:63], a[196:199], v[132:135], a[48:63]
 buffer_load_dwordx4 v[220:223], v1, s[8:11], s46 offen offset:3072
 ds_read_b64_tr_b16 a[224:225], v64 offset:8192
 ds_read_b64_tr_b16 a[226:227], v64 offset:9216
 v_cvt_pk_bf16_f32 v154, v104, v105
 v_cvt_pk_bf16_f32 v155, v106, v107
 v_mfma_f32_32x32x16_bf16 a[64:79], a[200:203], v[128:131], a[64:79]
 v_fma_mix_f32 v100, v156, v48, v56 op_sel_hi:[1,0,0]
 v_fma_mix_f32 v101, v156, v49, v57 op_sel:[1,0,0] op_sel_hi:[1,0,0]
 v_fma_mix_f32 v102, v157, v50, v58 op_sel_hi:[1,0,0]
 v_fma_mix_f32 v103, v157, v51, v59 op_sel:[1,0,0] op_sel_hi:[1,0,0]
 v_cvt_pk_bf16_f32 v156, v100, v101
 v_mfma_f32_32x32x16_bf16 a[80:95], a[200:203], v[132:135], a[80:95]
 ds_read_b64_tr_b16 a[228:229], v65 offset:8192
 ds_read_b64_tr_b16 a[230:231], v65 offset:9216
 v_cvt_pk_bf16_f32 v157, v102, v103
 v_fma_mix_f32 v104, v158, v52, v60 op_sel_hi:[1,0,0]
 v_fma_mix_f32 v105, v158, v53, v61 op_sel:[1,0,0] op_sel_hi:[1,0,0]
 v_fma_mix_f32 v106, v159, v54, v62 op_sel_hi:[1,0,0]
 v_mfma_f32_32x32x16_bf16 a[96:111], a[204:207], v[128:131], a[96:111]
 v_fma_mix_f32 v107, v159, v55, v63 op_sel:[1,0,0] op_sel_hi:[1,0,0]
 v_cvt_pk_bf16_f32 v158, v104, v105
 v_cvt_pk_bf16_f32 v159, v106, v107
 v_mfma_f32_32x32x16_bf16 a[112:127], a[204:207], v[132:135], a[112:127]
 s_waitcnt vmcnt(12)
 s_barrier
 s_add_u32 m0, s35, 0xc000
 ds_read_b64_tr_b16 a[232:233], v66 offset:8192
 s_waitcnt lgkmcnt(14)
 ds_read_b64_tr_b16 a[234:235], v66 offset:9216
 s_waitcnt lgkmcnt(14)
 ds_read_b128 v[48:51], v23 offset:2688
 v_mfma_f32_32x32x16_bf16 a[0:15], a[208:211], v[136:139], a[0:15]
 s_add_u32 s44, s31, 0x380000
 s_waitcnt lgkmcnt(14)
 ds_read_b128 v[52:55], v23 offset:2704
 s_waitcnt lgkmcnt(14)
 ds_read_b128 v[56:59], v23 offset:2720
 s_waitcnt lgkmcnt(14)
 ds_read_b128 v[60:63], v23 offset:2736
 s_waitcnt lgkmcnt(8)
 v_fma_mix_f32 v100, v160, v32, v40 op_sel_hi:[1,0,0]
 v_fma_mix_f32 v101, v160, v33, v41 op_sel:[1,0,0] op_sel_hi:[1,0,0]
 v_mfma_f32_32x32x16_bf16 a[16:31], a[208:211], v[140:143], a[16:31]
 ds_read_b64_tr_b16 a[236:237], v67 offset:8192
 ds_read_b64_tr_b16 a[238:239], v67 offset:9216
 v_fma_mix_f32 v102, v161, v34, v42 op_sel_hi:[1,0,0]
 v_fma_mix_f32 v103, v161, v35, v43 op_sel:[1,0,0] op_sel_hi:[1,0,0]
 v_cvt_pk_bf16_f32 v160, v100, v101
 v_cvt_pk_bf16_f32 v161, v102, v103
 v_mfma_f32_32x32x16_bf16 a[32:47], a[212:215], v[136:139], a[32:47]
 buffer_load_dwordx4 v2, s[12:15], s44 offen nt lds
 v_fma_mix_f32 v104, v162, v36, v44 op_sel_hi:[1,0,0]
 v_fma_mix_f32 v105, v162, v37, v45 op_sel:[1,0,0] op_sel_hi:[1,0,0]
 v_fma_mix_f32 v106, v163, v38, v46 op_sel_hi:[1,0,0]
 v_fma_mix_f32 v107, v163, v39, v47 op_sel:[1,0,0] op_sel_hi:[1,0,0]
 v_mfma_f32_32x32x16_bf16 a[48:63], a[212:215], v[140:143], a[48:63]
 ds_read_b64_tr_b16 a[240:241], v64 offset:12288
 ds_read_b64_tr_b16 a[242:243], v64 offset:13312
 v_cvt_pk_bf16_f32 v162, v104, v105
 v_cvt_pk_bf16_f32 v163, v106, v107
 v_fma_mix_f32 v100, v164, v32, v40 op_sel_hi:[1,0,0]
 v_fma_mix_f32 v101, v164, v33, v41 op_sel:[1,0,0] op_sel_hi:[1,0,0]
 v_mfma_f32_32x32x16_bf16 a[64:79], a[216:219], v[136:139], a[64:79]
 buffer_load_dwordx4 v3, s[12:15], s44 offen offset:1024 nt lds
 v_fma_mix_f32 v102, v165, v34, v42 op_sel_hi:[1,0,0]
 v_fma_mix_f32 v103, v165, v35, v43 op_sel:[1,0,0] op_sel_hi:[1,0,0]
 v_cvt_pk_bf16_f32 v164, v100, v101
 v_mfma_f32_32x32x16_bf16 a[80:95], a[216:219], v[140:143], a[80:95]
 ds_read_b64_tr_b16 a[244:245], v65 offset:12288
 ds_read_b64_tr_b16 a[246:247], v65 offset:13312
 v_cvt_pk_bf16_f32 v165, v102, v103
 v_fma_mix_f32 v104, v166, v36, v44 op_sel_hi:[1,0,0]
 v_fma_mix_f32 v105, v166, v37, v45 op_sel:[1,0,0] op_sel_hi:[1,0,0]
 v_fma_mix_f32 v106, v167, v38, v46 op_sel_hi:[1,0,0]
 v_mfma_f32_32x32x16_bf16 a[96:111], a[220:223], v[136:139], a[96:111]
 buffer_load_dwordx4 v4, s[12:15], s44 offen offset:2048 nt lds
 v_fma_mix_f32 v107, v167, v39, v47 op_sel:[1,0,0] op_sel_hi:[1,0,0]
 v_cvt_pk_bf16_f32 v166, v104, v105
 v_cvt_pk_bf16_f32 v167, v106, v107
 v_mfma_f32_32x32x16_bf16 a[112:127], a[220:223], v[140:143], a[112:127]
 ds_read_b64_tr_b16 a[248:249], v66 offset:12288
 s_waitcnt lgkmcnt(14)
 ds_read_b64_tr_b16 a[250:251], v66 offset:13312
 s_waitcnt lgkmcnt(14)
 ds_read_b128 v[32:35], v23 offset:2816
 s_waitcnt lgkmcnt(14)
 ds_read_b128 v[36:39], v23 offset:2832
 s_waitcnt lgkmcnt(14)
 ds_read_b128 v[40:43], v23 offset:2848
 s_waitcnt lgkmcnt(14)
 ds_read_b128 v[44:47], v23 offset:2864
 v_mfma_f32_32x32x16_bf16 a[0:15], a[224:227], v[144:147], a[0:15]
 buffer_load_dwordx4 v5, s[12:15], s44 offen offset:3072 nt lds
 s_waitcnt lgkmcnt(8)
 v_fma_mix_f32 v100, v168, v48, v56 op_sel_hi:[1,0,0]
 v_fma_mix_f32 v101, v168, v49, v57 op_sel:[1,0,0] op_sel_hi:[1,0,0]
 v_fma_mix_f32 v102, v169, v50, v58 op_sel_hi:[1,0,0]
 v_mfma_f32_32x32x16_bf16 a[16:31], a[224:227], v[148:151], a[16:31]
 ds_read_b64_tr_b16 a[252:253], v67 offset:12288
 ds_read_b64_tr_b16 a[254:255], v67 offset:13312
 v_fma_mix_f32 v103, v169, v51, v59 op_sel:[1,0,0] op_sel_hi:[1,0,0]
 v_cvt_pk_bf16_f32 v168, v100, v101
 v_cvt_pk_bf16_f32 v169, v102, v103
 v_fma_mix_f32 v104, v170, v52, v60 op_sel_hi:[1,0,0]
 v_mfma_f32_32x32x16_bf16 a[32:47], a[228:231], v[144:147], a[32:47]
 s_add_u32 s45, s33, 0x7000
 v_fma_mix_f32 v105, v170, v53, v61 op_sel:[1,0,0] op_sel_hi:[1,0,0]
 v_fma_mix_f32 v106, v171, v54, v62 op_sel_hi:[1,0,0]
 v_fma_mix_f32 v107, v171, v55, v63 op_sel:[1,0,0] op_sel_hi:[1,0,0]
 v_mfma_f32_32x32x16_bf16 a[48:63], a[228:231], v[148:151], a[48:63]
 ds_read_b64_tr_b16 a[192:193], v64 offset:16384
 ds_read_b64_tr_b16 a[194:195], v64 offset:17408
 v_cvt_pk_bf16_f32 v170, v104, v105
 v_cvt_pk_bf16_f32 v171, v106, v107
 v_fma_mix_f32 v100, v172, v48, v56 op_sel_hi:[1,0,0]
 v_fma_mix_f32 v101, v172, v49, v57 op_sel:[1,0,0] op_sel_hi:[1,0,0]
 v_mfma_f32_32x32x16_bf16 a[64:79], a[232:235], v[144:147], a[64:79]
 s_add_u32 s46, s34, 0x7000
 v_fma_mix_f32 v102, v173, v50, v58 op_sel_hi:[1,0,0]
 v_fma_mix_f32 v103, v173, v51, v59 op_sel:[1,0,0] op_sel_hi:[1,0,0]
 v_cvt_pk_bf16_f32 v172, v100, v101
 v_mfma_f32_32x32x16_bf16 a[80:95], a[232:235], v[148:151], a[80:95]
 ds_read_b64_tr_b16 a[196:197], v65 offset:16384
 ds_read_b64_tr_b16 a[198:199], v65 offset:17408
 v_cvt_pk_bf16_f32 v173, v102, v103
 v_fma_mix_f32 v104, v174, v52, v60 op_sel_hi:[1,0,0]
 v_fma_mix_f32 v105, v174, v53, v61 op_sel:[1,0,0] op_sel_hi:[1,0,0]
 v_fma_mix_f32 v106, v175, v54, v62 op_sel_hi:[1,0,0]
 v_mfma_f32_32x32x16_bf16 a[96:111], a[236:239], v[144:147], a[96:111]
 buffer_load_dwordx4 v[224:227], v1, s[8:11], s45 offen
 v_fma_mix_f32 v107, v175, v55, v63 op_sel:[1,0,0] op_sel_hi:[1,0,0]
 v_cvt_pk_bf16_f32 v174, v104, v105
 v_cvt_pk_bf16_f32 v175, v106, v107
 v_mfma_f32_32x32x16_bf16 a[112:127], a[236:239], v[148:151], a[112:127]
 buffer_load_dwordx4 v[228:231], v1, s[8:11], s46 offen
 ds_read_b64_tr_b16 a[200:201], v66 offset:16384
 s_waitcnt lgkmcnt(14)
 ds_read_b64_tr_b16 a[202:203], v66 offset:17408
 s_waitcnt lgkmcnt(14)
 ds_read_b128 v[48:51], v23 offset:2944
 s_waitcnt lgkmcnt(14)
 ds_read_b128 v[52:55], v23 offset:2960
 v_mfma_f32_32x32x16_bf16 a[0:15], a[240:243], v[152:155], a[0:15]
 s_waitcnt lgkmcnt(14)
 ds_read_b128 v[56:59], v23 offset:2976
 s_waitcnt lgkmcnt(14)
 ds_read_b128 v[60:63], v23 offset:2992
 s_waitcnt lgkmcnt(8)
 v_fma_mix_f32 v100, v176, v32, v40 op_sel_hi:[1,0,0]
 v_fma_mix_f32 v101, v176, v33, v41 op_sel:[1,0,0] op_sel_hi:[1,0,0]
 v_fma_mix_f32 v102, v177, v34, v42 op_sel_hi:[1,0,0]
 v_mfma_f32_32x32x16_bf16 a[16:31], a[240:243], v[156:159], a[16:31]
 buffer_load_dwordx4 v[232:235], v1, s[8:11], s45 offen offset:1024
 ds_read_b64_tr_b16 a[204:205], v67 offset:16384
 ds_read_b64_tr_b16 a[206:207], v67 offset:17408
 v_fma_mix_f32 v103, v177, v35, v43 op_sel:[1,0,0] op_sel_hi:[1,0,0]
 v_cvt_pk_bf16_f32 v176, v100, v101
 v_mfma_f32_32x32x16_bf16 a[32:47], a[244:247], v[152:155], a[32:47]
 v_cvt_pk_bf16_f32 v177, v102, v103
 v_fma_mix_f32 v104, v178, v36, v44 op_sel_hi:[1,0,0]
 v_fma_mix_f32 v105, v178, v37, v45 op_sel:[1,0,0] op_sel_hi:[1,0,0]
 v_fma_mix_f32 v106, v179, v38, v46 op_sel_hi:[1,0,0]
 v_fma_mix_f32 v107, v179, v39, v47 op_sel:[1,0,0] op_sel_hi:[1,0,0]
 v_mfma_f32_32x32x16_bf16 a[48:63], a[244:247], v[156:159], a[48:63]
 buffer_load_dwordx4 v[236:239], v1, s[8:11], s46 offen offset:1024
 ds_read_b64_tr_b16 a[208:209], v64 offset:20480
 ds_read_b64_tr_b16 a[210:211], v64 offset:21504
 v_cvt_pk_bf16_f32 v178, v104, v105
 v_cvt_pk_bf16_f32 v179, v106, v107
 v_mfma_f32_32x32x16_bf16 a[64:79], a[248:251], v[152:155], a[64:79]
 v_fma_mix_f32 v100, v180, v32, v40 op_sel_hi:[1,0,0]
 v_fma_mix_f32 v101, v180, v33, v41 op_sel:[1,0,0] op_sel_hi:[1,0,0]
 v_fma_mix_f32 v102, v181, v34, v42 op_sel_hi:[1,0,0]
 v_fma_mix_f32 v103, v181, v35, v43 op_sel:[1,0,0] op_sel_hi:[1,0,0]
 v_cvt_pk_bf16_f32 v180, v100, v101
 v_mfma_f32_32x32x16_bf16 a[80:95], a[248:251], v[156:159], a[80:95]
 buffer_load_dwordx4 v[240:243], v1, s[8:11], s45 offen offset:2048
 ds_read_b64_tr_b16 a[212:213], v65 offset:20480
 ds_read_b64_tr_b16 a[214:215], v65 offset:21504
 v_cvt_pk_bf16_f32 v181, v102, v103
 v_fma_mix_f32 v104, v182, v36, v44 op_sel_hi:[1,0,0]
 v_mfma_f32_32x32x16_bf16 a[96:111], a[252:255], v[152:155], a[96:111]
 v_fma_mix_f32 v105, v182, v37, v45 op_sel:[1,0,0] op_sel_hi:[1,0,0]
 v_fma_mix_f32 v106, v183, v38, v46 op_sel_hi:[1,0,0]
 v_fma_mix_f32 v107, v183, v39, v47 op_sel:[1,0,0] op_sel_hi:[1,0,0]
 v_cvt_pk_bf16_f32 v182, v104, v105
 v_cvt_pk_bf16_f32 v183, v106, v107
 v_mfma_f32_32x32x16_bf16 a[112:127], a[252:255], v[156:159], a[112:127]
 buffer_load_dwordx4 v[244:247], v1, s[8:11], s46 offen offset:2048
 ds_read_b64_tr_b16 a[216:217], v66 offset:20480
 s_waitcnt lgkmcnt(14)
 ds_read_b64_tr_b16 a[218:219], v66 offset:21504
 s_waitcnt lgkmcnt(14)
 ds_read_b128 v[32:35], v23 offset:3072
 s_waitcnt lgkmcnt(14)
 ds_read_b128 v[36:39], v23 offset:3088
 v_mfma_f32_32x32x16_bf16 a[0:15], a[192:195], v[160:163], a[0:15]
 s_waitcnt lgkmcnt(14)
 ds_read_b128 v[40:43], v23 offset:3104
 s_waitcnt lgkmcnt(14)
 ds_read_b128 v[44:47], v23 offset:3120
 s_waitcnt lgkmcnt(8)
 v_fma_mix_f32 v100, v184, v48, v56 op_sel_hi:[1,0,0]
 v_fma_mix_f32 v101, v184, v49, v57 op_sel:[1,0,0] op_sel_hi:[1,0,0]
 v_fma_mix_f32 v102, v185, v50, v58 op_sel_hi:[1,0,0]
 v_mfma_f32_32x32x16_bf16 a[16:31], a[192:195], v[164:167], a[16:31]
 buffer_load_dwordx4 v[248:251], v1, s[8:11], s45 offen offset:3072
 ds_read_b64_tr_b16 a[220:221], v67 offset:20480
 ds_read_b64_tr_b16 a[222:223], v67 offset:21504
 v_fma_mix_f32 v103, v185, v51, v59 op_sel:[1,0,0] op_sel_hi:[1,0,0]
 v_cvt_pk_bf16_f32 v184, v100, v101
 v_mfma_f32_32x32x16_bf16 a[32:47], a[196:199], v[160:163], a[32:47]
 v_cvt_pk_bf16_f32 v185, v102, v103
 v_fma_mix_f32 v104, v186, v52, v60 op_sel_hi:[1,0,0]
 v_fma_mix_f32 v105, v186, v53, v61 op_sel:[1,0,0] op_sel_hi:[1,0,0]
 v_fma_mix_f32 v106, v187, v54, v62 op_sel_hi:[1,0,0]
 v_fma_mix_f32 v107, v187, v55, v63 op_sel:[1,0,0] op_sel_hi:[1,0,0]
 v_mfma_f32_32x32x16_bf16 a[48:63], a[196:199], v[164:167], a[48:63]
 buffer_load_dwordx4 v[252:255], v1, s[8:11], s46 offen offset:3072
 ds_read_b64_tr_b16 a[224:225], v64 offset:24576
 ds_read_b64_tr_b16 a[226:227], v64 offset:25600
 v_cvt_pk_bf16_f32 v186, v104, v105
 v_cvt_pk_bf16_f32 v187, v106, v107
 v_mfma_f32_32x32x16_bf16 a[64:79], a[200:203], v[160:163], a[64:79]
 v_fma_mix_f32 v100, v188, v48, v56 op_sel_hi:[1,0,0]
 v_fma_mix_f32 v101, v188, v49, v57 op_sel:[1,0,0] op_sel_hi:[1,0,0]
 v_fma_mix_f32 v102, v189, v50, v58 op_sel_hi:[1,0,0]
 v_fma_mix_f32 v103, v189, v51, v59 op_sel:[1,0,0] op_sel_hi:[1,0,0]
 v_cvt_pk_bf16_f32 v188, v100, v101
 v_mfma_f32_32x32x16_bf16 a[80:95], a[200:203], v[164:167], a[80:95]
 ds_read_b64_tr_b16 a[228:229], v65 offset:24576
 ds_read_b64_tr_b16 a[230:231], v65 offset:25600
 v_cvt_pk_bf16_f32 v189, v102, v103
 v_fma_mix_f32 v104, v190, v52, v60 op_sel_hi:[1,0,0]
 v_fma_mix_f32 v105, v190, v53, v61 op_sel:[1,0,0] op_sel_hi:[1,0,0]
 v_fma_mix_f32 v106, v191, v54, v62 op_sel_hi:[1,0,0]
 v_mfma_f32_32x32x16_bf16 a[96:111], a[204:207], v[160:163], a[96:111]
 v_fma_mix_f32 v107, v191, v55, v63 op_sel:[1,0,0] op_sel_hi:[1,0,0]
 v_cvt_pk_bf16_f32 v190, v104, v105
 v_cvt_pk_bf16_f32 v191, v106, v107
 v_mfma_f32_32x32x16_bf16 a[112:127], a[204:207], v[164:167], a[112:127]
 s_waitcnt vmcnt(12)
 s_barrier
 s_add_u32 m0, s35, 0
 ds_read_b64_tr_b16 a[232:233], v66 offset:24576
 s_waitcnt lgkmcnt(14)
 ds_read_b64_tr_b16 a[234:235], v66 offset:25600
 s_waitcnt lgkmcnt(14)
 ds_read_b128 v[48:51], v23 offset:3200
 v_mfma_f32_32x32x16_bf16 a[0:15], a[208:211], v[168:171], a[0:15]
 s_add_u32 s43, s31, 0x400000
 s_waitcnt lgkmcnt(14)
 ds_read_b128 v[52:55], v23 offset:3216
 s_waitcnt lgkmcnt(14)
 ds_read_b128 v[56:59], v23 offset:3232
 s_waitcnt lgkmcnt(14)
 ds_read_b128 v[60:63], v23 offset:3248
 s_waitcnt lgkmcnt(8)
 v_fma_mix_f32 v100, v192, v32, v40 op_sel_hi:[1,0,0]
 v_fma_mix_f32 v101, v192, v33, v41 op_sel:[1,0,0] op_sel_hi:[1,0,0]
 v_mfma_f32_32x32x16_bf16 a[16:31], a[208:211], v[172:175], a[16:31]
 ds_read_b64_tr_b16 a[236:237], v67 offset:24576
 ds_read_b64_tr_b16 a[238:239], v67 offset:25600
 v_fma_mix_f32 v102, v193, v34, v42 op_sel_hi:[1,0,0]
 v_fma_mix_f32 v103, v193, v35, v43 op_sel:[1,0,0] op_sel_hi:[1,0,0]
 v_cvt_pk_bf16_f32 v192, v100, v101
 v_cvt_pk_bf16_f32 v193, v102, v103
 v_mfma_f32_32x32x16_bf16 a[32:47], a[212:215], v[168:171], a[32:47]
 buffer_load_dwordx4 v2, s[12:15], s43 offen nt lds
 v_fma_mix_f32 v104, v194, v36, v44 op_sel_hi:[1,0,0]
 v_fma_mix_f32 v105, v194, v37, v45 op_sel:[1,0,0] op_sel_hi:[1,0,0]
 v_fma_mix_f32 v106, v195, v38, v46 op_sel_hi:[1,0,0]
 v_fma_mix_f32 v107, v195, v39, v47 op_sel:[1,0,0] op_sel_hi:[1,0,0]
 v_mfma_f32_32x32x16_bf16 a[48:63], a[212:215], v[172:175], a[48:63]
 ds_read_b64_tr_b16 a[240:241], v64 offset:28672
 ds_read_b64_tr_b16 a[242:243], v64 offset:29696
 v_cvt_pk_bf16_f32 v194, v104, v105
 v_cvt_pk_bf16_f32 v195, v106, v107
 v_fma_mix_f32 v100, v196, v32, v40 op_sel_hi:[1,0,0]
 v_fma_mix_f32 v101, v196, v33, v41 op_sel:[1,0,0] op_sel_hi:[1,0,0]
 v_mfma_f32_32x32x16_bf16 a[64:79], a[216:219], v[168:171], a[64:79]
 buffer_load_dwordx4 v3, s[12:15], s43 offen offset:1024 nt lds
 v_fma_mix_f32 v102, v197, v34, v42 op_sel_hi:[1,0,0]
 v_fma_mix_f32 v103, v197, v35, v43 op_sel:[1,0,0] op_sel_hi:[1,0,0]
 v_cvt_pk_bf16_f32 v196, v100, v101
 v_mfma_f32_32x32x16_bf16 a[80:95], a[216:219], v[172:175], a[80:95]
 ds_read_b64_tr_b16 a[244:245], v65 offset:28672
 ds_read_b64_tr_b16 a[246:247], v65 offset:29696
 v_cvt_pk_bf16_f32 v197, v102, v103
 v_fma_mix_f32 v104, v198, v36, v44 op_sel_hi:[1,0,0]
 v_fma_mix_f32 v105, v198, v37, v45 op_sel:[1,0,0] op_sel_hi:[1,0,0]
 v_fma_mix_f32 v106, v199, v38, v46 op_sel_hi:[1,0,0]
 v_mfma_f32_32x32x16_bf16 a[96:111], a[220:223], v[168:171], a[96:111]
 buffer_load_dwordx4 v4, s[12:15], s43 offen offset:2048 nt lds
 v_fma_mix_f32 v107, v199, v39, v47 op_sel:[1,0,0] op_sel_hi:[1,0,0]
 v_cvt_pk_bf16_f32 v198, v104, v105
 v_cvt_pk_bf16_f32 v199, v106, v107
 v_mfma_f32_32x32x16_bf16 a[112:127], a[220:223], v[172:175], a[112:127]
 ds_read_b64_tr_b16 a[248:249], v66 offset:28672
 s_waitcnt lgkmcnt(14)
 ds_read_b64_tr_b16 a[250:251], v66 offset:29696
 s_waitcnt lgkmcnt(14)
 ds_read_b128 v[32:35], v23 offset:3328
 s_waitcnt lgkmcnt(14)
 ds_read_b128 v[36:39], v23 offset:3344
 s_waitcnt lgkmcnt(14)
 ds_read_b128 v[40:43], v23 offset:3360
 s_waitcnt lgkmcnt(14)
 ds_read_b128 v[44:47], v23 offset:3376
 v_mfma_f32_32x32x16_bf16 a[0:15], a[224:227], v[176:179], a[0:15]
 buffer_load_dwordx4 v5, s[12:15], s43 offen offset:3072 nt lds
 s_waitcnt lgkmcnt(8)
 v_fma_mix_f32 v100, v200, v48, v56 op_sel_hi:[1,0,0]
 v_fma_mix_f32 v101, v200, v49, v57 op_sel:[1,0,0] op_sel_hi:[1,0,0]
 v_fma_mix_f32 v102, v201, v50, v58 op_sel_hi:[1,0,0]
 v_mfma_f32_32x32x16_bf16 a[16:31], a[224:227], v[180:183], a[16:31]
 ds_read_b64_tr_b16 a[252:253], v67 offset:28672
 ds_read_b64_tr_b16 a[254:255], v67 offset:29696
 v_fma_mix_f32 v103, v201, v51, v59 op_sel:[1,0,0] op_sel_hi:[1,0,0]
 v_cvt_pk_bf16_f32 v200, v100, v101
 v_cvt_pk_bf16_f32 v201, v102, v103
 v_fma_mix_f32 v104, v202, v52, v60 op_sel_hi:[1,0,0]
 v_mfma_f32_32x32x16_bf16 a[32:47], a[228:231], v[176:179], a[32:47]
 s_add_u32 s45, s33, 0x8000
 v_fma_mix_f32 v105, v202, v53, v61 op_sel:[1,0,0] op_sel_hi:[1,0,0]
 v_fma_mix_f32 v106, v203, v54, v62 op_sel_hi:[1,0,0]
 v_fma_mix_f32 v107, v203, v55, v63 op_sel:[1,0,0] op_sel_hi:[1,0,0]
 v_mfma_f32_32x32x16_bf16 a[48:63], a[228:231], v[180:183], a[48:63]
 ds_read_b64_tr_b16 a[192:193], v64 offset:32768
 ds_read_b64_tr_b16 a[194:195], v64 offset:33792
 v_cvt_pk_bf16_f32 v202, v104, v105
 v_cvt_pk_bf16_f32 v203, v106, v107
 v_fma_mix_f32 v100, v204, v48, v56 op_sel_hi:[1,0,0]
 v_fma_mix_f32 v101, v204, v49, v57 op_sel:[1,0,0] op_sel_hi:[1,0,0]
 v_mfma_f32_32x32x16_bf16 a[64:79], a[232:235], v[176:179], a[64:79]
 s_add_u32 s46, s34, 0x8000
 v_fma_mix_f32 v102, v205, v50, v58 op_sel_hi:[1,0,0]
 v_fma_mix_f32 v103, v205, v51, v59 op_sel:[1,0,0] op_sel_hi:[1,0,0]
 v_cvt_pk_bf16_f32 v204, v100, v101
 v_mfma_f32_32x32x16_bf16 a[80:95], a[232:235], v[180:183], a[80:95]
 ds_read_b64_tr_b16 a[196:197], v65 offset:32768
 ds_read_b64_tr_b16 a[198:199], v65 offset:33792
 v_cvt_pk_bf16_f32 v205, v102, v103
 v_fma_mix_f32 v104, v206, v52, v60 op_sel_hi:[1,0,0]
 v_fma_mix_f32 v105, v206, v53, v61 op_sel:[1,0,0] op_sel_hi:[1,0,0]
 v_fma_mix_f32 v106, v207, v54, v62 op_sel_hi:[1,0,0]
 v_mfma_f32_32x32x16_bf16 a[96:111], a[236:239], v[176:179], a[96:111]
 buffer_load_dwordx4 v[128:131], v1, s[8:11], s45 offen
 v_fma_mix_f32 v107, v207, v55, v63 op_sel:[1,0,0] op_sel_hi:[1,0,0]
 v_cvt_pk_bf16_f32 v206, v104, v105
 v_cvt_pk_bf16_f32 v207, v106, v107
 v_mfma_f32_32x32x16_bf16 a[112:127], a[236:239], v[180:183], a[112:127]
 buffer_load_dwordx4 v[132:135], v1, s[8:11], s46 offen
 ds_read_b64_tr_b16 a[200:201], v66 offset:32768
 s_waitcnt lgkmcnt(14)
 ds_read_b64_tr_b16 a[202:203], v66 offset:33792
 s_waitcnt lgkmcnt(14)
 ds_read_b128 v[48:51], v23 offset:3456
 s_waitcnt lgkmcnt(14)
 ds_read_b128 v[52:55], v23 offset:3472
 v_mfma_f32_32x32x16_bf16 a[0:15], a[240:243], v[184:187], a[0:15]
 s_waitcnt lgkmcnt(14)
 ds_read_b128 v[56:59], v23 offset:3488
 s_waitcnt lgkmcnt(14)
 ds_read_b128 v[60:63], v23 offset:3504
 s_waitcnt lgkmcnt(8)
 v_fma_mix_f32 v100, v208, v32, v40 op_sel_hi:[1,0,0]
 v_fma_mix_f32 v101, v208, v33, v41 op_sel:[1,0,0] op_sel_hi:[1,0,0]
 v_fma_mix_f32 v102, v209, v34, v42 op_sel_hi:[1,0,0]
 v_mfma_f32_32x32x16_bf16 a[16:31], a[240:243], v[188:191], a[16:31]
 buffer_load_dwordx4 v[136:139], v1, s[8:11], s45 offen offset:1024
 ds_read_b64_tr_b16 a[204:205], v67 offset:32768
 ds_read_b64_tr_b16 a[206:207], v67 offset:33792
 v_fma_mix_f32 v103, v209, v35, v43 op_sel:[1,0,0] op_sel_hi:[1,0,0]
 v_cvt_pk_bf16_f32 v208, v100, v101
 v_mfma_f32_32x32x16_bf16 a[32:47], a[244:247], v[184:187], a[32:47]
 v_cvt_pk_bf16_f32 v209, v102, v103
 v_fma_mix_f32 v104, v210, v36, v44 op_sel_hi:[1,0,0]
 v_fma_mix_f32 v105, v210, v37, v45 op_sel:[1,0,0] op_sel_hi:[1,0,0]
 v_fma_mix_f32 v106, v211, v38, v46 op_sel_hi:[1,0,0]
 v_fma_mix_f32 v107, v211, v39, v47 op_sel:[1,0,0] op_sel_hi:[1,0,0]
 v_mfma_f32_32x32x16_bf16 a[48:63], a[244:247], v[188:191], a[48:63]
 buffer_load_dwordx4 v[140:143], v1, s[8:11], s46 offen offset:1024
 ds_read_b64_tr_b16 a[208:209], v64 offset:36864
 ds_read_b64_tr_b16 a[210:211], v64 offset:37888
 v_cvt_pk_bf16_f32 v210, v104, v105
 v_cvt_pk_bf16_f32 v211, v106, v107
 v_mfma_f32_32x32x16_bf16 a[64:79], a[248:251], v[184:187], a[64:79]
 v_fma_mix_f32 v100, v212, v32, v40 op_sel_hi:[1,0,0]
 v_fma_mix_f32 v101, v212, v33, v41 op_sel:[1,0,0] op_sel_hi:[1,0,0]
 v_fma_mix_f32 v102, v213, v34, v42 op_sel_hi:[1,0,0]
 v_fma_mix_f32 v103, v213, v35, v43 op_sel:[1,0,0] op_sel_hi:[1,0,0]
 v_cvt_pk_bf16_f32 v212, v100, v101
 v_mfma_f32_32x32x16_bf16 a[80:95], a[248:251], v[188:191], a[80:95]
 buffer_load_dwordx4 v[144:147], v1, s[8:11], s45 offen offset:2048
 ds_read_b64_tr_b16 a[212:213], v65 offset:36864
 ds_read_b64_tr_b16 a[214:215], v65 offset:37888
 v_cvt_pk_bf16_f32 v213, v102, v103
 v_fma_mix_f32 v104, v214, v36, v44 op_sel_hi:[1,0,0]
 v_mfma_f32_32x32x16_bf16 a[96:111], a[252:255], v[184:187], a[96:111]
 v_fma_mix_f32 v105, v214, v37, v45 op_sel:[1,0,0] op_sel_hi:[1,0,0]
 v_fma_mix_f32 v106, v215, v38, v46 op_sel_hi:[1,0,0]
 v_fma_mix_f32 v107, v215, v39, v47 op_sel:[1,0,0] op_sel_hi:[1,0,0]
 v_cvt_pk_bf16_f32 v214, v104, v105
 v_cvt_pk_bf16_f32 v215, v106, v107
 v_mfma_f32_32x32x16_bf16 a[112:127], a[252:255], v[188:191], a[112:127]
 buffer_load_dwordx4 v[148:151], v1, s[8:11], s46 offen offset:2048
 ds_read_b64_tr_b16 a[216:217], v66 offset:36864
 s_waitcnt lgkmcnt(14)
 ds_read_b64_tr_b16 a[218:219], v66 offset:37888
 s_waitcnt lgkmcnt(14)
 ds_read_b128 v[32:35], v23 offset:3584
 s_waitcnt lgkmcnt(14)
 ds_read_b128 v[36:39], v23 offset:3600
 v_mfma_f32_32x32x16_bf16 a[0:15], a[192:195], v[192:195], a[0:15]
 s_waitcnt lgkmcnt(14)
 ds_read_b128 v[40:43], v23 offset:3616
 s_waitcnt lgkmcnt(14)
 ds_read_b128 v[44:47], v23 offset:3632
 s_waitcnt lgkmcnt(8)
 v_fma_mix_f32 v100, v216, v48, v56 op_sel_hi:[1,0,0]
 v_fma_mix_f32 v101, v216, v49, v57 op_sel:[1,0,0] op_sel_hi:[1,0,0]
 v_fma_mix_f32 v102, v217, v50, v58 op_sel_hi:[1,0,0]
 v_mfma_f32_32x32x16_bf16 a[16:31], a[192:195], v[196:199], a[16:31]
 buffer_load_dwordx4 v[152:155], v1, s[8:11], s45 offen offset:3072
 ds_read_b64_tr_b16 a[220:221], v67 offset:36864
 ds_read_b64_tr_b16 a[222:223], v67 offset:37888
 v_fma_mix_f32 v103, v217, v51, v59 op_sel:[1,0,0] op_sel_hi:[1,0,0]
 v_cvt_pk_bf16_f32 v216, v100, v101
 v_mfma_f32_32x32x16_bf16 a[32:47], a[196:199], v[192:195], a[32:47]
 v_cvt_pk_bf16_f32 v217, v102, v103
 v_fma_mix_f32 v104, v218, v52, v60 op_sel_hi:[1,0,0]
 v_fma_mix_f32 v105, v218, v53, v61 op_sel:[1,0,0] op_sel_hi:[1,0,0]
 v_fma_mix_f32 v106, v219, v54, v62 op_sel_hi:[1,0,0]
 v_fma_mix_f32 v107, v219, v55, v63 op_sel:[1,0,0] op_sel_hi:[1,0,0]
 v_mfma_f32_32x32x16_bf16 a[48:63], a[196:199], v[196:199], a[48:63]
 buffer_load_dwordx4 v[156:159], v1, s[8:11], s46 offen offset:3072
 ds_read_b64_tr_b16 a[224:225], v64 offset:40960
 ds_read_b64_tr_b16 a[226:227], v64 offset:41984
 v_cvt_pk_bf16_f32 v218, v104, v105
 v_cvt_pk_bf16_f32 v219, v106, v107
 v_mfma_f32_32x32x16_bf16 a[64:79], a[200:203], v[192:195], a[64:79]
 v_fma_mix_f32 v100, v220, v48, v56 op_sel_hi:[1,0,0]
 v_fma_mix_f32 v101, v220, v49, v57 op_sel:[1,0,0] op_sel_hi:[1,0,0]
 v_fma_mix_f32 v102, v221, v50, v58 op_sel_hi:[1,0,0]
 v_fma_mix_f32 v103, v221, v51, v59 op_sel:[1,0,0] op_sel_hi:[1,0,0]
 v_cvt_pk_bf16_f32 v220, v100, v101
 v_mfma_f32_32x32x16_bf16 a[80:95], a[200:203], v[196:199], a[80:95]
 ds_read_b64_tr_b16 a[228:229], v65 offset:40960
 ds_read_b64_tr_b16 a[230:231], v65 offset:41984
 v_cvt_pk_bf16_f32 v221, v102, v103
 v_fma_mix_f32 v104, v222, v52, v60 op_sel_hi:[1,0,0]
 v_fma_mix_f32 v105, v222, v53, v61 op_sel:[1,0,0] op_sel_hi:[1,0,0]
 v_fma_mix_f32 v106, v223, v54, v62 op_sel_hi:[1,0,0]
 v_mfma_f32_32x32x16_bf16 a[96:111], a[204:207], v[192:195], a[96:111]
 v_fma_mix_f32 v107, v223, v55, v63 op_sel:[1,0,0] op_sel_hi:[1,0,0]
 v_cvt_pk_bf16_f32 v222, v104, v105
 v_cvt_pk_bf16_f32 v223, v106, v107
 v_mfma_f32_32x32x16_bf16 a[112:127], a[204:207], v[196:199], a[112:127]
 s_waitcnt vmcnt(12)
 s_barrier
 s_add_u32 s44, s32, 0
 ds_read_b64_tr_b16 a[232:233], v66 offset:40960
 s_waitcnt lgkmcnt(14)
 ds_read_b64_tr_b16 a[234:235], v66 offset:41984
 s_waitcnt lgkmcnt(14)
 ds_read_b128 v[48:51], v23 offset:3712
 v_mfma_f32_32x32x16_bf16 a[0:15], a[208:211], v[200:203], a[0:15]
 s_waitcnt lgkmcnt(14)
 ds_read_b128 v[52:55], v23 offset:3728
 s_waitcnt lgkmcnt(14)
 ds_read_b128 v[56:59], v23 offset:3744
 s_waitcnt lgkmcnt(14)
 ds_read_b128 v[60:63], v23 offset:3760
 s_waitcnt lgkmcnt(8)
 v_fma_mix_f32 v100, v224, v32, v40 op_sel_hi:[1,0,0]
 v_fma_mix_f32 v101, v224, v33, v41 op_sel:[1,0,0] op_sel_hi:[1,0,0]
 v_fma_mix_f32 v102, v225, v34, v42 op_sel_hi:[1,0,0]
 v_mfma_f32_32x32x16_bf16 a[16:31], a[208:211], v[204:207], a[16:31]
 ds_read_b64_tr_b16 a[236:237], v67 offset:40960
 ds_read_b64_tr_b16 a[238:239], v67 offset:41984
 v_fma_mix_f32 v103, v225, v35, v43 op_sel:[1,0,0] op_sel_hi:[1,0,0]
 v_cvt_pk_bf16_f32 v224, v100, v101
 v_cvt_pk_bf16_f32 v225, v102, v103
 v_fma_mix_f32 v104, v226, v36, v44 op_sel_hi:[1,0,0]
 v_mfma_f32_32x32x16_bf16 a[32:47], a[212:215], v[200:203], a[32:47]
 s_add_u32 m0, s35, 0x24000
 s_nop 0
 buffer_load_dwordx4 v6, s[16:19], s44 offen nt lds
 v_fma_mix_f32 v105, v226, v37, v45 op_sel:[1,0,0] op_sel_hi:[1,0,0]
 v_fma_mix_f32 v106, v227, v38, v46 op_sel_hi:[1,0,0]
 v_fma_mix_f32 v107, v227, v39, v47 op_sel:[1,0,0] op_sel_hi:[1,0,0]
 v_mfma_f32_32x32x16_bf16 a[48:63], a[212:215], v[204:207], a[48:63]
 ds_read_b64_tr_b16 a[240:241], v64 offset:45056
 ds_read_b64_tr_b16 a[242:243], v64 offset:46080
 v_cvt_pk_bf16_f32 v226, v104, v105
 v_cvt_pk_bf16_f32 v227, v106, v107
 v_fma_mix_f32 v100, v228, v32, v40 op_sel_hi:[1,0,0]
 v_fma_mix_f32 v101, v228, v33, v41 op_sel:[1,0,0] op_sel_hi:[1,0,0]
 v_mfma_f32_32x32x16_bf16 a[64:79], a[216:219], v[200:203], a[64:79]
 v_fma_mix_f32 v102, v229, v34, v42 op_sel_hi:[1,0,0]
 v_fma_mix_f32 v103, v229, v35, v43 op_sel:[1,0,0] op_sel_hi:[1,0,0]
 v_cvt_pk_bf16_f32 v228, v100, v101
 v_mfma_f32_32x32x16_bf16 a[80:95], a[216:219], v[204:207], a[80:95]
 s_add_u32 m0, s35, 0x24000
 s_nop 0
 buffer_load_dwordx4 v7, s[16:19], s44 offen offset:1024 nt lds
 ds_read_b64_tr_b16 a[244:245], v65 offset:45056
 ds_read_b64_tr_b16 a[246:247], v65 offset:46080
 v_cvt_pk_bf16_f32 v229, v102, v103
 v_fma_mix_f32 v104, v230, v36, v44 op_sel_hi:[1,0,0]
 v_mfma_f32_32x32x16_bf16 a[96:111], a[220:223], v[200:203], a[96:111]
 v_fma_mix_f32 v105, v230, v37, v45 op_sel:[1,0,0] op_sel_hi:[1,0,0]
 v_fma_mix_f32 v106, v231, v38, v46 op_sel_hi:[1,0,0]
 v_fma_mix_f32 v107, v231, v39, v47 op_sel:[1,0,0] op_sel_hi:[1,0,0]
 v_cvt_pk_bf16_f32 v230, v104, v105
 v_cvt_pk_bf16_f32 v231, v106, v107
 v_mfma_f32_32x32x16_bf16 a[112:127], a[220:223], v[204:207], a[112:127]
 ds_read_b64_tr_b16 a[248:249], v66 offset:45056
 s_waitcnt lgkmcnt(14)
 ds_read_b64_tr_b16 a[250:251], v66 offset:46080
 s_waitcnt lgkmcnt(14)
 ds_read_b128 v[32:35], v23 offset:3840
 s_waitcnt lgkmcnt(14)
 ds_read_b128 v[36:39], v23 offset:3856
 s_waitcnt lgkmcnt(14)
 ds_read_b128 v[40:43], v23 offset:3872
 s_waitcnt lgkmcnt(14)
 ds_read_b128 v[44:47], v23 offset:3888
 v_mfma_f32_32x32x16_bf16 a[0:15], a[224:227], v[208:211], a[0:15]
 s_add_u32 m0, s35, 0x24000
 s_nop 0
 buffer_load_dwordx4 v8, s[16:19], s44 offen offset:2048 nt lds
 s_waitcnt lgkmcnt(8)
 v_fma_mix_f32 v100, v232, v48, v56 op_sel_hi:[1,0,0]
 v_fma_mix_f32 v101, v232, v49, v57 op_sel:[1,0,0] op_sel_hi:[1,0,0]
 v_fma_mix_f32 v102, v233, v50, v58 op_sel_hi:[1,0,0]
 v_mfma_f32_32x32x16_bf16 a[16:31], a[224:227], v[212:215], a[16:31]
 ds_read_b64_tr_b16 a[252:253], v67 offset:45056
 ds_read_b64_tr_b16 a[254:255], v67 offset:46080
 v_fma_mix_f32 v103, v233, v51, v59 op_sel:[1,0,0] op_sel_hi:[1,0,0]
 v_cvt_pk_bf16_f32 v232, v100, v101
 v_cvt_pk_bf16_f32 v233, v102, v103
 v_fma_mix_f32 v104, v234, v52, v60 op_sel_hi:[1,0,0]
 v_mfma_f32_32x32x16_bf16 a[32:47], a[228:231], v[208:211], a[32:47]
 v_fma_mix_f32 v105, v234, v53, v61 op_sel:[1,0,0] op_sel_hi:[1,0,0]
 v_fma_mix_f32 v106, v235, v54, v62 op_sel_hi:[1,0,0]
 v_fma_mix_f32 v107, v235, v55, v63 op_sel:[1,0,0] op_sel_hi:[1,0,0]
 v_mfma_f32_32x32x16_bf16 a[48:63], a[228:231], v[212:215], a[48:63]
 s_add_u32 m0, s35, 0x24000
 s_nop 0
 buffer_load_dwordx4 v9, s[16:19], s44 offen offset:3072 nt lds
 ds_read_b64_tr_b16 a[192:193], v64 offset:49152
 ds_read_b64_tr_b16 a[194:195], v64 offset:50176
 v_cvt_pk_bf16_f32 v234, v104, v105
 v_cvt_pk_bf16_f32 v235, v106, v107
 v_mfma_f32_32x32x16_bf16 a[64:79], a[232:235], v[208:211], a[64:79]
 v_fma_mix_f32 v100, v236, v48, v56 op_sel_hi:[1,0,0]
 v_fma_mix_f32 v101, v236, v49, v57 op_sel:[1,0,0] op_sel_hi:[1,0,0]
 v_fma_mix_f32 v102, v237, v50, v58 op_sel_hi:[1,0,0]
 v_fma_mix_f32 v103, v237, v51, v59 op_sel:[1,0,0] op_sel_hi:[1,0,0]
 v_cvt_pk_bf16_f32 v236, v100, v101
 v_mfma_f32_32x32x16_bf16 a[80:95], a[232:235], v[212:215], a[80:95]
 ds_read_b64_tr_b16 a[196:197], v65 offset:49152
 ds_read_b64_tr_b16 a[198:199], v65 offset:50176
 v_cvt_pk_bf16_f32 v237, v102, v103
 v_fma_mix_f32 v104, v238, v52, v60 op_sel_hi:[1,0,0]
 v_fma_mix_f32 v105, v238, v53, v61 op_sel:[1,0,0] op_sel_hi:[1,0,0]
 v_fma_mix_f32 v106, v239, v54, v62 op_sel_hi:[1,0,0]
 v_mfma_f32_32x32x16_bf16 a[96:111], a[236:239], v[208:211], a[96:111]
 s_add_u32 s43, s32, 0x4000
 v_fma_mix_f32 v107, v239, v55, v63 op_sel:[1,0,0] op_sel_hi:[1,0,0]
 v_cvt_pk_bf16_f32 v238, v104, v105
 v_cvt_pk_bf16_f32 v239, v106, v107
 v_mfma_f32_32x32x16_bf16 a[112:127], a[236:239], v[212:215], a[112:127]
 ds_read_b64_tr_b16 a[200:201], v66 offset:49152
 s_waitcnt lgkmcnt(14)
 ds_read_b64_tr_b16 a[202:203], v66 offset:50176
 s_waitcnt lgkmcnt(14)
 ds_read_b128 v[48:51], v23 offset:3968
 s_waitcnt lgkmcnt(14)
 ds_read_b128 v[52:55], v23 offset:3984
 s_waitcnt lgkmcnt(14)
 ds_read_b128 v[56:59], v23 offset:4000
 s_waitcnt lgkmcnt(14)
 ds_read_b128 v[60:63], v23 offset:4016
 v_mfma_f32_32x32x16_bf16 a[0:15], a[240:243], v[216:219], a[0:15]
 s_waitcnt lgkmcnt(8)
 v_fma_mix_f32 v100, v240, v32, v40 op_sel_hi:[1,0,0]
 v_fma_mix_f32 v101, v240, v33, v41 op_sel:[1,0,0] op_sel_hi:[1,0,0]
 v_fma_mix_f32 v102, v241, v34, v42 op_sel_hi:[1,0,0]
 v_mfma_f32_32x32x16_bf16 a[16:31], a[240:243], v[220:223], a[16:31]
 s_add_u32 m0, s35, 0x14000
 s_nop 0
 buffer_load_dwordx4 v6, s[16:19], s43 offen nt lds
 ds_read_b64_tr_b16 a[204:205], v67 offset:49152
 ds_read_b64_tr_b16 a[206:207], v67 offset:50176
 v_fma_mix_f32 v103, v241, v35, v43 op_sel:[1,0,0] op_sel_hi:[1,0,0]
 v_cvt_pk_bf16_f32 v240, v100, v101
 v_mfma_f32_32x32x16_bf16 a[32:47], a[244:247], v[216:219], a[32:47]
 v_cvt_pk_bf16_f32 v241, v102, v103
 v_fma_mix_f32 v104, v242, v36, v44 op_sel_hi:[1,0,0]
 v_fma_mix_f32 v105, v242, v37, v45 op_sel:[1,0,0] op_sel_hi:[1,0,0]
 v_fma_mix_f32 v106, v243, v38, v46 op_sel_hi:[1,0,0]
 v_fma_mix_f32 v107, v243, v39, v47 op_sel:[1,0,0] op_sel_hi:[1,0,0]
 v_mfma_f32_32x32x16_bf16 a[48:63], a[244:247], v[220:223], a[48:63]
 ds_read_b64_tr_b16 a[208:209], v64 offset:53248
 ds_read_b64_tr_b16 a[210:211], v64 offset:54272
 v_cvt_pk_bf16_f32 v242, v104, v105
 v_cvt_pk_bf16_f32 v243, v106, v107
 v_fma_mix_f32 v100, v244, v32, v40 op_sel_hi:[1,0,0]
 v_fma_mix_f32 v101, v244, v33, v41 op_sel:[1,0,0] op_sel_hi:[1,0,0]
 v_mfma_f32_32x32x16_bf16 a[64:79], a[248:251], v[216:219], a[64:79]
 s_add_u32 m0, s35, 0x14000
 s_nop 0
 buffer_load_dwordx4 v7, s[16:19], s43 offen offset:1024 nt lds
 v_fma_mix_f32 v102, v245, v34, v42 op_sel_hi:[1,0,0]
 v_fma_mix_f32 v103, v245, v35, v43 op_sel:[1,0,0] op_sel_hi:[1,0,0]
 v_cvt_pk_bf16_f32 v244, v100, v101
 v_mfma_f32_32x32x16_bf16 a[80:95], a[248:251], v[220:223], a[80:95]
 ds_read_b64_tr_b16 a[212:213], v65 offset:53248
 ds_read_b64_tr_b16 a[214:215], v65 offset:54272
 v_cvt_pk_bf16_f32 v245, v102, v103
 v_fma_mix_f32 v104, v246, v36, v44 op_sel_hi:[1,0,0]
 v_fma_mix_f32 v105, v246, v37, v45 op_sel:[1,0,0] op_sel_hi:[1,0,0]
 v_fma_mix_f32 v106, v247, v38, v46 op_sel_hi:[1,0,0]
 v_mfma_f32_32x32x16_bf16 a[96:111], a[252:255], v[216:219], a[96:111]
 v_fma_mix_f32 v107, v247, v39, v47 op_sel:[1,0,0] op_sel_hi:[1,0,0]
 v_cvt_pk_bf16_f32 v246, v104, v105
 v_cvt_pk_bf16_f32 v247, v106, v107
 v_mfma_f32_32x32x16_bf16 a[112:127], a[252:255], v[220:223], a[112:127]
 s_add_u32 m0, s35, 0x14000
 s_nop 0
 buffer_load_dwordx4 v8, s[16:19], s43 offen offset:2048 nt lds
 ds_read_b64_tr_b16 a[216:217], v66 offset:53248
 s_waitcnt lgkmcnt(14)
 ds_read_b64_tr_b16 a[218:219], v66 offset:54272
 s_waitcnt lgkmcnt(14)
 ds_read_b128 v[32:35], v23 offset:4096
 s_waitcnt lgkmcnt(14)
 ds_read_b128 v[36:39], v23 offset:4112
 v_mfma_f32_32x32x16_bf16 a[0:15], a[192:195], v[224:227], a[0:15]
 s_waitcnt lgkmcnt(14)
 ds_read_b128 v[40:43], v23 offset:4128
 s_waitcnt lgkmcnt(14)
 ds_read_b128 v[44:47], v23 offset:4144
 s_waitcnt lgkmcnt(8)
 v_fma_mix_f32 v100, v248, v48, v56 op_sel_hi:[1,0,0]
 v_fma_mix_f32 v101, v248, v49, v57 op_sel:[1,0,0] op_sel_hi:[1,0,0]
 v_fma_mix_f32 v102, v249, v50, v58 op_sel_hi:[1,0,0]
 v_mfma_f32_32x32x16_bf16 a[16:31], a[192:195], v[228:231], a[16:31]
 ds_read_b64_tr_b16 a[220:221], v67 offset:53248
 ds_read_b64_tr_b16 a[222:223], v67 offset:54272
 v_fma_mix_f32 v103, v249, v51, v59 op_sel:[1,0,0] op_sel_hi:[1,0,0]
 v_cvt_pk_bf16_f32 v248, v100, v101
 v_cvt_pk_bf16_f32 v249, v102, v103
 v_fma_mix_f32 v104, v250, v52, v60 op_sel_hi:[1,0,0]
 v_mfma_f32_32x32x16_bf16 a[32:47], a[196:199], v[224:227], a[32:47]
 s_add_u32 m0, s35, 0x14000
 s_nop 0
 buffer_load_dwordx4 v9, s[16:19], s43 offen offset:3072 nt lds
 v_fma_mix_f32 v105, v250, v53, v61 op_sel:[1,0,0] op_sel_hi:[1,0,0]
 v_fma_mix_f32 v106, v251, v54, v62 op_sel_hi:[1,0,0]
 v_fma_mix_f32 v107, v251, v55, v63 op_sel:[1,0,0] op_sel_hi:[1,0,0]
 v_mfma_f32_32x32x16_bf16 a[48:63], a[196:199], v[228:231], a[48:63]
 ds_read_b64_tr_b16 a[224:225], v64 offset:57344
 ds_read_b64_tr_b16 a[226:227], v64 offset:58368
 v_cvt_pk_bf16_f32 v250, v104, v105
 v_cvt_pk_bf16_f32 v251, v106, v107
 v_fma_mix_f32 v100, v252, v48, v56 op_sel_hi:[1,0,0]
 v_fma_mix_f32 v101, v252, v49, v57 op_sel:[1,0,0] op_sel_hi:[1,0,0]
 v_mfma_f32_32x32x16_bf16 a[64:79], a[200:203], v[224:227], a[64:79]
 v_fma_mix_f32 v102, v253, v50, v58 op_sel_hi:[1,0,0]
 v_fma_mix_f32 v103, v253, v51, v59 op_sel:[1,0,0] op_sel_hi:[1,0,0]
 v_cvt_pk_bf16_f32 v252, v100, v101
 v_mfma_f32_32x32x16_bf16 a[80:95], a[200:203], v[228:231], a[80:95]
 ds_read_b64_tr_b16 a[228:229], v65 offset:57344
 ds_read_b64_tr_b16 a[230:231], v65 offset:58368
 v_cvt_pk_bf16_f32 v253, v102, v103
 v_fma_mix_f32 v104, v254, v52, v60 op_sel_hi:[1,0,0]
 v_fma_mix_f32 v105, v254, v53, v61 op_sel:[1,0,0] op_sel_hi:[1,0,0]
 v_fma_mix_f32 v106, v255, v54, v62 op_sel_hi:[1,0,0]
 v_mfma_f32_32x32x16_bf16 a[96:111], a[204:207], v[224:227], a[96:111]
 v_fma_mix_f32 v107, v255, v55, v63 op_sel:[1,0,0] op_sel_hi:[1,0,0]
 v_cvt_pk_bf16_f32 v254, v104, v105
 v_cvt_pk_bf16_f32 v255, v106, v107
 v_mfma_f32_32x32x16_bf16 a[112:127], a[204:207], v[228:231], a[112:127]
 s_waitcnt vmcnt(8)
 s_barrier
 s_add_u32 s44, s32, 0
 ds_read_b64_tr_b16 a[232:233], v66 offset:57344
 s_waitcnt lgkmcnt(14)
 ds_read_b64_tr_b16 a[234:235], v66 offset:58368
 s_waitcnt lgkmcnt(14)
 ds_read_b128 v[48:51], v23 offset:4224
 v_mfma_f32_32x32x16_bf16 a[0:15], a[208:211], v[232:235], a[0:15]
 s_waitcnt lgkmcnt(14)
 ds_read_b128 v[52:55], v23 offset:4240
 s_waitcnt lgkmcnt(14)
 ds_read_b128 v[56:59], v23 offset:4256
 s_waitcnt lgkmcnt(14)
 ds_read_b128 v[60:63], v23 offset:4272
 s_waitcnt lgkmcnt(8)
 v_fma_mix_f32 v100, v128, v32, v40 op_sel_hi:[1,0,0]
 v_fma_mix_f32 v101, v128, v33, v41 op_sel:[1,0,0] op_sel_hi:[1,0,0]
 v_fma_mix_f32 v102, v129, v34, v42 op_sel_hi:[1,0,0]
 v_mfma_f32_32x32x16_bf16 a[16:31], a[208:211], v[236:239], a[16:31]
 ds_read_b64_tr_b16 a[236:237], v67 offset:57344
 ds_read_b64_tr_b16 a[238:239], v67 offset:58368
 v_fma_mix_f32 v103, v129, v35, v43 op_sel:[1,0,0] op_sel_hi:[1,0,0]
 v_cvt_pk_bf16_f32 v128, v100, v101
 v_cvt_pk_bf16_f32 v129, v102, v103
 v_fma_mix_f32 v104, v130, v36, v44 op_sel_hi:[1,0,0]
 v_mfma_f32_32x32x16_bf16 a[32:47], a[212:215], v[232:235], a[32:47]
 v_fma_mix_f32 v105, v130, v37, v45 op_sel:[1,0,0] op_sel_hi:[1,0,0]
 v_fma_mix_f32 v106, v131, v38, v46 op_sel_hi:[1,0,0]
 v_fma_mix_f32 v107, v131, v39, v47 op_sel:[1,0,0] op_sel_hi:[1,0,0]
 v_cvt_pk_bf16_f32 v130, v104, v105
 v_cvt_pk_bf16_f32 v131, v106, v107
 v_fma_mix_f32 v100, v132, v32, v40 op_sel_hi:[1,0,0]
 v_mfma_f32_32x32x16_bf16 a[48:63], a[212:215], v[236:239], a[48:63]
 s_add_u32 m0, s35, 0x18000
 s_nop 0
 buffer_load_dwordx4 v10, s[20:23], s44 offen nt lds
 ds_read_b64_tr_b16 a[240:241], v64 offset:61440
 ds_read_b64_tr_b16 a[242:243], v64 offset:62464
 v_fma_mix_f32 v101, v132, v33, v41 op_sel:[1,0,0] op_sel_hi:[1,0,0]
 v_fma_mix_f32 v102, v133, v34, v42 op_sel_hi:[1,0,0]
 v_mfma_f32_32x32x16_bf16 a[64:79], a[216:219], v[232:235], a[64:79]
 v_fma_mix_f32 v103, v133, v35, v43 op_sel:[1,0,0] op_sel_hi:[1,0,0]
 v_cvt_pk_bf16_f32 v132, v100, v101
 v_cvt_pk_bf16_f32 v133, v102, v103
 v_fma_mix_f32 v104, v134, v36, v44 op_sel_hi:[1,0,0]
 v_fma_mix_f32 v105, v134, v37, v45 op_sel:[1,0,0] op_sel_hi:[1,0,0]
 v_fma_mix_f32 v106, v135, v38, v46 op_sel_hi:[1,0,0]
 v_mfma_f32_32x32x16_bf16 a[80:95], a[216:219], v[236:239], a[80:95]
 ds_read_b64_tr_b16 a[244:245], v65 offset:61440
 ds_read_b64_tr_b16 a[246:247], v65 offset:62464
 v_fma_mix_f32 v107, v135, v39, v47 op_sel:[1,0,0] op_sel_hi:[1,0,0]
 v_cvt_pk_bf16_f32 v134, v104, v105
 v_cvt_pk_bf16_f32 v135, v106, v107
 ds_read_b128 v[32:35], v23 offset:4352
 v_mfma_f32_32x32x16_bf16 a[96:111], a[220:223], v[232:235], a[96:111]
 s_waitcnt lgkmcnt(14)
 ds_read_b128 v[36:39], v23 offset:4368
 s_waitcnt lgkmcnt(14)
 ds_read_b128 v[40:43], v23 offset:4384
 s_waitcnt lgkmcnt(14)
 ds_read_b128 v[44:47], v23 offset:4400
 s_waitcnt lgkmcnt(8)
 v_fma_mix_f32 v100, v136, v48, v56 op_sel_hi:[1,0,0]
 v_fma_mix_f32 v101, v136, v49, v57 op_sel:[1,0,0] op_sel_hi:[1,0,0]
 v_fma_mix_f32 v102, v137, v50, v58 op_sel_hi:[1,0,0]
 v_mfma_f32_32x32x16_bf16 a[112:127], a[220:223], v[236:239], a[112:127]
 s_add_u32 m0, s35, 0x18000
 s_nop 0
 buffer_load_dwordx4 v10, s[20:23], s44 offen offset:1024 nt lds
 ds_read_b64_tr_b16 a[248:249], v66 offset:61440
 ds_read_b64_tr_b16 a[250:251], v66 offset:62464
 v_fma_mix_f32 v103, v137, v51, v59 op_sel:[1,0,0] op_sel_hi:[1,0,0]
 v_cvt_pk_bf16_f32 v136, v100, v101
 v_mfma_f32_32x32x16_bf16 a[0:15], a[224:227], v[240:243], a[0:15]
 v_cvt_pk_bf16_f32 v137, v102, v103
 v_fma_mix_f32 v104, v138, v52, v60 op_sel_hi:[1,0,0]
 v_fma_mix_f32 v105, v138, v53, v61 op_sel:[1,0,0] op_sel_hi:[1,0,0]
 v_fma_mix_f32 v106, v139, v54, v62 op_sel_hi:[1,0,0]
 v_fma_mix_f32 v107, v139, v55, v63 op_sel:[1,0,0] op_sel_hi:[1,0,0]
 v_cvt_pk_bf16_f32 v138, v104, v105
 v_mfma_f32_32x32x16_bf16 a[16:31], a[224:227], v[244:247], a[16:31]
 ds_read_b64_tr_b16 a[252:253], v67 offset:61440
 ds_read_b64_tr_b16 a[254:255], v67 offset:62464
 v_cvt_pk_bf16_f32 v139, v106, v107
 v_fma_mix_f32 v100, v140, v48, v56 op_sel_hi:[1,0,0]
 v_fma_mix_f32 v101, v140, v49, v57 op_sel:[1,0,0] op_sel_hi:[1,0,0]
 v_fma_mix_f32 v102, v141, v50, v58 op_sel_hi:[1,0,0]
 v_mfma_f32_32x32x16_bf16 a[32:47], a[228:231], v[240:243], a[32:47]
 v_fma_mix_f32 v103, v141, v51, v59 op_sel:[1,0,0] op_sel_hi:[1,0,0]
 v_cvt_pk_bf16_f32 v140, v100, v101
 v_cvt_pk_bf16_f32 v141, v102, v103
 v_fma_mix_f32 v104, v142, v52, v60 op_sel_hi:[1,0,0]
 v_fma_mix_f32 v105, v142, v53, v61 op_sel:[1,0,0] op_sel_hi:[1,0,0]
 v_fma_mix_f32 v106, v143, v54, v62 op_sel_hi:[1,0,0]
 v_mfma_f32_32x32x16_bf16 a[48:63], a[228:231], v[244:247], a[48:63]
 s_add_u32 m0, s35, 0x18000
 s_nop 0
 buffer_load_dwordx4 v10, s[20:23], s44 offen offset:2048 nt lds
 ds_read_b64_tr_b16 a[192:193], v64
 ds_read_b64_tr_b16 a[194:195], v64 offset:1024
 v_fma_mix_f32 v107, v143, v55, v63 op_sel:[1,0,0] op_sel_hi:[1,0,0]
 v_cvt_pk_bf16_f32 v142, v104, v105
 v_mfma_f32_32x32x16_bf16 a[64:79], a[232:235], v[240:243], a[64:79]
 v_cvt_pk_bf16_f32 v143, v106, v107
 ds_read_b128 v[48:51], v23 offset:4480
 s_waitcnt lgkmcnt(14)
 ds_read_b128 v[52:55], v23 offset:4496
 s_waitcnt lgkmcnt(14)
 ds_read_b128 v[56:59], v23 offset:4512
 s_waitcnt lgkmcnt(14)
 ds_read_b128 v[60:63], v23 offset:4528
 s_waitcnt lgkmcnt(8)
 v_fma_mix_f32 v100, v144, v32, v40 op_sel_hi:[1,0,0]
 v_mfma_f32_32x32x16_bf16 a[80:95], a[232:235], v[244:247], a[80:95]
 ds_read_b64_tr_b16 a[196:197], v64 offset:4096
 ds_read_b64_tr_b16 a[198:199], v64 offset:5120
 v_fma_mix_f32 v101, v144, v33, v41 op_sel:[1,0,0] op_sel_hi:[1,0,0]
 v_fma_mix_f32 v102, v145, v34, v42 op_sel_hi:[1,0,0]
 v_fma_mix_f32 v103, v145, v35, v43 op_sel:[1,0,0] op_sel_hi:[1,0,0]
 v_cvt_pk_bf16_f32 v144, v100, v101
 v_mfma_f32_32x32x16_bf16 a[96:111], a[236:239], v[240:243], a[96:111]
 v_cvt_pk_bf16_f32 v145, v102, v103
 v_fma_mix_f32 v104, v146, v36, v44 op_sel_hi:[1,0,0]
 v_fma_mix_f32 v105, v146, v37, v45 op_sel:[1,0,0] op_sel_hi:[1,0,0]
 v_fma_mix_f32 v106, v147, v38, v46 op_sel_hi:[1,0,0]
 v_fma_mix_f32 v107, v147, v39, v47 op_sel:[1,0,0] op_sel_hi:[1,0,0]
 v_cvt_pk_bf16_f32 v146, v104, v105
 v_mfma_f32_32x32x16_bf16 a[112:127], a[236:239], v[244:247], a[112:127]
 s_add_u32 m0, s35, 0x18000
 s_nop 0
 buffer_load_dwordx4 v10, s[20:23], s44 offen offset:3072 nt lds
 ds_read_b64_tr_b16 a[200:201], v64 offset:8192
 ds_read_b64_tr_b16 a[202:203], v64 offset:9216
 v_cvt_pk_bf16_f32 v147, v106, v107
 v_fma_mix_f32 v100, v148, v32, v40 op_sel_hi:[1,0,0]
 v_mfma_f32_32x32x16_bf16 a[0:15], a[240:243], v[248:251], a[0:15]
 v_fma_mix_f32 v101, v148, v33, v41 op_sel:[1,0,0] op_sel_hi:[1,0,0]
 v_fma_mix_f32 v102, v149, v34, v42 op_sel_hi:[1,0,0]
 v_fma_mix_f32 v103, v149, v35, v43 op_sel:[1,0,0] op_sel_hi:[1,0,0]
 v_cvt_pk_bf16_f32 v148, v100, v101
 v_cvt_pk_bf16_f32 v149, v102, v103
 v_fma_mix_f32 v104, v150, v36, v44 op_sel_hi:[1,0,0]
 v_mfma_f32_32x32x16_bf16 a[16:31], a[240:243], v[252:255], a[16:31]
 ds_read_b64_tr_b16 a[204:205], v64 offset:12288
 ds_read_b64_tr_b16 a[206:207], v64 offset:13312
 v_fma_mix_f32 v105, v150, v37, v45 op_sel:[1,0,0] op_sel_hi:[1,0,0]
 v_fma_mix_f32 v106, v151, v38, v46 op_sel_hi:[1,0,0]
 v_fma_mix_f32 v107, v151, v39, v47 op_sel:[1,0,0] op_sel_hi:[1,0,0]
 v_cvt_pk_bf16_f32 v150, v104, v105
 v_mfma_f32_32x32x16_bf16 a[32:47], a[244:247], v[248:251], a[32:47]
 v_cvt_pk_bf16_f32 v151, v106, v107
 s_waitcnt lgkmcnt(4)
 v_fma_mix_f32 v100, v152, v48, v56 op_sel_hi:[1,0,0]
 v_fma_mix_f32 v101, v152, v49, v57 op_sel:[1,0,0] op_sel_hi:[1,0,0]
 v_fma_mix_f32 v102, v153, v50, v58 op_sel_hi:[1,0,0]
 v_fma_mix_f32 v103, v153, v51, v59 op_sel:[1,0,0] op_sel_hi:[1,0,0]
 v_cvt_pk_bf16_f32 v152, v100, v101
 v_mfma_f32_32x32x16_bf16 a[48:63], a[244:247], v[252:255], a[48:63]
 s_add_u32 s43, s32, 0x8000
 ds_read_b64_tr_b16 a[208:209], v65
 ds_read_b64_tr_b16 a[210:211], v65 offset:1024
 v_cvt_pk_bf16_f32 v153, v102, v103
 v_fma_mix_f32 v104, v154, v52, v60 op_sel_hi:[1,0,0]
 v_fma_mix_f32 v105, v154, v53, v61 op_sel:[1,0,0] op_sel_hi:[1,0,0]
 v_mfma_f32_32x32x16_bf16 a[64:79], a[248:251], v[248:251], a[64:79]
 v_fma_mix_f32 v106, v155, v54, v62 op_sel_hi:[1,0,0]
 v_fma_mix_f32 v107, v155, v55, v63 op_sel:[1,0,0] op_sel_hi:[1,0,0]
 v_cvt_pk_bf16_f32 v154, v104, v105
 v_cvt_pk_bf16_f32 v155, v106, v107
 v_fma_mix_f32 v100, v156, v48, v56 op_sel_hi:[1,0,0]
 v_fma_mix_f32 v101, v156, v49, v57 op_sel:[1,0,0] op_sel_hi:[1,0,0]
 v_mfma_f32_32x32x16_bf16 a[80:95], a[248:251], v[252:255], a[80:95]
 v_fma_mix_f32 v102, v157, v50, v58 op_sel_hi:[1,0,0]
 v_fma_mix_f32 v103, v157, v51, v59 op_sel:[1,0,0] op_sel_hi:[1,0,0]
 v_cvt_pk_bf16_f32 v156, v100, v101
 v_cvt_pk_bf16_f32 v157, v102, v103
 v_fma_mix_f32 v104, v158, v52, v60 op_sel_hi:[1,0,0]
 v_fma_mix_f32 v105, v158, v53, v61 op_sel:[1,0,0] op_sel_hi:[1,0,0]
 v_mfma_f32_32x32x16_bf16 a[96:111], a[252:255], v[248:251], a[96:111]
 v_fma_mix_f32 v106, v159, v54, v62 op_sel_hi:[1,0,0]
 v_fma_mix_f32 v107, v159, v55, v63 op_sel:[1,0,0] op_sel_hi:[1,0,0]
 v_cvt_pk_bf16_f32 v158, v104, v105
 v_cvt_pk_bf16_f32 v159, v106, v107
 ds_read_b64_tr_b16 a[212:213], v65 offset:4096
 ds_read_b64_tr_b16 a[214:215], v65 offset:5120
 v_mfma_f32_32x32x16_bf16 a[112:127], a[252:255], v[252:255], a[112:127]
 s_add_u32 m0, s35, 0x1c000
 s_nop 0
 buffer_load_dwordx4 v6, s[16:19], s43 offen nt lds
 ds_read_b64_tr_b16 a[216:217], v65 offset:8192
 ds_read_b64_tr_b16 a[218:219], v65 offset:9216
 v_mfma_f32_32x32x16_bf16 a[0:15], a[192:195], v[128:131], a[0:15]
 v_mfma_f32_32x32x16_bf16 a[16:31], a[192:195], v[132:135], a[16:31]
 ds_read_b64_tr_b16 a[220:221], v65 offset:12288
 ds_read_b64_tr_b16 a[222:223], v65 offset:13312
 v_mfma_f32_32x32x16_bf16 a[0:15], a[196:199], v[136:139], a[0:15]
 v_mfma_f32_32x32x16_bf16 a[16:31], a[196:199], v[140:143], a[16:31]
 s_add_u32 m0, s35, 0x1c000
 s_nop 0
 buffer_load_dwordx4 v7, s[16:19], s43 offen offset:1024 nt lds
 ds_read_b64_tr_b16 a[224:225], v66
 ds_read_b64_tr_b16 a[226:227], v66 offset:1024
 s_waitcnt lgkmcnt(4)
 v_mfma_f32_32x32x16_bf16 a[0:15], a[200:203], v[144:147], a[0:15]
 v_mfma_f32_32x32x16_bf16 a[16:31], a[200:203], v[148:151], a[16:31]
 ds_read_b64_tr_b16 a[228:229], v66 offset:4096
 ds_read_b64_tr_b16 a[230:231], v66 offset:5120
 v_mfma_f32_32x32x16_bf16 a[0:15], a[204:207], v[152:155], a[0:15]
 v_mfma_f32_32x32x16_bf16 a[16:31], a[204:207], v[156:159], a[16:31]
 s_add_u32 m0, s35, 0x1c000
 s_nop 0
 buffer_load_dwordx4 v8, s[16:19], s43 offen offset:2048 nt lds
 ds_read_b64_tr_b16 a[232:233], v66 offset:8192
 ds_read_b64_tr_b16 a[234:235], v66 offset:9216
 v_mfma_f32_32x32x16_bf16 a[32:47], a[208:211], v[128:131], a[32:47]
 s_nop 4
 v_accvgpr_read_b32 v24, a0
 v_accvgpr_read_b32 v25, a1
 v_cvt_pk_bf16_f32 v24, v24, v25
 v_accvgpr_write_b32 a128, v24
 v_accvgpr_read_b32 v26, a2
 v_accvgpr_read_b32 v27, a3
 v_mfma_f32_32x32x16_bf16 a[48:63], a[208:211], v[132:135], a[48:63]
 ds_read_b64_tr_b16 a[236:237], v66 offset:12288
 ds_read_b64_tr_b16 a[238:239], v66 offset:13312
 v_cvt_pk_bf16_f32 v26, v26, v27
 v_accvgpr_write_b32 a129, v26
 v_accvgpr_read_b32 v28, a4
 v_accvgpr_read_b32 v29, a5
 v_mfma_f32_32x32x16_bf16 a[32:47], a[212:215], v[136:139], a[32:47]
 v_cvt_pk_bf16_f32 v28, v28, v29
 v_accvgpr_write_b32 a130, v28
 v_accvgpr_read_b32 v30, a6
 v_accvgpr_read_b32 v31, a7
 v_cvt_pk_bf16_f32 v30, v30, v31
 v_accvgpr_write_b32 a131, v30
 v_mfma_f32_32x32x16_bf16 a[48:63], a[212:215], v[140:143], a[48:63]
 s_add_u32 m0, s35, 0x1c000
 s_nop 0
 buffer_load_dwordx4 v9, s[16:19], s43 offen offset:3072 nt lds
 ds_read_b64_tr_b16 a[240:241], v67
 ds_read_b64_tr_b16 a[242:243], v67 offset:1024
 v_accvgpr_read_b32 v24, a8
 v_accvgpr_read_b32 v25, a9
 v_mfma_f32_32x32x16_bf16 a[32:47], a[216:219], v[144:147], a[32:47]
 v_cvt_pk_bf16_f32 v24, v24, v25
 v_accvgpr_write_b32 a132, v24
 v_accvgpr_read_b32 v26, a10
 v_accvgpr_read_b32 v27, a11
 v_cvt_pk_bf16_f32 v26, v26, v27
 v_accvgpr_write_b32 a133, v26
 v_mfma_f32_32x32x16_bf16 a[48:63], a[216:219], v[148:151], a[48:63]
 ds_read_b64_tr_b16 a[244:245], v67 offset:4096
 ds_read_b64_tr_b16 a[246:247], v67 offset:5120
 v_accvgpr_read_b32 v28, a12
 v_accvgpr_read_b32 v29, a13
 v_cvt_pk_bf16_f32 v28, v28, v29
 v_accvgpr_write_b32 a134, v28
 s_waitcnt lgkmcnt(4)
 v_mfma_f32_32x32x16_bf16 a[32:47], a[220:223], v[152:155], a[32:47]
 v_accvgpr_read_b32 v30, a14
 v_accvgpr_read_b32 v31, a15
 v_cvt_pk_bf16_f32 v30, v30, v31
 v_accvgpr_write_b32 a135, v30
 v_accvgpr_read_b32 v24, a16
 v_accvgpr_read_b32 v25, a17
 v_mfma_f32_32x32x16_bf16 a[48:63], a[220:223], v[156:159], a[48:63]
 ds_read_b64_tr_b16 a[248:249], v67 offset:8192
 ds_read_b64_tr_b16 a[250:251], v67 offset:9216
 v_cvt_pk_bf16_f32 v24, v24, v25
 v_accvgpr_write_b32 a160, v24
 v_accvgpr_read_b32 v26, a18
 v_accvgpr_read_b32 v27, a19
 v_mfma_f32_32x32x16_bf16 a[64:79], a[224:227], v[128:131], a[64:79]
 v_cvt_pk_bf16_f32 v26, v26, v27
 v_accvgpr_write_b32 a161, v26
 v_accvgpr_read_b32 v28, a20
 v_accvgpr_read_b32 v29, a21
 v_cvt_pk_bf16_f32 v28, v28, v29
 v_accvgpr_write_b32 a162, v28
 v_mfma_f32_32x32x16_bf16 a[80:95], a[224:227], v[132:135], a[80:95]
 ds_read_b64_tr_b16 a[252:253], v67 offset:12288
 ds_read_b64_tr_b16 a[254:255], v67 offset:13312
 v_accvgpr_read_b32 v30, a22
 v_accvgpr_read_b32 v31, a23
 v_cvt_pk_bf16_f32 v30, v30, v31
 v_accvgpr_write_b32 a163, v30
 v_mfma_f32_32x32x16_bf16 a[64:79], a[228:231], v[136:139], a[64:79]
 v_accvgpr_read_b32 v24, a24
 v_accvgpr_read_b32 v25, a25
 v_cvt_pk_bf16_f32 v24, v24, v25
 v_accvgpr_write_b32 a164, v24
 v_accvgpr_read_b32 v26, a26
 v_accvgpr_read_b32 v27, a27
 v_mfma_f32_32x32x16_bf16 a[80:95], a[228:231], v[140:143], a[80:95]
 s_waitcnt vmcnt(12)
 s_barrier
 s_add_u32 s44, s32, 0x4000
 ds_read_b128 a[192:195], v84
 v_cvt_pk_bf16_f32 v26, v26, v27
 v_accvgpr_write_b32 a165, v26
 v_mfma_f32_32x32x16_bf16 a[64:79], a[232:235], v[144:147], a[64:79]
 v_accvgpr_read_b32 v28, a28
 v_accvgpr_read_b32 v29, a29
 v_cvt_pk_bf16_f32 v28, v28, v29
 v_accvgpr_write_b32 a166, v28
 v_accvgpr_read_b32 v30, a30
 v_accvgpr_read_b32 v31, a31
 v_mfma_f32_32x32x16_bf16 a[80:95], a[232:235], v[148:151], a[80:95]
 ds_read_b128 a[196:199], v85
 v_cvt_pk_bf16_f32 v30, v30, v31
 v_accvgpr_write_b32 a167, v30
 v_accvgpr_read_b32 v24, a32
 v_accvgpr_read_b32 v25, a33
 v_cvt_pk_bf16_f32 v24, v24, v25
 v_mfma_f32_32x32x16_bf16 a[64:79], a[236:239], v[152:155], a[64:79]
 v_accvgpr_write_b32 a136, v24
 v_accvgpr_read_b32 v26, a34
 v_accvgpr_read_b32 v27, a35
 v_cvt_pk_bf16_f32 v26, v26, v27
 v_accvgpr_write_b32 a137, v26
 v_accvgpr_read_b32 v28, a36
 v_mfma_f32_32x32x16_bf16 a[80:95], a[236:239], v[156:159], a[80:95]
 ds_read_b128 a[200:203], v86
 v_accvgpr_read_b32 v29, a37
 v_cvt_pk_bf16_f32 v28, v28, v29
 v_accvgpr_write_b32 a138, v28
 v_accvgpr_read_b32 v30, a38
 v_accvgpr_read_b32 v31, a39
 s_waitcnt lgkmcnt(2)
 v_mfma_f32_32x32x16_bf16 a[96:111], a[240:243], v[128:131], a[96:111]
 v_cvt_pk_bf16_f32 v30, v30, v31
 v_accvgpr_write_b32 a139, v30
 v_accvgpr_read_b32 v24, a40
 v_accvgpr_read_b32 v25, a41
 v_cvt_pk_bf16_f32 v24, v24, v25
 v_accvgpr_write_b32 a140, v24
 v_mfma_f32_32x32x16_bf16 a[112:127], a[240:243], v[132:135], a[112:127]
 s_add_u32 m0, s35, 0x20000
 s_nop 0
 buffer_load_dwordx4 v10, s[20:23], s44 offen nt lds
 ds_read_b128 a[204:207], v87
 v_accvgpr_read_b32 v26, a42
 v_accvgpr_read_b32 v27, a43
 v_cvt_pk_bf16_f32 v26, v26, v27
 v_mfma_f32_32x32x16_bf16 a[96:111], a[244:247], v[136:139], a[96:111]
 v_accvgpr_write_b32 a141, v26
 v_accvgpr_read_b32 v28, a44
 v_accvgpr_read_b32 v29, a45
 v_cvt_pk_bf16_f32 v28, v28, v29
 v_accvgpr_write_b32 a142, v28
 v_accvgpr_read_b32 v30, a46
 v_mfma_f32_32x32x16_bf16 a[112:127], a[244:247], v[140:143], a[112:127]
 ds_read_b128 a[208:211], v88
 v_accvgpr_read_b32 v31, a47
 v_cvt_pk_bf16_f32 v30, v30, v31
 v_accvgpr_write_b32 a143, v30
 v_accvgpr_read_b32 v24, a48
 v_accvgpr_read_b32 v25, a49
 v_mfma_f32_32x32x16_bf16 a[96:111], a[248:251], v[144:147], a[96:111]
 v_cvt_pk_bf16_f32 v24, v24, v25
 v_accvgpr_write_b32 a168, v24
 v_accvgpr_read_b32 v26, a50
 v_accvgpr_read_b32 v27, a51
 v_cvt_pk_bf16_f32 v26, v26, v27
 v_accvgpr_write_b32 a169, v26
 v_mfma_f32_32x32x16_bf16 a[112:127], a[248:251], v[148:151], a[112:127]
 v_accvgpr_read_b32 v28, a52
 v_accvgpr_read_b32 v29, a53
 v_cvt_pk_bf16_f32 v28, v28, v29
 v_accvgpr_write_b32 a170, v28
 v_accvgpr_read_b32 v30, a54
 v_accvgpr_read_b32 v31, a55
 v_mfma_f32_32x32x16_bf16 a[96:111], a[252:255], v[152:155], a[96:111]
 v_cvt_pk_bf16_f32 v30, v30, v31
 v_accvgpr_write_b32 a171, v30
 ds_read_b128 a[212:215], v89
 v_accvgpr_read_b32 v24, a56
 v_accvgpr_read_b32 v25, a57
 v_cvt_pk_bf16_f32 v24, v24, v25
 v_mfma_f32_32x32x16_bf16 a[112:127], a[252:255], v[156:159], a[112:127]
 s_add_u32 m0, s35, 0x20000
 s_nop 0
 buffer_load_dwordx4 v10, s[20:23], s44 offen offset:1024 nt lds
 v_accvgpr_write_b32 a172, v24
 v_accvgpr_read_b32 v26, a58
 v_accvgpr_read_b32 v27, a59
 v_cvt_pk_bf16_f32 v26, v26, v27
 v_mfma_f32_32x32x16_bf16 v[128:143], a[192:195], a[128:131], 0
 v_accvgpr_write_b32 a173, v26
 v_accvgpr_read_b32 v28, a60
 v_accvgpr_read_b32 v29, a61
 v_cvt_pk_bf16_f32 v28, v28, v29
 v_accvgpr_write_b32 a174, v28
 v_accvgpr_read_b32 v30, a62
 v_mfma_f32_32x32x16_bf16 v[144:159], a[192:195], a[160:163], 0
 v_accvgpr_read_b32 v31, a63
 v_cvt_pk_bf16_f32 v30, v30, v31
 v_accvgpr_write_b32 a175, v30
 v_accvgpr_read_b32 v24, a64
 v_accvgpr_read_b32 v25, a65
 v_cvt_pk_bf16_f32 v24, v24, v25
 s_waitcnt lgkmcnt(1)
 v_mfma_f32_32x32x16_bf16 v[128:143], a[196:199], a[132:135], v[128:143]
 v_accvgpr_write_b32 a144, v24
 v_accvgpr_read_b32 v26, a66
 v_accvgpr_read_b32 v27, a67
 v_cvt_pk_bf16_f32 v26, v26, v27
 v_accvgpr_write_b32 a145, v26
 v_accvgpr_read_b32 v28, a68
 v_mfma_f32_32x32x16_bf16 v[144:159], a[196:199], a[164:167], v[144:159]
 v_accvgpr_read_b32 v29, a69
 v_cvt_pk_bf16_f32 v28, v28, v29
 v_accvgpr_write_b32 a146, v28
 v_accvgpr_read_b32 v30, a70
 v_accvgpr_read_b32 v31, a71
 v_cvt_pk_bf16_f32 v30, v30, v31
 v_mfma_f32_32x32x16_bf16 v[128:143], a[200:203], a[136:139], v[128:143]
 v_accvgpr_write_b32 a147, v30
 ds_read_b128 a[216:219], v90
 v_accvgpr_read_b32 v24, a72
 v_accvgpr_read_b32 v25, a73
 v_cvt_pk_bf16_f32 v24, v24, v25
 v_accvgpr_write_b32 a148, v24
 v_mfma_f32_32x32x16_bf16 v[144:159], a[200:203], a[168:171], v[144:159]
 s_add_u32 m0, s35, 0x20000
 s_nop 0
 buffer_load_dwordx4 v10, s[20:23], s44 offen offset:2048 nt lds
 v_accvgpr_read_b32 v26, a74
 v_accvgpr_read_b32 v27, a75
 v_cvt_pk_bf16_f32 v26, v26, v27
 v_accvgpr_write_b32 a149, v26
 v_mfma_f32_32x32x16_bf16 v[128:143], a[204:207], a[140:143], v[128:143]
 v_accvgpr_read_b32 v28, a76
 v_accvgpr_read_b32 v29, a77
 v_cvt_pk_bf16_f32 v28, v28, v29
 v_accvgpr_write_b32 a150, v28
 v_accvgpr_read_b32 v30, a78
 v_accvgpr_read_b32 v31, a79
 v_mfma_f32_32x32x16_bf16 v[144:159], a[204:207], a[172:175], v[144:159]
 v_cvt_pk_bf16_f32 v30, v30, v31
 v_accvgpr_write_b32 a151, v30
 v_accvgpr_read_b32 v24, a80
 v_accvgpr_read_b32 v25, a81
 v_cvt_pk_bf16_f32 v24, v24, v25
 v_accvgpr_write_b32 a176, v24
 v_accvgpr_read_b32 v26, a82
 v_accvgpr_read_b32 v27, a83
 v_cvt_pk_bf16_f32 v26, v26, v27
 v_accvgpr_write_b32 a177, v26
 v_accvgpr_read_b32 v28, a84
 v_accvgpr_read_b32 v29, a85
 v_cvt_pk_bf16_f32 v28, v28, v29
 v_accvgpr_write_b32 a178, v28
 v_accvgpr_read_b32 v30, a86
 v_accvgpr_read_b32 v31, a87
 v_cvt_pk_bf16_f32 v30, v30, v31
 v_accvgpr_write_b32 a179, v30
 v_mfma_f32_32x32x16_bf16 v[128:143], a[208:211], a[144:147], v[128:143]
 ds_read_b128 a[220:223], v91
 v_accvgpr_read_b32 v24, a88
 v_accvgpr_read_b32 v25, a89
 v_cvt_pk_bf16_f32 v24, v24, v25
 v_accvgpr_write_b32 a180, v24
 v_accvgpr_read_b32 v26, a90
 v_mfma_f32_32x32x16_bf16 v[144:159], a[208:211], a[176:179], v[144:159]
 v_accvgpr_read_b32 v27, a91
 v_cvt_pk_bf16_f32 v26, v26, v27
 v_accvgpr_write_b32 a181, v26
 v_accvgpr_read_b32 v28, a92
 v_accvgpr_read_b32 v29, a93
 v_cvt_pk_bf16_f32 v28, v28, v29
 v_accvgpr_write_b32 a182, v28
 v_accvgpr_read_b32 v30, a94
 v_accvgpr_read_b32 v31, a95
 v_cvt_pk_bf16_f32 v30, v30, v31
 v_accvgpr_write_b32 a183, v30
 s_waitcnt lgkmcnt(1)
 v_mfma_f32_32x32x16_bf16 v[128:143], a[212:215], a[148:151], v[128:143]
 v_accvgpr_read_b32 v24, a96
 v_accvgpr_read_b32 v25, a97
 v_cvt_pk_bf16_f32 v24, v24, v25
 v_accvgpr_write_b32 a152, v24
 v_accvgpr_read_b32 v26, a98
 v_accvgpr_read_b32 v27, a99
 v_cvt_pk_bf16_f32 v26, v26, v27
 v_accvgpr_write_b32 a153, v26
 v_accvgpr_read_b32 v28, a100
 v_accvgpr_read_b32 v29, a101
 v_cvt_pk_bf16_f32 v28, v28, v29
 v_accvgpr_write_b32 a154, v28
 v_accvgpr_read_b32 v30, a102
 v_accvgpr_read_b32 v31, a103
 v_cvt_pk_bf16_f32 v30, v30, v31
 v_accvgpr_write_b32 a155, v30
 v_mfma_f32_32x32x16_bf16 v[144:159], a[212:215], a[180:183], v[144:159]
 ds_read_b128 a[224:227], v84 offset:8192
 v_accvgpr_read_b32 v24, a104
 v_accvgpr_read_b32 v25, a105
 v_cvt_pk_bf16_f32 v24, v24, v25
 v_accvgpr_write_b32 a156, v24
 v_accvgpr_read_b32 v26, a106
 v_accvgpr_read_b32 v27, a107
 v_cvt_pk_bf16_f32 v26, v26, v27
 v_accvgpr_write_b32 a157, v26
 v_accvgpr_read_b32 v28, a108
 v_accvgpr_read_b32 v29, a109
 v_cvt_pk_bf16_f32 v28, v28, v29
 v_accvgpr_write_b32 a158, v28
 v_accvgpr_read_b32 v30, a110
 v_accvgpr_read_b32 v31, a111
 v_cvt_pk_bf16_f32 v30, v30, v31
 v_accvgpr_write_b32 a159, v30
 v_accvgpr_read_b32 v24, a112
 v_accvgpr_read_b32 v25, a113
 v_cvt_pk_bf16_f32 v24, v24, v25
 v_accvgpr_write_b32 a184, v24
 v_accvgpr_read_b32 v26, a114
 v_accvgpr_read_b32 v27, a115
 v_cvt_pk_bf16_f32 v26, v26, v27
 v_accvgpr_write_b32 a185, v26
 v_accvgpr_read_b32 v28, a116
 v_accvgpr_read_b32 v29, a117
 v_cvt_pk_bf16_f32 v28, v28, v29
 v_accvgpr_write_b32 a186, v28
 v_accvgpr_read_b32 v30, a118
 v_accvgpr_read_b32 v31, a119
 v_cvt_pk_bf16_f32 v30, v30, v31
 v_accvgpr_write_b32 a187, v30
 v_mfma_f32_32x32x16_bf16 v[128:143], a[216:219], a[152:155], v[128:143]
 s_add_u32 m0, s35, 0x20000
 s_nop 0
 buffer_load_dwordx4 v10, s[20:23], s44 offen offset:3072 nt lds
 ds_read_b128 a[228:231], v85 offset:8192
 v_accvgpr_read_b32 v24, a120
 v_accvgpr_read_b32 v25, a121
 v_cvt_pk_bf16_f32 v24, v24, v25
 v_mfma_f32_32x32x16_bf16 v[144:159], a[216:219], a[184:187], v[144:159]
 v_accvgpr_write_b32 a188, v24
 v_accvgpr_read_b32 v26, a122
 v_accvgpr_read_b32 v27, a123
 v_cvt_pk_bf16_f32 v26, v26, v27
 v_accvgpr_write_b32 a189, v26
 v_accvgpr_read_b32 v28, a124
 v_accvgpr_read_b32 v29, a125
 v_cvt_pk_bf16_f32 v28, v28, v29
 v_accvgpr_write_b32 a190, v28
 v_accvgpr_read_b32 v30, a126
 v_accvgpr_read_b32 v31, a127
 v_cvt_pk_bf16_f32 v30, v30, v31
 v_accvgpr_write_b32 a191, v30
 s_waitcnt lgkmcnt(2)
 v_mfma_f32_32x32x16_bf16 v[128:143], a[220:223], a[156:159], v[128:143]
 ds_read_b128 a[232:235], v86 offset:8192
 ds_read_b128 a[236:239], v87 offset:8192
 ds_read_b128 a[240:243], v88 offset:8192
 ds_read_b128 a[244:247], v89 offset:8192
 v_mfma_f32_32x32x16_bf16 v[144:159], a[220:223], a[188:191], v[144:159]
 ds_read_b128 a[248:251], v90 offset:8192
 s_waitcnt lgkmcnt(6)
 v_mfma_f32_32x32x16_bf16 v[160:175], a[224:227], a[128:131], 0
 s_nop 3
 v_max3_f32 v17, v128, v129, v130
 v_max3_f32 v17, v17, v131, v132
 v_max3_f32 v17, v17, v133, v134
 v_max3_f32 v17, v17, v135, v136
 v_max3_f32 v17, v17, v137, v138
 v_max3_f32 v17, v17, v139, v140
 v_mfma_f32_32x32x16_bf16 v[176:191], a[224:227], a[160:163], 0
 ds_read_b128 a[252:255], v91 offset:8192
 v_max3_f32 v17, v17, v141, v142
 v_max_f32 v17, v17, v143
 v_mov_b32 v19, v17
 s_nop 1
 v_permlane32_swap_b32 v17, v19
 v_min_f32 v15, -v17, -v19
 s_waitcnt lgkmcnt(6)
 v_mfma_f32_32x32x16_bf16 v[160:175], a[228:231], a[132:135], v[160:175]
 v_mov_b32 v32, v15
 v_mov_b32 v33, v15
 v_mov_b32 v34, v15
 v_mov_b32 v35, v15
 v_mov_b32 v36, v15
 v_mov_b32 v37, v15
 v_mfma_f32_32x32x16_bf16 v[176:191], a[228:231], a[164:167], v[176:191]
 s_waitcnt vmcnt(12)
 s_barrier
 ds_read_b128 a[192:195], v76
 v_mov_b32 v38, v15
 v_mov_b32 v39, v15
 v_mov_b32 v40, v15
 s_waitcnt lgkmcnt(2)
 v_mfma_f32_32x32x16_bf16 v[160:175], a[232:235], a[136:139], v[160:175]
 v_mov_b32 v41, v15
 v_mov_b32 v42, v15
 v_mov_b32 v43, v15
 v_mov_b32 v44, v15
 v_mov_b32 v45, v15
 v_mov_b32 v46, v15
 v_mfma_f32_32x32x16_bf16 v[176:191], a[232:235], a[168:171], v[176:191]
 ds_read_b128 a[196:199], v77
 v_mov_b32 v47, v15
 v_max3_f32 v18, v144, v145, v146
 v_max3_f32 v18, v18, v147, v148
 v_max3_f32 v18, v18, v149, v150
 v_max3_f32 v18, v18, v151, v152
 v_mfma_f32_32x32x16_bf16 v[160:175], a[236:239], a[140:143], v[160:175]
 v_max3_f32 v18, v18, v153, v154
 v_max3_f32 v18, v18, v155, v156
 v_max3_f32 v18, v18, v157, v158
 v_max_f32 v18, v18, v159
 v_mov_b32 v20, v18
 s_nop 1
 v_permlane32_swap_b32 v18, v20
 v_mfma_f32_32x32x16_bf16 v[176:191], a[236:239], a[172:175], v[176:191]
 ds_read_b128 a[200:203], v78
 v_min_f32 v16, -v18, -v20
 v_mov_b32 v48, v16
 v_mov_b32 v49, v16
 v_mov_b32 v50, v16
 v_mov_b32 v51, v16
 v_mfma_f32_32x32x16_bf16 v[160:175], a[240:243], a[144:147], v[160:175]
 v_mov_b32 v52, v16
 v_mov_b32 v53, v16
 v_mov_b32 v54, v16
 v_mov_b32 v55, v16
 v_mov_b32 v56, v16
 v_mov_b32 v57, v16
 v_mfma_f32_32x32x16_bf16 v[176:191], a[240:243], a[176:179], v[176:191]
 v_mov_b32 v58, v16
 v_mov_b32 v59, v16
 v_mov_b32 v60, v16
 v_mov_b32 v61, v16
 v_mov_b32 v62, v16
 v_mov_b32 v63, v16
 v_mfma_f32_32x32x16_bf16 v[160:175], a[244:247], a[148:151], v[160:175]
 ds_read_b128 a[204:207], v79
 v_add_f32 v128, v15, v128
 v_exp_f32 v128, v128
 v_add_f32 v129, v15, v129
 v_mfma_f32_32x32x16_bf16 v[176:191], a[244:247], a[180:183], v[176:191]
 ds_read_b128 a[208:211], v80
 v_exp_f32 v129, v129
 v_add_f32 v11, v11, v128
 v_add_f32 v130, v15, v130
 v_mfma_f32_32x32x16_bf16 v[160:175], a[248:251], a[152:155], v[160:175]
 v_exp_f32 v130, v130
 v_add_f32 v11, v11, v129
 v_cvt_pk_bf16_f32 v128, v128, v129
 v_add_f32 v131, v15, v131
 v_mfma_f32_32x32x16_bf16 v[176:191], a[248:251], a[184:187], v[176:191]
 ds_read_b128 a[212:215], v81
 buffer_load_dword v121, v123, s[96:99], s39 offen
 v_exp_f32 v131, v131
 v_add_f32 v11, v11, v130
 s_waitcnt lgkmcnt(3)
 v_mfma_f32_32x32x16_bf16 v[160:175], a[252:255], a[156:159], v[160:175]
 v_add_f32 v132, v15, v132
 v_exp_f32 v132, v132
 v_add_f32 v11, v11, v131
 v_cvt_pk_bf16_f32 v129, v130, v131
 v_add_f32 v133, v15, v133
 v_mfma_f32_32x32x16_bf16 v[176:191], a[252:255], a[188:191], v[176:191]
 ds_read_b128 a[216:219], v82
 v_exp_f32 v133, v133
 v_add_f32 v11, v11, v132
 v_add_f32 v134, v15, v134
 v_mfma_f32_32x32x16_bf16 v[192:207], a[192:195], a[128:131], v[32:47]
 v_exp_f32 v134, v134
 v_add_f32 v11, v11, v133
 v_cvt_pk_bf16_f32 v130, v132, v133
 v_add_f32 v135, v15, v135
 v_mfma_f32_32x32x16_bf16 v[208:223], a[192:195], a[160:163], v[48:63]
 ds_read_b128 a[220:223], v83
 v_exp_f32 v135, v135
 v_add_f32 v11, v11, v134
 v_add_f32 v11, v11, v135
 v_cvt_pk_bf16_f32 v131, v134, v135
 v_mfma_f32_32x32x16_bf16 v[192:207], a[196:199], a[132:135], v[192:207]
 v_add_f32 v136, v15, v136
 v_exp_f32 v136, v136
 v_add_f32 v137, v15, v137
 v_exp_f32 v137, v137
 v_mfma_f32_32x32x16_bf16 v[208:223], a[196:199], a[164:167], v[208:223]
 ds_read_b128 a[224:227], v76 offset:8192
 v_add_f32 v11, v11, v136
 v_add_f32 v138, v15, v138
 v_exp_f32 v138, v138
 v_add_f32 v11, v11, v137
 v_mfma_f32_32x32x16_bf16 v[192:207], a[200:203], a[136:139], v[192:207]
 v_cvt_pk_bf16_f32 v136, v136, v137
 v_add_f32 v139, v15, v139
 v_exp_f32 v139, v139
 v_add_f32 v11, v11, v138
 v_add_f32 v140, v15, v140
 v_mfma_f32_32x32x16_bf16 v[208:223], a[200:203], a[168:171], v[208:223]
 ds_read_b128 a[228:231], v77 offset:8192
 v_exp_f32 v140, v140
 v_add_f32 v11, v11, v139
 v_cvt_pk_bf16_f32 v137, v138, v139
 v_add_f32 v141, v15, v141
 s_waitcnt lgkmcnt(2)
 v_mfma_f32_32x32x16_bf16 v[192:207], a[204:207], a[140:143], v[192:207]
 v_exp_f32 v141, v141
 v_add_f32 v11, v11, v140
 v_add_f32 v142, v15, v142
 v_exp_f32 v142, v142
 v_mfma_f32_32x32x16_bf16 v[208:223], a[204:207], a[172:175], v[208:223]
 ds_read_b128 a[232:235], v78 offset:8192
 v_add_f32 v11, v11, v141
 v_cvt_pk_bf16_f32 v138, v140, v141
 v_add_f32 v143, v15, v143
 v_exp_f32 v143, v143
 v_mfma_f32_32x32x16_bf16 v[192:207], a[208:211], a[144:147], v[192:207]
 v_add_f32 v11, v11, v142
 v_add_f32 v11, v11, v143
 v_cvt_pk_bf16_f32 v139, v142, v143
 v_add_f32 v144, v16, v144
 v_exp_f32 v144, v144
 v_mfma_f32_32x32x16_bf16 v[208:223], a[208:211], a[176:179], v[208:223]
 ds_read_b128 a[236:239], v79 offset:8192
 v_add_f32 v145, v16, v145
 v_exp_f32 v145, v145
 v_add_f32 v12, v12, v144
 v_add_f32 v146, v16, v146
 v_mfma_f32_32x32x16_bf16 v[192:207], a[212:215], a[148:151], v[192:207]
 v_exp_f32 v146, v146
 v_add_f32 v12, v12, v145
 v_cvt_pk_bf16_f32 v144, v144, v145
 v_add_f32 v147, v16, v147
 v_mfma_f32_32x32x16_bf16 v[208:223], a[212:215], a[180:183], v[208:223]
 ds_read_b128 a[240:243], v80 offset:8192
 v_exp_f32 v147, v147
 v_add_f32 v12, v12, v146
 v_add_f32 v148, v16, v148
 v_mfma_f32_32x32x16_bf16 v[192:207], a[216:219], a[152:155], v[192:207]
 v_exp_f32 v148, v148
 v_add_f32 v12, v12, v147
 v_cvt_pk_bf16_f32 v145, v146, v147
 v_add_f32 v149, v16, v149
 v_mfma_f32_32x32x16_bf16 v[208:223], a[216:219], a[184:187], v[208:223]
 ds_read_b128 a[244:247], v81 offset:8192
 v_exp_f32 v149, v149
 v_add_f32 v12, v12, v148
 v_add_f32 v150, v16, v150
 v_mfma_f32_32x32x16_bf16 v[192:207], a[220:223], a[156:159], v[192:207]
 v_exp_f32 v150, v150
 v_add_f32 v12, v12, v149
 v_cvt_pk_bf16_f32 v146, v148, v149
 v_add_f32 v151, v16, v151
 v_mfma_f32_32x32x16_bf16 v[208:223], a[220:223], a[188:191], v[208:223]
 ds_read_b128 a[248:251], v82 offset:8192
 v_exp_f32 v151, v151
 v_add_f32 v12, v12, v150
 v_add_f32 v12, v12, v151
 v_cvt_pk_bf16_f32 v147, v150, v151
 s_waitcnt lgkmcnt(2)
 v_mfma_f32_32x32x16_bf16 v[224:239], a[224:227], a[128:131], v[32:47]
 v_add_f32 v152, v16, v152
 v_exp_f32 v152, v152
 v_add_f32 v153, v16, v153
 v_exp_f32 v153, v153
 v_mfma_f32_32x32x16_bf16 v[240:255], a[224:227], a[160:163], v[48:63]
 ds_read_b128 a[252:255], v83 offset:8192
 v_add_f32 v12, v12, v152
 v_add_f32 v154, v16, v154
 v_exp_f32 v154, v154
 v_add_f32 v12, v12, v153
 v_mfma_f32_32x32x16_bf16 v[224:239], a[228:231], a[132:135], v[224:239]
 v_cvt_pk_bf16_f32 v152, v152, v153
 v_add_f32 v155, v16, v155
 v_exp_f32 v155, v155
 v_add_f32 v12, v12, v154
 v_add_f32 v156, v16, v156
 v_mfma_f32_32x32x16_bf16 v[240:255], a[228:231], a[164:167], v[240:255]
 s_waitcnt vmcnt(9)
 s_barrier
 s_add_u32 s43, s32, 0xc000
 ds_read_b64_tr_b16 a[192:193], v68 offset:16384
 ds_read_b64_tr_b16 a[194:195], v68 offset:17408
 v_mfma_f32_32x32x16_bf16 v[224:239], a[232:235], a[136:139], v[224:239]
 v_exp_f32 v156, v156
 v_add_f32 v12, v12, v155
 v_cvt_pk_bf16_f32 v153, v154, v155
 v_add_f32 v157, v16, v157
 v_mfma_f32_32x32x16_bf16 v[240:255], a[232:235], a[168:171], v[240:255]
 ds_read_b64_tr_b16 a[196:197], v69 offset:16384
 ds_read_b64_tr_b16 a[198:199], v69 offset:17408
 v_exp_f32 v157, v157
 v_add_f32 v12, v12, v156
 v_add_f32 v158, v16, v158
 v_mfma_f32_32x32x16_bf16 v[224:239], a[236:239], a[140:143], v[224:239]
 v_exp_f32 v158, v158
 v_add_f32 v12, v12, v157
 v_cvt_pk_bf16_f32 v154, v156, v157
 v_add_f32 v159, v16, v159
 v_mfma_f32_32x32x16_bf16 v[240:255], a[236:239], a[172:175], v[240:255]
 ds_read_b64_tr_b16 a[200:201], v70 offset:16384
 ds_read_b64_tr_b16 a[202:203], v70 offset:17408
 v_exp_f32 v159, v159
 v_add_f32 v12, v12, v158
 v_add_f32 v12, v12, v159
 v_mfma_f32_32x32x16_bf16 v[224:239], a[240:243], a[144:147], v[224:239]
 v_cvt_pk_bf16_f32 v155, v158, v159
 v_add_f32 v160, v15, v160
 v_exp_f32 v160, v160
 v_add_f32 v161, v15, v161
 v_mfma_f32_32x32x16_bf16 v[240:255], a[240:243], a[176:179], v[240:255]
 s_add_u32 m0, s35, 0x24000
 s_nop 0
 buffer_load_dwordx4 v6, s[16:19], s43 offen nt lds
 ds_read_b64_tr_b16 a[204:205], v71 offset:16384
 ds_read_b64_tr_b16 a[206:207], v71 offset:17408
 v_exp_f32 v161, v161
 s_waitcnt lgkmcnt(4)
 v_mfma_f32_32x32x16_bf16 v[224:239], a[244:247], a[148:151], v[224:239]
 v_add_f32 v11, v11, v160
 v_add_f32 v162, v15, v162
 v_exp_f32 v162, v162
 v_add_f32 v11, v11, v161
 v_cvt_pk_bf16_f32 v160, v160, v161
 v_mfma_f32_32x32x16_bf16 v[240:255], a[244:247], a[180:183], v[240:255]
 ds_read_b64_tr_b16 a[208:209], v68 offset:20480
 ds_read_b64_tr_b16 a[210:211], v68 offset:21504
 v_add_f32 v163, v15, v163
 v_exp_f32 v163, v163
 v_add_f32 v11, v11, v162
 v_mfma_f32_32x32x16_bf16 v[224:239], a[248:251], a[152:155], v[224:239]
 v_add_f32 v164, v15, v164
 v_exp_f32 v164, v164
 v_add_f32 v11, v11, v163
 v_cvt_pk_bf16_f32 v161, v162, v163
 v_add_f32 v165, v15, v165
 v_mfma_f32_32x32x16_bf16 v[240:255], a[248:251], a[184:187], v[240:255]
 ds_read_b64_tr_b16 a[212:213], v69 offset:20480
 ds_read_b64_tr_b16 a[214:215], v69 offset:21504
 v_exp_f32 v165, v165
 v_add_f32 v11, v11, v164
 v_add_f32 v166, v15, v166
 v_mfma_f32_32x32x16_bf16 v[224:239], a[252:255], a[156:159], v[224:239]
 v_exp_f32 v166, v166
 v_add_f32 v11, v11, v165
 v_cvt_pk_bf16_f32 v162, v164, v165
 v_add_f32 v167, v15, v167
 v_mfma_f32_32x32x16_bf16 v[240:255], a[252:255], a[188:191], v[240:255]
 s_add_u32 m0, s35, 0x24000
 s_nop 0
 buffer_load_dwordx4 v7, s[16:19], s43 offen offset:1024 nt lds
 ds_read_b64_tr_b16 a[216:217], v70 offset:20480
 ds_read_b64_tr_b16 a[218:219], v70 offset:21504
 v_exp_f32 v167, v167
 v_mfma_f32_32x32x16_bf16 a[0:15], a[192:195], v[128:131], 0
 v_add_f32 v11, v11, v166
 v_add_f32 v11, v11, v167
 v_cvt_pk_bf16_f32 v163, v166, v167
 v_add_f32 v168, v15, v168
 v_exp_f32 v168, v168
 v_mfma_f32_32x32x16_bf16 a[16:31], a[192:195], v[144:147], 0
 ds_read_b64_tr_b16 a[220:221], v71 offset:20480
 ds_read_b64_tr_b16 a[222:223], v71 offset:21504
 v_add_f32 v169, v15, v169
 v_exp_f32 v169, v169
 v_add_f32 v11, v11, v168
 v_mfma_f32_32x32x16_bf16 a[32:47], a[196:199], v[128:131], 0
 v_add_f32 v170, v15, v170
 v_exp_f32 v170, v170
 v_add_f32 v11, v11, v169
 v_cvt_pk_bf16_f32 v168, v168, v169
 v_add_f32 v171, v15, v171
 v_mfma_f32_32x32x16_bf16 a[48:63], a[196:199], v[144:147], 0
 ds_read_b64_tr_b16 a[224:225], v68 offset:24576
 ds_read_b64_tr_b16 a[226:227], v68 offset:25600
 v_exp_f32 v171, v171
 v_add_f32 v11, v11, v170
 v_add_f32 v172, v15, v172
 s_waitcnt lgkmcnt(4)
 v_mfma_f32_32x32x16_bf16 a[64:79], a[200:203], v[128:131], 0
 v_exp_f32 v172, v172
 v_add_f32 v11, v11, v171
 v_cvt_pk_bf16_f32 v169, v170, v171
 v_add_f32 v173, v15, v173
 v_mfma_f32_32x32x16_bf16 a[80:95], a[200:203], v[144:147], 0
 s_add_u32 m0, s35, 0x24000
 s_nop 0
 buffer_load_dwordx4 v8, s[16:19], s43 offen offset:2048 nt lds
 ds_read_b64_tr_b16 a[228:229], v69 offset:24576
 ds_read_b64_tr_b16 a[230:231], v69 offset:25600
 v_exp_f32 v173, v173
 v_mfma_f32_32x32x16_bf16 a[96:111], a[204:207], v[128:131], 0
 v_add_f32 v11, v11, v172
 v_add_f32 v174, v15, v174
 v_exp_f32 v174, v174
 v_add_f32 v11, v11, v173
 v_cvt_pk_bf16_f32 v170, v172, v173
 v_mfma_f32_32x32x16_bf16 a[112:127], a[204:207], v[144:147], 0
 ds_read_b64_tr_b16 a[232:233], v70 offset:24576
 ds_read_b64_tr_b16 a[234:235], v70 offset:25600
 v_add_f32 v175, v15, v175
 v_exp_f32 v175, v175
 v_add_f32 v11, v11, v174
 v_mfma_f32_32x32x16_bf16 a[0:15], a[208:211], v[136:139], a[0:15]
 v_add_f32 v11, v11, v175
 v_cvt_pk_bf16_f32 v171, v174, v175
 v_add_f32 v176, v16, v176
 v_exp_f32 v176, v176
 v_add_f32 v177, v16, v177
 v_mfma_f32_32x32x16_bf16 a[16:31], a[208:211], v[152:155], a[16:31]
 v_exp_f32 v177, v177
 v_add_f32 v12, v12, v176
 v_add_f32 v178, v16, v178
 v_exp_f32 v178, v178
 v_mfma_f32_32x32x16_bf16 a[32:47], a[212:215], v[136:139], a[32:47]
 v_add_f32 v12, v12, v177
 v_cvt_pk_bf16_f32 v176, v176, v177
 v_add_f32 v179, v16, v179
 v_exp_f32 v179, v179
 v_add_f32 v12, v12, v178
 v_mfma_f32_32x32x16_bf16 a[48:63], a[212:215], v[152:155], a[48:63]
 s_add_u32 m0, s35, 0x24000
 s_nop 0
 buffer_load_dwordx4 v9, s[16:19], s43 offen offset:3072 nt lds
 v_add_f32 v180, v16, v180
 v_exp_f32 v180, v180
 v_add_f32 v12, v12, v179
 v_mfma_f32_32x32x16_bf16 a[64:79], a[216:219], v[136:139], a[64:79]
 v_cvt_pk_bf16_f32 v177, v178, v179
 v_add_f32 v181, v16, v181
 v_exp_f32 v181, v181
 v_add_f32 v12, v12, v180
 v_add_f32 v182, v16, v182
 v_mfma_f32_32x32x16_bf16 a[80:95], a[216:219], v[152:155], a[80:95]
 v_exp_f32 v182, v182
 v_add_f32 v12, v12, v181
 v_cvt_pk_bf16_f32 v178, v180, v181
 v_add_f32 v183, v16, v183
 s_waitcnt lgkmcnt(0)
 v_mfma_f32_32x32x16_bf16 a[96:111], a[220:223], v[136:139], a[96:111]
 v_exp_f32 v183, v183
 v_add_f32 v12, v12, v182
 v_add_f32 v12, v12, v183
 v_cvt_pk_bf16_f32 v179, v182, v183
 ds_read_b64_tr_b16 a[236:237], v71 offset:24576
 v_mfma_f32_32x32x16_bf16 a[112:127], a[220:223], v[152:155], a[112:127]
 ds_read_b64_tr_b16 a[238:239], v71 offset:25600
 ds_read_b64_tr_b16 a[240:241], v68 offset:28672
 ds_read_b64_tr_b16 a[242:243], v68 offset:29696
 ds_read_b64_tr_b16 a[244:245], v69 offset:28672
 ds_read_b64_tr_b16 a[246:247], v69 offset:29696
 ds_read_b64_tr_b16 a[248:249], v70 offset:28672
 v_mfma_f32_32x32x16_bf16 a[0:15], a[224:227], v[160:163], a[0:15]
 ds_read_b64_tr_b16 a[250:251], v70 offset:29696
 v_add_f32 v184, v16, v184
 v_exp_f32 v184, v184
 v_add_f32 v185, v16, v185
 v_mfma_f32_32x32x16_bf16 a[16:31], a[224:227], v[176:179], a[16:31]
 v_exp_f32 v185, v185
 v_add_f32 v12, v12, v184
 v_add_f32 v186, v16, v186
 v_exp_f32 v186, v186
 v_mfma_f32_32x32x16_bf16 a[32:47], a[228:231], v[160:163], a[32:47]
 v_add_f32 v12, v12, v185
 v_cvt_pk_bf16_f32 v184, v184, v185
 v_add_f32 v187, v16, v187
 v_exp_f32 v187, v187
 v_add_f32 v12, v12, v186
 v_mfma_f32_32x32x16_bf16 a[48:63], a[228:231], v[176:179], a[48:63]
 s_waitcnt vmcnt(9)
 s_barrier
 s_add_u32 s44, s32, 0x8000
 v_add_f32 v188, v16, v188
 v_exp_f32 v188, v188
 v_mfma_f32_32x32x16_bf16 a[64:79], a[232:235], v[160:163], a[64:79]
 v_add_f32 v12, v12, v187
 v_cvt_pk_bf16_f32 v185, v186, v187
 v_add_f32 v189, v16, v189
 v_exp_f32 v189, v189
 v_add_f32 v12, v12, v188
 v_mfma_f32_32x32x16_bf16 a[80:95], a[232:235], v[176:179], a[80:95]
 v_add_f32 v190, v16, v190
 v_exp_f32 v190, v190
 v_add_f32 v12, v12, v189
 v_cvt_pk_bf16_f32 v186, v188, v189
 v_add_f32 v191, v16, v191
 s_waitcnt lgkmcnt(0)
 v_mfma_f32_32x32x16_bf16 a[96:111], a[236:239], v[160:163], a[96:111]
 v_exp_f32 v191, v191
 v_add_f32 v12, v12, v190
 v_add_f32 v12, v12, v191
 v_cvt_pk_bf16_f32 v187, v190, v191
 ds_read_b64_tr_b16 a[252:253], v71 offset:28672
 v_mfma_f32_32x32x16_bf16 a[112:127], a[236:239], v[176:179], a[112:127]
 ds_read_b64_tr_b16 a[254:255], v71 offset:29696
 buffer_load_dword v121, v123, s[96:99], s39 offen offset:2688
 ds_read_b128 a[192:195], v76 offset:32768
 ds_read_b128 a[196:199], v77 offset:32768
 ds_read_b128 a[200:203], v78 offset:32768
 v_mfma_f32_32x32x16_bf16 a[0:15], a[240:243], v[168:171], a[0:15]
 v_exp_f32 v192, v192
 v_exp_f32 v193, v193
 v_add_f32 v11, v11, v192
 v_mfma_f32_32x32x16_bf16 a[16:31], a[240:243], v[184:187], a[16:31]
 s_add_u32 m0, s35, 0x14000
 s_nop 0
 buffer_load_dwordx4 v10, s[20:23], s44 offen nt lds
 ds_read_b128 a[204:207], v79 offset:32768
 v_exp_f32 v194, v194
 v_add_f32 v11, v11, v193
 v_mfma_f32_32x32x16_bf16 a[32:47], a[244:247], v[168:171], a[32:47]
 v_cvt_pk_bf16_f32 v192, v192, v193
 v_exp_f32 v195, v195
 v_add_f32 v11, v11, v194
 v_exp_f32 v196, v196
 v_mfma_f32_32x32x16_bf16 a[48:63], a[244:247], v[184:187], a[48:63]
 ds_read_b128 a[208:211], v80 offset:32768
 v_add_f32 v11, v11, v195
 v_cvt_pk_bf16_f32 v193, v194, v195
 v_exp_f32 v197, v197
 v_add_f32 v11, v11, v196
 v_mfma_f32_32x32x16_bf16 a[64:79], a[248:251], v[168:171], a[64:79]
 v_exp_f32 v198, v198
 v_add_f32 v11, v11, v197
 v_cvt_pk_bf16_f32 v194, v196, v197
 v_exp_f32 v199, v199
 v_mfma_f32_32x32x16_bf16 a[80:95], a[248:251], v[184:187], a[80:95]
 ds_read_b128 a[212:215], v81 offset:32768
 v_add_f32 v11, v11, v198
 v_add_f32 v11, v11, v199
 v_cvt_pk_bf16_f32 v195, v198, v199
 v_exp_f32 v200, v200
 s_waitcnt lgkmcnt(2)
 v_mfma_f32_32x32x16_bf16 a[96:111], a[252:255], v[168:171], a[96:111]
 v_exp_f32 v201, v201
 v_add_f32 v11, v11, v200
 v_exp_f32 v202, v202
 v_add_f32 v11, v11, v201
 v_mfma_f32_32x32x16_bf16 a[112:127], a[252:255], v[184:187], a[112:127]
 s_add_u32 m0, s35, 0x14000
 s_nop 0
 buffer_load_dwordx4 v10, s[20:23], s44 offen offset:1024 nt lds
 ds_read_b128 a[216:219], v82 offset:32768
 v_cvt_pk_bf16_f32 v200, v200, v201
 v_exp_f32 v203, v203
 v_mfma_f32_32x32x16_bf16 v[128:143], a[192:195], a[128:131], v[32:47]
 v_add_f32 v11, v11, v202
 v_exp_f32 v204, v204
 v_add_f32 v11, v11, v203
 v_cvt_pk_bf16_f32 v201, v202, v203
 v_mfma_f32_32x32x16_bf16 v[144:159], a[192:195], a[160:163], v[48:63]
 ds_read_b128 a[220:223], v83 offset:32768
 v_exp_f32 v205, v205
 v_add_f32 v11, v11, v204
 v_exp_f32 v206, v206
 v_mfma_f32_32x32x16_bf16 v[128:143], a[196:199], a[132:135], v[128:143]
 v_add_f32 v11, v11, v205
 v_cvt_pk_bf16_f32 v202, v204, v205
 v_exp_f32 v207, v207
 v_add_f32 v11, v11, v206
 v_add_f32 v11, v11, v207
 v_mfma_f32_32x32x16_bf16 v[144:159], a[196:199], a[164:167], v[144:159]
 ds_read_b128 a[224:227], v76 offset:40960
 v_cvt_pk_bf16_f32 v203, v206, v207
 v_exp_f32 v208, v208
 v_exp_f32 v209, v209
 v_mfma_f32_32x32x16_bf16 v[128:143], a[200:203], a[136:139], v[128:143]
 v_add_f32 v12, v12, v208
 v_exp_f32 v210, v210
 v_add_f32 v12, v12, v209
 v_cvt_pk_bf16_f32 v208, v208, v209
 v_mfma_f32_32x32x16_bf16 v[144:159], a[200:203], a[168:171], v[144:159]
 s_add_u32 m0, s35, 0x14000
 s_nop 0
 buffer_load_dwordx4 v10, s[20:23], s44 offen offset:2048 nt lds
 ds_read_b128 a[228:231], v77 offset:40960
 v_exp_f32 v211, v211
 v_add_f32 v12, v12, v210
 v_mfma_f32_32x32x16_bf16 v[128:143], a[204:207], a[140:143], v[128:143]
 v_exp_f32 v212, v212
 v_add_f32 v12, v12, v211
 v_cvt_pk_bf16_f32 v209, v210, v211
 v_exp_f32 v213, v213
 v_mfma_f32_32x32x16_bf16 v[144:159], a[204:207], a[172:175], v[144:159]
 ds_read_b128 a[232:235], v78 offset:40960
 v_add_f32 v12, v12, v212
 v_exp_f32 v214, v214
 v_add_f32 v12, v12, v213
 v_cvt_pk_bf16_f32 v210, v212, v213
 s_waitcnt lgkmcnt(2)
 v_mfma_f32_32x32x16_bf16 v[128:143], a[208:211], a[144:147], v[128:143]
 v_exp_f32 v215, v215
 v_add_f32 v12, v12, v214
 v_add_f32 v12, v12, v215
 v_cvt_pk_bf16_f32 v211, v214, v215
 v_mfma_f32_32x32x16_bf16 v[144:159], a[208:211], a[176:179], v[144:159]
 ds_read_b128 a[236:239], v79 offset:40960
 v_exp_f32 v216, v216
 v_exp_f32 v217, v217
 v_add_f32 v12, v12, v216
 v_mfma_f32_32x32x16_bf16 v[128:143], a[212:215], a[148:151], v[128:143]
 v_exp_f32 v218, v218
 v_add_f32 v12, v12, v217
 v_cvt_pk_bf16_f32 v216, v216, v217
 v_exp_f32 v219, v219
 v_mfma_f32_32x32x16_bf16 v[144:159], a[212:215], a[180:183], v[144:159]
 s_add_u32 m0, s35, 0x14000
 s_nop 0
 buffer_load_dwordx4 v10, s[20:23], s44 offen offset:3072 nt lds
 ds_read_b128 a[240:243], v80 offset:40960
 v_add_f32 v12, v12, v218
 v_exp_f32 v220, v220
 v_mfma_f32_32x32x16_bf16 v[128:143], a[216:219], a[152:155], v[128:143]
 v_add_f32 v12, v12, v219
 v_cvt_pk_bf16_f32 v217, v218, v219
 v_exp_f32 v221, v221
 v_add_f32 v12, v12, v220
 v_mfma_f32_32x32x16_bf16 v[144:159], a[216:219], a[184:187], v[144:159]
 ds_read_b128 a[244:247], v81 offset:40960
 v_exp_f32 v222, v222
 v_add_f32 v12, v12, v221
 v_cvt_pk_bf16_f32 v218, v220, v221
 v_mfma_f32_32x32x16_bf16 v[128:143], a[220:223], a[156:159], v[128:143]
 v_exp_f32 v223, v223
 v_add_f32 v12, v12, v222
 v_add_f32 v12, v12, v223
 v_cvt_pk_bf16_f32 v219, v222, v223
 v_mfma_f32_32x32x16_bf16 v[144:159], a[220:223], a[188:191], v[144:159]
 ds_read_b128 a[248:251], v82 offset:40960
 v_exp_f32 v224, v224
 v_exp_f32 v225, v225
 v_add_f32 v11, v11, v224
 v_mfma_f32_32x32x16_bf16 v[160:175], a[224:227], a[128:131], v[32:47]
 v_exp_f32 v226, v226
 v_add_f32 v11, v11, v225
 v_cvt_pk_bf16_f32 v224, v224, v225
 v_exp_f32 v227, v227
 v_mfma_f32_32x32x16_bf16 v[176:191], a[224:227], a[160:163], v[48:63]
 ds_read_b128 a[252:255], v83 offset:40960
 v_add_f32 v11, v11, v226
 v_exp_f32 v228, v228
 v_add_f32 v11, v11, v227
 v_cvt_pk_bf16_f32 v225, v226, v227
 s_waitcnt lgkmcnt(2)
 v_mfma_f32_32x32x16_bf16 v[160:175], a[228:231], a[132:135], v[160:175]
 v_exp_f32 v229, v229
 v_add_f32 v11, v11, v228
 v_exp_f32 v230, v230
 v_add_f32 v11, v11, v229
 v_mfma_f32_32x32x16_bf16 v[176:191], a[228:231], a[164:167], v[176:191]
 s_waitcnt vmcnt(10)
 s_barrier
 s_add_u32 s43, s32, 0x10000
 ds_read_b64_tr_b16 a[192:193], v68 offset:49152
 ds_read_b64_tr_b16 a[194:195], v68 offset:50176
 v_cvt_pk_bf16_f32 v226, v228, v229
 v_mfma_f32_32x32x16_bf16 v[160:175], a[232:235], a[136:139], v[160:175]
 v_exp_f32 v231, v231
 v_add_f32 v11, v11, v230
 v_add_f32 v11, v11, v231
 v_cvt_pk_bf16_f32 v227, v230, v231
 v_mfma_f32_32x32x16_bf16 v[176:191], a[232:235], a[168:171], v[176:191]
 ds_read_b64_tr_b16 a[196:197], v69 offset:49152
 ds_read_b64_tr_b16 a[198:199], v69 offset:50176
 v_exp_f32 v232, v232
 v_exp_f32 v233, v233
 v_mfma_f32_32x32x16_bf16 v[160:175], a[236:239], a[140:143], v[160:175]
 v_add_f32 v11, v11, v232
 v_exp_f32 v234, v234
 v_add_f32 v11, v11, v233
 v_cvt_pk_bf16_f32 v232, v232, v233
 v_mfma_f32_32x32x16_bf16 v[176:191], a[236:239], a[172:175], v[176:191]
 ds_read_b64_tr_b16 a[200:201], v70 offset:49152
 ds_read_b64_tr_b16 a[202:203], v70 offset:50176
 v_exp_f32 v235, v235
 v_add_f32 v11, v11, v234
 v_mfma_f32_32x32x16_bf16 v[160:175], a[240:243], a[144:147], v[160:175]
 v_exp_f32 v236, v236
 v_add_f32 v11, v11, v235
 v_cvt_pk_bf16_f32 v233, v234, v235
 v_exp_f32 v237, v237
 v_mfma_f32_32x32x16_bf16 v[176:191], a[240:243], a[176:179], v[176:191]
 s_add_u32 m0, s35, 0x18000
 s_nop 0
 buffer_load_dwordx4 v6, s[16:19], s43 offen nt lds
 ds_read_b64_tr_b16 a[204:205], v71 offset:49152
 ds_read_b64_tr_b16 a[206:207], v71 offset:50176
 v_add_f32 v11, v11, v236
 v_mfma_f32_32x32x16_bf16 v[160:175], a[244:247], a[148:151], v[160:175]
 v_exp_f32 v238, v238
 v_add_f32 v11, v11, v237
 v_cvt_pk_bf16_f32 v234, v236, v237
 v_exp_f32 v239, v239
 v_mfma_f32_32x32x16_bf16 v[176:191], a[244:247], a[180:183], v[176:191]
 ds_read_b64_tr_b16 a[208:209], v68 offset:53248
 ds_read_b64_tr_b16 a[210:211], v68 offset:54272
 v_add_f32 v11, v11, v238
 v_add_f32 v11, v11, v239
 v_cvt_pk_bf16_f32 v235, v238, v239
 s_waitcnt lgkmcnt(4)
 v_mfma_f32_32x32x16_bf16 v[160:175], a[248:251], a[152:155], v[160:175]
 v_exp_f32 v240, v240
 v_exp_f32 v241, v241
 v_add_f32 v12, v12, v240
 v_mfma_f32_32x32x16_bf16 v[176:191], a[248:251], a[184:187], v[176:191]
 ds_read_b64_tr_b16 a[212:213], v69 offset:53248
 ds_read_b64_tr_b16 a[214:215], v69 offset:54272
 v_exp_f32 v242, v242
 v_add_f32 v12, v12, v241
 v_cvt_pk_bf16_f32 v240, v240, v241
 v_mfma_f32_32x32x16_bf16 v[160:175], a[252:255], a[156:159], v[160:175]
 v_exp_f32 v243, v243
 v_add_f32 v12, v12, v242
 v_exp_f32 v244, v244
 v_add_f32 v12, v12, v243
 v_mfma_f32_32x32x16_bf16 v[176:191], a[252:255], a[188:191], v[176:191]
 s_add_u32 m0, s35, 0x18000
 s_nop 0
 buffer_load_dwordx4 v7, s[16:19], s43 offen offset:1024 nt lds
 ds_read_b64_tr_b16 a[216:217], v70 offset:53248
 ds_read_b64_tr_b16 a[218:219], v70 offset:54272
 v_cvt_pk_bf16_f32 v241, v242, v243
 v_mfma_f32_32x32x16_bf16 a[0:15], a[192:195], v[192:195], a[0:15]
 v_exp_f32 v245, v245
 v_add_f32 v12, v12, v244
 v_exp_f32 v246, v246
 v_add_f32 v12, v12, v245
 v_mfma_f32_32x32x16_bf16 a[16:31], a[192:195], v[208:211], a[16:31]
 ds_read_b64_tr_b16 a[220:221], v71 offset:53248
 ds_read_b64_tr_b16 a[222:223], v71 offset:54272
 v_cvt_pk_bf16_f32 v242, v244, v245
 v_exp_f32 v247, v247
 v_add_f32 v12, v12, v246
 v_mfma_f32_32x32x16_bf16 a[32:47], a[196:199], v[192:195], a[32:47]
 v_add_f32 v12, v12, v247
 v_cvt_pk_bf16_f32 v243, v246, v247
 v_exp_f32 v248, v248
 v_exp_f32 v249, v249
 v_mfma_f32_32x32x16_bf16 a[48:63], a[196:199], v[208:211], a[48:63]
 ds_read_b64_tr_b16 a[224:225], v68 offset:57344
 ds_read_b64_tr_b16 a[226:227], v68 offset:58368
 v_add_f32 v12, v12, v248
 v_exp_f32 v250, v250
 v_add_f32 v12, v12, v249
 v_mfma_f32_32x32x16_bf16 a[64:79], a[200:203], v[192:195], a[64:79]
 v_cvt_pk_bf16_f32 v248, v248, v249
 v_exp_f32 v251, v251
 v_add_f32 v12, v12, v250
 v_exp_f32 v252, v252
 v_mfma_f32_32x32x16_bf16 a[80:95], a[200:203], v[208:211], a[80:95]
 s_add_u32 m0, s35, 0x18000
 s_nop 0
 buffer_load_dwordx4 v8, s[16:19], s43 offen offset:2048 nt lds
 ds_read_b64_tr_b16 a[228:229], v69 offset:57344
 ds_read_b64_tr_b16 a[230:231], v69 offset:58368
 buffer_load_dword v121, v123, s[80:83], s39 offen
 s_waitcnt lgkmcnt(4)
 v_mfma_f32_32x32x16_bf16 a[96:111], a[204:207], v[192:195], a[96:111]
 v_add_f32 v12, v12, v251
 v_cvt_pk_bf16_f32 v249, v250, v251
 v_exp_f32 v253, v253
 v_add_f32 v12, v12, v252
 v_mfma_f32_32x32x16_bf16 a[112:127], a[204:207], v[208:211], a[112:127]
 ds_read_b64_tr_b16 a[232:233], v70 offset:57344
 ds_read_b64_tr_b16 a[234:235], v70 offset:58368
 v_exp_f32 v254, v254
 v_add_f32 v12, v12, v253
 v_cvt_pk_bf16_f32 v250, v252, v253
 v_mfma_f32_32x32x16_bf16 a[0:15], a[208:211], v[200:203], a[0:15]
 v_exp_f32 v255, v255
 v_add_f32 v12, v12, v254
 v_add_f32 v12, v12, v255
 v_cvt_pk_bf16_f32 v251, v254, v255
 v_mfma_f32_32x32x16_bf16 a[16:31], a[208:211], v[216:219], a[16:31]
 ds_read_b64_tr_b16 a[236:237], v71 offset:57344
 ds_read_b64_tr_b16 a[238:239], v71 offset:58368
 v_exp_f32 v128, v128
 v_exp_f32 v129, v129
 v_mfma_f32_32x32x16_bf16 a[32:47], a[212:215], v[200:203], a[32:47]
 v_add_f32 v11, v11, v128
 v_exp_f32 v130, v130
 v_add_f32 v11, v11, v129
 v_cvt_pk_bf16_f32 v128, v128, v129
 v_mfma_f32_32x32x16_bf16 a[48:63], a[212:215], v[216:219], a[48:63]
 s_add_u32 m0, s35, 0x18000
 s_nop 0
 buffer_load_dwordx4 v9, s[16:19], s43 offen offset:3072 nt lds
 ds_read_b64_tr_b16 a[240:241], v68 offset:61440
 ds_read_b64_tr_b16 a[242:243], v68 offset:62464
 v_exp_f32 v131, v131
 v_mfma_f32_32x32x16_bf16 a[64:79], a[216:219], v[200:203], a[64:79]
 v_add_f32 v11, v11, v130
 v_exp_f32 v132, v132
 v_add_f32 v11, v11, v131
 v_cvt_pk_bf16_f32 v129, v130, v131
 v_mfma_f32_32x32x16_bf16 a[80:95], a[216:219], v[216:219], a[80:95]
 ds_read_b64_tr_b16 a[244:245], v69 offset:61440
 ds_read_b64_tr_b16 a[246:247], v69 offset:62464
 v_exp_f32 v133, v133
 v_add_f32 v11, v11, v132
 v_mfma_f32_32x32x16_bf16 a[96:111], a[220:223], v[200:203], a[96:111]
 v_exp_f32 v134, v134
 v_add_f32 v11, v11, v133
 v_cvt_pk_bf16_f32 v130, v132, v133
 v_exp_f32 v135, v135
 v_mfma_f32_32x32x16_bf16 a[112:127], a[220:223], v[216:219], a[112:127]
 ds_read_b64_tr_b16 a[248:249], v70 offset:61440
 ds_read_b64_tr_b16 a[250:251], v70 offset:62464
 v_add_f32 v11, v11, v134
 v_add_f32 v11, v11, v135
 v_cvt_pk_bf16_f32 v131, v134, v135
 s_waitcnt lgkmcnt(4)
 v_mfma_f32_32x32x16_bf16 a[0:15], a[224:227], v[224:227], a[0:15]
 v_exp_f32 v136, v136
 v_exp_f32 v137, v137
 v_add_f32 v11, v11, v136
 v_mfma_f32_32x32x16_bf16 a[16:31], a[224:227], v[240:243], a[16:31]
 ds_read_b64_tr_b16 a[252:253], v71 offset:61440
 ds_read_b64_tr_b16 a[254:255], v71 offset:62464
 v_exp_f32 v138, v138
 v_add_f32 v11, v11, v137
 v_cvt_pk_bf16_f32 v136, v136, v137
 v_mfma_f32_32x32x16_bf16 a[32:47], a[228:231], v[224:227], a[32:47]
 v_exp_f32 v139, v139
 v_add_f32 v11, v11, v138
 v_exp_f32 v140, v140
 v_add_f32 v11, v11, v139
 v_mfma_f32_32x32x16_bf16 a[48:63], a[228:231], v[240:243], a[48:63]
 s_waitcnt vmcnt(10)
 s_barrier
 s_add_u32 s44, s32, 0xc000
 ds_read_b128 a[192:195], v84
 v_cvt_pk_bf16_f32 v137, v138, v139
 v_mfma_f32_32x32x16_bf16 a[64:79], a[232:235], v[224:227], a[64:79]
 v_exp_f32 v141, v141
 v_add_f32 v11, v11, v140
 v_exp_f32 v142, v142
 v_add_f32 v11, v11, v141
 v_mfma_f32_32x32x16_bf16 a[80:95], a[232:235], v[240:243], a[80:95]
 ds_read_b128 a[196:199], v85
 v_cvt_pk_bf16_f32 v138, v140, v141
 v_exp_f32 v143, v143
 v_add_f32 v11, v11, v142
 v_add_f32 v11, v11, v143
 v_mfma_f32_32x32x16_bf16 a[96:111], a[236:239], v[224:227], a[96:111]
 v_cvt_pk_bf16_f32 v139, v142, v143
 v_exp_f32 v144, v144
 v_exp_f32 v145, v145
 v_add_f32 v12, v12, v144
 v_mfma_f32_32x32x16_bf16 a[112:127], a[236:239], v[240:243], a[112:127]
 ds_read_b128 a[200:203], v86
 v_exp_f32 v146, v146
 v_add_f32 v12, v12, v145
 v_cvt_pk_bf16_f32 v144, v144, v145
 v_mfma_f32_32x32x16_bf16 a[0:15], a[240:243], v[232:235], a[0:15]
 v_exp_f32 v147, v147
 v_add_f32 v12, v12, v146
 v_exp_f32 v148, v148
 v_add_f32 v12, v12, v147
 v_mfma_f32_32x32x16_bf16 a[16:31], a[240:243], v[248:251], a[16:31]
 s_add_u32 m0, s35, 0x1c000
 s_nop 0
 buffer_load_dwordx4 v10, s[20:23], s44 offen nt lds
 ds_read_b128 a[204:207], v87
 v_cvt_pk_bf16_f32 v145, v146, v147
 v_exp_f32 v149, v149
 s_waitcnt lgkmcnt(2)
 v_mfma_f32_32x32x16_bf16 a[32:47], a[244:247], v[232:235], a[32:47]
 v_add_f32 v12, v12, v148
 v_exp_f32 v150, v150
 v_add_f32 v12, v12, v149
 v_cvt_pk_bf16_f32 v146, v148, v149
 v_mfma_f32_32x32x16_bf16 a[48:63], a[244:247], v[248:251], a[48:63]
 ds_read_b128 a[208:211], v88
 v_exp_f32 v151, v151
 v_add_f32 v12, v12, v150
 v_add_f32 v12, v12, v151
 v_cvt_pk_bf16_f32 v147, v150, v151
 v_mfma_f32_32x32x16_bf16 a[64:79], a[248:251], v[232:235], a[64:79]
 v_exp_f32 v152, v152
 v_exp_f32 v153, v153
 v_add_f32 v12, v12, v152
 v_mfma_f32_32x32x16_bf16 a[80:95], a[248:251], v[248:251], a[80:95]
 ds_read_b128 a[212:215], v89
 v_exp_f32 v154, v154
 v_add_f32 v12, v12, v153
 v_cvt_pk_bf16_f32 v152, v152, v153
 v_mfma_f32_32x32x16_bf16 a[96:111], a[252:255], v[232:235], a[96:111]
 v_exp_f32 v155, v155
 v_add_f32 v12, v12, v154
 v_exp_f32 v156, v156
 v_add_f32 v12, v12, v155
 v_mfma_f32_32x32x16_bf16 a[112:127], a[252:255], v[248:251], a[112:127]
 s_add_u32 m0, s35, 0x1c000
 s_nop 0
 buffer_load_dwordx4 v10, s[20:23], s44 offen offset:1024 nt lds
 ds_read_b128 a[216:219], v90
 v_cvt_pk_bf16_f32 v153, v154, v155
 v_exp_f32 v157, v157
 v_mfma_f32_32x32x16_bf16 v[192:207], a[192:195], a[128:131], v[32:47]
 v_add_f32 v12, v12, v156
 v_exp_f32 v158, v158
 v_add_f32 v12, v12, v157
 v_cvt_pk_bf16_f32 v154, v156, v157
 v_mfma_f32_32x32x16_bf16 v[208:223], a[192:195], a[160:163], v[48:63]
 ds_read_b128 a[220:223], v91
 v_exp_f32 v159, v159
 v_add_f32 v12, v12, v158
 v_add_f32 v12, v12, v159
 v_cvt_pk_bf16_f32 v155, v158, v159
 v_mfma_f32_32x32x16_bf16 v[192:207], a[196:199], a[132:135], v[192:207]
 v_exp_f32 v160, v160
 v_exp_f32 v161, v161
 v_add_f32 v11, v11, v160
 v_mfma_f32_32x32x16_bf16 v[208:223], a[196:199], a[164:167], v[208:223]
 ds_read_b128 a[224:227], v84 offset:8192
 v_exp_f32 v162, v162
 v_add_f32 v11, v11, v161
 v_cvt_pk_bf16_f32 v160, v160, v161
 s_waitcnt lgkmcnt(2)
 v_mfma_f32_32x32x16_bf16 v[192:207], a[200:203], a[136:139], v[192:207]
 v_exp_f32 v163, v163
 v_add_f32 v11, v11, v162
 v_exp_f32 v164, v164
 v_add_f32 v11, v11, v163
 v_mfma_f32_32x32x16_bf16 v[208:223], a[200:203], a[168:171], v[208:223]
 s_add_u32 m0, s35, 0x1c000
 s_nop 0
 buffer_load_dwordx4 v10, s[20:23], s44 offen offset:2048 nt lds
 ds_read_b128 a[228:231], v85 offset:8192
 v_cvt_pk_bf16_f32 v161, v162, v163
 v_exp_f32 v165, v165
 v_mfma_f32_32x32x16_bf16 v[192:207], a[204:207], a[140:143], v[192:207]
 v_add_f32 v11, v11, v164
 v_exp_f32 v166, v166
 v_add_f32 v11, v11, v165
 v_cvt_pk_bf16_f32 v162, v164, v165
 v_mfma_f32_32x32x16_bf16 v[208:223], a[204:207], a[172:175], v[208:223]
 ds_read_b128 a[232:235], v86 offset:8192
 v_exp_f32 v167, v167
 v_add_f32 v11, v11, v166
 v_add_f32 v11, v11, v167
 v_cvt_pk_bf16_f32 v163, v166, v167
 v_mfma_f32_32x32x16_bf16 v[192:207], a[208:211], a[144:147], v[192:207]
 v_exp_f32 v168, v168
 v_exp_f32 v169, v169
 v_add_f32 v11, v11, v168
 v_mfma_f32_32x32x16_bf16 v[208:223], a[208:211], a[176:179], v[208:223]
 ds_read_b128 a[236:239], v87 offset:8192
 v_exp_f32 v170, v170
 v_add_f32 v11, v11, v169
 v_cvt_pk_bf16_f32 v168, v168, v169
 v_mfma_f32_32x32x16_bf16 v[192:207], a[212:215], a[148:151], v[192:207]
 v_exp_f32 v171, v171
 v_add_f32 v11, v11, v170
 v_exp_f32 v172, v172
 v_add_f32 v11, v11, v171
 v_mfma_f32_32x32x16_bf16 v[208:223], a[212:215], a[180:183], v[208:223]
 s_add_u32 m0, s35, 0x1c000
 s_nop 0
 buffer_load_dwordx4 v10, s[20:23], s44 offen offset:3072 nt lds
 ds_read_b128 a[240:243], v88 offset:8192
 v_cvt_pk_bf16_f32 v169, v170, v171
 v_exp_f32 v173, v173
 v_mfma_f32_32x32x16_bf16 v[192:207], a[216:219], a[152:155], v[192:207]
 v_add_f32 v11, v11, v172
 v_exp_f32 v174, v174
 v_add_f32 v11, v11, v173
 v_cvt_pk_bf16_f32 v170, v172, v173
 v_mfma_f32_32x32x16_bf16 v[208:223], a[216:219], a[184:187], v[208:223]
 ds_read_b128 a[244:247], v89 offset:8192
 v_exp_f32 v175, v175
 v_add_f32 v11, v11, v174
 v_add_f32 v11, v11, v175
 v_cvt_pk_bf16_f32 v171, v174, v175
 s_waitcnt lgkmcnt(2)
 v_mfma_f32_32x32x16_bf16 v[192:207], a[220:223], a[156:159], v[192:207]
 v_exp_f32 v176, v176
 v_exp_f32 v177, v177
 v_add_f32 v12, v12, v176
 v_mfma_f32_32x32x16_bf16 v[208:223], a[220:223], a[188:191], v[208:223]
 ds_read_b128 a[248:251], v90 offset:8192
 v_exp_f32 v178, v178
 v_add_f32 v12, v12, v177
 v_cvt_pk_bf16_f32 v176, v176, v177
 v_mfma_f32_32x32x16_bf16 v[224:239], a[224:227], a[128:131], v[32:47]
 v_exp_f32 v179, v179
 v_add_f32 v12, v12, v178
 v_exp_f32 v180, v180
 v_add_f32 v12, v12, v179
 v_mfma_f32_32x32x16_bf16 v[240:255], a[224:227], a[160:163], v[48:63]
 ds_read_b128 a[252:255], v91 offset:8192
 v_cvt_pk_bf16_f32 v177, v178, v179
 v_exp_f32 v181, v181
 v_add_f32 v12, v12, v180
 v_mfma_f32_32x32x16_bf16 v[224:239], a[228:231], a[132:135], v[224:239]
 v_exp_f32 v182, v182
 v_add_f32 v12, v12, v181
 v_cvt_pk_bf16_f32 v178, v180, v181
 v_exp_f32 v183, v183
 v_mfma_f32_32x32x16_bf16 v[240:255], a[228:231], a[164:167], v[240:255]
 s_waitcnt vmcnt(9)
 s_barrier
 s_add_u32 s43, s32, 0x14000
 ds_read_b64_tr_b16 a[192:193], v68
 ds_read_b64_tr_b16 a[194:195], v68 offset:1024
 v_add_f32 v12, v12, v182
 v_mfma_f32_32x32x16_bf16 v[224:239], a[232:235], a[136:139], v[224:239]
 v_add_f32 v12, v12, v183
 v_cvt_pk_bf16_f32 v179, v182, v183
 v_exp_f32 v184, v184
 v_exp_f32 v185, v185
 v_mfma_f32_32x32x16_bf16 v[240:255], a[232:235], a[168:171], v[240:255]
 ds_read_b64_tr_b16 a[196:197], v69
 ds_read_b64_tr_b16 a[198:199], v69 offset:1024
 v_add_f32 v12, v12, v184
 v_exp_f32 v186, v186
 v_add_f32 v12, v12, v185
 v_mfma_f32_32x32x16_bf16 v[224:239], a[236:239], a[140:143], v[224:239]
 v_cvt_pk_bf16_f32 v184, v184, v185
 v_exp_f32 v187, v187
 v_add_f32 v12, v12, v186
 v_exp_f32 v188, v188
 v_mfma_f32_32x32x16_bf16 v[240:255], a[236:239], a[172:175], v[240:255]
 ds_read_b64_tr_b16 a[200:201], v70
 ds_read_b64_tr_b16 a[202:203], v70 offset:1024
 v_add_f32 v12, v12, v187
 v_cvt_pk_bf16_f32 v185, v186, v187
 v_exp_f32 v189, v189
 s_waitcnt lgkmcnt(4)
 v_mfma_f32_32x32x16_bf16 v[224:239], a[240:243], a[144:147], v[224:239]
 v_add_f32 v12, v12, v188
 v_exp_f32 v190, v190
 v_add_f32 v12, v12, v189
 v_cvt_pk_bf16_f32 v186, v188, v189
 v_mfma_f32_32x32x16_bf16 v[240:255], a[240:243], a[176:179], v[240:255]
 s_add_u32 m0, s35, 0x20000
 s_nop 0
 buffer_load_dwordx4 v6, s[16:19], s43 offen nt lds
 ds_read_b64_tr_b16 a[204:205], v71
 ds_read_b64_tr_b16 a[206:207], v71 offset:1024
 buffer_load_dword v121, v123, s[80:83], s39 offen offset:2688
 v_mfma_f32_32x32x16_bf16 v[224:239], a[244:247], a[148:151], v[224:239]
 v_exp_f32 v191, v191
 v_add_f32 v12, v12, v190
 v_add_f32 v12, v12, v191
 v_cvt_pk_bf16_f32 v187, v190, v191
 s_movk_i32 s92, 0xe39
 v_mfma_f32_32x32x16_bf16 v[240:255], a[244:247], a[180:183], v[240:255]
 ds_read_b64_tr_b16 a[208:209], v68 offset:4096
 ds_read_b64_tr_b16 a[210:211], v68 offset:5120
 v_add_u32 v100, 0, v0
 v_mul_u32_u24 v101, v100, s92
 v_lshrrev_b32 v101, 16, v101
 v_mul_u32_u24 v102, 18, v101
 v_mfma_f32_32x32x16_bf16 v[224:239], a[248:251], a[152:155], v[224:239]
 v_sub_u32 v100, v100, v102
 v_and_b32 v102, 19, v101
 v_bfe_u32 v103, v101, 2, 1
 v_lshl_or_b32 v102, v103, 3, v102
 v_bfe_u32 v103, v101, 3, 1
 v_lshl_or_b32 v102, v103, 2, v102
 v_mfma_f32_32x32x16_bf16 v[240:255], a[248:251], a[184:187], v[240:255]
 ds_read_b64_tr_b16 a[212:213], v69 offset:4096
 ds_read_b64_tr_b16 a[214:215], v69 offset:5120
 v_mul_u32_u24 v102, 0x480, v102
 v_lshl_add_u32 v108, v100, 4, v102
 v_add_u32 v100, 64, v0
 v_mul_u32_u24 v101, v100, s92
 v_mfma_f32_32x32x16_bf16 v[224:239], a[252:255], a[156:159], v[224:239]
 v_lshrrev_b32 v101, 16, v101
 v_mul_u32_u24 v102, 18, v101
 v_sub_u32 v100, v100, v102
 v_and_b32 v102, 19, v101
 v_bfe_u32 v103, v101, 2, 1
 v_lshl_or_b32 v102, v103, 3, v102
 v_mfma_f32_32x32x16_bf16 v[240:255], a[252:255], a[188:191], v[240:255]
 s_add_u32 m0, s35, 0x20000
 s_nop 0
 buffer_load_dwordx4 v7, s[16:19], s43 offen offset:1024 nt lds
 ds_read_b64_tr_b16 a[216:217], v70 offset:4096
 ds_read_b64_tr_b16 a[218:219], v70 offset:5120
 v_bfe_u32 v103, v101, 3, 1
 v_lshl_or_b32 v102, v103, 2, v102
 v_mfma_f32_32x32x16_bf16 a[0:15], a[192:195], v[128:131], a[0:15]
 v_mul_u32_u24 v102, 0x480, v102
 v_lshl_add_u32 v109, v100, 4, v102
 v_subrev_u32 v109, 0x400, v109
 v_add_u32 v100, 0x80, v0
 v_mul_u32_u24 v101, v100, s92
 v_lshrrev_b32 v101, 16, v101
 v_mfma_f32_32x32x16_bf16 a[16:31], a[192:195], v[144:147], a[16:31]
 ds_read_b64_tr_b16 a[220:221], v71 offset:4096
 ds_read_b64_tr_b16 a[222:223], v71 offset:5120
 v_mul_u32_u24 v102, 18, v101
 v_sub_u32 v100, v100, v102
 v_and_b32 v102, 19, v101
 v_bfe_u32 v103, v101, 2, 1
 s_waitcnt lgkmcnt(4)
 v_mfma_f32_32x32x16_bf16 a[32:47], a[196:199], v[128:131], a[32:47]
 v_lshl_or_b32 v102, v103, 3, v102
 v_bfe_u32 v103, v101, 3, 1
 v_lshl_or_b32 v102, v103, 2, v102
 v_mul_u32_u24 v102, 0x480, v102
 v_lshl_add_u32 v110, v100, 4, v102
 v_subrev_u32 v110, 0x800, v110
 v_mfma_f32_32x32x16_bf16 a[48:63], a[196:199], v[144:147], a[48:63]
 ds_read_b64_tr_b16 a[224:225], v68 offset:8192
 ds_read_b64_tr_b16 a[226:227], v68 offset:9216
 v_add_u32 v100, 0xc0, v0
 v_mul_u32_u24 v101, v100, s92
 v_lshrrev_b32 v101, 16, v101
 v_mul_u32_u24 v102, 18, v101
 v_mfma_f32_32x32x16_bf16 a[64:79], a[200:203], v[128:131], a[64:79]
 v_sub_u32 v100, v100, v102
 v_and_b32 v102, 19, v101
 v_bfe_u32 v103, v101, 2, 1
 v_lshl_or_b32 v102, v103, 3, v102
 v_bfe_u32 v103, v101, 3, 1
 v_lshl_or_b32 v102, v103, 2, v102
 v_mfma_f32_32x32x16_bf16 a[80:95], a[200:203], v[144:147], a[80:95]
 s_add_u32 m0, s35, 0x20000
 s_nop 0
 buffer_load_dwordx4 v8, s[16:19], s43 offen offset:2048 nt lds
 ds_read_b64_tr_b16 a[228:229], v69 offset:8192
 ds_read_b64_tr_b16 a[230:231], v69 offset:9216
 v_mul_u32_u24 v102, 0x480, v102
 v_lshl_add_u32 v111, v100, 4, v102
 v_mfma_f32_32x32x16_bf16 a[96:111], a[204:207], v[128:131], a[96:111]
 v_subrev_u32 v111, 0xc00, v111
 v_add_u32 v100, 0x100, v0
 v_mul_u32_u24 v101, v100, s92
 v_lshrrev_b32 v101, 16, v101
 v_mul_u32_u24 v102, 18, v101
 v_sub_u32 v100, v100, v102
 v_mfma_f32_32x32x16_bf16 a[112:127], a[204:207], v[144:147], a[112:127]
 ds_read_b64_tr_b16 a[232:233], v70 offset:8192
 ds_read_b64_tr_b16 a[234:235], v70 offset:9216
 v_and_b32 v102, 19, v101
 v_bfe_u32 v103, v101, 2, 1
 v_lshl_or_b32 v102, v103, 3, v102
 v_bfe_u32 v103, v101, 3, 1
 v_mfma_f32_32x32x16_bf16 a[0:15], a[208:211], v[136:139], a[0:15]
 v_lshl_or_b32 v102, v103, 2, v102
 v_mul_u32_u24 v102, 0x480, v102
 v_lshl_add_u32 v112, v100, 4, v102
 v_add_u32 v100, 0x140, v0
 v_mul_u32_u24 v101, v100, s92
 v_lshrrev_b32 v101, 16, v101
 v_mfma_f32_32x32x16_bf16 a[16:31], a[208:211], v[152:155], a[16:31]
 ds_read_b64_tr_b16 a[236:237], v71 offset:8192
 ds_read_b64_tr_b16 a[238:239], v71 offset:9216
 v_mul_u32_u24 v102, 18, v101
 v_sub_u32 v100, v100, v102
 v_and_b32 v102, 19, v101
 v_bfe_u32 v103, v101, 2, 1
 v_mfma_f32_32x32x16_bf16 a[32:47], a[212:215], v[136:139], a[32:47]
 v_lshl_or_b32 v102, v103, 3, v102
 v_bfe_u32 v103, v101, 3, 1
 v_lshl_or_b32 v102, v103, 2, v102
 v_mul_u32_u24 v102, 0x480, v102
 v_lshl_add_u32 v113, v100, 4, v102
 v_subrev_u32 v113, 0x400, v113
 v_mfma_f32_32x32x16_bf16 a[48:63], a[212:215], v[152:155], a[48:63]
 s_add_u32 m0, s35, 0x20000
 s_nop 0
 buffer_load_dwordx4 v9, s[16:19], s43 offen offset:3072 nt lds
 ds_read_b64_tr_b16 a[240:241], v68 offset:12288
 ds_read_b64_tr_b16 a[242:243], v68 offset:13312
 v_add_u32 v100, 0x180, v0
 v_mul_u32_u24 v101, v100, s92
 s_waitcnt lgkmcnt(4)
 v_mfma_f32_32x32x16_bf16 a[64:79], a[216:219], v[136:139], a[64:79]
 v_lshrrev_b32 v101, 16, v101
 v_mul_u32_u24 v102, 18, v101
 v_sub_u32 v100, v100, v102
 v_and_b32 v102, 19, v101
 v_bfe_u32 v103, v101, 2, 1
 v_lshl_or_b32 v102, v103, 3, v102
 v_mfma_f32_32x32x16_bf16 a[80:95], a[216:219], v[152:155], a[80:95]
 ds_read_b64_tr_b16 a[244:245], v69 offset:12288
 ds_read_b64_tr_b16 a[246:247], v69 offset:13312
 v_bfe_u32 v103, v101, 3, 1
 v_lshl_or_b32 v102, v103, 2, v102
 v_mul_u32_u24 v102, 0x480, v102
 v_lshl_add_u32 v114, v100, 4, v102
 v_mfma_f32_32x32x16_bf16 a[96:111], a[220:223], v[136:139], a[96:111]
 v_subrev_u32 v114, 0x800, v114
 v_add_u32 v100, 0x1c0, v0
 v_mul_u32_u24 v101, v100, s92
 v_lshrrev_b32 v101, 16, v101
 v_mul_u32_u24 v102, 18, v101
 v_sub_u32 v100, v100, v102
 v_mfma_f32_32x32x16_bf16 a[112:127], a[220:223], v[152:155], a[112:127]
 ds_read_b64_tr_b16 a[248:249], v70 offset:12288
 ds_read_b64_tr_b16 a[250:251], v70 offset:13312
 v_and_b32 v102, 19, v101
 v_bfe_u32 v103, v101, 2, 1
 v_lshl_or_b32 v102, v103, 3, v102
 v_bfe_u32 v103, v101, 3, 1
 v_mfma_f32_32x32x16_bf16 a[0:15], a[224:227], v[160:163], a[0:15]
 v_lshl_or_b32 v102, v103, 2, v102
 v_mul_u32_u24 v102, 0x480, v102
 v_lshl_add_u32 v115, v100, 4, v102
 v_subrev_u32 v115, 0xc00, v115
 v_add_u32 v100, 0x200, v0
 v_mul_u32_u24 v101, v100, s92
 v_mfma_f32_32x32x16_bf16 a[16:31], a[224:227], v[176:179], a[16:31]
 ds_read_b64_tr_b16 a[252:253], v71 offset:12288
 ds_read_b64_tr_b16 a[254:255], v71 offset:13312
 v_lshrrev_b32 v101, 16, v101
 v_mul_u32_u24 v102, 18, v101
 v_sub_u32 v100, v100, v102
 v_and_b32 v102, 19, v101
 v_mfma_f32_32x32x16_bf16 a[32:47], a[228:231], v[160:163], a[32:47]
 v_bfe_u32 v103, v101, 2, 1
 v_lshl_or_b32 v102, v103, 3, v102
 v_bfe_u32 v103, v101, 3, 1
 v_lshl_or_b32 v102, v103, 2, v102
 v_mul_u32_u24 v102, 0x480, v102
 v_lshl_add_u32 v116, v100, 4, v102
 v_mfma_f32_32x32x16_bf16 a[48:63], a[228:231], v[176:179], a[48:63]
 s_waitcnt vmcnt(9)
 s_barrier
 s_add_u32 s44, s32, 0x10000
 ds_read_b128 a[192:195], v76 offset:16384
 v_exp_f32 v192, v192
 v_mfma_f32_32x32x16_bf16 a[64:79], a[232:235], v[160:163], a[64:79]
 v_exp_f32 v193, v193
 v_add_f32 v11, v11, v192
 v_exp_f32 v194, v194
 v_add_f32 v11, v11, v193
 v_mfma_f32_32x32x16_bf16 a[80:95], a[232:235], v[176:179], a[80:95]
 ds_read_b128 a[196:199], v77 offset:16384
 v_cvt_pk_bf16_f32 v192, v192, v193
 v_exp_f32 v195, v195
 v_add_f32 v11, v11, v194
 s_waitcnt lgkmcnt(2)
 v_mfma_f32_32x32x16_bf16 a[96:111], a[236:239], v[160:163], a[96:111]
 v_exp_f32 v196, v196
 v_add_f32 v11, v11, v195
 v_cvt_pk_bf16_f32 v193, v194, v195
 v_exp_f32 v197, v197
 v_mfma_f32_32x32x16_bf16 a[112:127], a[236:239], v[176:179], a[112:127]
 ds_read_b128 a[200:203], v78 offset:16384
 v_add_f32 v11, v11, v196
 v_exp_f32 v198, v198
 v_add_f32 v11, v11, v197
 v_cvt_pk_bf16_f32 v194, v196, v197
 v_mfma_f32_32x32x16_bf16 a[0:15], a[240:243], v[168:171], a[0:15]
 v_exp_f32 v199, v199
 v_add_f32 v11, v11, v198
 v_add_f32 v11, v11, v199
 v_cvt_pk_bf16_f32 v195, v198, v199
 v_mfma_f32_32x32x16_bf16 a[16:31], a[240:243], v[184:187], a[16:31]
 s_add_u32 m0, s35, 0x24000
 s_nop 0
 buffer_load_dwordx4 v10, s[20:23], s44 offen nt lds
 ds_read_b128 a[204:207], v79 offset:16384
 v_exp_f32 v200, v200
 v_mfma_f32_32x32x16_bf16 a[32:47], a[244:247], v[168:171], a[32:47]
 v_exp_f32 v201, v201
 v_add_f32 v11, v11, v200
 v_exp_f32 v202, v202
 v_add_f32 v11, v11, v201
 v_mfma_f32_32x32x16_bf16 a[48:63], a[244:247], v[184:187], a[48:63]
 ds_read_b128 a[208:211], v80 offset:16384
 v_cvt_pk_bf16_f32 v200, v200, v201
 v_exp_f32 v203, v203
 v_add_f32 v11, v11, v202
 v_mfma_f32_32x32x16_bf16 a[64:79], a[248:251], v[168:171], a[64:79]
 v_exp_f32 v204, v204
 v_add_f32 v11, v11, v203
 v_cvt_pk_bf16_f32 v201, v202, v203
 v_exp_f32 v205, v205
 v_mfma_f32_32x32x16_bf16 a[80:95], a[248:251], v[184:187], a[80:95]
 ds_read_b128 a[212:215], v81 offset:16384
 v_add_f32 v11, v11, v204
 v_exp_f32 v206, v206
 v_add_f32 v11, v11, v205
 v_cvt_pk_bf16_f32 v202, v204, v205
 v_mfma_f32_32x32x16_bf16 a[96:111], a[252:255], v[168:171], a[96:111]
 v_exp_f32 v207, v207
 v_add_f32 v11, v11, v206
 v_add_f32 v11, v11, v207
 v_cvt_pk_bf16_f32 v203, v206, v207
 v_mfma_f32_32x32x16_bf16 a[112:127], a[252:255], v[184:187], a[112:127]
 s_add_u32 m0, s35, 0x24000
 s_nop 0
 buffer_load_dwordx4 v10, s[20:23], s44 offen offset:1024 nt lds
 ds_read_b128 a[216:219], v82 offset:16384
 s_and_b32 s92, s29, 3
 s_andn2_b32 s93, s29, 3
 s_add_u32 s92, s92, s93
 s_waitcnt lgkmcnt(2)
 v_mfma_f32_32x32x16_bf16 v[128:143], a[192:195], a[128:131], v[32:47]
 s_lshl_b32 s92, s92, 2
 s_add_u32 s92, s92, s28
 s_mul_i32 s92, s92, 0x9000
 s_and_b32 s93, s29, 3
 s_mul_i32 s93, s93, 0x120
 s_add_u32 s92, s92, s93
 v_mfma_f32_32x32x16_bf16 v[144:159], a[192:195], a[160:163], v[48:63]
 s_mul_i32 s93, s28, 0x2400
 ds_read_b128 a[220:223], v83 offset:16384
 v_exp_f32 v208, v208
 v_exp_f32 v209, v209
 v_mfma_f32_32x32x16_bf16 v[128:143], a[196:199], a[132:135], v[128:143]
 v_add_f32 v12, v12, v208
 v_exp_f32 v210, v210
 v_add_f32 v12, v12, v209
 v_cvt_pk_bf16_f32 v208, v208, v209
 v_mfma_f32_32x32x16_bf16 v[144:159], a[196:199], a[164:167], v[144:159]
 ds_read_b128 a[224:227], v76 offset:24576
 v_exp_f32 v211, v211
 v_add_f32 v12, v12, v210
 v_exp_f32 v212, v212
 v_mfma_f32_32x32x16_bf16 v[128:143], a[200:203], a[136:139], v[128:143]
 v_add_f32 v12, v12, v211
 v_cvt_pk_bf16_f32 v209, v210, v211
 v_exp_f32 v213, v213
 v_add_f32 v12, v12, v212
 v_mfma_f32_32x32x16_bf16 v[144:159], a[200:203], a[168:171], v[144:159]
 s_add_u32 m0, s35, 0x24000
 s_nop 0
 buffer_load_dwordx4 v10, s[20:23], s44 offen offset:2048 nt lds
 ds_read_b128 a[228:231], v77 offset:24576
 v_exp_f32 v214, v214
 v_add_f32 v12, v12, v213
 v_mfma_f32_32x32x16_bf16 v[128:143], a[204:207], a[140:143], v[128:143]
 v_cvt_pk_bf16_f32 v210, v212, v213
 v_exp_f32 v215, v215
 v_add_f32 v12, v12, v214
 v_add_f32 v12, v12, v215
 v_cvt_pk_bf16_f32 v211, v214, v215
 v_mfma_f32_32x32x16_bf16 v[144:159], a[204:207], a[172:175], v[144:159]
 ds_read_b128 a[232:235], v78 offset:24576
 v_exp_f32 v216, v216
 v_exp_f32 v217, v217
 v_add_f32 v12, v12, v216
 v_mfma_f32_32x32x16_bf16 v[128:143], a[208:211], a[144:147], v[128:143]
 v_exp_f32 v218, v218
 v_add_f32 v12, v12, v217
 v_cvt_pk_bf16_f32 v216, v216, v217
 v_exp_f32 v219, v219
 v_mfma_f32_32x32x16_bf16 v[144:159], a[208:211], a[176:179], v[144:159]
 s_add_u32 m0, s93, 0x0
 s_nop 0
 buffer_load_dwordx4 v108, s[96:99], s92 offen lds
 ds_read_b128 a[236:239], v79 offset:24576
 v_add_f32 v12, v12, v218
 v_exp_f32 v220, v220
 s_waitcnt lgkmcnt(2)
 v_mfma_f32_32x32x16_bf16 v[128:143], a[212:215], a[148:151], v[128:143]
 v_add_f32 v12, v12, v219
 v_cvt_pk_bf16_f32 v217, v218, v219
 v_exp_f32 v221, v221
 v_add_f32 v12, v12, v220
 v_mfma_f32_32x32x16_bf16 v[144:159], a[212:215], a[180:183], v[144:159]
 s_add_u32 m0, s35, 0x24000
 s_nop 0
 buffer_load_dwordx4 v10, s[20:23], s44 offen offset:3072 nt lds
 ds_read_b128 a[240:243], v80 offset:24576
 v_exp_f32 v222, v222
 v_add_f32 v12, v12, v221
 v_mfma_f32_32x32x16_bf16 v[128:143], a[216:219], a[152:155], v[128:143]
 v_cvt_pk_bf16_f32 v218, v220, v221
 v_exp_f32 v223, v223
 v_add_f32 v12, v12, v222
 v_add_f32 v12, v12, v223
 v_cvt_pk_bf16_f32 v219, v222, v223
 v_mfma_f32_32x32x16_bf16 v[144:159], a[216:219], a[184:187], v[144:159]
 ds_read_b128 a[244:247], v81 offset:24576
 buffer_load_dword v121, v123, s[84:87], s39 offen
 v_exp_f32 v224, v224
 v_mfma_f32_32x32x16_bf16 v[128:143], a[220:223], a[156:159], v[128:143]
 v_exp_f32 v225, v225
 v_add_f32 v11, v11, v224
 v_exp_f32 v226, v226
 v_add_f32 v11, v11, v225
 v_mfma_f32_32x32x16_bf16 v[144:159], a[220:223], a[188:191], v[144:159]
 ds_read_b128 a[248:251], v82 offset:24576
 v_cvt_pk_bf16_f32 v224, v224, v225
 v_exp_f32 v227, v227
 v_add_f32 v11, v11, v226
 v_mfma_f32_32x32x16_bf16 v[160:175], a[224:227], a[128:131], v[32:47]
 v_exp_f32 v228, v228
 v_add_f32 v11, v11, v227
 v_cvt_pk_bf16_f32 v225, v226, v227
 v_exp_f32 v229, v229
 v_mfma_f32_32x32x16_bf16 v[176:191], a[224:227], a[160:163], v[48:63]
 ds_read_b128 a[252:255], v83 offset:24576
 v_add_f32 v11, v11, v228
 v_exp_f32 v230, v230
 v_add_f32 v11, v11, v229
 v_cvt_pk_bf16_f32 v226, v228, v229
 v_mfma_f32_32x32x16_bf16 v[160:175], a[228:231], a[132:135], v[160:175]
 s_add_u32 m0, s93, 0x0
 s_nop 0
 buffer_load_dwordx4 v109, s[96:99], s92 offen offset:1024 lds
 v_exp_f32 v231, v231
 v_add_f32 v11, v11, v230
 v_add_f32 v11, v11, v231
 v_mfma_f32_32x32x16_bf16 v[176:191], a[228:231], a[164:167], v[176:191]
 s_waitcnt vmcnt(12)
 s_barrier
 s_add_u32 s43, s32, 0x18000
 ds_read_b64_tr_b16 a[192:193], v68 offset:32768
 ds_read_b64_tr_b16 a[194:195], v68 offset:33792
 v_cvt_pk_bf16_f32 v227, v230, v231
 s_waitcnt lgkmcnt(3)
 v_mfma_f32_32x32x16_bf16 v[160:175], a[232:235], a[136:139], v[160:175]
 v_exp_f32 v232, v232
 v_exp_f32 v233, v233
 v_add_f32 v11, v11, v232
 v_mfma_f32_32x32x16_bf16 v[176:191], a[232:235], a[168:171], v[176:191]
 ds_read_b64_tr_b16 a[196:197], v69 offset:32768
 ds_read_b64_tr_b16 a[198:199], v69 offset:33792
 v_exp_f32 v234, v234
 v_add_f32 v11, v11, v233
 v_cvt_pk_bf16_f32 v232, v232, v233
 v_mfma_f32_32x32x16_bf16 v[160:175], a[236:239], a[140:143], v[160:175]
 v_exp_f32 v235, v235
 v_add_f32 v11, v11, v234
 v_exp_f32 v236, v236
 v_add_f32 v11, v11, v235
 v_mfma_f32_32x32x16_bf16 v[176:191], a[236:239], a[172:175], v[176:191]
 ds_read_b64_tr_b16 a[200:201], v70 offset:32768
 ds_read_b64_tr_b16 a[202:203], v70 offset:33792
 v_cvt_pk_bf16_f32 v233, v234, v235
 v_exp_f32 v237, v237
 v_add_f32 v11, v11, v236
 v_mfma_f32_32x32x16_bf16 v[160:175], a[240:243], a[144:147], v[160:175]
 v_exp_f32 v238, v238
 v_add_f32 v11, v11, v237
 v_cvt_pk_bf16_f32 v234, v236, v237
 v_exp_f32 v239, v239
 v_mfma_f32_32x32x16_bf16 v[176:191], a[240:243], a[176:179], v[176:191]
 s_add_u32 m0, s35, 0x14000
 s_nop 0
 buffer_load_dwordx4 v6, s[16:19], s43 offen nt lds
 ds_read_b64_tr_b16 a[204:205], v71 offset:32768
 ds_read_b64_tr_b16 a[206:207], v71 offset:33792
 v_add_f32 v11, v11, v238
 v_add_f32 v11, v11, v239
 v_mfma_f32_32x32x16_bf16 v[160:175], a[244:247], a[148:151], v[160:175]
 v_cvt_pk_bf16_f32 v235, v238, v239
 v_exp_f32 v240, v240
 v_exp_f32 v241, v241
 v_add_f32 v12, v12, v240
 v_mfma_f32_32x32x16_bf16 v[176:191], a[244:247], a[180:183], v[176:191]
 s_add_u32 m0, s93, 0x0
 s_nop 0
 buffer_load_dwordx4 v110, s[96:99], s92 offen offset:2048 lds
 ds_read_b64_tr_b16 a[208:209], v68 offset:36864
 ds_read_b64_tr_b16 a[210:211], v68 offset:37888
 v_exp_f32 v242, v242
 v_mfma_f32_32x32x16_bf16 v[160:175], a[248:251], a[152:155], v[160:175]
 v_add_f32 v12, v12, v241
 v_cvt_pk_bf16_f32 v240, v240, v241
 v_exp_f32 v243, v243
 v_add_f32 v12, v12, v242
 v_mfma_f32_32x32x16_bf16 v[176:191], a[248:251], a[184:187], v[176:191]
 ds_read_b64_tr_b16 a[212:213], v69 offset:36864
 ds_read_b64_tr_b16 a[214:215], v69 offset:37888
 v_exp_f32 v244, v244
 v_add_f32 v12, v12, v243
 v_cvt_pk_bf16_f32 v241, v242, v243
 s_waitcnt lgkmcnt(4)
 v_mfma_f32_32x32x16_bf16 v[160:175], a[252:255], a[156:159], v[160:175]
 v_exp_f32 v245, v245
 v_add_f32 v12, v12, v244
 v_exp_f32 v246, v246
 v_add_f32 v12, v12, v245
 v_mfma_f32_32x32x16_bf16 v[176:191], a[252:255], a[188:191], v[176:191]
 s_add_u32 m0, s35, 0x14000
 s_nop 0
 buffer_load_dwordx4 v7, s[16:19], s43 offen offset:1024 nt lds
 ds_read_b64_tr_b16 a[216:217], v70 offset:36864
 ds_read_b64_tr_b16 a[218:219], v70 offset:37888
 v_cvt_pk_bf16_f32 v242, v244, v245
 v_mfma_f32_32x32x16_bf16 a[0:15], a[192:195], v[192:195], a[0:15]
 v_exp_f32 v247, v247
 v_add_f32 v12, v12, v246
 v_add_f32 v12, v12, v247
 v_cvt_pk_bf16_f32 v243, v246, v247
 v_mfma_f32_32x32x16_bf16 a[16:31], a[192:195], v[208:211], a[16:31]
 ds_read_b64_tr_b16 a[220:221], v71 offset:36864
 ds_read_b64_tr_b16 a[222:223], v71 offset:37888
 v_exp_f32 v248, v248
 v_exp_f32 v249, v249
 v_mfma_f32_32x32x16_bf16 a[32:47], a[196:199], v[192:195], a[32:47]
 v_add_f32 v12, v12, v248
 v_exp_f32 v250, v250
 v_add_f32 v12, v12, v249
 v_cvt_pk_bf16_f32 v248, v248, v249
 v_mfma_f32_32x32x16_bf16 a[48:63], a[196:199], v[208:211], a[48:63]
 ds_read_b64_tr_b16 a[224:225], v68 offset:40960
 ds_read_b64_tr_b16 a[226:227], v68 offset:41984
 v_exp_f32 v251, v251
 v_add_f32 v12, v12, v250
 v_mfma_f32_32x32x16_bf16 a[64:79], a[200:203], v[192:195], a[64:79]
 s_add_u32 m0, s93, 0x0
 s_nop 0
 buffer_load_dwordx4 v111, s[96:99], s92 offen offset:3072 lds
 v_exp_f32 v252, v252
 v_add_f32 v12, v12, v251
 v_cvt_pk_bf16_f32 v249, v250, v251
 v_mfma_f32_32x32x16_bf16 a[80:95], a[200:203], v[208:211], a[80:95]
 s_add_u32 m0, s35, 0x14000
 s_nop 0
 buffer_load_dwordx4 v8, s[16:19], s43 offen offset:2048 nt lds
 ds_read_b64_tr_b16 a[228:229], v69 offset:40960
 ds_read_b64_tr_b16 a[230:231], v69 offset:41984
 v_exp_f32 v253, v253
 v_mfma_f32_32x32x16_bf16 a[96:111], a[204:207], v[192:195], a[96:111]
 v_add_f32 v12, v12, v252
 v_exp_f32 v254, v254
 v_add_f32 v12, v12, v253
 v_cvt_pk_bf16_f32 v250, v252, v253
 v_mfma_f32_32x32x16_bf16 a[112:127], a[204:207], v[208:211], a[112:127]
 ds_read_b64_tr_b16 a[232:233], v70 offset:40960
 ds_read_b64_tr_b16 a[234:235], v70 offset:41984
 v_exp_f32 v255, v255
 v_add_f32 v12, v12, v254
 v_add_f32 v12, v12, v255
 s_waitcnt lgkmcnt(4)
 v_mfma_f32_32x32x16_bf16 a[0:15], a[208:211], v[200:203], a[0:15]
 v_cvt_pk_bf16_f32 v251, v254, v255
 v_exp_f32 v128, v128
 v_exp_f32 v129, v129
 v_add_f32 v11, v11, v128
 v_mfma_f32_32x32x16_bf16 a[16:31], a[208:211], v[216:219], a[16:31]
 ds_read_b64_tr_b16 a[236:237], v71 offset:40960
 ds_read_b64_tr_b16 a[238:239], v71 offset:41984
 v_exp_f32 v130, v130
 v_add_f32 v11, v11, v129
 v_cvt_pk_bf16_f32 v128, v128, v129
 v_mfma_f32_32x32x16_bf16 a[32:47], a[212:215], v[200:203], a[32:47]
 v_exp_f32 v131, v131
 v_add_f32 v11, v11, v130
 v_exp_f32 v132, v132
 v_add_f32 v11, v11, v131
 v_mfma_f32_32x32x16_bf16 a[48:63], a[212:215], v[216:219], a[48:63]
 s_add_u32 m0, s35, 0x14000
 s_nop 0
 buffer_load_dwordx4 v9, s[16:19], s43 offen offset:3072 nt lds
 ds_read_b64_tr_b16 a[240:241], v68 offset:45056
 ds_read_b64_tr_b16 a[242:243], v68 offset:46080
 v_cvt_pk_bf16_f32 v129, v130, v131
 v_mfma_f32_32x32x16_bf16 a[64:79], a[216:219], v[200:203], a[64:79]
 v_exp_f32 v133, v133
 v_add_f32 v11, v11, v132
 v_exp_f32 v134, v134
 v_add_f32 v11, v11, v133
 v_mfma_f32_32x32x16_bf16 a[80:95], a[216:219], v[216:219], a[80:95]
 s_add_u32 m0, s93, 0x1000
 s_nop 0
 buffer_load_dwordx4 v112, s[96:99], s92 offen lds
 ds_read_b64_tr_b16 a[244:245], v69 offset:45056
 ds_read_b64_tr_b16 a[246:247], v69 offset:46080
 v_cvt_pk_bf16_f32 v130, v132, v133
 v_mfma_f32_32x32x16_bf16 a[96:111], a[220:223], v[200:203], a[96:111]
 v_exp_f32 v135, v135
 v_add_f32 v11, v11, v134
 v_add_f32 v11, v11, v135
 v_cvt_pk_bf16_f32 v131, v134, v135
 v_mfma_f32_32x32x16_bf16 a[112:127], a[220:223], v[216:219], a[112:127]
 ds_read_b64_tr_b16 a[248:249], v70 offset:45056
 ds_read_b64_tr_b16 a[250:251], v70 offset:46080
 v_exp_f32 v136, v136
 v_exp_f32 v137, v137
 v_mfma_f32_32x32x16_bf16 a[0:15], a[224:227], v[224:227], a[0:15]
 v_add_f32 v11, v11, v136
 v_exp_f32 v138, v138
 v_add_f32 v11, v11, v137
 v_cvt_pk_bf16_f32 v136, v136, v137
 v_mfma_f32_32x32x16_bf16 a[16:31], a[224:227], v[240:243], a[16:31]
 ds_read_b64_tr_b16 a[252:253], v71 offset:45056
 ds_read_b64_tr_b16 a[254:255], v71 offset:46080
 v_exp_f32 v139, v139
 v_add_f32 v11, v11, v138
 s_waitcnt lgkmcnt(4)
 v_mfma_f32_32x32x16_bf16 a[32:47], a[228:231], v[224:227], a[32:47]
 v_exp_f32 v140, v140
 v_add_f32 v11, v11, v139
 v_cvt_pk_bf16_f32 v137, v138, v139
 v_exp_f32 v141, v141
 v_mfma_f32_32x32x16_bf16 a[48:63], a[228:231], v[240:243], a[48:63]
 s_waitcnt vmcnt(14)
 s_barrier
 s_add_u32 s44, s32, 0x14000
 ds_read_b128 a[192:195], v76 offset:49152
 v_add_f32 v11, v11, v140
 v_mfma_f32_32x32x16_bf16 a[64:79], a[232:235], v[224:227], a[64:79]
 v_exp_f32 v142, v142
 v_add_f32 v11, v11, v141
 v_cvt_pk_bf16_f32 v138, v140, v141
 v_exp_f32 v143, v143
 v_mfma_f32_32x32x16_bf16 a[80:95], a[232:235], v[240:243], a[80:95]
 ds_read_b128 a[196:199], v77 offset:49152
 v_add_f32 v11, v11, v142
 v_add_f32 v11, v11, v143
 v_cvt_pk_bf16_f32 v139, v142, v143
 v_exp_f32 v144, v144
 v_mfma_f32_32x32x16_bf16 a[96:111], a[236:239], v[224:227], a[96:111]
 s_add_u32 m0, s93, 0x1000
 s_nop 0
 buffer_load_dwordx4 v113, s[96:99], s92 offen offset:1024 lds
 v_exp_f32 v145, v145
 v_add_f32 v12, v12, v144
 v_mfma_f32_32x32x16_bf16 a[112:127], a[236:239], v[240:243], a[112:127]
 ds_read_b128 a[200:203], v78 offset:49152
 v_exp_f32 v146, v146
 v_add_f32 v12, v12, v145
 v_cvt_pk_bf16_f32 v144, v144, v145
 v_mfma_f32_32x32x16_bf16 a[0:15], a[240:243], v[232:235], a[0:15]
 v_exp_f32 v147, v147
 v_add_f32 v12, v12, v146
 v_exp_f32 v148, v148
 v_add_f32 v12, v12, v147
 v_mfma_f32_32x32x16_bf16 a[16:31], a[240:243], v[248:251], a[16:31]
 s_add_u32 m0, s35, 0x18000
 s_nop 0
 buffer_load_dwordx4 v10, s[20:23], s44 offen nt lds
 ds_read_b128 a[204:207], v79 offset:49152
 v_cvt_pk_bf16_f32 v145, v146, v147
 v_exp_f32 v149, v149
 v_mfma_f32_32x32x16_bf16 a[32:47], a[244:247], v[232:235], a[32:47]
 v_add_f32 v12, v12, v148
 v_exp_f32 v150, v150
 v_add_f32 v12, v12, v149
 v_cvt_pk_bf16_f32 v146, v148, v149
 v_mfma_f32_32x32x16_bf16 a[48:63], a[244:247], v[248:251], a[48:63]
 ds_read_b128 a[208:211], v80 offset:49152
 v_exp_f32 v151, v151
 v_add_f32 v12, v12, v150
 v_add_f32 v12, v12, v151
 v_cvt_pk_bf16_f32 v147, v150, v151
 s_waitcnt lgkmcnt(2)
 v_mfma_f32_32x32x16_bf16 a[64:79], a[248:251], v[232:235], a[64:79]
 v_exp_f32 v152, v152
 v_exp_f32 v153, v153
 v_add_f32 v12, v12, v152
 v_mfma_f32_32x32x16_bf16 a[80:95], a[248:251], v[248:251], a[80:95]
 ds_read_b128 a[212:215], v81 offset:49152
 v_exp_f32 v154, v154
 v_add_f32 v12, v12, v153
 v_cvt_pk_bf16_f32 v152, v152, v153
 v_mfma_f32_32x32x16_bf16 a[96:111], a[252:255], v[232:235], a[96:111]
 v_exp_f32 v155, v155
 v_add_f32 v12, v12, v154
 v_exp_f32 v156, v156
 v_add_f32 v12, v12, v155
 v_mfma_f32_32x32x16_bf16 a[112:127], a[252:255], v[248:251], a[112:127]
 s_add_u32 m0, s35, 0x18000
 s_nop 0
 buffer_load_dwordx4 v10, s[20:23], s44 offen offset:1024 nt lds
 s_add_u32 m0, s93, 0x1000
 s_nop 0
 buffer_load_dwordx4 v114, s[96:99], s92 offen offset:2048 lds
 ds_read_b128 a[216:219], v82 offset:49152
 v_cvt_pk_bf16_f32 v153, v154, v155
 v_mfma_f32_32x32x16_bf16 v[192:207], a[192:195], a[128:131], v[32:47]
 v_exp_f32 v157, v157
 v_add_f32 v12, v12, v156
 v_exp_f32 v158, v158
 v_add_f32 v12, v12, v157
 v_mfma_f32_32x32x16_bf16 v[208:223], a[192:195], a[160:163], v[48:63]
 ds_read_b128 a[220:223], v83 offset:49152
 buffer_load_dword v121, v123, s[84:87], s39 offen offset:2688
 v_cvt_pk_bf16_f32 v154, v156, v157
 v_exp_f32 v159, v159
 v_mfma_f32_32x32x16_bf16 v[192:207], a[196:199], a[132:135], v[192:207]
 v_add_f32 v12, v12, v158
 v_add_f32 v12, v12, v159
 v_cvt_pk_bf16_f32 v155, v158, v159
 v_exp_f32 v160, v160
 v_mfma_f32_32x32x16_bf16 v[208:223], a[196:199], a[164:167], v[208:223]
 ds_read_b128 a[224:227], v76 offset:57344
 v_exp_f32 v161, v161
 v_add_f32 v11, v11, v160
 v_exp_f32 v162, v162
 v_mfma_f32_32x32x16_bf16 v[192:207], a[200:203], a[136:139], v[192:207]
 v_add_f32 v11, v11, v161
 v_cvt_pk_bf16_f32 v160, v160, v161
 v_exp_f32 v163, v163
 v_add_f32 v11, v11, v162
 v_mfma_f32_32x32x16_bf16 v[208:223], a[200:203], a[168:171], v[208:223]
 s_add_u32 m0, s35, 0x18000
 s_nop 0
 buffer_load_dwordx4 v10, s[20:23], s44 offen offset:2048 nt lds
 ds_read_b128 a[228:231], v77 offset:57344
 v_exp_f32 v164, v164
 v_add_f32 v11, v11, v163
 s_waitcnt lgkmcnt(2)
 v_mfma_f32_32x32x16_bf16 v[192:207], a[204:207], a[140:143], v[192:207]
 v_cvt_pk_bf16_f32 v161, v162, v163
 v_exp_f32 v165, v165
 v_add_f32 v11, v11, v164
 v_exp_f32 v166, v166
 v_mfma_f32_32x32x16_bf16 v[208:223], a[204:207], a[172:175], v[208:223]
 ds_read_b128 a[232:235], v78 offset:57344
 v_add_f32 v11, v11, v165
 v_cvt_pk_bf16_f32 v162, v164, v165
 v_exp_f32 v167, v167
 v_add_f32 v11, v11, v166
 v_mfma_f32_32x32x16_bf16 v[192:207], a[208:211], a[144:147], v[192:207]
 s_add_u32 m0, s93, 0x1000
 s_nop 0
 buffer_load_dwordx4 v115, s[96:99], s92 offen offset:3072 lds
 v_add_f32 v11, v11, v167
 v_cvt_pk_bf16_f32 v163, v166, v167
 v_exp_f32 v168, v168
 v_mfma_f32_32x32x16_bf16 v[208:223], a[208:211], a[176:179], v[208:223]
 ds_read_b128 a[236:239], v79 offset:57344
 v_exp_f32 v169, v169
 v_add_f32 v11, v11, v168
 v_exp_f32 v170, v170
 v_mfma_f32_32x32x16_bf16 v[192:207], a[212:215], a[148:151], v[192:207]
 v_add_f32 v11, v11, v169
 v_cvt_pk_bf16_f32 v168, v168, v169
 v_exp_f32 v171, v171
 v_add_f32 v11, v11, v170
 v_mfma_f32_32x32x16_bf16 v[208:223], a[212:215], a[180:183], v[208:223]
 s_add_u32 m0, s35, 0x18000
 s_nop 0
 buffer_load_dwordx4 v10, s[20:23], s44 offen offset:3072 nt lds
 ds_read_b128 a[240:243], v80 offset:57344
 v_exp_f32 v172, v172
 v_add_f32 v11, v11, v171
 v_mfma_f32_32x32x16_bf16 v[192:207], a[216:219], a[152:155], v[192:207]
 v_cvt_pk_bf16_f32 v169, v170, v171
 v_exp_f32 v173, v173
 v_add_f32 v11, v11, v172
 v_exp_f32 v174, v174
 v_mfma_f32_32x32x16_bf16 v[208:223], a[216:219], a[184:187], v[208:223]
 ds_read_b128 a[244:247], v81 offset:57344
 v_add_f32 v11, v11, v173
 v_cvt_pk_bf16_f32 v170, v172, v173
 v_exp_f32 v175, v175
 v_add_f32 v11, v11, v174
 v_mfma_f32_32x32x16_bf16 v[192:207], a[220:223], a[156:159], v[192:207]
 v_add_f32 v11, v11, v175
 v_cvt_pk_bf16_f32 v171, v174, v175
 v_exp_f32 v176, v176
 v_exp_f32 v177, v177
 v_mfma_f32_32x32x16_bf16 v[208:223], a[220:223], a[188:191], v[208:223]
 ds_read_b128 a[248:251], v82 offset:57344
 v_add_f32 v12, v12, v176
 v_exp_f32 v178, v178
 v_add_f32 v12, v12, v177
 v_cvt_pk_bf16_f32 v176, v176, v177
 s_waitcnt lgkmcnt(2)
 v_mfma_f32_32x32x16_bf16 v[224:239], a[224:227], a[128:131], v[32:47]
 v_exp_f32 v179, v179
 v_add_f32 v12, v12, v178
 v_exp_f32 v180, v180
 v_add_f32 v12, v12, v179
 v_mfma_f32_32x32x16_bf16 v[240:255], a[224:227], a[160:163], v[48:63]
 s_add_u32 m0, s93, 0x2000
 s_nop 0
 buffer_load_dwordx4 v116, s[96:99], s92 offen lds
 ds_read_b128 a[252:255], v83 offset:57344
 v_cvt_pk_bf16_f32 v177, v178, v179
 v_exp_f32 v181, v181
 v_mfma_f32_32x32x16_bf16 v[224:239], a[228:231], a[132:135], v[224:239]
 v_add_f32 v12, v12, v180
 v_exp_f32 v182, v182
 v_add_f32 v12, v12, v181
 v_cvt_pk_bf16_f32 v178, v180, v181
 v_mfma_f32_32x32x16_bf16 v[240:255], a[228:231], a[164:167], v[240:255]
 s_waitcnt vmcnt(18)
 s_barrier
 s_add_u32 s43, s32, 0x1c000
 ds_read_b64_tr_b16 a[192:193], v72
 ds_read_b64_tr_b16 a[194:195], v72 offset:1024
 v_mfma_f32_32x32x16_bf16 v[224:239], a[232:235], a[136:139], v[224:239]
 v_exp_f32 v183, v183
 v_add_f32 v12, v12, v182
 v_add_f32 v12, v12, v183
 v_cvt_pk_bf16_f32 v179, v182, v183
 v_mfma_f32_32x32x16_bf16 v[240:255], a[232:235], a[168:171], v[240:255]
 ds_read_b64_tr_b16 a[196:197], v73
 ds_read_b64_tr_b16 a[198:199], v73 offset:1024
 v_exp_f32 v184, v184
 v_exp_f32 v185, v185
 v_mfma_f32_32x32x16_bf16 v[224:239], a[236:239], a[140:143], v[224:239]
 v_add_f32 v12, v12, v184
 v_exp_f32 v186, v186
 v_add_f32 v12, v12, v185
 v_cvt_pk_bf16_f32 v184, v184, v185
 v_mfma_f32_32x32x16_bf16 v[240:255], a[236:239], a[172:175], v[240:255]
 ds_read_b64_tr_b16 a[200:201], v74
 ds_read_b64_tr_b16 a[202:203], v74 offset:1024
 v_exp_f32 v187, v187
 v_add_f32 v12, v12, v186
 v_mfma_f32_32x32x16_bf16 v[224:239], a[240:243], a[144:147], v[224:239]
 v_exp_f32 v188, v188
 v_add_f32 v12, v12, v187
 v_cvt_pk_bf16_f32 v185, v186, v187
 v_exp_f32 v189, v189
 v_mfma_f32_32x32x16_bf16 v[240:255], a[240:243], a[176:179], v[240:255]
 s_add_u32 m0, s35, 0x1c000
 s_nop 0
 buffer_load_dwordx4 v6, s[16:19], s43 offen nt lds
 ds_read_b64_tr_b16 a[204:205], v75
 ds_read_b64_tr_b16 a[206:207], v75 offset:1024
 v_add_f32 v12, v12, v188
 s_waitcnt lgkmcnt(4)
 v_mfma_f32_32x32x16_bf16 v[224:239], a[244:247], a[148:151], v[224:239]
 v_exp_f32 v190, v190
 v_add_f32 v12, v12, v189
 v_cvt_pk_bf16_f32 v186, v188, v189
 v_exp_f32 v191, v191
 v_mfma_f32_32x32x16_bf16 v[240:255], a[244:247], a[180:183], v[240:255]
 ds_read_b64_tr_b16 a[208:209], v72 offset:4096
 ds_read_b64_tr_b16 a[210:211], v72 offset:5120
 v_add_f32 v12, v12, v190
 v_add_f32 v12, v12, v191
 v_cvt_pk_bf16_f32 v187, v190, v191
 v_mfma_f32_32x32x16_bf16 v[224:239], a[248:251], a[152:155], v[224:239]
 v_exp_f32 v192, v192
 v_exp_f32 v193, v193
 v_add_f32 v11, v11, v192
 v_mfma_f32_32x32x16_bf16 v[240:255], a[248:251], a[184:187], v[240:255]
 ds_read_b64_tr_b16 a[212:213], v73 offset:4096
 ds_read_b64_tr_b16 a[214:215], v73 offset:5120
 v_exp_f32 v194, v194
 v_add_f32 v11, v11, v193
 v_cvt_pk_bf16_f32 v192, v192, v193
 v_mfma_f32_32x32x16_bf16 v[224:239], a[252:255], a[156:159], v[224:239]
 v_exp_f32 v195, v195
 v_add_f32 v11, v11, v194
 v_exp_f32 v196, v196
 v_add_f32 v11, v11, v195
 v_mfma_f32_32x32x16_bf16 v[240:255], a[252:255], a[188:191], v[240:255]
 s_add_u32 m0, s35, 0x1c000
 s_nop 0
 buffer_load_dwordx4 v7, s[16:19], s43 offen offset:1024 nt lds
 ds_read_b64_tr_b16 a[216:217], v74 offset:4096
 ds_read_b64_tr_b16 a[218:219], v74 offset:5120
 s_and_b32 s92, s29, 3
 s_cmp_le_u32 s92, 0
 s_cselect_b32 s92, 1, 0
 v_mfma_f32_32x32x16_bf16 a[0:15], a[192:195], v[128:131], a[0:15]
 s_andn2_b32 s93, s29, 3
 s_add_u32 s92, s92, s93
 s_lshl_b32 s92, s92, 2
 s_add_u32 s92, s92, s28
 s_mul_i32 s92, s92, 0x9000
 s_and_b32 s93, s29, 3
 v_mfma_f32_32x32x16_bf16 a[16:31], a[192:195], v[144:147], a[16:31]
 s_mul_i32 s93, s93, 0x120
 s_add_u32 s92, s92, s93
 s_mul_i32 s93, s28, 0x2400
 ds_read_b64_tr_b16 a[220:221], v75 offset:4096
 ds_read_b64_tr_b16 a[222:223], v75 offset:5120
 v_cvt_pk_bf16_f32 v193, v194, v195
 v_mfma_f32_32x32x16_bf16 a[32:47], a[196:199], v[128:131], a[32:47]
 v_exp_f32 v197, v197
 v_add_f32 v11, v11, v196
 v_exp_f32 v198, v198
 v_add_f32 v11, v11, v197
 v_mfma_f32_32x32x16_bf16 a[48:63], a[196:199], v[144:147], a[48:63]
 ds_read_b64_tr_b16 a[224:225], v72 offset:8192
 ds_read_b64_tr_b16 a[226:227], v72 offset:9216
 v_cvt_pk_bf16_f32 v194, v196, v197
 v_exp_f32 v199, v199
 v_add_f32 v11, v11, v198
 s_waitcnt lgkmcnt(4)
 v_mfma_f32_32x32x16_bf16 a[64:79], a[200:203], v[128:131], a[64:79]
 v_add_f32 v11, v11, v199
 v_cvt_pk_bf16_f32 v195, v198, v199
 v_exp_f32 v200, v200
 v_exp_f32 v201, v201
 v_mfma_f32_32x32x16_bf16 a[80:95], a[200:203], v[144:147], a[80:95]
 s_add_u32 m0, s35, 0x1c000
 s_nop 0
 buffer_load_dwordx4 v8, s[16:19], s43 offen offset:2048 nt lds
 ds_read_b64_tr_b16 a[228:229], v73 offset:8192
 ds_read_b64_tr_b16 a[230:231], v73 offset:9216
 v_add_f32 v11, v11, v200
 v_mfma_f32_32x32x16_bf16 a[96:111], a[204:207], v[128:131], a[96:111]
 v_exp_f32 v202, v202
 v_add_f32 v11, v11, v201
 v_cvt_pk_bf16_f32 v200, v200, v201
 v_exp_f32 v203, v203
 v_mfma_f32_32x32x16_bf16 a[112:127], a[204:207], v[144:147], a[112:127]
 ds_read_b64_tr_b16 a[232:233], v74 offset:8192
 ds_read_b64_tr_b16 a[234:235], v74 offset:9216
 v_add_f32 v11, v11, v202
 v_exp_f32 v204, v204
 v_add_f32 v11, v11, v203
 v_mfma_f32_32x32x16_bf16 a[0:15], a[208:211], v[136:139], a[0:15]
 v_cvt_pk_bf16_f32 v201, v202, v203
 v_exp_f32 v205, v205
 v_add_f32 v11, v11, v204
 v_exp_f32 v206, v206
 v_mfma_f32_32x32x16_bf16 a[16:31], a[208:211], v[152:155], a[16:31]
 s_add_u32 m0, s93, 0x9000
 s_nop 0
 buffer_load_dwordx4 v108, s[96:99], s92 offen lds
 ds_read_b64_tr_b16 a[236:237], v75 offset:8192
 ds_read_b64_tr_b16 a[238:239], v75 offset:9216
 v_add_f32 v11, v11, v205
 v_cvt_pk_bf16_f32 v202, v204, v205
 v_mfma_f32_32x32x16_bf16 a[32:47], a[212:215], v[136:139], a[32:47]
 v_exp_f32 v207, v207
 v_add_f32 v11, v11, v206
 v_add_f32 v11, v11, v207
 v_cvt_pk_bf16_f32 v203, v206, v207
 v_mfma_f32_32x32x16_bf16 a[48:63], a[212:215], v[152:155], a[48:63]
 s_add_u32 m0, s35, 0x1c000
 s_nop 0
 buffer_load_dwordx4 v9, s[16:19], s43 offen offset:3072 nt lds
 ds_read_b64_tr_b16 a[240:241], v72 offset:12288
 ds_read_b64_tr_b16 a[242:243], v72 offset:13312
 v_exp_f32 v208, v208
 v_mfma_f32_32x32x16_bf16 a[64:79], a[216:219], v[136:139], a[64:79]
 v_exp_f32 v209, v209
 v_add_f32 v12, v12, v208
 v_exp_f32 v210, v210
 v_add_f32 v12, v12, v209
 v_mfma_f32_32x32x16_bf16 a[80:95], a[216:219], v[152:155], a[80:95]
 ds_read_b64_tr_b16 a[244:245], v73 offset:12288
 ds_read_b64_tr_b16 a[246:247], v73 offset:13312
 v_cvt_pk_bf16_f32 v208, v208, v209
 v_exp_f32 v211, v211
 v_add_f32 v12, v12, v210
 s_waitcnt lgkmcnt(4)
 v_mfma_f32_32x32x16_bf16 a[96:111], a[220:223], v[136:139], a[96:111]
 v_exp_f32 v212, v212
 v_add_f32 v12, v12, v211
 v_cvt_pk_bf16_f32 v209, v210, v211
 v_exp_f32 v213, v213
 v_mfma_f32_32x32x16_bf16 a[112:127], a[220:223], v[152:155], a[112:127]
 ds_read_b64_tr_b16 a[248:249], v74 offset:12288
 ds_read_b64_tr_b16 a[250:251], v74 offset:13312
 v_add_f32 v12, v12, v212
 v_exp_f32 v214, v214
 v_add_f32 v12, v12, v213
 v_mfma_f32_32x32x16_bf16 a[0:15], a[224:227], v[160:163], a[0:15]
 v_cvt_pk_bf16_f32 v210, v212, v213
 v_exp_f32 v215, v215
 v_add_f32 v12, v12, v214
 v_add_f32 v12, v12, v215
 v_cvt_pk_bf16_f32 v211, v214, v215
 v_mfma_f32_32x32x16_bf16 a[16:31], a[224:227], v[176:179], a[16:31]
 ds_read_b64_tr_b16 a[252:253], v75 offset:12288
 ds_read_b64_tr_b16 a[254:255], v75 offset:13312
 v_exp_f32 v216, v216
 v_exp_f32 v217, v217
 v_mfma_f32_32x32x16_bf16 a[32:47], a[228:231], v[160:163], a[32:47]
 s_add_u32 m0, s93, 0x9000
 s_nop 0
 buffer_load_dwordx4 v109, s[96:99], s92 offen offset:1024 lds
 v_add_f32 v12, v12, v216
 v_exp_f32 v218, v218
 v_add_f32 v12, v12, v217
 v_mfma_f32_32x32x16_bf16 a[48:63], a[228:231], v[176:179], a[48:63]
 s_waitcnt vmcnt(16)
 s_barrier
 s_add_u32 s44, s32, 0x18000
 ds_read_b128 a[192:195], v76
 v_cvt_pk_bf16_f32 v216, v216, v217
 v_mfma_f32_32x32x16_bf16 a[64:79], a[232:235], v[160:163], a[64:79]
 v_exp_f32 v219, v219
 v_add_f32 v12, v12, v218
 v_exp_f32 v220, v220
 v_add_f32 v12, v12, v219
 v_mfma_f32_32x32x16_bf16 a[80:95], a[232:235], v[176:179], a[80:95]
 ds_read_b128 a[196:199], v77
 buffer_load_dword v121, v123, s[88:91], s39 offen
 v_cvt_pk_bf16_f32 v217, v218, v219
 v_exp_f32 v221, v221
 v_mfma_f32_32x32x16_bf16 a[96:111], a[236:239], v[160:163], a[96:111]
 v_add_f32 v12, v12, v220
 v_exp_f32 v222, v222
 v_add_f32 v12, v12, v221
 v_cvt_pk_bf16_f32 v218, v220, v221
 v_mfma_f32_32x32x16_bf16 a[112:127], a[236:239], v[176:179], a[112:127]
 ds_read_b128 a[200:203], v78
 v_exp_f32 v223, v223
 v_add_f32 v12, v12, v222
 v_add_f32 v12, v12, v223
 v_cvt_pk_bf16_f32 v219, v222, v223
 s_waitcnt lgkmcnt(2)
 v_mfma_f32_32x32x16_bf16 a[0:15], a[240:243], v[168:171], a[0:15]
 v_exp_f32 v224, v224
 v_exp_f32 v225, v225
 v_add_f32 v11, v11, v224
 v_mfma_f32_32x32x16_bf16 a[16:31], a[240:243], v[184:187], a[16:31]
 s_add_u32 m0, s35, 0x20000
 s_nop 0
 buffer_load_dwordx4 v10, s[20:23], s44 offen nt lds
 ds_read_b128 a[204:207], v79
 v_exp_f32 v226, v226
 v_add_f32 v11, v11, v225
 v_mfma_f32_32x32x16_bf16 a[32:47], a[244:247], v[168:171], a[32:47]
 v_cvt_pk_bf16_f32 v224, v224, v225
 v_exp_f32 v227, v227
 v_add_f32 v11, v11, v226
 v_exp_f32 v228, v228
 v_mfma_f32_32x32x16_bf16 a[48:63], a[244:247], v[184:187], a[48:63]
 s_add_u32 m0, s93, 0x9000
 s_nop 0
 buffer_load_dwordx4 v110, s[96:99], s92 offen offset:2048 lds
 ds_read_b128 a[208:211], v80
 v_add_f32 v11, v11, v227
 v_cvt_pk_bf16_f32 v225, v226, v227
 v_mfma_f32_32x32x16_bf16 a[64:79], a[248:251], v[168:171], a[64:79]
 v_exp_f32 v229, v229
 v_add_f32 v11, v11, v228
 v_exp_f32 v230, v230
 v_add_f32 v11, v11, v229
 v_mfma_f32_32x32x16_bf16 a[80:95], a[248:251], v[184:187], a[80:95]
 ds_read_b128 a[212:215], v81
 v_cvt_pk_bf16_f32 v226, v228, v229
 v_exp_f32 v231, v231
 v_add_f32 v11, v11, v230
 v_add_f32 v11, v11, v231
 v_mfma_f32_32x32x16_bf16 a[96:111], a[252:255], v[168:171], a[96:111]
 v_cvt_pk_bf16_f32 v227, v230, v231
 v_exp_f32 v232, v232
 v_exp_f32 v233, v233
 v_add_f32 v11, v11, v232
 v_mfma_f32_32x32x16_bf16 a[112:127], a[252:255], v[184:187], a[112:127]
 s_add_u32 m0, s35, 0x20000
 s_nop 0
 buffer_load_dwordx4 v10, s[20:23], s44 offen offset:1024 nt lds
 ds_read_b128 a[216:219], v82
 v_exp_f32 v234, v234
 v_add_f32 v11, v11, v233
 v_mfma_f32_32x32x16_bf16 v[128:143], a[192:195], a[128:131], v[32:47]
 v_cvt_pk_bf16_f32 v232, v232, v233
 v_exp_f32 v235, v235
 v_add_f32 v11, v11, v234
 v_exp_f32 v236, v236
 v_mfma_f32_32x32x16_bf16 v[144:159], a[192:195], a[160:163], v[48:63]
 ds_read_b128 a[220:223], v83
 v_add_f32 v11, v11, v235
 v_cvt_pk_bf16_f32 v233, v234, v235
 v_exp_f32 v237, v237
 v_add_f32 v11, v11, v236
 s_waitcnt lgkmcnt(2)
 v_mfma_f32_32x32x16_bf16 v[128:143], a[196:199], a[132:135], v[128:143]
 v_exp_f32 v238, v238
 v_add_f32 v11, v11, v237
 v_cvt_pk_bf16_f32 v234, v236, v237
 v_exp_f32 v239, v239
 v_mfma_f32_32x32x16_bf16 v[144:159], a[196:199], a[164:167], v[144:159]
 ds_read_b128 a[224:227], v76 offset:8192
 v_add_f32 v11, v11, v238
 v_add_f32 v11, v11, v239
 v_cvt_pk_bf16_f32 v235, v238, v239
 v_exp_f32 v240, v240
 v_mfma_f32_32x32x16_bf16 v[128:143], a[200:203], a[136:139], v[128:143]
 s_add_u32 m0, s93, 0x9000
 s_nop 0
 buffer_load_dwordx4 v111, s[96:99], s92 offen offset:3072 lds
 v_exp_f32 v241, v241
 v_add_f32 v12, v12, v240
 v_mfma_f32_32x32x16_bf16 v[144:159], a[200:203], a[168:171], v[144:159]
 s_add_u32 m0, s35, 0x20000
 s_nop 0
 buffer_load_dwordx4 v10, s[20:23], s44 offen offset:2048 nt lds
 ds_read_b128 a[228:231], v77 offset:8192
 v_exp_f32 v242, v242
 v_add_f32 v12, v12, v241
 v_mfma_f32_32x32x16_bf16 v[128:143], a[204:207], a[140:143], v[128:143]
 v_cvt_pk_bf16_f32 v240, v240, v241
 v_exp_f32 v243, v243
 v_add_f32 v12, v12, v242
 v_exp_f32 v244, v244
 v_mfma_f32_32x32x16_bf16 v[144:159], a[204:207], a[172:175], v[144:159]
 ds_read_b128 a[232:235], v78 offset:8192
 v_add_f32 v12, v12, v243
 v_cvt_pk_bf16_f32 v241, v242, v243
 v_exp_f32 v245, v245
 v_add_f32 v12, v12, v244
 v_mfma_f32_32x32x16_bf16 v[128:143], a[208:211], a[144:147], v[128:143]
 v_exp_f32 v246, v246
 v_add_f32 v12, v12, v245
 v_cvt_pk_bf16_f32 v242, v244, v245
 v_exp_f32 v247, v247
 v_mfma_f32_32x32x16_bf16 v[144:159], a[208:211], a[176:179], v[144:159]
 ds_read_b128 a[236:239], v79 offset:8192
 v_add_f32 v12, v12, v246
 v_add_f32 v12, v12, v247
 v_cvt_pk_bf16_f32 v243, v246, v247
 v_exp_f32 v248, v248
 v_mfma_f32_32x32x16_bf16 v[128:143], a[212:215], a[148:151], v[128:143]
 v_exp_f32 v249, v249
 v_add_f32 v12, v12, v248
 v_exp_f32 v250, v250
 v_add_f32 v12, v12, v249
 v_mfma_f32_32x32x16_bf16 v[144:159], a[212:215], a[180:183], v[144:159]
 s_add_u32 m0, s35, 0x20000
 s_nop 0
 buffer_load_dwordx4 v10, s[20:23], s44 offen offset:3072 nt lds
 ds_read_b128 a[240:243], v80 offset:8192
 v_cvt_pk_bf16_f32 v248, v248, v249
 v_exp_f32 v251, v251
 s_waitcnt lgkmcnt(2)
 v_mfma_f32_32x32x16_bf16 v[128:143], a[216:219], a[152:155], v[128:143]
 v_add_f32 v12, v12, v250
 v_exp_f32 v252, v252
 v_add_f32 v12, v12, v251
 v_cvt_pk_bf16_f32 v249, v250, v251
 v_mfma_f32_32x32x16_bf16 v[144:159], a[216:219], a[184:187], v[144:159]
 s_add_u32 m0, s93, 0xa000
 s_nop 0
 buffer_load_dwordx4 v112, s[96:99], s92 offen lds
 ds_read_b128 a[244:247], v81 offset:8192
 v_exp_f32 v253, v253
 v_add_f32 v12, v12, v252
 v_mfma_f32_32x32x16_bf16 v[128:143], a[220:223], a[156:159], v[128:143]
 v_exp_f32 v254, v254
 v_add_f32 v12, v12, v253
 v_cvt_pk_bf16_f32 v250, v252, v253
 v_exp_f32 v255, v255
 v_mfma_f32_32x32x16_bf16 v[144:159], a[220:223], a[188:191], v[144:159]
 ds_read_b128 a[248:251], v82 offset:8192
 v_add_f32 v12, v12, v254
 v_add_f32 v12, v12, v255
 v_cvt_pk_bf16_f32 v251, v254, v255
 v_mfma_f32_32x32x16_bf16 v[160:175], a[224:227], a[128:131], v[32:47]
 s_nop 1
 v_exp_f32 v128, v128
 v_exp_f32 v129, v129
 v_add_f32 v11, v11, v128
 v_mfma_f32_32x32x16_bf16 v[176:191], a[224:227], a[160:163], v[48:63]
 ds_read_b128 a[252:255], v83 offset:8192
 v_exp_f32 v130, v130
 v_add_f32 v11, v11, v129
 v_cvt_pk_bf16_f32 v128, v128, v129
 v_mfma_f32_32x32x16_bf16 v[160:175], a[228:231], a[132:135], v[160:175]
 v_exp_f32 v131, v131
 v_add_f32 v11, v11, v130
 v_exp_f32 v132, v132
 v_add_f32 v11, v11, v131
 v_mfma_f32_32x32x16_bf16 v[176:191], a[228:231], a[164:167], v[176:191]
 s_waitcnt vmcnt(15)
 s_barrier
 s_add_u32 s43, s32, 0x1c000
 ds_read_b64_tr_b16 a[192:193], v68 offset:16384
 ds_read_b64_tr_b16 a[194:195], v68 offset:17408
 v_cvt_pk_bf16_f32 v129, v130, v131
 v_mfma_f32_32x32x16_bf16 v[160:175], a[232:235], a[136:139], v[160:175]
 v_exp_f32 v133, v133
 v_add_f32 v11, v11, v132
 v_exp_f32 v134, v134
 v_add_f32 v11, v11, v133
 v_mfma_f32_32x32x16_bf16 v[176:191], a[232:235], a[168:171], v[176:191]
 ds_read_b64_tr_b16 a[196:197], v69 offset:16384
 ds_read_b64_tr_b16 a[198:199], v69 offset:17408
 v_cvt_pk_bf16_f32 v130, v132, v133
 v_exp_f32 v135, v135
 v_add_f32 v11, v11, v134
 s_waitcnt lgkmcnt(4)
 v_mfma_f32_32x32x16_bf16 v[160:175], a[236:239], a[140:143], v[160:175]
 s_add_u32 m0, s93, 0xa000
 s_nop 0
 buffer_load_dwordx4 v113, s[96:99], s92 offen offset:1024 lds
 v_add_f32 v11, v11, v135
 v_cvt_pk_bf16_f32 v131, v134, v135
 v_exp_f32 v136, v136
 v_mfma_f32_32x32x16_bf16 v[176:191], a[236:239], a[172:175], v[176:191]
 ds_read_b64_tr_b16 a[200:201], v70 offset:16384
 ds_read_b64_tr_b16 a[202:203], v70 offset:17408
 v_exp_f32 v137, v137
 v_add_f32 v11, v11, v136
 v_mfma_f32_32x32x16_bf16 v[160:175], a[240:243], a[144:147], v[160:175]
 v_exp_f32 v138, v138
 v_add_f32 v11, v11, v137
 v_cvt_pk_bf16_f32 v136, v136, v137
 v_exp_f32 v139, v139
 v_mfma_f32_32x32x16_bf16 v[176:191], a[240:243], a[176:179], v[176:191]
 s_add_u32 m0, s35, 0x24000
 s_nop 0
 buffer_load_dwordx4 v10, s[20:23], s43 offen nt lds
 ds_read_b64_tr_b16 a[204:205], v71 offset:16384
 ds_read_b64_tr_b16 a[206:207], v71 offset:17408
 v_add_f32 v11, v11, v138
 v_mfma_f32_32x32x16_bf16 v[160:175], a[244:247], a[148:151], v[160:175]
 v_exp_f32 v140, v140
 v_add_f32 v11, v11, v139
 v_cvt_pk_bf16_f32 v137, v138, v139
 v_exp_f32 v141, v141
 v_mfma_f32_32x32x16_bf16 v[176:191], a[244:247], a[180:183], v[176:191]
 ds_read_b64_tr_b16 a[208:209], v68 offset:20480
 ds_read_b64_tr_b16 a[210:211], v68 offset:21504
 v_add_f32 v11, v11, v140
 v_exp_f32 v142, v142
 v_add_f32 v11, v11, v141
 v_mfma_f32_32x32x16_bf16 v[160:175], a[248:251], a[152:155], v[160:175]
 v_cvt_pk_bf16_f32 v138, v140, v141
 v_exp_f32 v143, v143
 v_add_f32 v11, v11, v142
 v_add_f32 v11, v11, v143
 v_cvt_pk_bf16_f32 v139, v142, v143
 v_mfma_f32_32x32x16_bf16 v[176:191], a[248:251], a[184:187], v[176:191]
 ds_read_b64_tr_b16 a[212:213], v69 offset:20480
 ds_read_b64_tr_b16 a[214:215], v69 offset:21504
 v_exp_f32 v144, v144
 v_exp_f32 v145, v145
 v_mfma_f32_32x32x16_bf16 v[160:175], a[252:255], a[156:159], v[160:175]
 v_add_f32 v12, v12, v144
 v_exp_f32 v146, v146
 v_add_f32 v12, v12, v145
 v_cvt_pk_bf16_f32 v144, v144, v145
 v_mfma_f32_32x32x16_bf16 v[176:191], a[252:255], a[188:191], v[176:191]
 s_add_u32 m0, s35, 0x24000
 s_nop 0
 buffer_load_dwordx4 v10, s[20:23], s43 offen offset:1024 nt lds
 s_add_u32 m0, s93, 0xa000
 s_nop 0
 buffer_load_dwordx4 v114, s[96:99], s92 offen offset:2048 lds
 ds_read_b64_tr_b16 a[216:217], v70 offset:20480
 ds_read_b64_tr_b16 a[218:219], v70 offset:21504
 s_waitcnt lgkmcnt(4)
 v_mfma_f32_32x32x16_bf16 a[0:15], a[192:195], v[192:195], a[0:15]
 v_exp_f32 v147, v147
 v_add_f32 v12, v12, v146
 v_exp_f32 v148, v148
 v_add_f32 v12, v12, v147
 v_mfma_f32_32x32x16_bf16 a[16:31], a[192:195], v[208:211], a[16:31]
 ds_read_b64_tr_b16 a[220:221], v71 offset:20480
 ds_read_b64_tr_b16 a[222:223], v71 offset:21504
 v_cvt_pk_bf16_f32 v145, v146, v147
 v_exp_f32 v149, v149
 v_add_f32 v12, v12, v148
 v_mfma_f32_32x32x16_bf16 a[32:47], a[196:199], v[192:195], a[32:47]
 v_exp_f32 v150, v150
 v_add_f32 v12, v12, v149
 v_cvt_pk_bf16_f32 v146, v148, v149
 v_exp_f32 v151, v151
 v_mfma_f32_32x32x16_bf16 a[48:63], a[196:199], v[208:211], a[48:63]
 ds_read_b64_tr_b16 a[224:225], v68 offset:24576
 ds_read_b64_tr_b16 a[226:227], v68 offset:25600
 v_add_f32 v12, v12, v150
 v_add_f32 v12, v12, v151
 v_cvt_pk_bf16_f32 v147, v150, v151
 v_mfma_f32_32x32x16_bf16 a[64:79], a[200:203], v[192:195], a[64:79]
 v_exp_f32 v152, v152
 v_exp_f32 v153, v153
 v_add_f32 v12, v12, v152
 v_mfma_f32_32x32x16_bf16 a[80:95], a[200:203], v[208:211], a[80:95]
 s_add_u32 m0, s35, 0x24000
 s_nop 0
 buffer_load_dwordx4 v10, s[20:23], s43 offen offset:2048 nt lds
 ds_read_b64_tr_b16 a[228:229], v69 offset:24576
 ds_read_b64_tr_b16 a[230:231], v69 offset:25600
 v_exp_f32 v154, v154
 v_mfma_f32_32x32x16_bf16 a[96:111], a[204:207], v[192:195], a[96:111]
 v_add_f32 v12, v12, v153
 v_cvt_pk_bf16_f32 v152, v152, v153
 v_exp_f32 v155, v155
 v_add_f32 v12, v12, v154
 v_mfma_f32_32x32x16_bf16 a[112:127], a[204:207], v[208:211], a[112:127]
 ds_read_b64_tr_b16 a[232:233], v70 offset:24576
 ds_read_b64_tr_b16 a[234:235], v70 offset:25600
 v_exp_f32 v156, v156
 v_add_f32 v12, v12, v155
 v_cvt_pk_bf16_f32 v153, v154, v155
 v_mfma_f32_32x32x16_bf16 a[0:15], a[208:211], v[200:203], a[0:15]
 s_add_u32 m0, s93, 0xa000
 s_nop 0
 buffer_load_dwordx4 v115, s[96:99], s92 offen offset:3072 lds
 v_exp_f32 v157, v157
 v_add_f32 v12, v12, v156
 v_mfma_f32_32x32x16_bf16 a[16:31], a[208:211], v[216:219], a[16:31]
 ds_read_b64_tr_b16 a[236:237], v71 offset:24576
 ds_read_b64_tr_b16 a[238:239], v71 offset:25600
 buffer_load_dword v121, v123, s[88:91], s39 offen offset:2688
 v_exp_f32 v158, v158
 s_waitcnt lgkmcnt(4)
 v_mfma_f32_32x32x16_bf16 a[32:47], a[212:215], v[200:203], a[32:47]
 v_add_f32 v12, v12, v157
 v_cvt_pk_bf16_f32 v154, v156, v157
 v_exp_f32 v159, v159
 v_add_f32 v12, v12, v158
 v_add_f32 v12, v12, v159
 v_mfma_f32_32x32x16_bf16 a[48:63], a[212:215], v[216:219], a[48:63]
 s_add_u32 m0, s35, 0x24000
 s_nop 0
 buffer_load_dwordx4 v10, s[20:23], s43 offen offset:3072 nt lds
 ds_read_b64_tr_b16 a[240:241], v68 offset:28672
 ds_read_b64_tr_b16 a[242:243], v68 offset:29696
 v_cvt_pk_bf16_f32 v155, v158, v159
 v_mfma_f32_32x32x16_bf16 a[64:79], a[216:219], v[200:203], a[64:79]
 v_exp_f32 v160, v160
 v_exp_f32 v161, v161
 v_add_f32 v11, v11, v160
 v_mfma_f32_32x32x16_bf16 a[80:95], a[216:219], v[216:219], a[80:95]
 ds_read_b64_tr_b16 a[244:245], v69 offset:28672
 ds_read_b64_tr_b16 a[246:247], v69 offset:29696
 v_exp_f32 v162, v162
 v_add_f32 v11, v11, v161
 v_cvt_pk_bf16_f32 v160, v160, v161
 v_mfma_f32_32x32x16_bf16 a[96:111], a[220:223], v[200:203], a[96:111]
 v_exp_f32 v163, v163
 v_add_f32 v11, v11, v162
 v_exp_f32 v164, v164
 v_add_f32 v11, v11, v163
 v_mfma_f32_32x32x16_bf16 a[112:127], a[220:223], v[216:219], a[112:127]
 ds_read_b64_tr_b16 a[248:249], v70 offset:28672
 ds_read_b64_tr_b16 a[250:251], v70 offset:29696
 v_cvt_pk_bf16_f32 v161, v162, v163
 v_exp_f32 v165, v165
 v_add_f32 v11, v11, v164
 v_mfma_f32_32x32x16_bf16 a[0:15], a[224:227], v[224:227], a[0:15]
 v_exp_f32 v166, v166
 v_add_f32 v11, v11, v165
 v_cvt_pk_bf16_f32 v162, v164, v165
 v_exp_f32 v167, v167
 v_mfma_f32_32x32x16_bf16 a[16:31], a[224:227], v[240:243], a[16:31]
 s_add_u32 m0, s93, 0xb000
 s_nop 0
 buffer_load_dwordx4 v116, s[96:99], s92 offen lds
 ds_read_b64_tr_b16 a[252:253], v71 offset:28672
 ds_read_b64_tr_b16 a[254:255], v71 offset:29696
 v_add_f32 v11, v11, v166
 v_add_f32 v11, v11, v167
 v_mfma_f32_32x32x16_bf16 a[32:47], a[228:231], v[224:227], a[32:47]
 v_cvt_pk_bf16_f32 v163, v166, v167
 v_exp_f32 v168, v168
 v_exp_f32 v169, v169
 v_add_f32 v11, v11, v168
 v_mfma_f32_32x32x16_bf16 a[48:63], a[228:231], v[240:243], a[48:63]
 s_waitcnt vmcnt(18)
 s_barrier
 ds_read_b128 a[192:195], v76 offset:32768
 v_exp_f32 v170, v170
 v_add_f32 v11, v11, v169
 s_waitcnt lgkmcnt(3)
 v_mfma_f32_32x32x16_bf16 a[64:79], a[232:235], v[224:227], a[64:79]
 v_cvt_pk_bf16_f32 v168, v168, v169
 v_exp_f32 v171, v171
 v_add_f32 v11, v11, v170
 v_exp_f32 v172, v172
 v_mfma_f32_32x32x16_bf16 a[80:95], a[232:235], v[240:243], a[80:95]
 ds_read_b128 a[196:199], v77 offset:32768
 v_add_f32 v11, v11, v171
 v_cvt_pk_bf16_f32 v169, v170, v171
 v_exp_f32 v173, v173
 v_add_f32 v11, v11, v172
 v_mfma_f32_32x32x16_bf16 a[96:111], a[236:239], v[224:227], a[96:111]
 v_exp_f32 v174, v174
 v_add_f32 v11, v11, v173
 v_cvt_pk_bf16_f32 v170, v172, v173
 v_exp_f32 v175, v175
 v_mfma_f32_32x32x16_bf16 a[112:127], a[236:239], v[240:243], a[112:127]
 ds_read_b128 a[200:203], v78 offset:32768
 v_add_f32 v11, v11, v174
 v_add_f32 v11, v11, v175
 v_cvt_pk_bf16_f32 v171, v174, v175
 v_exp_f32 v176, v176
 v_mfma_f32_32x32x16_bf16 a[0:15], a[240:243], v[232:235], a[0:15]
 v_exp_f32 v177, v177
 v_add_f32 v12, v12, v176
 v_exp_f32 v178, v178
 v_add_f32 v12, v12, v177
 v_mfma_f32_32x32x16_bf16 a[16:31], a[240:243], v[248:251], a[16:31]
 ds_read_b128 a[204:207], v79 offset:32768
 v_cvt_pk_bf16_f32 v176, v176, v177
 v_exp_f32 v179, v179
 v_add_f32 v12, v12, v178
 v_mfma_f32_32x32x16_bf16 a[32:47], a[244:247], v[232:235], a[32:47]
 v_exp_f32 v180, v180
 v_add_f32 v12, v12, v179
 v_cvt_pk_bf16_f32 v177, v178, v179
 v_exp_f32 v181, v181
 v_mfma_f32_32x32x16_bf16 a[48:63], a[244:247], v[248:251], a[48:63]
 ds_read_b128 a[208:211], v80 offset:32768
 v_add_f32 v12, v12, v180
 v_exp_f32 v182, v182
 v_add_f32 v12, v12, v181
 v_cvt_pk_bf16_f32 v178, v180, v181
 v_mfma_f32_32x32x16_bf16 a[64:79], a[248:251], v[232:235], a[64:79]
 v_exp_f32 v183, v183
 v_add_f32 v12, v12, v182
 v_add_f32 v12, v12, v183
 v_cvt_pk_bf16_f32 v179, v182, v183
 v_mfma_f32_32x32x16_bf16 a[80:95], a[248:251], v[248:251], a[80:95]
 ds_read_b128 a[212:215], v81 offset:32768
 v_exp_f32 v184, v184
 v_exp_f32 v185, v185
 v_add_f32 v12, v12, v184
 s_waitcnt lgkmcnt(2)
 v_mfma_f32_32x32x16_bf16 a[96:111], a[252:255], v[232:235], a[96:111]
 v_exp_f32 v186, v186
 v_add_f32 v12, v12, v185
 v_cvt_pk_bf16_f32 v184, v184, v185
 v_exp_f32 v187, v187
 v_mfma_f32_32x32x16_bf16 a[112:127], a[252:255], v[248:251], a[112:127]
 ds_read_b128 a[216:219], v82 offset:32768
 v_add_f32 v12, v12, v186
 v_exp_f32 v188, v188
 v_add_f32 v12, v12, v187
 v_cvt_pk_bf16_f32 v185, v186, v187
 v_mfma_f32_32x32x16_bf16 v[192:207], a[192:195], a[128:131], v[32:47]
 v_exp_f32 v189, v189
 v_add_f32 v12, v12, v188
 v_exp_f32 v190, v190
 v_add_f32 v12, v12, v189
 v_mfma_f32_32x32x16_bf16 v[208:223], a[192:195], a[160:163], v[48:63]
 ds_read_b128 a[220:223], v83 offset:32768
 v_cvt_pk_bf16_f32 v186, v188, v189
 v_exp_f32 v191, v191
 v_add_f32 v12, v12, v190
 v_add_f32 v12, v12, v191
 v_mfma_f32_32x32x16_bf16 v[192:207], a[196:199], a[132:135], v[192:207]
 v_cvt_pk_bf16_f32 v187, v190, v191
 v_mfma_f32_32x32x16_bf16 v[208:223], a[196:199], a[164:167], v[208:223]
 ds_read_b128 a[224:227], v76 offset:40960
 v_mfma_f32_32x32x16_bf16 v[192:207], a[200:203], a[136:139], v[192:207]
 v_mfma_f32_32x32x16_bf16 v[208:223], a[200:203], a[168:171], v[208:223]
 ds_read_b128 a[228:231], v77 offset:40960
 v_mfma_f32_32x32x16_bf16 v[192:207], a[204:207], a[140:143], v[192:207]
 v_mfma_f32_32x32x16_bf16 v[208:223], a[204:207], a[172:175], v[208:223]
 ds_read_b128 a[232:235], v78 offset:40960
 s_waitcnt lgkmcnt(2)
 v_mfma_f32_32x32x16_bf16 v[192:207], a[208:211], a[144:147], v[192:207]
 v_mfma_f32_32x32x16_bf16 v[208:223], a[208:211], a[176:179], v[208:223]
 ds_read_b128 a[236:239], v79 offset:40960
 v_mfma_f32_32x32x16_bf16 v[192:207], a[212:215], a[148:151], v[192:207]
 s_and_b32 s92, s29, 3
 s_cmp_le_u32 s92, 1
 s_cselect_b32 s92, 2, 1
 s_andn2_b32 s93, s29, 3
 s_add_u32 s92, s92, s93
 s_lshl_b32 s92, s92, 2
 s_add_u32 s92, s92, s28
 v_mfma_f32_32x32x16_bf16 v[208:223], a[212:215], a[180:183], v[208:223]
 s_mul_i32 s92, s92, 0x9000
 s_and_b32 s93, s29, 3
 s_mul_i32 s93, s93, 0x120
 s_add_u32 s92, s92, s93
 s_mul_i32 s93, s28, 0x2400
 ds_read_b128 a[240:243], v80 offset:40960
 v_mfma_f32_32x32x16_bf16 v[192:207], a[216:219], a[152:155], v[192:207]
 v_mfma_f32_32x32x16_bf16 v[208:223], a[216:219], a[184:187], v[208:223]
 ds_read_b128 a[244:247], v81 offset:40960
 v_mfma_f32_32x32x16_bf16 v[192:207], a[220:223], a[156:159], v[192:207]
 v_mfma_f32_32x32x16_bf16 v[208:223], a[220:223], a[188:191], v[208:223]
 ds_read_b128 a[248:251], v82 offset:40960
 v_mfma_f32_32x32x16_bf16 v[224:239], a[224:227], a[128:131], v[32:47]
 s_nop 8
 v_exp_f32 v192, v192
 v_exp_f32 v193, v193
 v_add_f32 v11, v11, v192
 v_mfma_f32_32x32x16_bf16 v[240:255], a[224:227], a[160:163], v[48:63]
 ds_read_b128 a[252:255], v83 offset:40960
 v_exp_f32 v194, v194
 v_add_f32 v11, v11, v193
 v_cvt_pk_bf16_f32 v192, v192, v193
 s_waitcnt lgkmcnt(2)
 v_mfma_f32_32x32x16_bf16 v[224:239], a[228:231], a[132:135], v[224:239]
 v_exp_f32 v195, v195
 v_add_f32 v11, v11, v194
 v_exp_f32 v196, v196
 v_add_f32 v11, v11, v195
 v_mfma_f32_32x32x16_bf16 v[240:255], a[228:231], a[164:167], v[240:255]
 s_waitcnt vmcnt(10)
 s_barrier
 ds_read_b64_tr_b16 a[192:193], v68 offset:49152
 ds_read_b64_tr_b16 a[194:195], v68 offset:50176
 v_cvt_pk_bf16_f32 v193, v194, v195
 v_mfma_f32_32x32x16_bf16 v[224:239], a[232:235], a[136:139], v[224:239]
 s_add_u32 m0, s93, 0x12000
 s_nop 0
 buffer_load_dwordx4 v108, s[96:99], s92 offen lds
 v_exp_f32 v197, v197
 v_add_f32 v11, v11, v196
 v_mfma_f32_32x32x16_bf16 v[240:255], a[232:235], a[168:171], v[240:255]
 ds_read_b64_tr_b16 a[196:197], v69 offset:49152
 ds_read_b64_tr_b16 a[198:199], v69 offset:50176
 v_exp_f32 v198, v198
 v_add_f32 v11, v11, v197
 v_cvt_pk_bf16_f32 v194, v196, v197
 v_mfma_f32_32x32x16_bf16 v[224:239], a[236:239], a[140:143], v[224:239]
 v_exp_f32 v199, v199
 v_add_f32 v11, v11, v198
 v_add_f32 v11, v11, v199
 v_cvt_pk_bf16_f32 v195, v198, v199
 v_mfma_f32_32x32x16_bf16 v[240:255], a[236:239], a[172:175], v[240:255]
 ds_read_b64_tr_b16 a[200:201], v70 offset:49152
 ds_read_b64_tr_b16 a[202:203], v70 offset:50176
 v_exp_f32 v200, v200
 v_exp_f32 v201, v201
 v_mfma_f32_32x32x16_bf16 v[224:239], a[240:243], a[144:147], v[224:239]
 s_add_u32 m0, s93, 0x12000
 s_nop 0
 buffer_load_dwordx4 v109, s[96:99], s92 offen offset:1024 lds
 v_add_f32 v11, v11, v200
 v_exp_f32 v202, v202
 v_add_f32 v11, v11, v201
 v_mfma_f32_32x32x16_bf16 v[240:255], a[240:243], a[176:179], v[240:255]
 ds_read_b64_tr_b16 a[204:205], v71 offset:49152
 ds_read_b64_tr_b16 a[206:207], v71 offset:50176
 v_cvt_pk_bf16_f32 v200, v200, v201
 v_exp_f32 v203, v203
 v_add_f32 v11, v11, v202
 v_mfma_f32_32x32x16_bf16 v[224:239], a[244:247], a[148:151], v[224:239]
 v_exp_f32 v204, v204
 v_add_f32 v11, v11, v203
 v_cvt_pk_bf16_f32 v201, v202, v203
 v_exp_f32 v205, v205
 v_mfma_f32_32x32x16_bf16 v[240:255], a[244:247], a[180:183], v[240:255]
 ds_read_b64_tr_b16 a[208:209], v68 offset:53248
 ds_read_b64_tr_b16 a[210:211], v68 offset:54272
 v_add_f32 v11, v11, v204
 v_exp_f32 v206, v206
 v_add_f32 v11, v11, v205
 s_waitcnt lgkmcnt(4)
 v_mfma_f32_32x32x16_bf16 v[224:239], a[248:251], a[152:155], v[224:239]
 s_add_u32 m0, s93, 0x12000
 s_nop 0
 buffer_load_dwordx4 v110, s[96:99], s92 offen offset:2048 lds
 v_cvt_pk_bf16_f32 v202, v204, v205
 v_exp_f32 v207, v207
 v_add_f32 v11, v11, v206
 v_mfma_f32_32x32x16_bf16 v[240:255], a[248:251], a[184:187], v[240:255]
 ds_read_b64_tr_b16 a[212:213], v69 offset:53248
 ds_read_b64_tr_b16 a[214:215], v69 offset:54272
 v_add_f32 v11, v11, v207
 v_cvt_pk_bf16_f32 v203, v206, v207
 v_exp_f32 v208, v208
 v_mfma_f32_32x32x16_bf16 v[224:239], a[252:255], a[156:159], v[224:239]
 v_exp_f32 v209, v209
 v_add_f32 v12, v12, v208
 v_exp_f32 v210, v210
 v_add_f32 v12, v12, v209
 v_mfma_f32_32x32x16_bf16 v[240:255], a[252:255], a[188:191], v[240:255]
 ds_read_b64_tr_b16 a[216:217], v70 offset:53248
 ds_read_b64_tr_b16 a[218:219], v70 offset:54272
 v_cvt_pk_bf16_f32 v208, v208, v209
 v_exp_f32 v211, v211
 v_add_f32 v12, v12, v210
 v_mfma_f32_32x32x16_bf16 a[0:15], a[192:195], v[128:131], a[0:15]
 s_add_u32 m0, s93, 0x12000
 s_nop 0
 buffer_load_dwordx4 v111, s[96:99], s92 offen offset:3072 lds
 v_exp_f32 v212, v212
 v_add_f32 v12, v12, v211
 v_cvt_pk_bf16_f32 v209, v210, v211
 v_mfma_f32_32x32x16_bf16 a[16:31], a[192:195], v[144:147], a[16:31]
 ds_read_b64_tr_b16 a[220:221], v71 offset:53248
 ds_read_b64_tr_b16 a[222:223], v71 offset:54272
 v_exp_f32 v213, v213
 v_add_f32 v12, v12, v212
 v_mfma_f32_32x32x16_bf16 a[32:47], a[196:199], v[128:131], a[32:47]
 v_exp_f32 v214, v214
 v_add_f32 v12, v12, v213
 v_cvt_pk_bf16_f32 v210, v212, v213
 v_exp_f32 v215, v215
 v_mfma_f32_32x32x16_bf16 a[48:63], a[196:199], v[144:147], a[48:63]
 ds_read_b64_tr_b16 a[224:225], v68 offset:57344
 ds_read_b64_tr_b16 a[226:227], v68 offset:58368
 v_add_f32 v12, v12, v214
 v_add_f32 v12, v12, v215
 v_cvt_pk_bf16_f32 v211, v214, v215
 v_mfma_f32_32x32x16_bf16 a[64:79], a[200:203], v[128:131], a[64:79]
 s_add_u32 m0, s93, 0x13000
 s_nop 0
 buffer_load_dwordx4 v112, s[96:99], s92 offen lds
 v_exp_f32 v216, v216
 v_exp_f32 v217, v217
 v_mfma_f32_32x32x16_bf16 a[80:95], a[200:203], v[144:147], a[80:95]
 ds_read_b64_tr_b16 a[228:229], v69 offset:57344
 ds_read_b64_tr_b16 a[230:231], v69 offset:58368
 v_add_f32 v12, v12, v216
 v_exp_f32 v218, v218
 v_add_f32 v12, v12, v217
 s_waitcnt lgkmcnt(4)
 v_mfma_f32_32x32x16_bf16 a[96:111], a[204:207], v[128:131], a[96:111]
 v_cvt_pk_bf16_f32 v216, v216, v217
 v_exp_f32 v219, v219
 v_add_f32 v12, v12, v218
 v_exp_f32 v220, v220
 v_mfma_f32_32x32x16_bf16 a[112:127], a[204:207], v[144:147], a[112:127]
 ds_read_b64_tr_b16 a[232:233], v70 offset:57344
 ds_read_b64_tr_b16 a[234:235], v70 offset:58368
 v_add_f32 v12, v12, v219
 v_cvt_pk_bf16_f32 v217, v218, v219
 v_exp_f32 v221, v221
 v_mfma_f32_32x32x16_bf16 a[0:15], a[208:211], v[136:139], a[0:15]
 s_add_u32 m0, s93, 0x13000
 s_nop 0
 buffer_load_dwordx4 v113, s[96:99], s92 offen offset:1024 lds
 v_add_f32 v12, v12, v220
 v_exp_f32 v222, v222
 v_add_f32 v12, v12, v221
 v_mfma_f32_32x32x16_bf16 a[16:31], a[208:211], v[152:155], a[16:31]
 ds_read_b64_tr_b16 a[236:237], v71 offset:57344
 ds_read_b64_tr_b16 a[238:239], v71 offset:58368
 v_cvt_pk_bf16_f32 v218, v220, v221
 v_exp_f32 v223, v223
 v_add_f32 v12, v12, v222
 v_mfma_f32_32x32x16_bf16 a[32:47], a[212:215], v[136:139], a[32:47]
 v_add_f32 v12, v12, v223
 v_cvt_pk_bf16_f32 v219, v222, v223
 v_exp_f32 v224, v224
 v_exp_f32 v225, v225
 v_mfma_f32_32x32x16_bf16 a[48:63], a[212:215], v[152:155], a[48:63]
 ds_read_b64_tr_b16 a[240:241], v68 offset:61440
 ds_read_b64_tr_b16 a[242:243], v68 offset:62464
 v_add_f32 v11, v11, v224
 v_exp_f32 v226, v226
 v_add_f32 v11, v11, v225
 v_mfma_f32_32x32x16_bf16 a[64:79], a[216:219], v[136:139], a[64:79]
 s_add_u32 m0, s93, 0x13000
 s_nop 0
 buffer_load_dwordx4 v114, s[96:99], s92 offen offset:2048 lds
 v_cvt_pk_bf16_f32 v224, v224, v225
 v_exp_f32 v227, v227
 v_add_f32 v11, v11, v226
 v_mfma_f32_32x32x16_bf16 a[80:95], a[216:219], v[152:155], a[80:95]
 ds_read_b64_tr_b16 a[244:245], v69 offset:61440
 ds_read_b64_tr_b16 a[246:247], v69 offset:62464
 v_exp_f32 v228, v228
 v_add_f32 v11, v11, v227
 v_cvt_pk_bf16_f32 v225, v226, v227
 v_mfma_f32_32x32x16_bf16 a[96:111], a[220:223], v[136:139], a[96:111]
 v_exp_f32 v229, v229
 v_add_f32 v11, v11, v228
 v_exp_f32 v230, v230
 v_add_f32 v11, v11, v229
 v_mfma_f32_32x32x16_bf16 a[112:127], a[220:223], v[152:155], a[112:127]
 ds_read_b64_tr_b16 a[248:249], v70 offset:61440
 ds_read_b64_tr_b16 a[250:251], v70 offset:62464
 v_cvt_pk_bf16_f32 v226, v228, v229
 v_exp_f32 v231, v231
 v_add_f32 v11, v11, v230
 s_waitcnt lgkmcnt(4)
 v_mfma_f32_32x32x16_bf16 a[0:15], a[224:227], v[160:163], a[0:15]
 s_add_u32 m0, s93, 0x13000
 s_nop 0
 buffer_load_dwordx4 v115, s[96:99], s92 offen offset:3072 lds
 v_add_f32 v11, v11, v231
 v_cvt_pk_bf16_f32 v227, v230, v231
 v_exp_f32 v232, v232
 v_mfma_f32_32x32x16_bf16 a[16:31], a[224:227], v[176:179], a[16:31]
 ds_read_b64_tr_b16 a[252:253], v71 offset:61440
 ds_read_b64_tr_b16 a[254:255], v71 offset:62464
 v_exp_f32 v233, v233
 v_add_f32 v11, v11, v232
 v_mfma_f32_32x32x16_bf16 a[32:47], a[228:231], v[160:163], a[32:47]
 v_exp_f32 v234, v234
 v_add_f32 v11, v11, v233
 v_cvt_pk_bf16_f32 v232, v232, v233
 v_exp_f32 v235, v235
 v_mfma_f32_32x32x16_bf16 a[48:63], a[228:231], v[176:179], a[48:63]
 s_waitcnt vmcnt(9)
 s_barrier
 ds_read_b64_tr_b16 a[192:193], v72
 ds_read_b64_tr_b16 a[194:195], v72 offset:1024
 v_add_f32 v11, v11, v234
 v_mfma_f32_32x32x16_bf16 a[64:79], a[232:235], v[160:163], a[64:79]
 s_add_u32 m0, s93, 0x14000
 s_nop 0
 buffer_load_dwordx4 v116, s[96:99], s92 offen lds
 v_exp_f32 v236, v236
 v_add_f32 v11, v11, v235
 v_cvt_pk_bf16_f32 v233, v234, v235
 v_mfma_f32_32x32x16_bf16 a[80:95], a[232:235], v[176:179], a[80:95]
 ds_read_b64_tr_b16 a[196:197], v72 offset:4096
 ds_read_b64_tr_b16 a[198:199], v72 offset:5120
 v_exp_f32 v237, v237
 v_add_f32 v11, v11, v236
 v_mfma_f32_32x32x16_bf16 a[96:111], a[236:239], v[160:163], a[96:111]
 v_exp_f32 v238, v238
 v_add_f32 v11, v11, v237
 v_cvt_pk_bf16_f32 v234, v236, v237
 v_exp_f32 v239, v239
 v_mfma_f32_32x32x16_bf16 a[112:127], a[236:239], v[176:179], a[112:127]
 ds_read_b64_tr_b16 a[200:201], v72 offset:8192
 ds_read_b64_tr_b16 a[202:203], v72 offset:9216
 v_add_f32 v11, v11, v238
 v_add_f32 v11, v11, v239
 v_cvt_pk_bf16_f32 v235, v238, v239
 v_mfma_f32_32x32x16_bf16 a[0:15], a[240:243], v[168:171], a[0:15]
 v_exp_f32 v240, v240
 v_exp_f32 v241, v241
 v_add_f32 v12, v12, v240
 v_mfma_f32_32x32x16_bf16 a[16:31], a[240:243], v[184:187], a[16:31]
 ds_read_b64_tr_b16 a[204:205], v72 offset:12288
 ds_read_b64_tr_b16 a[206:207], v72 offset:13312
 v_exp_f32 v242, v242
 v_add_f32 v12, v12, v241
 v_cvt_pk_bf16_f32 v240, v240, v241
 s_waitcnt lgkmcnt(4)
 v_mfma_f32_32x32x16_bf16 a[32:47], a[244:247], v[168:171], a[32:47]
 v_exp_f32 v243, v243
 v_add_f32 v12, v12, v242
 v_exp_f32 v244, v244
 v_add_f32 v12, v12, v243
 v_mfma_f32_32x32x16_bf16 a[48:63], a[244:247], v[184:187], a[48:63]
 ds_read_b64_tr_b16 a[208:209], v73
 ds_read_b64_tr_b16 a[210:211], v73 offset:1024
 v_cvt_pk_bf16_f32 v241, v242, v243
 v_exp_f32 v245, v245
 v_add_f32 v12, v12, v244
 v_mfma_f32_32x32x16_bf16 a[64:79], a[248:251], v[168:171], a[64:79]
 v_exp_f32 v246, v246
 v_add_f32 v12, v12, v245
 v_cvt_pk_bf16_f32 v242, v244, v245
 v_exp_f32 v247, v247
 v_mfma_f32_32x32x16_bf16 a[80:95], a[248:251], v[184:187], a[80:95]
 v_add_f32 v12, v12, v246
 v_add_f32 v12, v12, v247
 v_cvt_pk_bf16_f32 v243, v246, v247
 ds_read_b64_tr_b16 a[212:213], v73 offset:4096
 ds_read_b64_tr_b16 a[214:215], v73 offset:5120
 v_mfma_f32_32x32x16_bf16 a[96:111], a[252:255], v[168:171], a[96:111]
 v_exp_f32 v248, v248
 v_exp_f32 v249, v249
 v_add_f32 v12, v12, v248
 v_mfma_f32_32x32x16_bf16 a[112:127], a[252:255], v[184:187], a[112:127]
 v_exp_f32 v250, v250
 v_add_f32 v12, v12, v249
 v_cvt_pk_bf16_f32 v248, v248, v249
 v_exp_f32 v251, v251
 v_mfma_f32_32x32x16_bf16 a[0:15], a[192:195], v[192:195], a[0:15]
 v_add_f32 v12, v12, v250
 v_exp_f32 v252, v252
 v_add_f32 v12, v12, v251
 v_cvt_pk_bf16_f32 v249, v250, v251
 v_mfma_f32_32x32x16_bf16 a[16:31], a[192:195], v[208:211], a[16:31]
 v_exp_f32 v253, v253
 v_add_f32 v12, v12, v252
 v_exp_f32 v254, v254
 v_add_f32 v12, v12, v253
 v_mfma_f32_32x32x16_bf16 a[0:15], a[196:199], v[200:203], a[0:15]
 v_cvt_pk_bf16_f32 v250, v252, v253
 v_exp_f32 v255, v255
 v_add_f32 v12, v12, v254
 v_add_f32 v12, v12, v255
 v_cvt_pk_bf16_f32 v251, v254, v255
 v_mfma_f32_32x32x16_bf16 a[16:31], a[196:199], v[216:219], a[16:31]
 ds_read_b64_tr_b16 a[216:217], v73 offset:8192
 ds_read_b64_tr_b16 a[218:219], v73 offset:9216
 ds_read_b64_tr_b16 a[220:221], v73 offset:12288
 ds_read_b64_tr_b16 a[222:223], v73 offset:13312
 ds_read_b64_tr_b16 a[224:225], v74
 ds_read_b64_tr_b16 a[226:227], v74 offset:1024
 s_waitcnt lgkmcnt(6)
 v_mfma_f32_32x32x16_bf16 a[0:15], a[200:203], v[224:227], a[0:15]
 v_mfma_f32_32x32x16_bf16 a[16:31], a[200:203], v[240:243], a[16:31]
 ds_read_b64_tr_b16 a[228:229], v74 offset:4096
 ds_read_b64_tr_b16 a[230:231], v74 offset:5120
 v_mfma_f32_32x32x16_bf16 a[0:15], a[204:207], v[232:235], a[0:15]
 v_mov_b32 v17, v11
 s_nop 1
 v_permlane32_swap_b32 v17, v11
 v_add_f32 v11, v17, v11
 v_rcp_f32 v13, v11
 v_mov_b32 v18, v12
 v_mfma_f32_32x32x16_bf16 a[16:31], a[204:207], v[248:251], a[16:31]
 ds_read_b64_tr_b16 a[232:233], v74 offset:8192
 ds_read_b64_tr_b16 a[234:235], v74 offset:9216
 v_permlane32_swap_b32 v18, v12
 v_add_f32 v12, v18, v12
 v_rcp_f32 v14, v12
 v_mfma_f32_32x32x16_bf16 a[32:47], a[208:211], v[192:195], a[32:47]
 v_mov_b32 v122, 0
 v_mov_b32 v120, 0
 v_accvgpr_read_b32 v24, a0
 v_accvgpr_read_b32 v25, a1
 v_accvgpr_read_b32 v26, a2
 v_accvgpr_read_b32 v27, a3
 v_mfma_f32_32x32x16_bf16 a[48:63], a[208:211], v[208:211], a[48:63]
 ds_read_b64_tr_b16 a[236:237], v74 offset:12288
 ds_read_b64_tr_b16 a[238:239], v74 offset:13312
 v_accvgpr_read_b32 v28, a4
 v_accvgpr_read_b32 v29, a5
 v_accvgpr_read_b32 v30, a6
 v_accvgpr_read_b32 v31, a7
 v_mfma_f32_32x32x16_bf16 a[32:47], a[212:215], v[200:203], a[32:47]
 v_mul_f32 v24, v24, v13
 v_mul_f32 v25, v25, v13
 v_mul_f32 v26, v26, v13
 v_mul_f32 v27, v27, v13
 v_mul_f32 v28, v28, v13
 v_mul_f32 v29, v29, v13
 v_mfma_f32_32x32x16_bf16 a[48:63], a[212:215], v[216:219], a[48:63]
 ds_read_b64_tr_b16 a[240:241], v75
 ds_read_b64_tr_b16 a[242:243], v75 offset:1024
 v_mul_f32 v30, v30, v13
 v_mul_f32 v31, v31, v13
 v_cvt_pk_bf16_f32 v32, v24, v25
 v_cvt_pk_bf16_f32 v33, v26, v27
 s_waitcnt lgkmcnt(4)
 v_mfma_f32_32x32x16_bf16 a[32:47], a[216:219], v[224:227], a[32:47]
 v_cvt_pk_bf16_f32 v34, v28, v29
 v_cvt_pk_bf16_f32 v35, v30, v31
 buffer_store_dwordx4 v[32:35], v1, s[24:27], s36 offen sc1
 v_dot2c_f32_bf16 v122, v32, v120
 v_dot2c_f32_bf16 v122, v33, v120
 v_mfma_f32_32x32x16_bf16 a[48:63], a[216:219], v[240:243], a[48:63]
 ds_read_b64_tr_b16 a[244:245], v75 offset:4096
 ds_read_b64_tr_b16 a[246:247], v75 offset:5120
 v_dot2c_f32_bf16 v122, v34, v120
 v_dot2c_f32_bf16 v122, v35, v120
 v_accvgpr_read_b32 v36, a8
 v_accvgpr_read_b32 v37, a9
 v_mfma_f32_32x32x16_bf16 a[32:47], a[220:223], v[232:235], a[32:47]
 v_accvgpr_read_b32 v38, a10
 v_accvgpr_read_b32 v39, a11
 v_accvgpr_read_b32 v40, a12
 v_accvgpr_read_b32 v41, a13
 v_accvgpr_read_b32 v42, a14
 v_accvgpr_read_b32 v43, a15
 v_mfma_f32_32x32x16_bf16 a[48:63], a[220:223], v[248:251], a[48:63]
 ds_read_b64_tr_b16 a[248:249], v75 offset:8192
 ds_read_b64_tr_b16 a[250:251], v75 offset:9216
 v_mul_f32 v36, v36, v13
 v_mul_f32 v37, v37, v13
 v_mul_f32 v38, v38, v13
 v_mul_f32 v39, v39, v13
 v_mfma_f32_32x32x16_bf16 a[64:79], a[224:227], v[192:195], a[64:79]
 v_mul_f32 v40, v40, v13
 v_mul_f32 v41, v41, v13
 v_mul_f32 v42, v42, v13
 v_mul_f32 v43, v43, v13
 v_cvt_pk_bf16_f32 v44, v36, v37
 v_cvt_pk_bf16_f32 v45, v38, v39
 v_mfma_f32_32x32x16_bf16 a[80:95], a[224:227], v[208:211], a[80:95]
 ds_read_b64_tr_b16 a[252:253], v75 offset:12288
 ds_read_b64_tr_b16 a[254:255], v75 offset:13312
 v_cvt_pk_bf16_f32 v46, v40, v41
 v_cvt_pk_bf16_f32 v47, v42, v43
 buffer_store_dwordx4 v[44:47], v1, s[24:27], s36 offen offset:1024 sc1
 v_mfma_f32_32x32x16_bf16 a[64:79], a[228:231], v[200:203], a[64:79]
 v_dot2c_f32_bf16 v122, v44, v120
 v_dot2c_f32_bf16 v122, v45, v120
 v_dot2c_f32_bf16 v122, v46, v120
 v_dot2c_f32_bf16 v122, v47, v120
 v_permlane32_swap_b32 v32, v44
 v_permlane32_swap_b32 v33, v45
 v_mfma_f32_32x32x16_bf16 a[80:95], a[228:231], v[216:219], a[80:95]
 v_permlane32_swap_b32 v34, v46
 v_permlane32_swap_b32 v35, v47
 v_permlane16_swap_b32 v32, v44
 v_permlane16_swap_b32 v33, v45
 v_permlane16_swap_b32 v34, v46
 v_permlane16_swap_b32 v35, v47
 v_mfma_f32_32x32x16_bf16 a[64:79], a[232:235], v[224:227], a[64:79]
 v_accvgpr_write_b32 a0, v32
 v_accvgpr_write_b32 a4, v44
 v_accvgpr_write_b32 a1, v33
 v_accvgpr_write_b32 a5, v45
 v_accvgpr_write_b32 a2, v34
 v_accvgpr_write_b32 a6, v46
 v_mfma_f32_32x32x16_bf16 a[80:95], a[232:235], v[240:243], a[80:95]
 v_accvgpr_write_b32 a3, v35
 v_accvgpr_write_b32 a7, v47
 v_accvgpr_read_b32 v24, a16
 v_accvgpr_read_b32 v25, a17
 v_accvgpr_read_b32 v26, a18
 v_accvgpr_read_b32 v27, a19
 s_waitcnt lgkmcnt(0)
 v_mfma_f32_32x32x16_bf16 a[64:79], a[236:239], v[232:235], a[64:79]
 v_accvgpr_read_b32 v28, a20
 v_accvgpr_read_b32 v29, a21
 v_accvgpr_read_b32 v30, a22
 v_accvgpr_read_b32 v31, a23
 v_mul_f32 v24, v24, v14
 v_mul_f32 v25, v25, v14
 v_mfma_f32_32x32x16_bf16 a[80:95], a[236:239], v[248:251], a[80:95]
 v_mul_f32 v26, v26, v14
 v_mul_f32 v27, v27, v14
 v_mul_f32 v28, v28, v14
 v_mul_f32 v29, v29, v14
 v_mul_f32 v30, v30, v14
 v_mul_f32 v31, v31, v14
 v_mfma_f32_32x32x16_bf16 a[96:111], a[240:243], v[192:195], a[96:111]
 v_cvt_pk_bf16_f32 v32, v24, v25
 v_cvt_pk_bf16_f32 v33, v26, v27
 v_cvt_pk_bf16_f32 v34, v28, v29
 v_cvt_pk_bf16_f32 v35, v30, v31
 buffer_store_dwordx4 v[32:35], v1, s[24:27], s37 offen sc1
 v_mfma_f32_32x32x16_bf16 a[112:127], a[240:243], v[208:211], a[112:127]
 v_dot2c_f32_bf16 v122, v32, v120
 v_dot2c_f32_bf16 v122, v33, v120
 v_dot2c_f32_bf16 v122, v34, v120
 v_dot2c_f32_bf16 v122, v35, v120
 v_accvgpr_read_b32 v36, a24
 v_accvgpr_read_b32 v37, a25
 v_mfma_f32_32x32x16_bf16 a[96:111], a[244:247], v[200:203], a[96:111]
 v_accvgpr_read_b32 v38, a26
 v_accvgpr_read_b32 v39, a27
 v_accvgpr_read_b32 v40, a28
 v_accvgpr_read_b32 v41, a29
 v_accvgpr_read_b32 v42, a30
 v_accvgpr_read_b32 v43, a31
 v_mfma_f32_32x32x16_bf16 a[112:127], a[244:247], v[216:219], a[112:127]
 v_mul_f32 v36, v36, v14
 v_mul_f32 v37, v37, v14
 v_mul_f32 v38, v38, v14
 v_mul_f32 v39, v39, v14
 v_mul_f32 v40, v40, v14
 v_mul_f32 v41, v41, v14
 v_mfma_f32_32x32x16_bf16 a[96:111], a[248:251], v[224:227], a[96:111]
 v_mul_f32 v42, v42, v14
 v_mul_f32 v43, v43, v14
 v_cvt_pk_bf16_f32 v44, v36, v37
 v_cvt_pk_bf16_f32 v45, v38, v39
 v_cvt_pk_bf16_f32 v46, v40, v41
 v_cvt_pk_bf16_f32 v47, v42, v43
 v_mfma_f32_32x32x16_bf16 a[112:127], a[248:251], v[240:243], a[112:127]
 buffer_store_dwordx4 v[44:47], v1, s[24:27], s37 offen offset:1024 sc1
 v_dot2c_f32_bf16 v122, v44, v120
 v_dot2c_f32_bf16 v122, v45, v120
 v_dot2c_f32_bf16 v122, v46, v120
 v_dot2c_f32_bf16 v122, v47, v120
 v_mfma_f32_32x32x16_bf16 a[96:111], a[252:255], v[232:235], a[96:111]
 v_permlane32_swap_b32 v32, v44
 v_permlane32_swap_b32 v33, v45
 v_permlane32_swap_b32 v34, v46
 v_permlane32_swap_b32 v35, v47
 v_permlane16_swap_b32 v32, v44
 v_permlane16_swap_b32 v33, v45
 v_mfma_f32_32x32x16_bf16 a[112:127], a[252:255], v[248:251], a[112:127]
 v_permlane16_swap_b32 v34, v46
 v_permlane16_swap_b32 v35, v47
 v_accvgpr_write_b32 a8, v32
 v_accvgpr_write_b32 a12, v44
 v_accvgpr_write_b32 a9, v33
 v_accvgpr_write_b32 a13, v45
 v_accvgpr_write_b32 a10, v34
 v_accvgpr_write_b32 a14, v46
 v_accvgpr_write_b32 a11, v35
 v_accvgpr_write_b32 a15, v47
 v_accvgpr_read_b32 v24, a32
 v_accvgpr_read_b32 v25, a33
 v_accvgpr_read_b32 v26, a34
 v_accvgpr_read_b32 v27, a35
 v_accvgpr_read_b32 v28, a36
 v_accvgpr_read_b32 v29, a37
 v_accvgpr_read_b32 v30, a38
 v_accvgpr_read_b32 v31, a39
 v_mul_f32 v24, v24, v13
 v_mul_f32 v25, v25, v13
 v_mul_f32 v26, v26, v13
 v_mul_f32 v27, v27, v13
 v_mul_f32 v28, v28, v13
 v_mul_f32 v29, v29, v13
 v_mul_f32 v30, v30, v13
 v_mul_f32 v31, v31, v13
 v_cvt_pk_bf16_f32 v32, v24, v25
 v_cvt_pk_bf16_f32 v33, v26, v27
 v_cvt_pk_bf16_f32 v34, v28, v29
 v_cvt_pk_bf16_f32 v35, v30, v31
 buffer_store_dwordx4 v[32:35], v1, s[24:27], s36 offen offset:2048 sc1
 v_dot2c_f32_bf16 v122, v32, v120
 v_dot2c_f32_bf16 v122, v33, v120
 v_dot2c_f32_bf16 v122, v34, v120
 v_dot2c_f32_bf16 v122, v35, v120
 v_accvgpr_read_b32 v36, a40
 v_accvgpr_read_b32 v37, a41
 v_accvgpr_read_b32 v38, a42
 v_accvgpr_read_b32 v39, a43
 v_accvgpr_read_b32 v40, a44
 v_accvgpr_read_b32 v41, a45
 v_accvgpr_read_b32 v42, a46
 v_accvgpr_read_b32 v43, a47
 v_mul_f32 v36, v36, v13
 v_mul_f32 v37, v37, v13
 v_mul_f32 v38, v38, v13
 v_mul_f32 v39, v39, v13
 v_mul_f32 v40, v40, v13
 v_mul_f32 v41, v41, v13
 v_mul_f32 v42, v42, v13
 v_mul_f32 v43, v43, v13
 v_cvt_pk_bf16_f32 v44, v36, v37
 v_cvt_pk_bf16_f32 v45, v38, v39
 v_cvt_pk_bf16_f32 v46, v40, v41
 v_cvt_pk_bf16_f32 v47, v42, v43
 buffer_store_dwordx4 v[44:47], v1, s[24:27], s36 offen offset:3072 sc1
 v_dot2c_f32_bf16 v122, v44, v120
 v_dot2c_f32_bf16 v122, v45, v120
 v_dot2c_f32_bf16 v122, v46, v120
 v_dot2c_f32_bf16 v122, v47, v120
 v_permlane32_swap_b32 v32, v44
 v_permlane32_swap_b32 v33, v45
 v_permlane32_swap_b32 v34, v46
 v_permlane32_swap_b32 v35, v47
 v_permlane16_swap_b32 v32, v44
 v_permlane16_swap_b32 v33, v45
 v_permlane16_swap_b32 v34, v46
 v_permlane16_swap_b32 v35, v47
 v_accvgpr_write_b32 a16, v32
 v_accvgpr_write_b32 a20, v44
 v_accvgpr_write_b32 a17, v33
 v_accvgpr_write_b32 a21, v45
 v_accvgpr_write_b32 a18, v34
 v_accvgpr_write_b32 a22, v46
 v_accvgpr_write_b32 a19, v35
 v_accvgpr_write_b32 a23, v47
 v_accvgpr_read_b32 v24, a48
 v_accvgpr_read_b32 v25, a49
 v_accvgpr_read_b32 v26, a50
 v_accvgpr_read_b32 v27, a51
 v_accvgpr_read_b32 v28, a52
 v_accvgpr_read_b32 v29, a53
 v_accvgpr_read_b32 v30, a54
 v_accvgpr_read_b32 v31, a55
 v_mul_f32 v24, v24, v14
 v_mul_f32 v25, v25, v14
 v_mul_f32 v26, v26, v14
 v_mul_f32 v27, v27, v14
 v_mul_f32 v28, v28, v14
 v_mul_f32 v29, v29, v14
 v_mul_f32 v30, v30, v14
 v_mul_f32 v31, v31, v14
 v_cvt_pk_bf16_f32 v32, v24, v25
 v_cvt_pk_bf16_f32 v33, v26, v27
 v_cvt_pk_bf16_f32 v34, v28, v29
 v_cvt_pk_bf16_f32 v35, v30, v31
 buffer_store_dwordx4 v[32:35], v1, s[24:27], s37 offen offset:2048 sc1
 v_dot2c_f32_bf16 v122, v32, v120
 v_dot2c_f32_bf16 v122, v33, v120
 v_dot2c_f32_bf16 v122, v34, v120
 v_dot2c_f32_bf16 v122, v35, v120
 v_accvgpr_read_b32 v36, a56
 v_accvgpr_read_b32 v37, a57
 v_accvgpr_read_b32 v38, a58
 v_accvgpr_read_b32 v39, a59
 v_accvgpr_read_b32 v40, a60
 v_accvgpr_read_b32 v41, a61
 v_accvgpr_read_b32 v42, a62
 v_accvgpr_read_b32 v43, a63
 v_mul_f32 v36, v36, v14
 v_mul_f32 v37, v37, v14
 v_mul_f32 v38, v38, v14
 v_mul_f32 v39, v39, v14
 v_mul_f32 v40, v40, v14
 v_mul_f32 v41, v41, v14
 v_mul_f32 v42, v42, v14
 v_mul_f32 v43, v43, v14
 v_cvt_pk_bf16_f32 v44, v36, v37
 v_cvt_pk_bf16_f32 v45, v38, v39
 v_cvt_pk_bf16_f32 v46, v40, v41
 v_cvt_pk_bf16_f32 v47, v42, v43
 buffer_store_dwordx4 v[44:47], v1, s[24:27], s37 offen offset:3072 sc1
 v_dot2c_f32_bf16 v122, v44, v120
 v_dot2c_f32_bf16 v122, v45, v120
 v_dot2c_f32_bf16 v122, v46, v120
 v_dot2c_f32_bf16 v122, v47, v120
 v_permlane32_swap_b32 v32, v44
 v_permlane32_swap_b32 v33, v45
 v_permlane32_swap_b32 v34, v46
 v_permlane32_swap_b32 v35, v47
 v_permlane16_swap_b32 v32, v44
 v_permlane16_swap_b32 v33, v45
 v_permlane16_swap_b32 v34, v46
 v_permlane16_swap_b32 v35, v47
 v_accvgpr_write_b32 a24, v32
 v_accvgpr_write_b32 a28, v44
 v_accvgpr_write_b32 a25, v33
 v_accvgpr_write_b32 a29, v45
 v_accvgpr_write_b32 a26, v34
 v_accvgpr_write_b32 a30, v46
 v_accvgpr_write_b32 a27, v35
 v_accvgpr_write_b32 a31, v47
 v_accvgpr_read_b32 v24, a64
 v_accvgpr_read_b32 v25, a65
 v_accvgpr_read_b32 v26, a66
 v_accvgpr_read_b32 v27, a67
 v_accvgpr_read_b32 v28, a68
 v_accvgpr_read_b32 v29, a69
 v_accvgpr_read_b32 v30, a70
 v_accvgpr_read_b32 v31, a71
 v_mul_f32 v24, v24, v13
 v_mul_f32 v25, v25, v13
 v_mul_f32 v26, v26, v13
 v_mul_f32 v27, v27, v13
 v_mul_f32 v28, v28, v13
 v_mul_f32 v29, v29, v13
 v_mul_f32 v30, v30, v13
 v_mul_f32 v31, v31, v13
 v_cvt_pk_bf16_f32 v32, v24, v25
 v_cvt_pk_bf16_f32 v33, v26, v27
 v_cvt_pk_bf16_f32 v34, v28, v29
 v_cvt_pk_bf16_f32 v35, v30, v31
 s_add_u32 s47, s36, 0x1000
 buffer_store_dwordx4 v[32:35], v1, s[24:27], s47 offen sc1
 v_dot2c_f32_bf16 v122, v32, v120
 v_dot2c_f32_bf16 v122, v33, v120
 v_dot2c_f32_bf16 v122, v34, v120
 v_dot2c_f32_bf16 v122, v35, v120
 v_accvgpr_read_b32 v36, a72
 v_accvgpr_read_b32 v37, a73
 v_accvgpr_read_b32 v38, a74
 v_accvgpr_read_b32 v39, a75
 v_accvgpr_read_b32 v40, a76
 v_accvgpr_read_b32 v41, a77
 v_accvgpr_read_b32 v42, a78
 v_accvgpr_read_b32 v43, a79
 v_mul_f32 v36, v36, v13
 v_mul_f32 v37, v37, v13
 v_mul_f32 v38, v38, v13
 v_mul_f32 v39, v39, v13
 v_mul_f32 v40, v40, v13
 v_mul_f32 v41, v41, v13
 v_mul_f32 v42, v42, v13
 v_mul_f32 v43, v43, v13
 v_cvt_pk_bf16_f32 v44, v36, v37
 v_cvt_pk_bf16_f32 v45, v38, v39
 v_cvt_pk_bf16_f32 v46, v40, v41
 v_cvt_pk_bf16_f32 v47, v42, v43
 s_add_u32 s47, s36, 0x1000
 buffer_store_dwordx4 v[44:47], v1, s[24:27], s47 offen offset:1024 sc1
 v_dot2c_f32_bf16 v122, v44, v120
 v_dot2c_f32_bf16 v122, v45, v120
 v_dot2c_f32_bf16 v122, v46, v120
 v_dot2c_f32_bf16 v122, v47, v120
 v_permlane32_swap_b32 v32, v44
 v_permlane32_swap_b32 v33, v45
 v_permlane32_swap_b32 v34, v46
 v_permlane32_swap_b32 v35, v47
 v_permlane16_swap_b32 v32, v44
 v_permlane16_swap_b32 v33, v45
 v_permlane16_swap_b32 v34, v46
 v_permlane16_swap_b32 v35, v47
 v_accvgpr_write_b32 a32, v32
 v_accvgpr_write_b32 a36, v44
 v_accvgpr_write_b32 a33, v33
 v_accvgpr_write_b32 a37, v45
 v_accvgpr_write_b32 a34, v34
 v_accvgpr_write_b32 a38, v46
 v_accvgpr_write_b32 a35, v35
 v_accvgpr_write_b32 a39, v47
 v_accvgpr_read_b32 v24, a80
 v_accvgpr_read_b32 v25, a81
 v_accvgpr_read_b32 v26, a82
 v_accvgpr_read_b32 v27, a83
 v_accvgpr_read_b32 v28, a84
 v_accvgpr_read_b32 v29, a85
 v_accvgpr_read_b32 v30, a86
 v_accvgpr_read_b32 v31, a87
 v_mul_f32 v24, v24, v14
 v_mul_f32 v25, v25, v14
 v_mul_f32 v26, v26, v14
 v_mul_f32 v27, v27, v14
 v_mul_f32 v28, v28, v14
 v_mul_f32 v29, v29, v14
 v_mul_f32 v30, v30, v14
 v_mul_f32 v31, v31, v14
 v_cvt_pk_bf16_f32 v32, v24, v25
 v_cvt_pk_bf16_f32 v33, v26, v27
 v_cvt_pk_bf16_f32 v34, v28, v29
 v_cvt_pk_bf16_f32 v35, v30, v31
 s_add_u32 s47, s37, 0x1000
 buffer_store_dwordx4 v[32:35], v1, s[24:27], s47 offen sc1
 v_dot2c_f32_bf16 v122, v32, v120
 v_dot2c_f32_bf16 v122, v33, v120
 v_dot2c_f32_bf16 v122, v34, v120
 v_dot2c_f32_bf16 v122, v35, v120
 v_accvgpr_read_b32 v36, a88
 v_accvgpr_read_b32 v37, a89
 v_accvgpr_read_b32 v38, a90
 v_accvgpr_read_b32 v39, a91
 v_accvgpr_read_b32 v40, a92
 v_accvgpr_read_b32 v41, a93
 v_accvgpr_read_b32 v42, a94
 v_accvgpr_read_b32 v43, a95
 v_mul_f32 v36, v36, v14
 v_mul_f32 v37, v37, v14
 v_mul_f32 v38, v38, v14
 v_mul_f32 v39, v39, v14
 v_mul_f32 v40, v40, v14
 v_mul_f32 v41, v41, v14
 v_mul_f32 v42, v42, v14
 v_mul_f32 v43, v43, v14
 v_cvt_pk_bf16_f32 v44, v36, v37
 v_cvt_pk_bf16_f32 v45, v38, v39
 v_cvt_pk_bf16_f32 v46, v40, v41
 v_cvt_pk_bf16_f32 v47, v42, v43
 s_add_u32 s47, s37, 0x1000
 buffer_store_dwordx4 v[44:47], v1, s[24:27], s47 offen offset:1024 sc1
 v_dot2c_f32_bf16 v122, v44, v120
 v_dot2c_f32_bf16 v122, v45, v120
 v_dot2c_f32_bf16 v122, v46, v120
 v_dot2c_f32_bf16 v122, v47, v120
 v_permlane32_swap_b32 v32, v44
 v_permlane32_swap_b32 v33, v45
 v_permlane32_swap_b32 v34, v46
 v_permlane32_swap_b32 v35, v47
 v_permlane16_swap_b32 v32, v44
 v_permlane16_swap_b32 v33, v45
 v_permlane16_swap_b32 v34, v46
 v_permlane16_swap_b32 v35, v47
 v_accvgpr_write_b32 a40, v32
 v_accvgpr_write_b32 a44, v44
 v_accvgpr_write_b32 a41, v33
 v_accvgpr_write_b32 a45, v45
 v_accvgpr_write_b32 a42, v34
 v_accvgpr_write_b32 a46, v46
 v_accvgpr_write_b32 a43, v35
 v_accvgpr_write_b32 a47, v47
 v_accvgpr_read_b32 v24, a96
 v_accvgpr_read_b32 v25, a97
 v_accvgpr_read_b32 v26, a98
 v_accvgpr_read_b32 v27, a99
 v_accvgpr_read_b32 v28, a100
 v_accvgpr_read_b32 v29, a101
 v_accvgpr_read_b32 v30, a102
 v_accvgpr_read_b32 v31, a103
 v_mul_f32 v24, v24, v13
 v_mul_f32 v25, v25, v13
 v_mul_f32 v26, v26, v13
 v_mul_f32 v27, v27, v13
 v_mul_f32 v28, v28, v13
 v_mul_f32 v29, v29, v13
 v_mul_f32 v30, v30, v13
 v_mul_f32 v31, v31, v13
 v_cvt_pk_bf16_f32 v32, v24, v25
 v_cvt_pk_bf16_f32 v33, v26, v27
 v_cvt_pk_bf16_f32 v34, v28, v29
 v_cvt_pk_bf16_f32 v35, v30, v31
 s_add_u32 s47, s36, 0x1000
 buffer_store_dwordx4 v[32:35], v1, s[24:27], s47 offen offset:2048 sc1
 v_dot2c_f32_bf16 v122, v32, v120
 v_dot2c_f32_bf16 v122, v33, v120
 v_dot2c_f32_bf16 v122, v34, v120
 v_dot2c_f32_bf16 v122, v35, v120
 v_accvgpr_read_b32 v36, a104
 v_accvgpr_read_b32 v37, a105
 v_accvgpr_read_b32 v38, a106
 v_accvgpr_read_b32 v39, a107
 v_accvgpr_read_b32 v40, a108
 v_accvgpr_read_b32 v41, a109
 v_accvgpr_read_b32 v42, a110
 v_accvgpr_read_b32 v43, a111
 v_mul_f32 v36, v36, v13
 v_mul_f32 v37, v37, v13
 v_mul_f32 v38, v38, v13
 v_mul_f32 v39, v39, v13
 v_mul_f32 v40, v40, v13
 v_mul_f32 v41, v41, v13
 v_mul_f32 v42, v42, v13
 v_mul_f32 v43, v43, v13
 v_cvt_pk_bf16_f32 v44, v36, v37
 v_cvt_pk_bf16_f32 v45, v38, v39
 v_cvt_pk_bf16_f32 v46, v40, v41
 v_cvt_pk_bf16_f32 v47, v42, v43
 s_add_u32 s47, s36, 0x1000
 buffer_store_dwordx4 v[44:47], v1, s[24:27], s47 offen offset:3072 sc1
 v_dot2c_f32_bf16 v122, v44, v120
 v_dot2c_f32_bf16 v122, v45, v120
 v_dot2c_f32_bf16 v122, v46, v120
 v_dot2c_f32_bf16 v122, v47, v120
 v_permlane32_swap_b32 v32, v44
 v_permlane32_swap_b32 v33, v45
 v_permlane32_swap_b32 v34, v46
 v_permlane32_swap_b32 v35, v47
 v_permlane16_swap_b32 v32, v44
 v_permlane16_swap_b32 v33, v45
 v_permlane16_swap_b32 v34, v46
 v_permlane16_swap_b32 v35, v47
 v_accvgpr_write_b32 a48, v32
 v_accvgpr_write_b32 a52, v44
 v_accvgpr_write_b32 a49, v33
 v_accvgpr_write_b32 a53, v45
 v_accvgpr_write_b32 a50, v34
 v_accvgpr_write_b32 a54, v46
 v_accvgpr_write_b32 a51, v35
 v_accvgpr_write_b32 a55, v47
 v_accvgpr_read_b32 v24, a112
 v_accvgpr_read_b32 v25, a113
 v_accvgpr_read_b32 v26, a114
 v_accvgpr_read_b32 v27, a115
 v_accvgpr_read_b32 v28, a116
 v_accvgpr_read_b32 v29, a117
 v_accvgpr_read_b32 v30, a118
 v_accvgpr_read_b32 v31, a119
 v_mul_f32 v24, v24, v14
 v_mul_f32 v25, v25, v14
 v_mul_f32 v26, v26, v14
 v_mul_f32 v27, v27, v14
 v_mul_f32 v28, v28, v14
 v_mul_f32 v29, v29, v14
 v_mul_f32 v30, v30, v14
 v_mul_f32 v31, v31, v14
 v_cvt_pk_bf16_f32 v32, v24, v25
 v_cvt_pk_bf16_f32 v33, v26, v27
 v_cvt_pk_bf16_f32 v34, v28, v29
 v_cvt_pk_bf16_f32 v35, v30, v31
 s_add_u32 s47, s37, 0x1000
 buffer_store_dwordx4 v[32:35], v1, s[24:27], s47 offen offset:2048 sc1
 v_dot2c_f32_bf16 v122, v32, v120
 v_dot2c_f32_bf16 v122, v33, v120
 v_dot2c_f32_bf16 v122, v34, v120
 v_dot2c_f32_bf16 v122, v35, v120
 v_accvgpr_read_b32 v36, a120
 v_accvgpr_read_b32 v37, a121
 v_accvgpr_read_b32 v38, a122
 v_accvgpr_read_b32 v39, a123
 v_accvgpr_read_b32 v40, a124
 v_accvgpr_read_b32 v41, a125
 v_accvgpr_read_b32 v42, a126
 v_accvgpr_read_b32 v43, a127
 v_mul_f32 v36, v36, v14
 v_mul_f32 v37, v37, v14
 v_mul_f32 v38, v38, v14
 v_mul_f32 v39, v39, v14
 v_mul_f32 v40, v40, v14
 v_mul_f32 v41, v41, v14
 v_mul_f32 v42, v42, v14
 v_mul_f32 v43, v43, v14
 v_cvt_pk_bf16_f32 v44, v36, v37
 v_cvt_pk_bf16_f32 v45, v38, v39
 v_cvt_pk_bf16_f32 v46, v40, v41
 v_cvt_pk_bf16_f32 v47, v42, v43
 s_add_u32 s47, s37, 0x1000
 buffer_store_dwordx4 v[44:47], v1, s[24:27], s47 offen offset:3072 sc1
 v_dot2c_f32_bf16 v122, v44, v120
 v_dot2c_f32_bf16 v122, v45, v120
 v_dot2c_f32_bf16 v122, v46, v120
 v_dot2c_f32_bf16 v122, v47, v120
 v_permlane32_swap_b32 v32, v44
 v_permlane32_swap_b32 v33, v45
 v_permlane32_swap_b32 v34, v46
 v_permlane32_swap_b32 v35, v47
 v_permlane16_swap_b32 v32, v44
 v_permlane16_swap_b32 v33, v45
 v_permlane16_swap_b32 v34, v46
 v_permlane16_swap_b32 v35, v47
 v_accvgpr_write_b32 a56, v32
 v_accvgpr_write_b32 a60, v44
 v_accvgpr_write_b32 a57, v33
 v_accvgpr_write_b32 a61, v45
 v_accvgpr_write_b32 a58, v34
 v_accvgpr_write_b32 a62, v46
 v_accvgpr_write_b32 a59, v35
 v_accvgpr_write_b32 a63, v47
 s_nop 3
 v_max_f32 v17, v11, v12
 v_add_f32 v18, v11, v12
 v_fma_f32 v17, v18, v120, v17
 v_add_f32 v17, v17, v122
 v_mov_b32 v18, 0x71800000
 v_cmp_nlt_f32 vcc, v17, v18
 v_mov_b32 v19, 0x1c000
 s_cmp_lg_u64 vcc, 0
 s_cselect_b32 s40, 1, 0
 v_mov_b32 v20, s40
 s_lshl_b32 s41, s28, 2
 v_add_u32 v21, s41, v19
 ds_write_b32 v21, v20
 s_waitcnt lgkmcnt(0)
 s_barrier
 ds_read_b128 v[24:27], v19
 s_waitcnt lgkmcnt(0)
 v_or3_b32 v17, v24, v25, v26
 v_or_b32 v17, v17, v27
 s_nop 0
 v_readfirstlane_b32 s40, v17
 s_nop 0
 s_cmp_lg_u32 s40, 0
 s_cbranch_scc1 attn_slow
attn_cont:
 s_barrier
ph_oproj:
 v_mov_b32 v2, v108
 v_mov_b32 v3, v109
 v_mov_b32 v4, v110
 v_mov_b32 v5, v111
 v_mov_b32 v6, v112
 v_mov_b32 v7, v113
 v_mov_b32 v8, v114
 v_mov_b32 v9, v115
 v_mov_b32 v10, v116
 v_mbcnt_lo_u32_b32 v0, -1, 0
 v_mbcnt_hi_u32_b32 v0, -1, v0
 v_lshl_add_u32 v0, s100, 6, v0
 s_load_dwordx2 s[4:5], s[0:1], 0x68
 s_load_dwordx2 s[8:9], s[0:1], 32
 s_load_dwordx2 s[12:13], s[0:1], 0x68
 s_load_dwordx2 s[16:17], s[0:1], 0x68
 s_load_dwordx2 s[20:21], s[0:1], 0x68
 s_load_dwordx2 s[24:25], s[0:1], 0
 s_load_dwordx2 s[28:29], s[0:1], 0x68
 s_load_dwordx2 s[32:33], s[0:1], 0x68
 v_mov_b32 v17, v0
 v_lshrrev_b32 v1, 6, v0
 s_nop 0
 v_readfirstlane_b32 s36, v1
 v_and_b32 v0, 63, v0
 v_lshlrev_b32 v1, 4, v0
 s_and_b32 s37, s2, 7
 s_lshr_b32 s84, s2, 3
 s_and_b32 s39, s84, 3
 s_lshr_b32 s38, s84, 2
 s_lshl_b32 s84, s38, 3
 s_lshl_b32 s85, s36, 1
 s_add_u32 s86, s84, s85
 s_mul_i32 s42, s86, 0x48000
 s_mul_i32 s84, s37, 0x9000
 s_add_u32 s42, s42, s84
 s_add_u32 s43, s42, 0x48000
 s_mul_i32 s45, s37, 0x240000
 s_mul_i32 s84, s86, 0x9000
 s_add_u32 s45, s45, s84
 s_mul_i32 s84, s39, 0x2400
 s_add_u32 s45, s45, s84
 s_add_u32 s46, s45, 0x9000
 s_mul_i32 s41, s37, 0x90000
 s_mul_i32 s84, s36, 0x9000
 s_add_u32 s41, s41, s84
 s_mul_i32 s84, s39, 0x120
 s_add_u32 s41, s41, s84
 s_mul_i32 s44, s36, 0x2400
 v_lshrrev_b32 v18, 5, v0
 v_lshlrev_b32 v11, 10, v18
 v_bfe_u32 v18, v0, 4, 1
 v_lshl_add_u32 v11, v18, 9, v11
 v_and_b32 v19, 15, v0
 v_lshl_add_u32 v11, v19, 4, v11
 s_movk_i32 s85, 0xe39
 s_waitcnt lgkmcnt(0)
 s_add_u32 s4, s4, 0x5800000
 s_addc_u32 s5, s5, 0
 s_mov_b32 s6, 0x1200000
 s_mov_b32 s7, 0x20000
 s_mov_b32 s10, 0x480000
 s_mov_b32 s11, 0x20000
 s_mov_b32 s14, 0xa200
 s_mov_b32 s15, 0x20000
 s_add_u32 s16, s16, 0x3200000
 s_addc_u32 s17, s17, 0
 s_mov_b32 s18, 0x1200000
 s_mov_b32 s19, 0x20000
 s_add_u32 s20, s20, 0x2a00000
 s_addc_u32 s21, s21, 0
 s_mov_b32 s22, 0x40000
 s_mov_b32 s23, 0x20000
 s_mov_b32 s26, 0x240000
 s_mov_b32 s27, 0x20000
 s_add_u32 s28, s28, 0x280000
 s_addc_u32 s29, s29, 0
 s_mov_b32 s30, 0x240000
 s_mov_b32 s31, 0x20000
 s_add_u32 s32, s32, 0x4c0000
 s_addc_u32 s33, s33, 0
 s_mov_b32 s34, 0x240000
 s_mov_b32 s35, 0x20000
 s_lshl_b32 s84, s38, 3
 s_add_u32 s84, s84, s37
 s_lshl_b32 s84, s84, 2
 s_add_u32 s84, s84, s36
 s_lshl_b32 s84, s84, 7
 s_add_u32 s93, s84, 0x18000
 s_cmp_le_u32 s39, 2
 s_cselect_b32 s87, 3, 2
 s_mul_i32 s87, s87, 0x24000
 s_add_u32 s87, s87, s41
 s_add_u32 m0, s44, 0x1b000
 s_nop 0
 buffer_load_dwordx4 v2, s[8:11], s87 offen lds
 buffer_load_dwordx4 v3, s[8:11], s87 offen offset:1024 lds
 buffer_load_dwordx4 v4, s[8:11], s87 offen offset:2048 lds
 buffer_load_dwordx4 v5, s[8:11], s87 offen offset:3072 lds
 s_add_u32 m0, s44, 0x1c000
 s_nop 0
 buffer_load_dwordx4 v6, s[8:11], s87 offen lds
 buffer_load_dwordx4 v7, s[8:11], s87 offen offset:1024 lds
 buffer_load_dwordx4 v8, s[8:11], s87 offen offset:2048 lds
 buffer_load_dwordx4 v9, s[8:11], s87 offen offset:3072 lds
 s_add_u32 m0, s44, 0x1d000
 s_nop 0
 buffer_load_dwordx4 v10, s[8:11], s87 offen lds
 v_bfe_u32 v19, v0, 2, 2
 v_lshrrev_b32 v20, 5, v0
 v_lshlrev_b32 v20, 4, v20
 v_bfe_u32 v23, v0, 4, 1
 v_lshl_add_u32 v20, v23, 2, v20
 v_add_u32 v20, v20, v19
 v_mul_u32_u24 v20, 0x120, v20
 v_and_b32 v21, 3, v0
 v_lshl_add_u32 v12, v21, 3, v20
 v_add_u32 v13, 0xd800, v12
 v_add_u32 v14, 0x1b000, v12
 v_mov_b32 v16, 1
 v_lshlrev_b32 v15, 20, v0
 s_lshl_b32 s84, s38, 2
 s_add_u32 s84, s84, s36
 s_lshl_b32 s84, s84, 2
 s_add_u32 s84, s84, s39
 s_mul_i32 s92, s84, 0x180
 s_add_u32 s92, s92, 0
 ds_read_b64_tr_b16 v[64:65], v12
 ds_read_b64_tr_b16 v[66:67], v12 offset:2304
 ds_read_b64_tr_b16 v[68:69], v12 offset:32
 ds_read_b64_tr_b16 v[70:71], v12 offset:2336
 ds_read_b64_tr_b16 v[72:73], v12 offset:64
 ds_read_b64_tr_b16 v[74:75], v12 offset:2368
 s_waitcnt lgkmcnt(4)
 v_mfma_f32_16x16x32_bf16 v[112:115], v[64:67], a[0:3], 0
 ds_read_b64_tr_b16 v[76:77], v12 offset:96
 ds_read_b64_tr_b16 v[78:79], v12 offset:2400
 v_mfma_f32_16x16x32_bf16 v[116:119], v[64:67], a[4:7], 0
 ds_read_b64_tr_b16 v[80:81], v12 offset:128
 ds_read_b64_tr_b16 v[82:83], v12 offset:2432
 v_mfma_f32_16x16x32_bf16 v[120:123], v[64:67], a[8:11], 0
 ds_read_b64_tr_b16 v[84:85], v12 offset:160
 ds_read_b64_tr_b16 v[86:87], v12 offset:2464
 v_mfma_f32_16x16x32_bf16 v[124:127], v[64:67], a[12:15], 0
 ds_read_b64_tr_b16 v[88:89], v12 offset:192
 ds_read_b64_tr_b16 v[90:91], v12 offset:2496
 s_waitcnt lgkmcnt(10)
 v_mfma_f32_16x16x32_bf16 v[128:131], v[68:71], a[0:3], 0
 ds_read_b64_tr_b16 v[92:93], v12 offset:224
 ds_read_b64_tr_b16 v[94:95], v12 offset:2528
 v_mfma_f32_16x16x32_bf16 v[132:135], v[68:71], a[4:7], 0
 ds_read_b64_tr_b16 v[96:97], v12 offset:256
 ds_read_b64_tr_b16 v[98:99], v12 offset:2560
 v_mfma_f32_16x16x32_bf16 v[136:139], v[68:71], a[8:11], 0
 v_mfma_f32_16x16x32_bf16 v[140:143], v[68:71], a[12:15], 0
 ds_read_b64_tr_b16 v[100:101], v12 offset:9216
 s_waitcnt lgkmcnt(14)
 ds_read_b64_tr_b16 v[102:103], v12 offset:11520
 s_waitcnt lgkmcnt(12)
 v_mfma_f32_16x16x32_bf16 v[144:147], v[72:75], a[0:3], 0
 v_mfma_f32_16x16x32_bf16 v[148:151], v[72:75], a[4:7], 0
 v_mfma_f32_16x16x32_bf16 v[152:155], v[72:75], a[8:11], 0
 v_mfma_f32_16x16x32_bf16 v[156:159], v[72:75], a[12:15], 0
 ds_read_b64_tr_b16 v[104:105], v12 offset:9248
 ds_read_b64_tr_b16 v[106:107], v12 offset:11552
 v_mfma_f32_16x16x32_bf16 v[160:163], v[76:79], a[0:3], 0
 v_mfma_f32_16x16x32_bf16 v[164:167], v[76:79], a[4:7], 0
 v_mfma_f32_16x16x32_bf16 v[168:171], v[76:79], a[8:11], 0
 v_mfma_f32_16x16x32_bf16 v[172:175], v[76:79], a[12:15], 0
 ds_read_b64_tr_b16 v[108:109], v12 offset:9280
 s_waitcnt lgkmcnt(14)
 ds_read_b64_tr_b16 v[110:111], v12 offset:11584
 s_waitcnt lgkmcnt(4)
 v_mfma_f32_16x16x32_bf16 v[176:179], v[80:83], a[0:3], 0
 v_mfma_f32_16x16x32_bf16 v[180:183], v[80:83], a[4:7], 0
 v_mfma_f32_16x16x32_bf16 v[184:187], v[80:83], a[8:11], 0
 v_mfma_f32_16x16x32_bf16 v[188:191], v[80:83], a[12:15], 0
 ds_read_b64_tr_b16 v[64:65], v12 offset:9312
 ds_read_b64_tr_b16 v[66:67], v12 offset:11616
 v_mfma_f32_16x16x32_bf16 v[192:195], v[84:87], a[0:3], 0
 v_mfma_f32_16x16x32_bf16 v[196:199], v[84:87], a[4:7], 0
 v_mfma_f32_16x16x32_bf16 v[200:203], v[84:87], a[8:11], 0
 v_mfma_f32_16x16x32_bf16 v[204:207], v[84:87], a[12:15], 0
 ds_read_b64_tr_b16 v[68:69], v12 offset:9344
 ds_read_b64_tr_b16 v[70:71], v12 offset:11648
 v_mfma_f32_16x16x32_bf16 v[208:211], v[88:91], a[0:3], 0
 v_mfma_f32_16x16x32_bf16 v[212:215], v[88:91], a[4:7], 0
 v_mfma_f32_16x16x32_bf16 v[216:219], v[88:91], a[8:11], 0
 v_mfma_f32_16x16x32_bf16 v[220:223], v[88:91], a[12:15], 0
 ds_read_b64_tr_b16 v[72:73], v12 offset:9376
 ds_read_b64_tr_b16 v[74:75], v12 offset:11680
 v_mfma_f32_16x16x32_bf16 v[224:227], v[92:95], a[0:3], 0
 v_mfma_f32_16x16x32_bf16 v[228:231], v[92:95], a[4:7], 0
 v_mfma_f32_16x16x32_bf16 v[232:235], v[92:95], a[8:11], 0
 v_mfma_f32_16x16x32_bf16 v[236:239], v[92:95], a[12:15], 0
 ds_read_b64_tr_b16 v[76:77], v12 offset:9408
 ds_read_b64_tr_b16 v[78:79], v12 offset:11712
 v_mfma_f32_16x16x32_bf16 v[240:243], v[96:99], a[0:3], 0
 v_mfma_f32_16x16x32_bf16 v[244:247], v[96:99], a[4:7], 0
 v_mfma_f32_16x16x32_bf16 v[248:251], v[96:99], a[8:11], 0
 v_mfma_f32_16x16x32_bf16 v[252:255], v[96:99], a[12:15], 0
 ds_read_b64_tr_b16 v[80:81], v12 offset:9440
 ds_read_b64_tr_b16 v[82:83], v12 offset:11744
 v_mfma_f32_16x16x32_bf16 v[112:115], v[100:103], a[16:19], v[112:115]
 v_mfma_f32_16x16x32_bf16 v[116:119], v[100:103], a[20:23], v[116:119]
 v_mfma_f32_16x16x32_bf16 v[120:123], v[100:103], a[24:27], v[120:123]
 v_mfma_f32_16x16x32_bf16 v[124:127], v[100:103], a[28:31], v[124:127]
 ds_read_b64_tr_b16 v[84:85], v12 offset:9472
 s_waitcnt lgkmcnt(14)
 ds_read_b64_tr_b16 v[86:87], v12 offset:11776
 s_waitcnt lgkmcnt(4)
 v_mfma_f32_16x16x32_bf16 v[128:131], v[104:107], a[16:19], v[128:131]
 v_mfma_f32_16x16x32_bf16 v[132:135], v[104:107], a[20:23], v[132:135]
 v_mfma_f32_16x16x32_bf16 v[136:139], v[104:107], a[24:27], v[136:139]
 v_mfma_f32_16x16x32_bf16 v[140:143], v[104:107], a[28:31], v[140:143]
 ds_read_b64_tr_b16 v[88:89], v12 offset:18432
 ds_read_b64_tr_b16 v[90:91], v12 offset:20736
 v_mfma_f32_16x16x32_bf16 v[144:147], v[108:111], a[16:19], v[144:147]
 v_mfma_f32_16x16x32_bf16 v[148:151], v[108:111], a[20:23], v[148:151]
 v_mfma_f32_16x16x32_bf16 v[152:155], v[108:111], a[24:27], v[152:155]
 v_mfma_f32_16x16x32_bf16 v[156:159], v[108:111], a[28:31], v[156:159]
 ds_read_b64_tr_b16 v[92:93], v12 offset:18464
 ds_read_b64_tr_b16 v[94:95], v12 offset:20768
 v_mfma_f32_16x16x32_bf16 v[160:163], v[64:67], a[16:19], v[160:163]
 v_mfma_f32_16x16x32_bf16 v[164:167], v[64:67], a[20:23], v[164:167]
 v_mfma_f32_16x16x32_bf16 v[168:171], v[64:67], a[24:27], v[168:171]
 v_mfma_f32_16x16x32_bf16 v[172:175], v[64:67], a[28:31], v[172:175]
 ds_read_b64_tr_b16 v[96:97], v12 offset:18496
 ds_read_b64_tr_b16 v[98:99], v12 offset:20800
 v_mfma_f32_16x16x32_bf16 v[176:179], v[68:71], a[16:19], v[176:179]
 v_mfma_f32_16x16x32_bf16 v[180:183], v[68:71], a[20:23], v[180:183]
 v_mfma_f32_16x16x32_bf16 v[184:187], v[68:71], a[24:27], v[184:187]
 v_mfma_f32_16x16x32_bf16 v[188:191], v[68:71], a[28:31], v[188:191]
 ds_read_b64_tr_b16 v[100:101], v12 offset:18528
 ds_read_b64_tr_b16 v[102:103], v12 offset:20832
 v_mfma_f32_16x16x32_bf16 v[192:195], v[72:75], a[16:19], v[192:195]
 v_mfma_f32_16x16x32_bf16 v[196:199], v[72:75], a[20:23], v[196:199]
 v_mfma_f32_16x16x32_bf16 v[200:203], v[72:75], a[24:27], v[200:203]
 v_mfma_f32_16x16x32_bf16 v[204:207], v[72:75], a[28:31], v[204:207]
 ds_read_b64_tr_b16 v[104:105], v12 offset:18560
 ds_read_b64_tr_b16 v[106:107], v12 offset:20864
 v_mfma_f32_16x16x32_bf16 v[208:211], v[76:79], a[16:19], v[208:211]
 v_mfma_f32_16x16x32_bf16 v[212:215], v[76:79], a[20:23], v[212:215]
 v_mfma_f32_16x16x32_bf16 v[216:219], v[76:79], a[24:27], v[216:219]
 v_mfma_f32_16x16x32_bf16 v[220:223], v[76:79], a[28:31], v[220:223]
 ds_read_b64_tr_b16 v[108:109], v12 offset:18592
 s_waitcnt lgkmcnt(14)
 ds_read_b64_tr_b16 v[110:111], v12 offset:20896
 s_waitcnt lgkmcnt(4)
 v_mfma_f32_16x16x32_bf16 v[224:227], v[80:83], a[16:19], v[224:227]
 v_mfma_f32_16x16x32_bf16 v[228:231], v[80:83], a[20:23], v[228:231]
 v_mfma_f32_16x16x32_bf16 v[232:235], v[80:83], a[24:27], v[232:235]
 v_mfma_f32_16x16x32_bf16 v[236:239], v[80:83], a[28:31], v[236:239]
 ds_read_b64_tr_b16 v[64:65], v12 offset:18624
 ds_read_b64_tr_b16 v[66:67], v12 offset:20928
 v_mfma_f32_16x16x32_bf16 v[240:243], v[84:87], a[16:19], v[240:243]
 v_mfma_f32_16x16x32_bf16 v[244:247], v[84:87], a[20:23], v[244:247]
 v_mfma_f32_16x16x32_bf16 v[248:251], v[84:87], a[24:27], v[248:251]
 v_mfma_f32_16x16x32_bf16 v[252:255], v[84:87], a[28:31], v[252:255]
 ds_read_b64_tr_b16 v[68:69], v12 offset:18656
 ds_read_b64_tr_b16 v[70:71], v12 offset:20960
 v_mfma_f32_16x16x32_bf16 v[112:115], v[88:91], a[32:35], v[112:115]
 v_mfma_f32_16x16x32_bf16 v[116:119], v[88:91], a[36:39], v[116:119]
 v_mfma_f32_16x16x32_bf16 v[120:123], v[88:91], a[40:43], v[120:123]
 v_mfma_f32_16x16x32_bf16 v[124:127], v[88:91], a[44:47], v[124:127]
 ds_read_b64_tr_b16 v[72:73], v12 offset:18688
 ds_read_b64_tr_b16 v[74:75], v12 offset:20992
 v_mfma_f32_16x16x32_bf16 v[128:131], v[92:95], a[32:35], v[128:131]
 v_mfma_f32_16x16x32_bf16 v[132:135], v[92:95], a[36:39], v[132:135]
 v_mfma_f32_16x16x32_bf16 v[136:139], v[92:95], a[40:43], v[136:139]
 v_mfma_f32_16x16x32_bf16 v[140:143], v[92:95], a[44:47], v[140:143]
 ds_read_b64_tr_b16 v[76:77], v12 offset:27648
 ds_read_b64_tr_b16 v[78:79], v12 offset:29952
 v_mfma_f32_16x16x32_bf16 v[144:147], v[96:99], a[32:35], v[144:147]
 v_mfma_f32_16x16x32_bf16 v[148:151], v[96:99], a[36:39], v[148:151]
 v_mfma_f32_16x16x32_bf16 v[152:155], v[96:99], a[40:43], v[152:155]
 v_mfma_f32_16x16x32_bf16 v[156:159], v[96:99], a[44:47], v[156:159]
 ds_read_b64_tr_b16 v[80:81], v12 offset:27680
 ds_read_b64_tr_b16 v[82:83], v12 offset:29984
 v_mfma_f32_16x16x32_bf16 v[160:163], v[100:103], a[32:35], v[160:163]
 v_mfma_f32_16x16x32_bf16 v[164:167], v[100:103], a[36:39], v[164:167]
 v_mfma_f32_16x16x32_bf16 v[168:171], v[100:103], a[40:43], v[168:171]
 v_mfma_f32_16x16x32_bf16 v[172:175], v[100:103], a[44:47], v[172:175]
 v_lshlrev_b32 v18, 20, v0
 v_mov_b32 v19, 1
 s_waitcnt vmcnt(0)
 s_waitcnt vmcnt(0)
 buffer_atomic_add v19, v18, s[20:23], s93 offen sc1
 s_barrier
 ds_read_b64_tr_b16 v[84:85], v12 offset:27712
 s_waitcnt lgkmcnt(14)
 ds_read_b64_tr_b16 v[86:87], v12 offset:30016
 s_waitcnt lgkmcnt(4)
 v_mfma_f32_16x16x32_bf16 v[176:179], v[104:107], a[32:35], v[176:179]
 v_mfma_f32_16x16x32_bf16 v[180:183], v[104:107], a[36:39], v[180:183]
 v_mfma_f32_16x16x32_bf16 v[184:187], v[104:107], a[40:43], v[184:187]
 v_mfma_f32_16x16x32_bf16 v[188:191], v[104:107], a[44:47], v[188:191]
 ds_read_b64_tr_b16 v[88:89], v12 offset:27744
 ds_read_b64_tr_b16 v[90:91], v12 offset:30048
 v_mfma_f32_16x16x32_bf16 v[192:195], v[108:111], a[32:35], v[192:195]
 v_mfma_f32_16x16x32_bf16 v[196:199], v[108:111], a[36:39], v[196:199]
 v_mfma_f32_16x16x32_bf16 v[200:203], v[108:111], a[40:43], v[200:203]
 v_mfma_f32_16x16x32_bf16 v[204:207], v[108:111], a[44:47], v[204:207]
 ds_read_b64_tr_b16 v[92:93], v12 offset:27776
 ds_read_b64_tr_b16 v[94:95], v12 offset:30080
 v_mfma_f32_16x16x32_bf16 v[208:211], v[64:67], a[32:35], v[208:211]
 v_mfma_f32_16x16x32_bf16 v[212:215], v[64:67], a[36:39], v[212:215]
 v_mfma_f32_16x16x32_bf16 v[216:219], v[64:67], a[40:43], v[216:219]
 v_mfma_f32_16x16x32_bf16 v[220:223], v[64:67], a[44:47], v[220:223]
 ds_read_b64_tr_b16 v[96:97], v12 offset:27808
 ds_read_b64_tr_b16 v[98:99], v12 offset:30112
 v_mfma_f32_16x16x32_bf16 v[224:227], v[68:71], a[32:35], v[224:227]
 v_mfma_f32_16x16x32_bf16 v[228:231], v[68:71], a[36:39], v[228:231]
 v_mfma_f32_16x16x32_bf16 v[232:235], v[68:71], a[40:43], v[232:235]
 v_mfma_f32_16x16x32_bf16 v[236:239], v[68:71], a[44:47], v[236:239]
 ds_read_b64_tr_b16 v[100:101], v12 offset:27840
 ds_read_b64_tr_b16 v[102:103], v12 offset:30144
 v_mfma_f32_16x16x32_bf16 v[240:243], v[72:75], a[32:35], v[240:243]
 v_mfma_f32_16x16x32_bf16 v[244:247], v[72:75], a[36:39], v[244:247]
 v_mfma_f32_16x16x32_bf16 v[248:251], v[72:75], a[40:43], v[248:251]
 v_mfma_f32_16x16x32_bf16 v[252:255], v[72:75], a[44:47], v[252:255]
 ds_read_b64_tr_b16 v[104:105], v12 offset:27872
 ds_read_b64_tr_b16 v[106:107], v12 offset:30176
 v_mfma_f32_16x16x32_bf16 v[112:115], v[76:79], a[48:51], v[112:115]
 v_mfma_f32_16x16x32_bf16 v[116:119], v[76:79], a[52:55], v[116:119]
 v_mfma_f32_16x16x32_bf16 v[120:123], v[76:79], a[56:59], v[120:123]
 v_mfma_f32_16x16x32_bf16 v[124:127], v[76:79], a[60:63], v[124:127]
 ds_read_b64_tr_b16 v[108:109], v12 offset:27904
 s_waitcnt lgkmcnt(14)
 ds_read_b64_tr_b16 v[110:111], v12 offset:30208
 s_waitcnt lgkmcnt(4)
 v_mfma_f32_16x16x32_bf16 v[128:131], v[80:83], a[48:51], v[128:131]
 v_mfma_f32_16x16x32_bf16 v[132:135], v[80:83], a[52:55], v[132:135]
 v_mfma_f32_16x16x32_bf16 v[136:139], v[80:83], a[56:59], v[136:139]
 v_mfma_f32_16x16x32_bf16 v[140:143], v[80:83], a[60:63], v[140:143]
 ds_read_b64_tr_b16 v[64:65], v12 offset:36864
 ds_read_b64_tr_b16 v[66:67], v12 offset:39168
 v_mfma_f32_16x16x32_bf16 v[144:147], v[84:87], a[48:51], v[144:147]
 v_mfma_f32_16x16x32_bf16 v[148:151], v[84:87], a[52:55], v[148:151]
 v_mfma_f32_16x16x32_bf16 v[152:155], v[84:87], a[56:59], v[152:155]
 v_mfma_f32_16x16x32_bf16 v[156:159], v[84:87], a[60:63], v[156:159]
 ds_read_b64_tr_b16 v[68:69], v12 offset:36896
 ds_read_b64_tr_b16 v[70:71], v12 offset:39200
 v_mfma_f32_16x16x32_bf16 v[160:163], v[88:91], a[48:51], v[160:163]
 v_mfma_f32_16x16x32_bf16 v[164:167], v[88:91], a[52:55], v[164:167]
 v_mfma_f32_16x16x32_bf16 v[168:171], v[88:91], a[56:59], v[168:171]
 v_mfma_f32_16x16x32_bf16 v[172:175], v[88:91], a[60:63], v[172:175]
 ds_read_b64_tr_b16 v[72:73], v12 offset:36928
 ds_read_b64_tr_b16 v[74:75], v12 offset:39232
 v_mfma_f32_16x16x32_bf16 v[176:179], v[92:95], a[48:51], v[176:179]
 v_mfma_f32_16x16x32_bf16 v[180:183], v[92:95], a[52:55], v[180:183]
 v_mfma_f32_16x16x32_bf16 v[184:187], v[92:95], a[56:59], v[184:187]
 v_mfma_f32_16x16x32_bf16 v[188:191], v[92:95], a[60:63], v[188:191]
 ds_read_b64_tr_b16 v[76:77], v12 offset:36960
 ds_read_b64_tr_b16 v[78:79], v12 offset:39264
 v_mfma_f32_16x16x32_bf16 v[192:195], v[96:99], a[48:51], v[192:195]
 v_mfma_f32_16x16x32_bf16 v[196:199], v[96:99], a[52:55], v[196:199]
 v_mov_b32 v18, 0
 s_mov_b32 s47, 0
oproj_in:
 buffer_load_dword v19, v18, s[20:23], s93 offen sc1
 s_waitcnt vmcnt(0)
 v_cmp_ne_u32 vcc, 4, v19
 s_add_u32 s47, s47, 1
 s_cmp_ge_u32 s47, 0x100000
 s_cbranch_scc1 oproj_in_done
 s_cbranch_vccz oproj_in_done
 s_sleep 4
 s_branch oproj_in
oproj_in_done:
 s_nop 3
 s_cmp_le_u32 s39, 0
 s_cselect_b32 s88, 1, 0
 s_lshl_b32 s88, s88, 13
 v_mfma_f32_16x16x32_bf16 v[200:203], v[96:99], a[56:59], v[200:203]
 s_add_u32 s89, s88, s43
 s_add_u32 s88, s88, s42
 v_mfma_f32_16x16x32_bf16 v[204:207], v[96:99], a[60:63], v[204:207]
 buffer_load_dwordx4 a[64:67], v11, s[4:7], s88 offen sc1
 v_mfma_f32_16x16x32_bf16 v[208:211], v[100:103], a[48:51], v[208:211]
 buffer_load_dwordx4 a[68:71], v11, s[4:7], s88 offen offset:256 sc1
 v_mfma_f32_16x16x32_bf16 v[212:215], v[100:103], a[52:55], v[212:215]
 buffer_load_dwordx4 a[72:75], v11, s[4:7], s89 offen sc1
 v_mfma_f32_16x16x32_bf16 v[216:219], v[100:103], a[56:59], v[216:219]
 buffer_load_dwordx4 a[76:79], v11, s[4:7], s89 offen offset:256 sc1
 v_mfma_f32_16x16x32_bf16 v[220:223], v[100:103], a[60:63], v[220:223]
 buffer_load_dwordx4 a[80:83], v11, s[4:7], s88 offen offset:2048 sc1
 buffer_load_dwordx4 a[84:87], v11, s[4:7], s88 offen offset:2304 sc1
 buffer_load_dwordx4 a[88:91], v11, s[4:7], s89 offen offset:2048 sc1
 buffer_load_dwordx4 a[92:95], v11, s[4:7], s89 offen offset:2304 sc1
 s_add_u32 s88, s88, 0x1000
 s_add_u32 s89, s89, 0x1000
 buffer_load_dwordx4 a[96:99], v11, s[4:7], s88 offen sc1
 buffer_load_dwordx4 a[100:103], v11, s[4:7], s88 offen offset:256 sc1
 buffer_load_dwordx4 a[104:107], v11, s[4:7], s89 offen sc1
 buffer_load_dwordx4 a[108:111], v11, s[4:7], s89 offen offset:256 sc1
 buffer_load_dwordx4 a[112:115], v11, s[4:7], s88 offen offset:2048 sc1
 buffer_load_dwordx4 a[116:119], v11, s[4:7], s88 offen offset:2304 sc1
 buffer_load_dwordx4 a[120:123], v11, s[4:7], s89 offen offset:2048 sc1
 buffer_load_dwordx4 a[124:127], v11, s[4:7], s89 offen offset:2304 sc1
 s_waitcnt lgkmcnt(0)
 v_mfma_f32_16x16x32_bf16 v[224:227], v[104:107], a[48:51], v[224:227]
 ds_read_b64_tr_b16 v[80:81], v12 offset:36992
 ds_read_b64_tr_b16 v[82:83], v12 offset:39296
 v_mfma_f32_16x16x32_bf16 v[228:231], v[104:107], a[52:55], v[228:231]
 s_cmp_le_u32 s39, 1
 s_cselect_b32 s88, 2, 1
 ds_read_b64_tr_b16 v[84:85], v12 offset:37024
 v_mfma_f32_16x16x32_bf16 v[232:235], v[104:107], a[56:59], v[232:235]
 ds_read_b64_tr_b16 v[86:87], v12 offset:39328
 v_mfma_f32_16x16x32_bf16 v[236:239], v[104:107], a[60:63], v[236:239]
 s_lshl_b32 s88, s88, 13
 ds_read_b64_tr_b16 v[88:89], v12 offset:37056
 v_mfma_f32_16x16x32_bf16 v[240:243], v[108:111], a[48:51], v[240:243]
 ds_read_b64_tr_b16 v[90:91], v12 offset:39360
 v_mfma_f32_16x16x32_bf16 v[244:247], v[108:111], a[52:55], v[244:247]
 v_mfma_f32_16x16x32_bf16 v[248:251], v[108:111], a[56:59], v[248:251]
 s_add_u32 s89, s88, s43
 v_mfma_f32_16x16x32_bf16 v[252:255], v[108:111], a[60:63], v[252:255]
 ds_read_b64_tr_b16 v[92:93], v12 offset:37088
 ds_read_b64_tr_b16 v[94:95], v12 offset:39392
 s_waitcnt vmcnt(15)
 v_mfma_f32_16x16x32_bf16 v[112:115], v[64:67], a[64:67], v[112:115]
 s_add_u32 s88, s88, s42
 s_waitcnt vmcnt(14)
 v_mfma_f32_16x16x32_bf16 v[116:119], v[64:67], a[68:71], v[116:119]
 s_waitcnt vmcnt(13)
 v_mfma_f32_16x16x32_bf16 v[120:123], v[64:67], a[72:75], v[120:123]
 s_waitcnt vmcnt(12)
 v_mfma_f32_16x16x32_bf16 v[124:127], v[64:67], a[76:79], v[124:127]
 buffer_load_dwordx4 a[128:131], v11, s[4:7], s88 offen sc1
 v_mfma_f32_16x16x32_bf16 v[128:131], v[68:71], a[64:67], v[128:131]
 ds_read_b64_tr_b16 v[96:97], v12 offset:37120
 ds_read_b64_tr_b16 v[98:99], v12 offset:39424
 v_mfma_f32_16x16x32_bf16 v[132:135], v[68:71], a[68:71], v[132:135]
 buffer_load_dwordx4 a[132:135], v11, s[4:7], s88 offen offset:256 sc1
 v_mfma_f32_16x16x32_bf16 v[136:139], v[68:71], a[72:75], v[136:139]
 v_mfma_f32_16x16x32_bf16 v[140:143], v[68:71], a[76:79], v[140:143]
 ds_read_b64_tr_b16 v[100:101], v12 offset:46080
 ds_read_b64_tr_b16 v[102:103], v12 offset:48384
 v_mfma_f32_16x16x32_bf16 v[144:147], v[72:75], a[64:67], v[144:147]
 buffer_load_dwordx4 a[136:139], v11, s[4:7], s89 offen sc1
 v_mfma_f32_16x16x32_bf16 v[148:151], v[72:75], a[68:71], v[148:151]
 v_mfma_f32_16x16x32_bf16 v[152:155], v[72:75], a[72:75], v[152:155]
 v_mfma_f32_16x16x32_bf16 v[156:159], v[72:75], a[76:79], v[156:159]
 buffer_load_dwordx4 a[140:143], v11, s[4:7], s89 offen offset:256 sc1
 v_mfma_f32_16x16x32_bf16 v[160:163], v[76:79], a[64:67], v[160:163]
 ds_read_b64_tr_b16 v[104:105], v12 offset:46112
 ds_read_b64_tr_b16 v[106:107], v12 offset:48416
 v_mfma_f32_16x16x32_bf16 v[164:167], v[76:79], a[68:71], v[164:167]
 buffer_load_dwordx4 a[144:147], v11, s[4:7], s88 offen offset:2048 sc1
 v_mfma_f32_16x16x32_bf16 v[168:171], v[76:79], a[72:75], v[168:171]
 v_mfma_f32_16x16x32_bf16 v[172:175], v[76:79], a[76:79], v[172:175]
 ds_read_b64_tr_b16 v[108:109], v12 offset:46144
 s_waitcnt lgkmcnt(14)
 ds_read_b64_tr_b16 v[110:111], v12 offset:48448
 s_waitcnt lgkmcnt(4)
 v_mfma_f32_16x16x32_bf16 v[176:179], v[80:83], a[64:67], v[176:179]
 buffer_load_dwordx4 a[148:151], v11, s[4:7], s88 offen offset:2304 sc1
 v_mfma_f32_16x16x32_bf16 v[180:183], v[80:83], a[68:71], v[180:183]
 v_mfma_f32_16x16x32_bf16 v[184:187], v[80:83], a[72:75], v[184:187]
 buffer_load_dwordx4 a[152:155], v11, s[4:7], s89 offen offset:2048 sc1
 v_mfma_f32_16x16x32_bf16 v[188:191], v[80:83], a[76:79], v[188:191]
 ds_read_b64_tr_b16 v[64:65], v12 offset:46176
 ds_read_b64_tr_b16 v[66:67], v12 offset:48480
 v_mfma_f32_16x16x32_bf16 v[192:195], v[84:87], a[64:67], v[192:195]
 v_mfma_f32_16x16x32_bf16 v[196:199], v[84:87], a[68:71], v[196:199]
 buffer_load_dwordx4 a[156:159], v11, s[4:7], s89 offen offset:2304 sc1
 v_mfma_f32_16x16x32_bf16 v[200:203], v[84:87], a[72:75], v[200:203]
 v_mfma_f32_16x16x32_bf16 v[204:207], v[84:87], a[76:79], v[204:207]
 ds_read_b64_tr_b16 v[68:69], v12 offset:46208
 ds_read_b64_tr_b16 v[70:71], v12 offset:48512
 v_mfma_f32_16x16x32_bf16 v[208:211], v[88:91], a[64:67], v[208:211]
 s_add_u32 s88, s88, 0x1000
 v_mfma_f32_16x16x32_bf16 v[212:215], v[88:91], a[68:71], v[212:215]
 v_mfma_f32_16x16x32_bf16 v[216:219], v[88:91], a[72:75], v[216:219]
 s_add_u32 s89, s89, 0x1000
 v_mfma_f32_16x16x32_bf16 v[220:223], v[88:91], a[76:79], v[220:223]
 ds_read_b64_tr_b16 v[72:73], v12 offset:46240
 ds_read_b64_tr_b16 v[74:75], v12 offset:48544
 v_mfma_f32_16x16x32_bf16 v[224:227], v[92:95], a[64:67], v[224:227]
 v_mfma_f32_16x16x32_bf16 v[228:231], v[92:95], a[68:71], v[228:231]
 buffer_load_dwordx4 a[160:163], v11, s[4:7], s88 offen sc1
 v_mfma_f32_16x16x32_bf16 v[232:235], v[92:95], a[72:75], v[232:235]
 v_mfma_f32_16x16x32_bf16 v[236:239], v[92:95], a[76:79], v[236:239]
 buffer_load_dwordx4 a[164:167], v11, s[4:7], s88 offen offset:256 sc1
 v_mfma_f32_16x16x32_bf16 v[240:243], v[96:99], a[64:67], v[240:243]
 ds_read_b64_tr_b16 v[76:77], v12 offset:46272
 ds_read_b64_tr_b16 v[78:79], v12 offset:48576
 v_mfma_f32_16x16x32_bf16 v[244:247], v[96:99], a[68:71], v[244:247]
 v_mfma_f32_16x16x32_bf16 v[248:251], v[96:99], a[72:75], v[248:251]
 buffer_load_dwordx4 a[168:171], v11, s[4:7], s89 offen sc1
 v_mfma_f32_16x16x32_bf16 v[252:255], v[96:99], a[76:79], v[252:255]
 ds_read_b64_tr_b16 v[80:81], v12 offset:46304
 ds_read_b64_tr_b16 v[82:83], v12 offset:48608
 s_waitcnt vmcnt(22)
 v_mfma_f32_16x16x32_bf16 v[112:115], v[100:103], a[80:83], v[112:115]
 s_waitcnt vmcnt(21)
 v_mfma_f32_16x16x32_bf16 v[116:119], v[100:103], a[84:87], v[116:119]
 buffer_load_dwordx4 a[172:175], v11, s[4:7], s89 offen offset:256 sc1
 s_waitcnt vmcnt(21)
 v_mfma_f32_16x16x32_bf16 v[120:123], v[100:103], a[88:91], v[120:123]
 s_waitcnt vmcnt(20)
 v_mfma_f32_16x16x32_bf16 v[124:127], v[100:103], a[92:95], v[124:127]
 buffer_load_dwordx4 a[176:179], v11, s[4:7], s88 offen offset:2048 sc1
 s_waitcnt lgkmcnt(2)
 v_mfma_f32_16x16x32_bf16 v[128:131], v[104:107], a[80:83], v[128:131]
 ds_read_b64_tr_b16 v[84:85], v12 offset:46336
 ds_read_b64_tr_b16 v[86:87], v12 offset:48640
 v_mfma_f32_16x16x32_bf16 v[132:135], v[104:107], a[84:87], v[132:135]
 v_mfma_f32_16x16x32_bf16 v[136:139], v[104:107], a[88:91], v[136:139]
 buffer_load_dwordx4 a[180:183], v11, s[4:7], s88 offen offset:2304 sc1
 v_mfma_f32_16x16x32_bf16 v[140:143], v[104:107], a[92:95], v[140:143]
 ds_read_b64_tr_b16 v[88:89], v13
 ds_read_b64_tr_b16 v[90:91], v13 offset:2304
 v_mfma_f32_16x16x32_bf16 v[144:147], v[108:111], a[80:83], v[144:147]
 buffer_load_dwordx4 a[184:187], v11, s[4:7], s89 offen offset:2048 sc1
 v_mfma_f32_16x16x32_bf16 v[148:151], v[108:111], a[84:87], v[148:151]
 v_mfma_f32_16x16x32_bf16 v[152:155], v[108:111], a[88:91], v[152:155]
 v_mfma_f32_16x16x32_bf16 v[156:159], v[108:111], a[92:95], v[156:159]
 buffer_load_dwordx4 a[188:191], v11, s[4:7], s89 offen offset:2304 sc1
 v_mfma_f32_16x16x32_bf16 v[160:163], v[64:67], a[80:83], v[160:163]
 ds_read_b64_tr_b16 v[92:93], v13 offset:32
 ds_read_b64_tr_b16 v[94:95], v13 offset:2336
 v_mfma_f32_16x16x32_bf16 v[164:167], v[64:67], a[84:87], v[164:167]
 v_mfma_f32_16x16x32_bf16 v[168:171], v[64:67], a[88:91], v[168:171]
 s_cmp_le_u32 s39, 2
 s_cselect_b32 s88, 3, 2
 v_mfma_f32_16x16x32_bf16 v[172:175], v[64:67], a[92:95], v[172:175]
 ds_read_b64_tr_b16 v[96:97], v13 offset:64
 ds_read_b64_tr_b16 v[98:99], v13 offset:2368
 v_mfma_f32_16x16x32_bf16 v[176:179], v[68:71], a[80:83], v[176:179]
 s_lshl_b32 s88, s88, 13
 v_mfma_f32_16x16x32_bf16 v[180:183], v[68:71], a[84:87], v[180:183]
 v_mfma_f32_16x16x32_bf16 v[184:187], v[68:71], a[88:91], v[184:187]
 v_mfma_f32_16x16x32_bf16 v[188:191], v[68:71], a[92:95], v[188:191]
 s_add_u32 s89, s88, s43
 ds_read_b64_tr_b16 v[100:101], v13 offset:96
 v_mfma_f32_16x16x32_bf16 v[192:195], v[72:75], a[80:83], v[192:195]
 ds_read_b64_tr_b16 v[102:103], v13 offset:2400
 v_mfma_f32_16x16x32_bf16 v[196:199], v[72:75], a[84:87], v[196:199]
 s_add_u32 s88, s88, s42
 v_mfma_f32_16x16x32_bf16 v[200:203], v[72:75], a[88:91], v[200:203]
 v_mfma_f32_16x16x32_bf16 v[204:207], v[72:75], a[92:95], v[204:207]
 ds_read_b64_tr_b16 v[104:105], v13 offset:128
 ds_read_b64_tr_b16 v[106:107], v13 offset:2432
 v_mfma_f32_16x16x32_bf16 v[208:211], v[76:79], a[80:83], v[208:211]
 buffer_load_dwordx4 a[192:195], v11, s[4:7], s88 offen sc1
 v_mfma_f32_16x16x32_bf16 v[212:215], v[76:79], a[84:87], v[212:215]
 v_mfma_f32_16x16x32_bf16 v[216:219], v[76:79], a[88:91], v[216:219]
 buffer_load_dwordx4 a[196:199], v11, s[4:7], s88 offen offset:256 sc1
 v_mfma_f32_16x16x32_bf16 v[220:223], v[76:79], a[92:95], v[220:223]
 ds_read_b64_tr_b16 v[108:109], v13 offset:160
 s_waitcnt lgkmcnt(14)
 ds_read_b64_tr_b16 v[110:111], v13 offset:2464
 s_waitcnt lgkmcnt(4)
 v_mfma_f32_16x16x32_bf16 v[224:227], v[80:83], a[80:83], v[224:227]
 v_mfma_f32_16x16x32_bf16 v[228:231], v[80:83], a[84:87], v[228:231]
 buffer_load_dwordx4 a[200:203], v11, s[4:7], s89 offen sc1
 v_mfma_f32_16x16x32_bf16 v[232:235], v[80:83], a[88:91], v[232:235]
 v_mfma_f32_16x16x32_bf16 v[236:239], v[80:83], a[92:95], v[236:239]
 ds_read_b64_tr_b16 v[64:65], v13 offset:192
 ds_read_b64_tr_b16 v[66:67], v13 offset:2496
 v_mfma_f32_16x16x32_bf16 v[240:243], v[84:87], a[80:83], v[240:243]
 buffer_load_dwordx4 a[204:207], v11, s[4:7], s89 offen offset:256 sc1
 v_mfma_f32_16x16x32_bf16 v[244:247], v[84:87], a[84:87], v[244:247]
 v_mfma_f32_16x16x32_bf16 v[248:251], v[84:87], a[88:91], v[248:251]
 buffer_load_dwordx4 a[208:211], v11, s[4:7], s88 offen offset:2048 sc1
 v_mfma_f32_16x16x32_bf16 v[252:255], v[84:87], a[92:95], v[252:255]
 ds_read_b64_tr_b16 v[68:69], v13 offset:224
 ds_read_b64_tr_b16 v[70:71], v13 offset:2528
 s_waitcnt vmcnt(28)
 v_mfma_f32_16x16x32_bf16 v[112:115], v[88:91], a[96:99], v[112:115]
 s_waitcnt vmcnt(27)
 v_mfma_f32_16x16x32_bf16 v[116:119], v[88:91], a[100:103], v[116:119]
 buffer_load_dwordx4 a[212:215], v11, s[4:7], s88 offen offset:2304 sc1
 s_waitcnt vmcnt(27)
 v_mfma_f32_16x16x32_bf16 v[120:123], v[88:91], a[104:107], v[120:123]
 s_waitcnt vmcnt(26)
 v_mfma_f32_16x16x32_bf16 v[124:127], v[88:91], a[108:111], v[124:127]
 buffer_load_dwordx4 a[216:219], v11, s[4:7], s89 offen offset:2048 sc1
 v_mfma_f32_16x16x32_bf16 v[128:131], v[92:95], a[96:99], v[128:131]
 ds_read_b64_tr_b16 v[72:73], v13 offset:256
 ds_read_b64_tr_b16 v[74:75], v13 offset:2560
 v_mfma_f32_16x16x32_bf16 v[132:135], v[92:95], a[100:103], v[132:135]
 v_mfma_f32_16x16x32_bf16 v[136:139], v[92:95], a[104:107], v[136:139]
 buffer_load_dwordx4 a[220:223], v11, s[4:7], s89 offen offset:2304 sc1
 v_mfma_f32_16x16x32_bf16 v[140:143], v[92:95], a[108:111], v[140:143]
 ds_read_b64_tr_b16 v[76:77], v13 offset:9216
 ds_read_b64_tr_b16 v[78:79], v13 offset:11520
 v_mfma_f32_16x16x32_bf16 v[144:147], v[96:99], a[96:99], v[144:147]
 v_mfma_f32_16x16x32_bf16 v[148:151], v[96:99], a[100:103], v[148:151]
 s_add_u32 s88, s88, 0x1000
 v_mfma_f32_16x16x32_bf16 v[152:155], v[96:99], a[104:107], v[152:155]
 v_mfma_f32_16x16x32_bf16 v[156:159], v[96:99], a[108:111], v[156:159]
 s_add_u32 s89, s89, 0x1000
 ds_read_b64_tr_b16 v[80:81], v13 offset:9248
 v_mfma_f32_16x16x32_bf16 v[160:163], v[100:103], a[96:99], v[160:163]
 ds_read_b64_tr_b16 v[82:83], v13 offset:11552
 v_mfma_f32_16x16x32_bf16 v[164:167], v[100:103], a[100:103], v[164:167]
 v_mfma_f32_16x16x32_bf16 v[168:171], v[100:103], a[104:107], v[168:171]
 buffer_load_dwordx4 a[224:227], v11, s[4:7], s88 offen sc1
 v_mfma_f32_16x16x32_bf16 v[172:175], v[100:103], a[108:111], v[172:175]
 ds_read_b64_tr_b16 v[84:85], v13 offset:9280
 s_waitcnt lgkmcnt(14)
 ds_read_b64_tr_b16 v[86:87], v13 offset:11584
 s_waitcnt lgkmcnt(4)
 v_mfma_f32_16x16x32_bf16 v[176:179], v[104:107], a[96:99], v[176:179]
 buffer_load_dwordx4 a[228:231], v11, s[4:7], s88 offen offset:256 sc1
 v_mfma_f32_16x16x32_bf16 v[180:183], v[104:107], a[100:103], v[180:183]
 v_mfma_f32_16x16x32_bf16 v[184:187], v[104:107], a[104:107], v[184:187]
 v_mfma_f32_16x16x32_bf16 v[188:191], v[104:107], a[108:111], v[188:191]
 buffer_load_dwordx4 a[232:235], v11, s[4:7], s89 offen sc1
 v_mfma_f32_16x16x32_bf16 v[192:195], v[108:111], a[96:99], v[192:195]
 ds_read_b64_tr_b16 v[88:89], v13 offset:9312
 ds_read_b64_tr_b16 v[90:91], v13 offset:11616
 v_mfma_f32_16x16x32_bf16 v[196:199], v[108:111], a[100:103], v[196:199]
 v_mfma_f32_16x16x32_bf16 v[200:203], v[108:111], a[104:107], v[200:203]
 buffer_load_dwordx4 a[236:239], v11, s[4:7], s89 offen offset:256 sc1
 v_mfma_f32_16x16x32_bf16 v[204:207], v[108:111], a[108:111], v[204:207]
 ds_read_b64_tr_b16 v[92:93], v13 offset:9344
 ds_read_b64_tr_b16 v[94:95], v13 offset:11648
 v_mfma_f32_16x16x32_bf16 v[208:211], v[64:67], a[96:99], v[208:211]
 buffer_load_dwordx4 a[240:243], v11, s[4:7], s88 offen offset:2048 sc1
 v_mfma_f32_16x16x32_bf16 v[212:215], v[64:67], a[100:103], v[212:215]
 v_mfma_f32_16x16x32_bf16 v[216:219], v[64:67], a[104:107], v[216:219]
 v_mfma_f32_16x16x32_bf16 v[220:223], v[64:67], a[108:111], v[220:223]
 buffer_load_dwordx4 a[244:247], v11, s[4:7], s88 offen offset:2304 sc1
 v_mfma_f32_16x16x32_bf16 v[224:227], v[68:71], a[96:99], v[224:227]
 ds_read_b64_tr_b16 v[96:97], v13 offset:9376
 ds_read_b64_tr_b16 v[98:99], v13 offset:11680
 v_mfma_f32_16x16x32_bf16 v[228:231], v[68:71], a[100:103], v[228:231]
 buffer_load_dwordx4 a[248:251], v11, s[4:7], s89 offen offset:2048 sc1
 v_mfma_f32_16x16x32_bf16 v[232:235], v[68:71], a[104:107], v[232:235]
 v_mfma_f32_16x16x32_bf16 v[236:239], v[68:71], a[108:111], v[236:239]
 ds_read_b64_tr_b16 v[100:101], v13 offset:9408
 ds_read_b64_tr_b16 v[102:103], v13 offset:11712
 v_mfma_f32_16x16x32_bf16 v[240:243], v[72:75], a[96:99], v[240:243]
 buffer_load_dwordx4 a[252:255], v11, s[4:7], s89 offen offset:2304 sc1
 v_mfma_f32_16x16x32_bf16 v[244:247], v[72:75], a[100:103], v[244:247]
 v_mfma_f32_16x16x32_bf16 v[248:251], v[72:75], a[104:107], v[248:251]
 v_mfma_f32_16x16x32_bf16 v[252:255], v[72:75], a[108:111], v[252:255]
 ds_read_b64_tr_b16 v[104:105], v13 offset:9440
 ds_read_b64_tr_b16 v[106:107], v13 offset:11744
 s_waitcnt vmcnt(35)
 v_mfma_f32_16x16x32_bf16 v[112:115], v[76:79], a[112:115], v[112:115]
 s_waitcnt vmcnt(34)
 v_mfma_f32_16x16x32_bf16 v[116:119], v[76:79], a[116:119], v[116:119]
 s_waitcnt vmcnt(33)
 v_mfma_f32_16x16x32_bf16 v[120:123], v[76:79], a[120:123], v[120:123]
 s_waitcnt vmcnt(32)
 v_mfma_f32_16x16x32_bf16 v[124:127], v[76:79], a[124:127], v[124:127]
 ds_read_b64_tr_b16 v[108:109], v13 offset:9472
 s_waitcnt lgkmcnt(14)
 ds_read_b64_tr_b16 v[110:111], v13 offset:11776
 s_waitcnt lgkmcnt(4)
 v_mfma_f32_16x16x32_bf16 v[128:131], v[80:83], a[112:115], v[128:131]
 v_mfma_f32_16x16x32_bf16 v[132:135], v[80:83], a[116:119], v[132:135]
 v_mfma_f32_16x16x32_bf16 v[136:139], v[80:83], a[120:123], v[136:139]
 v_mfma_f32_16x16x32_bf16 v[140:143], v[80:83], a[124:127], v[140:143]
 ds_read_b64_tr_b16 v[64:65], v13 offset:18432
 ds_read_b64_tr_b16 v[66:67], v13 offset:20736
 v_mfma_f32_16x16x32_bf16 v[144:147], v[84:87], a[112:115], v[144:147]
 v_mfma_f32_16x16x32_bf16 v[148:151], v[84:87], a[116:119], v[148:151]
 v_mfma_f32_16x16x32_bf16 v[152:155], v[84:87], a[120:123], v[152:155]
 v_mfma_f32_16x16x32_bf16 v[156:159], v[84:87], a[124:127], v[156:159]
 ds_read_b64_tr_b16 v[68:69], v13 offset:27648
 ds_read_b64_tr_b16 v[70:71], v13 offset:29952
 v_mfma_f32_16x16x32_bf16 v[160:163], v[88:91], a[112:115], v[160:163]
 v_mfma_f32_16x16x32_bf16 v[164:167], v[88:91], a[116:119], v[164:167]
 v_mfma_f32_16x16x32_bf16 v[168:171], v[88:91], a[120:123], v[168:171]
 v_mfma_f32_16x16x32_bf16 v[172:175], v[88:91], a[124:127], v[172:175]
 v_lshlrev_b32 v18, 4, v17
 v_min_u32 v19, 0xbf0, v18
 v_mfma_f32_16x16x32_bf16 v[176:179], v[92:95], a[112:115], v[176:179]
 v_add_u32 v19, 0x24000, v19
 ds_read_b64_tr_b16 v[72:73], v13 offset:36864
 v_mfma_f32_16x16x32_bf16 v[180:183], v[92:95], a[116:119], v[180:183]
 ds_read_b64_tr_b16 v[74:75], v13 offset:39168
 v_mfma_f32_16x16x32_bf16 v[184:187], v[92:95], a[120:123], v[184:187]
 v_mfma_f32_16x16x32_bf16 v[188:191], v[92:95], a[124:127], v[188:191]
 ds_read_b64_tr_b16 v[76:77], v13 offset:46080
 ds_read_b64_tr_b16 v[78:79], v13 offset:48384
 v_mfma_f32_16x16x32_bf16 v[192:195], v[96:99], a[112:115], v[192:195]
 v_mfma_f32_16x16x32_bf16 v[196:199], v[96:99], a[116:119], v[196:199]
 v_mfma_f32_16x16x32_bf16 v[200:203], v[96:99], a[120:123], v[200:203]
 v_mfma_f32_16x16x32_bf16 v[204:207], v[96:99], a[124:127], v[204:207]
 ds_read_b64_tr_b16 v[80:81], v14
 ds_read_b64_tr_b16 v[82:83], v14 offset:2304
 v_mfma_f32_16x16x32_bf16 v[208:211], v[100:103], a[112:115], v[208:211]
 v_mfma_f32_16x16x32_bf16 v[212:215], v[100:103], a[116:119], v[212:215]
 s_mov_b32 s90, 0x1200
 v_mfma_f32_16x16x32_bf16 v[216:219], v[100:103], a[120:123], v[216:219]
 buffer_load_dwordx4 v[20:23], v18, s[12:15], s90 offen
 v_mfma_f32_16x16x32_bf16 v[220:223], v[100:103], a[124:127], v[220:223]
 s_mov_b32 s90, 0x4800
 s_waitcnt lgkmcnt(2)
 v_mfma_f32_16x16x32_bf16 v[224:227], v[104:107], a[112:115], v[224:227]
 buffer_load_dwordx4 v[24:27], v18, s[12:15], s90 offen
 v_mfma_f32_16x16x32_bf16 v[228:231], v[104:107], a[116:119], v[228:231]
 s_mov_b32 s90, 0x7e00
 v_mfma_f32_16x16x32_bf16 v[232:235], v[104:107], a[120:123], v[232:235]
 buffer_load_dwordx4 v[28:31], v18, s[12:15], s90 offen
 v_mfma_f32_16x16x32_bf16 v[236:239], v[104:107], a[124:127], v[236:239]
 ds_read_b64_tr_b16 v[84:85], v14 offset:9216
 ds_read_b64_tr_b16 v[86:87], v14 offset:11520
 v_mfma_f32_16x16x32_bf16 v[240:243], v[108:111], a[112:115], v[240:243]
 ds_read_b64_tr_b16 v[88:89], v14 offset:18432
 ds_read_b64_tr_b16 v[90:91], v14 offset:20736
 v_mfma_f32_16x16x32_bf16 v[244:247], v[108:111], a[116:119], v[244:247]
 v_mfma_f32_16x16x32_bf16 v[248:251], v[108:111], a[120:123], v[248:251]
 v_mfma_f32_16x16x32_bf16 v[252:255], v[108:111], a[124:127], v[252:255]
 ds_read_b64_tr_b16 v[92:93], v14 offset:27648
 ds_read_b64_tr_b16 v[94:95], v14 offset:29952
 s_waitcnt vmcnt(34)
 v_mfma_f32_16x16x32_bf16 v[112:115], v[64:67], a[128:131], v[112:115]
 s_waitcnt vmcnt(33)
 v_mfma_f32_16x16x32_bf16 v[116:119], v[64:67], a[132:135], v[116:119]
 s_waitcnt vmcnt(32)
 v_mfma_f32_16x16x32_bf16 v[120:123], v[64:67], a[136:139], v[120:123]
 s_waitcnt vmcnt(31)
 v_mfma_f32_16x16x32_bf16 v[124:127], v[64:67], a[140:143], v[124:127]
 s_lshl_b32 s40, s37, 2
 s_add_u32 s40, s40, s39
 s_lshl_b32 s84, s38, 2
 s_lshr_b32 s86, s40, 3
 s_add_u32 s84, s84, s86
 s_lshl_b32 s93, s84, 7
 s_add_u32 s93, s93, 0x28000
 s_lshl_b32 s84, s84, 2
 s_add_u32 s84, s84, s36
 s_mul_i32 s99, s84, 0x180
 s_add_u32 s99, s99, 0
 v_and_b32 v11, 7, v0
 s_mul_i32 s84, s36, 18
 v_lshrrev_b32 v8, 3, v0
 v_min_u32 v8, 5, v8
 v_add_u32 v8, 0, v8
 v_add_u32 v8, s84, v8
 v_lshlrev_b32 v2, 9, v8
 v_lshl_add_u32 v2, v11, 4, v2
 v_mul_u32_u24 v5, 0x480, v11
 v_lshl_add_u32 v5, v8, 4, v5
 v_lshlrev_b32 v8, 5, v8
 v_add_u32 v8, 0x24000, v8
 v_lshrrev_b32 v9, 3, v0
 v_min_u32 v9, 5, v9
 v_add_u32 v9, 6, v9
 v_add_u32 v9, s84, v9
 v_lshlrev_b32 v3, 9, v9
 v_lshl_add_u32 v3, v11, 4, v3
 v_mul_u32_u24 v6, 0x480, v11
 v_lshl_add_u32 v6, v9, 4, v6
 v_lshlrev_b32 v9, 5, v9
 v_add_u32 v9, 0x24000, v9
 v_lshrrev_b32 v10, 3, v0
 v_min_u32 v10, 5, v10
 v_add_u32 v10, 12, v10
 v_add_u32 v10, s84, v10
 v_lshlrev_b32 v4, 9, v10
 v_lshl_add_u32 v4, v11, 4, v4
 v_mul_u32_u24 v7, 0x480, v11
 v_lshl_add_u32 v7, v10, 4, v7
 v_lshlrev_b32 v10, 5, v10
 v_add_u32 v10, 0x24000, v10
 s_lshl_b32 s84, s38, 3
 s_lshr_b32 s86, s40, 2
 s_add_u32 s84, s84, s86
 s_mul_i32 s98, s84, 0x9000
 s_and_b32 s86, s40, 3
 s_lshl_b32 s86, s86, 7
 s_add_u32 s98, s98, s86
 s_lshl_b32 s84, s38, 5
 s_add_u32 s84, s84, s40
 s_mul_i32 s97, s84, 0x2400
 ds_read_b64_tr_b16 v[96:97], v13 offset:18464
 ds_read_b64_tr_b16 v[98:99], v13 offset:20768
 s_waitcnt vmcnt(30)
 v_mfma_f32_16x16x32_bf16 v[112:115], v[68:71], a[144:147], v[112:115]
 s_waitcnt vmcnt(29)
 v_mfma_f32_16x16x32_bf16 v[116:119], v[68:71], a[148:151], v[116:119]
 s_waitcnt vmcnt(28)
 v_mfma_f32_16x16x32_bf16 v[120:123], v[68:71], a[152:155], v[120:123]
 s_waitcnt vmcnt(27)
 v_mfma_f32_16x16x32_bf16 v[124:127], v[68:71], a[156:159], v[124:127]
 ds_read_b64_tr_b16 v[100:101], v13 offset:27680
 ds_read_b64_tr_b16 v[102:103], v13 offset:29984
 s_waitcnt vmcnt(26)
 v_mfma_f32_16x16x32_bf16 v[112:115], v[72:75], a[160:163], v[112:115]
 s_waitcnt vmcnt(25)
 v_mfma_f32_16x16x32_bf16 v[116:119], v[72:75], a[164:167], v[116:119]
 s_waitcnt vmcnt(24)
 v_mfma_f32_16x16x32_bf16 v[120:123], v[72:75], a[168:171], v[120:123]
 s_waitcnt vmcnt(23)
 v_mfma_f32_16x16x32_bf16 v[124:127], v[72:75], a[172:175], v[124:127]
 ds_read_b64_tr_b16 v[104:105], v13 offset:36896
 ds_read_b64_tr_b16 v[106:107], v13 offset:39200
 s_waitcnt vmcnt(22)
 v_mfma_f32_16x16x32_bf16 v[112:115], v[76:79], a[176:179], v[112:115]
 s_waitcnt vmcnt(21)
 v_mfma_f32_16x16x32_bf16 v[116:119], v[76:79], a[180:183], v[116:119]
 s_waitcnt vmcnt(20)
 v_mfma_f32_16x16x32_bf16 v[120:123], v[76:79], a[184:187], v[120:123]
 s_waitcnt vmcnt(19)
 v_mfma_f32_16x16x32_bf16 v[124:127], v[76:79], a[188:191], v[124:127]
 ds_read_b64_tr_b16 v[108:109], v13 offset:46112
 s_waitcnt lgkmcnt(14)
 ds_read_b64_tr_b16 v[110:111], v13 offset:48416
 s_waitcnt vmcnt(18) lgkmcnt(4)
 v_mfma_f32_16x16x32_bf16 v[112:115], v[80:83], a[192:195], v[112:115]
 s_waitcnt vmcnt(17)
 v_mfma_f32_16x16x32_bf16 v[116:119], v[80:83], a[196:199], v[116:119]
 s_waitcnt vmcnt(16)
 v_mfma_f32_16x16x32_bf16 v[120:123], v[80:83], a[200:203], v[120:123]
 s_waitcnt vmcnt(15)
 v_mfma_f32_16x16x32_bf16 v[124:127], v[80:83], a[204:207], v[124:127]
 ds_read_b64_tr_b16 v[64:65], v14 offset:32
 ds_read_b64_tr_b16 v[66:67], v14 offset:2336
 s_waitcnt vmcnt(14)
 v_mfma_f32_16x16x32_bf16 v[112:115], v[84:87], a[208:211], v[112:115]
 s_waitcnt vmcnt(13)
 v_mfma_f32_16x16x32_bf16 v[116:119], v[84:87], a[212:215], v[116:119]
 s_waitcnt vmcnt(12)
 v_mfma_f32_16x16x32_bf16 v[120:123], v[84:87], a[216:219], v[120:123]
 s_waitcnt vmcnt(11)
 v_mfma_f32_16x16x32_bf16 v[124:127], v[84:87], a[220:223], v[124:127]
 ds_read_b64_tr_b16 v[68:69], v14 offset:9248
 ds_read_b64_tr_b16 v[70:71], v14 offset:11552
 s_waitcnt vmcnt(10)
 v_mfma_f32_16x16x32_bf16 v[112:115], v[88:91], a[224:227], v[112:115]
 s_waitcnt vmcnt(9)
 v_mfma_f32_16x16x32_bf16 v[116:119], v[88:91], a[228:231], v[116:119]
 s_waitcnt vmcnt(8)
 v_mfma_f32_16x16x32_bf16 v[120:123], v[88:91], a[232:235], v[120:123]
 s_waitcnt vmcnt(7)
 v_mfma_f32_16x16x32_bf16 v[124:127], v[88:91], a[236:239], v[124:127]
 ds_read_b64_tr_b16 v[72:73], v14 offset:18464
 ds_read_b64_tr_b16 v[74:75], v14 offset:20768
 s_waitcnt vmcnt(6)
 v_mfma_f32_16x16x32_bf16 v[112:115], v[92:95], a[240:243], v[112:115]
 s_waitcnt vmcnt(5)
 v_mfma_f32_16x16x32_bf16 v[116:119], v[92:95], a[244:247], v[116:119]
 s_waitcnt vmcnt(1)
 v_add_f32 v20, v20, v24
 s_waitcnt vmcnt(0)
 v_add_f32 v20, v20, v28
 v_mfma_f32_16x16x32_bf16 v[120:123], v[92:95], a[248:251], v[120:123]
 v_cvt_pk_bf16_f32 v20, v20, v20
 v_and_b32 v20, 0xffff0000, v20
 v_mfma_f32_16x16x32_bf16 v[124:127], v[92:95], a[252:255], v[124:127]
 v_add_f32 v21, v21, v25
 v_add_f32 v21, v21, v29
 v_mfma_f32_16x16x32_bf16 v[128:131], v[96:99], a[128:131], v[128:131]
 v_cvt_pk_bf16_f32 v21, v21, v21
 v_and_b32 v21, 0xffff0000, v21
 v_mfma_f32_16x16x32_bf16 v[132:135], v[96:99], a[132:135], v[132:135]
 v_add_f32 v22, v22, v26
 v_add_f32 v22, v22, v30
 v_mfma_f32_16x16x32_bf16 v[136:139], v[96:99], a[136:139], v[136:139]
 v_cvt_pk_bf16_f32 v22, v22, v22
 v_and_b32 v22, 0xffff0000, v22
 v_mfma_f32_16x16x32_bf16 v[140:143], v[96:99], a[140:143], v[140:143]
 v_add_f32 v23, v23, v27
 v_add_f32 v23, v23, v31
 v_mfma_f32_16x16x32_bf16 v[128:131], v[100:103], a[144:147], v[128:131]
 v_cvt_pk_bf16_f32 v23, v23, v23
 v_and_b32 v23, 0xffff0000, v23
 v_mfma_f32_16x16x32_bf16 v[132:135], v[100:103], a[148:151], v[132:135]
 ds_write_b128 v19, v[20:23]
 v_mfma_f32_16x16x32_bf16 v[136:139], v[100:103], a[152:155], v[136:139]
 ds_read_b64_tr_b16 v[76:77], v14 offset:27680
 ds_read_b64_tr_b16 v[78:79], v14 offset:29984
 v_mfma_f32_16x16x32_bf16 v[140:143], v[100:103], a[156:159], v[140:143]
 s_mov_b32 s90, 0x2400
 s_waitcnt lgkmcnt(3)
 v_mfma_f32_16x16x32_bf16 v[128:131], v[104:107], a[160:163], v[128:131]
 buffer_load_dwordx4 v[20:23], v18, s[12:15], s90 offen
 v_mfma_f32_16x16x32_bf16 v[132:135], v[104:107], a[164:167], v[132:135]
 s_mov_b32 s90, 0x5a00
 v_mfma_f32_16x16x32_bf16 v[136:139], v[104:107], a[168:171], v[136:139]
 buffer_load_dwordx4 v[24:27], v18, s[12:15], s90 offen
 v_mfma_f32_16x16x32_bf16 v[140:143], v[104:107], a[172:175], v[140:143]
 s_mov_b32 s90, 0x9000
 v_mfma_f32_16x16x32_bf16 v[128:131], v[108:111], a[176:179], v[128:131]
 buffer_load_dwordx4 v[28:31], v18, s[12:15], s90 offen
 v_mfma_f32_16x16x32_bf16 v[132:135], v[108:111], a[180:183], v[132:135]
 ds_read_b64_tr_b16 v[80:81], v13 offset:18496
 ds_read_b64_tr_b16 v[82:83], v13 offset:20800
 v_mfma_f32_16x16x32_bf16 v[136:139], v[108:111], a[184:187], v[136:139]
 ds_read_b64_tr_b16 v[84:85], v13 offset:27712
 ds_read_b64_tr_b16 v[86:87], v13 offset:30016
 v_mfma_f32_16x16x32_bf16 v[140:143], v[108:111], a[188:191], v[140:143]
 ds_read_b64_tr_b16 v[88:89], v13 offset:36928
 ds_read_b64_tr_b16 v[90:91], v13 offset:39232
 v_mfma_f32_16x16x32_bf16 v[128:131], v[64:67], a[192:195], v[128:131]
 ds_read_b64_tr_b16 v[92:93], v13 offset:46144
 ds_read_b64_tr_b16 v[94:95], v13 offset:48448
 v_mfma_f32_16x16x32_bf16 v[132:135], v[64:67], a[196:199], v[132:135]
 v_cvt_pk_bf16_f32 v112, v112, v113
 v_cvt_pk_bf16_f32 v113, v114, v115
 v_mfma_f32_16x16x32_bf16 v[136:139], v[64:67], a[200:203], v[136:139]
 v_cvt_pk_bf16_f32 v114, v116, v117
 v_cvt_pk_bf16_f32 v115, v118, v119
 v_mfma_f32_16x16x32_bf16 v[140:143], v[64:67], a[204:207], v[140:143]
 ds_read_b64_tr_b16 v[96:97], v14 offset:64
 ds_read_b64_tr_b16 v[98:99], v14 offset:2368
 v_mfma_f32_16x16x32_bf16 v[128:131], v[68:71], a[208:211], v[128:131]
 v_permlane16_swap_b32 v112, v114
 v_permlane16_swap_b32 v113, v115
 v_mfma_f32_16x16x32_bf16 v[132:135], v[68:71], a[212:215], v[132:135]
 buffer_store_dwordx4 v[112:115], v1, s[16:19], s45 offen sc1
 v_mfma_f32_16x16x32_bf16 v[136:139], v[68:71], a[216:219], v[136:139]
 v_cvt_pk_bf16_f32 v120, v120, v121
 v_cvt_pk_bf16_f32 v121, v122, v123
 v_mfma_f32_16x16x32_bf16 v[140:143], v[68:71], a[220:223], v[140:143]
 ds_read_b64_tr_b16 v[100:101], v14 offset:9280
 ds_read_b64_tr_b16 v[102:103], v14 offset:11584
 v_mfma_f32_16x16x32_bf16 v[128:131], v[72:75], a[224:227], v[128:131]
 v_cvt_pk_bf16_f32 v122, v124, v125
 v_cvt_pk_bf16_f32 v123, v126, v127
 v_mfma_f32_16x16x32_bf16 v[132:135], v[72:75], a[228:231], v[132:135]
 v_permlane16_swap_b32 v120, v122
 v_permlane16_swap_b32 v121, v123
 v_mfma_f32_16x16x32_bf16 v[136:139], v[72:75], a[232:235], v[136:139]
 buffer_store_dwordx4 v[120:123], v1, s[16:19], s46 offen sc1
 v_mfma_f32_16x16x32_bf16 v[140:143], v[72:75], a[236:239], v[140:143]
 s_waitcnt lgkmcnt(14)
 ds_read_b64_tr_b16 v[104:105], v14 offset:18496
 s_waitcnt lgkmcnt(14)
 ds_read_b64_tr_b16 v[106:107], v14 offset:20800
 s_waitcnt lgkmcnt(4)
 v_mfma_f32_16x16x32_bf16 v[128:131], v[76:79], a[240:243], v[128:131]
 v_mfma_f32_16x16x32_bf16 v[132:135], v[76:79], a[244:247], v[132:135]
 v_mfma_f32_16x16x32_bf16 v[136:139], v[76:79], a[248:251], v[136:139]
 v_mfma_f32_16x16x32_bf16 v[140:143], v[76:79], a[252:255], v[140:143]
 ds_read_b64_tr_b16 v[108:109], v14 offset:27712
 ds_read_b64_tr_b16 v[110:111], v14 offset:30016
 v_mfma_f32_16x16x32_bf16 v[144:147], v[80:83], a[128:131], v[144:147]
 v_mfma_f32_16x16x32_bf16 v[148:151], v[80:83], a[132:135], v[148:151]
 v_mfma_f32_16x16x32_bf16 v[152:155], v[80:83], a[136:139], v[152:155]
 v_cvt_pk_bf16_f32 v128, v128, v129
 v_cvt_pk_bf16_f32 v129, v130, v131
 v_mfma_f32_16x16x32_bf16 v[156:159], v[80:83], a[140:143], v[156:159]
 ds_read_b64_tr_b16 v[64:65], v13 offset:18528
 ds_read_b64_tr_b16 v[66:67], v13 offset:20832
 v_mfma_f32_16x16x32_bf16 v[144:147], v[84:87], a[144:147], v[144:147]
 v_cvt_pk_bf16_f32 v130, v132, v133
 v_cvt_pk_bf16_f32 v131, v134, v135
 v_mfma_f32_16x16x32_bf16 v[148:151], v[84:87], a[148:151], v[148:151]
 v_permlane16_swap_b32 v128, v130
 v_permlane16_swap_b32 v129, v131
 v_mfma_f32_16x16x32_bf16 v[152:155], v[84:87], a[152:155], v[152:155]
 buffer_store_dwordx4 v[128:131], v1, s[16:19], s45 offen offset:1024 sc1
 v_mfma_f32_16x16x32_bf16 v[156:159], v[84:87], a[156:159], v[156:159]
 ds_read_b64_tr_b16 v[68:69], v13 offset:27744
 ds_read_b64_tr_b16 v[70:71], v13 offset:30048
 v_mfma_f32_16x16x32_bf16 v[144:147], v[88:91], a[160:163], v[144:147]
 v_cvt_pk_bf16_f32 v136, v136, v137
 v_cvt_pk_bf16_f32 v137, v138, v139
 v_mfma_f32_16x16x32_bf16 v[148:151], v[88:91], a[164:167], v[148:151]
 v_cvt_pk_bf16_f32 v138, v140, v141
 v_cvt_pk_bf16_f32 v139, v142, v143
 v_mfma_f32_16x16x32_bf16 v[152:155], v[88:91], a[168:171], v[152:155]
 v_permlane16_swap_b32 v136, v138
 v_permlane16_swap_b32 v137, v139
 v_mfma_f32_16x16x32_bf16 v[156:159], v[88:91], a[172:175], v[156:159]
 ds_read_b64_tr_b16 v[72:73], v13 offset:36960
 ds_read_b64_tr_b16 v[74:75], v13 offset:39264
 v_mfma_f32_16x16x32_bf16 v[144:147], v[92:95], a[176:179], v[144:147]
 buffer_store_dwordx4 v[136:139], v1, s[16:19], s46 offen offset:1024 sc1
 v_mfma_f32_16x16x32_bf16 v[148:151], v[92:95], a[180:183], v[148:151]
 v_mfma_f32_16x16x32_bf16 v[152:155], v[92:95], a[184:187], v[152:155]
 v_mfma_f32_16x16x32_bf16 v[156:159], v[92:95], a[188:191], v[156:159]
 s_waitcnt vmcnt(5)
 v_add_f32 v20, v20, v24
 s_waitcnt vmcnt(4)
 v_add_f32 v20, v20, v28
 v_mfma_f32_16x16x32_bf16 v[144:147], v[96:99], a[192:195], v[144:147]
 v_cvt_pk_bf16_f32 v20, v20, v20
 v_and_b32 v20, 0xffff0000, v20
 v_mfma_f32_16x16x32_bf16 v[148:151], v[96:99], a[196:199], v[148:151]
 v_add_f32 v20, 1.0, v20
 v_cvt_pk_bf16_f32 v20, v20, v20
 v_mfma_f32_16x16x32_bf16 v[152:155], v[96:99], a[200:203], v[152:155]
 v_and_b32 v20, 0xffff0000, v20
 v_mul_f32 v20, 0xbfb8aa3b, v20
 v_mfma_f32_16x16x32_bf16 v[156:159], v[96:99], a[204:207], v[156:159]
 v_add_f32 v21, v21, v25
 v_add_f32 v21, v21, v29
 s_waitcnt lgkmcnt(0)
 v_mfma_f32_16x16x32_bf16 v[144:147], v[100:103], a[208:211], v[144:147]
 v_cvt_pk_bf16_f32 v21, v21, v21
 v_and_b32 v21, 0xffff0000, v21
 v_mfma_f32_16x16x32_bf16 v[148:151], v[100:103], a[212:215], v[148:151]
 v_add_f32 v21, 1.0, v21
 v_cvt_pk_bf16_f32 v21, v21, v21
 v_mfma_f32_16x16x32_bf16 v[152:155], v[100:103], a[216:219], v[152:155]
 v_and_b32 v21, 0xffff0000, v21
 v_mul_f32 v21, 0xbfb8aa3b, v21
 v_mfma_f32_16x16x32_bf16 v[156:159], v[100:103], a[220:223], v[156:159]
 v_add_f32 v22, v22, v26
 v_add_f32 v22, v22, v30
 v_mfma_f32_16x16x32_bf16 v[144:147], v[104:107], a[224:227], v[144:147]
 v_cvt_pk_bf16_f32 v22, v22, v22
 v_and_b32 v22, 0xffff0000, v22
 v_mfma_f32_16x16x32_bf16 v[148:151], v[104:107], a[228:231], v[148:151]
 v_add_f32 v22, 1.0, v22
 v_cvt_pk_bf16_f32 v22, v22, v22
 v_mfma_f32_16x16x32_bf16 v[152:155], v[104:107], a[232:235], v[152:155]
 v_and_b32 v22, 0xffff0000, v22
 v_mul_f32 v22, 0xbfb8aa3b, v22
 v_mfma_f32_16x16x32_bf16 v[156:159], v[104:107], a[236:239], v[156:159]
 v_add_f32 v23, v23, v27
 v_add_f32 v23, v23, v31
 v_mfma_f32_16x16x32_bf16 v[144:147], v[108:111], a[240:243], v[144:147]
 v_cvt_pk_bf16_f32 v23, v23, v23
 v_and_b32 v23, 0xffff0000, v23
 v_mfma_f32_16x16x32_bf16 v[148:151], v[108:111], a[244:247], v[148:151]
 v_add_f32 v23, 1.0, v23
 v_cvt_pk_bf16_f32 v23, v23, v23
 v_mfma_f32_16x16x32_bf16 v[152:155], v[108:111], a[248:251], v[152:155]
 v_and_b32 v23, 0xffff0000, v23
 v_mul_f32 v23, 0xbfb8aa3b, v23
 v_mfma_f32_16x16x32_bf16 v[156:159], v[108:111], a[252:255], v[156:159]
 ds_write_b128 v19, v[20:23] offset:3072
 v_mfma_f32_16x16x32_bf16 v[160:163], v[64:67], a[128:131], v[160:163]
 s_mov_b32 s90, 0x1b00
 v_mfma_f32_16x16x32_bf16 v[164:167], v[64:67], a[132:135], v[164:167]
 buffer_load_dwordx4 v[20:23], v18, s[12:15], s90 offen
 s_mov_b32 s90, 0x5100
 buffer_load_dwordx4 v[24:27], v18, s[12:15], s90 offen
 s_mov_b32 s90, 0x8700
 buffer_load_dwordx4 v[28:31], v18, s[12:15], s90 offen
 v_mfma_f32_16x16x32_bf16 v[168:171], v[64:67], a[136:139], v[168:171]
 ds_read_b64_tr_b16 v[76:77], v13 offset:46176
 ds_read_b64_tr_b16 v[78:79], v13 offset:48480
 v_mfma_f32_16x16x32_bf16 v[172:175], v[64:67], a[140:143], v[172:175]
 ds_read_b64_tr_b16 v[80:81], v14 offset:96
 ds_read_b64_tr_b16 v[82:83], v14 offset:2400
 v_mfma_f32_16x16x32_bf16 v[160:163], v[68:71], a[144:147], v[160:163]
 ds_read_b64_tr_b16 v[84:85], v14 offset:9312
 ds_read_b64_tr_b16 v[86:87], v14 offset:11616
 v_mfma_f32_16x16x32_bf16 v[164:167], v[68:71], a[148:151], v[164:167]
 ds_read_b64_tr_b16 v[88:89], v14 offset:18528
 ds_read_b64_tr_b16 v[90:91], v14 offset:20832
 v_mfma_f32_16x16x32_bf16 v[168:171], v[68:71], a[152:155], v[168:171]
 ds_read_b64_tr_b16 v[92:93], v14 offset:27744
 ds_read_b64_tr_b16 v[94:95], v14 offset:30048
 v_mfma_f32_16x16x32_bf16 v[172:175], v[68:71], a[156:159], v[172:175]
 ds_read_b64_tr_b16 v[96:97], v13 offset:18560
 ds_read_b64_tr_b16 v[98:99], v13 offset:20864
 v_mfma_f32_16x16x32_bf16 v[160:163], v[72:75], a[160:163], v[160:163]
 ds_read_b64_tr_b16 v[100:101], v13 offset:27776
 ds_read_b64_tr_b16 v[102:103], v13 offset:30080
 v_mfma_f32_16x16x32_bf16 v[164:167], v[72:75], a[164:167], v[164:167]
 v_cvt_pk_bf16_f32 v144, v144, v145
 v_cvt_pk_bf16_f32 v145, v146, v147
 v_mfma_f32_16x16x32_bf16 v[168:171], v[72:75], a[168:171], v[168:171]
 v_cvt_pk_bf16_f32 v146, v148, v149
 v_cvt_pk_bf16_f32 v147, v150, v151
 v_mfma_f32_16x16x32_bf16 v[172:175], v[72:75], a[172:175], v[172:175]
 s_waitcnt lgkmcnt(14)
 ds_read_b64_tr_b16 v[104:105], v13 offset:36992
 s_waitcnt lgkmcnt(14)
 ds_read_b64_tr_b16 v[106:107], v13 offset:39296
 s_waitcnt lgkmcnt(10)
 v_mfma_f32_16x16x32_bf16 v[160:163], v[76:79], a[176:179], v[160:163]
 v_permlane16_swap_b32 v144, v146
 v_permlane16_swap_b32 v145, v147
 v_mfma_f32_16x16x32_bf16 v[164:167], v[76:79], a[180:183], v[164:167]
 buffer_store_dwordx4 v[144:147], v1, s[16:19], s45 offen offset:2048 sc1
 v_mfma_f32_16x16x32_bf16 v[168:171], v[76:79], a[184:187], v[168:171]
 v_cvt_pk_bf16_f32 v152, v152, v153
 v_cvt_pk_bf16_f32 v153, v154, v155
 v_mfma_f32_16x16x32_bf16 v[172:175], v[76:79], a[188:191], v[172:175]
 ds_read_b64_tr_b16 v[108:109], v13 offset:46208
 ds_read_b64_tr_b16 v[110:111], v13 offset:48512
 v_mfma_f32_16x16x32_bf16 v[160:163], v[80:83], a[192:195], v[160:163]
 v_cvt_pk_bf16_f32 v154, v156, v157
 v_cvt_pk_bf16_f32 v155, v158, v159
 v_mfma_f32_16x16x32_bf16 v[164:167], v[80:83], a[196:199], v[164:167]
 v_permlane16_swap_b32 v152, v154
 v_permlane16_swap_b32 v153, v155
 v_mfma_f32_16x16x32_bf16 v[168:171], v[80:83], a[200:203], v[168:171]
 buffer_store_dwordx4 v[152:155], v1, s[16:19], s46 offen offset:2048 sc1
 v_mfma_f32_16x16x32_bf16 v[172:175], v[80:83], a[204:207], v[172:175]
 ds_read_b64_tr_b16 v[64:65], v14 offset:128
 ds_read_b64_tr_b16 v[66:67], v14 offset:2432
 v_mfma_f32_16x16x32_bf16 v[160:163], v[84:87], a[208:211], v[160:163]
 v_mfma_f32_16x16x32_bf16 v[164:167], v[84:87], a[212:215], v[164:167]
 v_mfma_f32_16x16x32_bf16 v[168:171], v[84:87], a[216:219], v[168:171]
 v_mfma_f32_16x16x32_bf16 v[172:175], v[84:87], a[220:223], v[172:175]
 ds_read_b64_tr_b16 v[68:69], v14 offset:9344
 s_waitcnt lgkmcnt(14)
 ds_read_b64_tr_b16 v[70:71], v14 offset:11648
 s_waitcnt lgkmcnt(4)
 v_mfma_f32_16x16x32_bf16 v[160:163], v[88:91], a[224:227], v[160:163]
 v_mfma_f32_16x16x32_bf16 v[164:167], v[88:91], a[228:231], v[164:167]
 v_mfma_f32_16x16x32_bf16 v[168:171], v[88:91], a[232:235], v[168:171]
 v_mfma_f32_16x16x32_bf16 v[172:175], v[88:91], a[236:239], v[172:175]
 ds_read_b64_tr_b16 v[72:73], v14 offset:18560
 ds_read_b64_tr_b16 v[74:75], v14 offset:20864
 v_mfma_f32_16x16x32_bf16 v[160:163], v[92:95], a[240:243], v[160:163]
 v_mfma_f32_16x16x32_bf16 v[164:167], v[92:95], a[244:247], v[164:167]
 v_mfma_f32_16x16x32_bf16 v[168:171], v[92:95], a[248:251], v[168:171]
 v_mfma_f32_16x16x32_bf16 v[172:175], v[92:95], a[252:255], v[172:175]
 ds_read_b64_tr_b16 v[76:77], v14 offset:27776
 ds_read_b64_tr_b16 v[78:79], v14 offset:30080
 v_mfma_f32_16x16x32_bf16 v[176:179], v[96:99], a[128:131], v[176:179]
 v_mfma_f32_16x16x32_bf16 v[180:183], v[96:99], a[132:135], v[180:183]
 s_waitcnt vmcnt(3)
 v_add_f32 v20, v20, v24
 s_waitcnt vmcnt(2)
 v_add_f32 v20, v20, v28
 v_mfma_f32_16x16x32_bf16 v[184:187], v[96:99], a[136:139], v[184:187]
 v_cvt_pk_bf16_f32 v160, v160, v161
 v_cvt_pk_bf16_f32 v161, v162, v163
 v_mfma_f32_16x16x32_bf16 v[188:191], v[96:99], a[140:143], v[188:191]
 ds_read_b64_tr_b16 v[80:81], v13 offset:18592
 ds_read_b64_tr_b16 v[82:83], v13 offset:20896
 v_mfma_f32_16x16x32_bf16 v[176:179], v[100:103], a[144:147], v[176:179]
 v_cvt_pk_bf16_f32 v162, v164, v165
 v_cvt_pk_bf16_f32 v163, v166, v167
 v_mfma_f32_16x16x32_bf16 v[180:183], v[100:103], a[148:151], v[180:183]
 v_permlane16_swap_b32 v160, v162
 v_permlane16_swap_b32 v161, v163
 v_mfma_f32_16x16x32_bf16 v[184:187], v[100:103], a[152:155], v[184:187]
 buffer_store_dwordx4 v[160:163], v1, s[16:19], s45 offen offset:3072 sc1
 v_mfma_f32_16x16x32_bf16 v[188:191], v[100:103], a[156:159], v[188:191]
 ds_read_b64_tr_b16 v[84:85], v13 offset:27808
 ds_read_b64_tr_b16 v[86:87], v13 offset:30112
 v_mfma_f32_16x16x32_bf16 v[176:179], v[104:107], a[160:163], v[176:179]
 v_cvt_pk_bf16_f32 v168, v168, v169
 v_cvt_pk_bf16_f32 v169, v170, v171
 v_mfma_f32_16x16x32_bf16 v[180:183], v[104:107], a[164:167], v[180:183]
 v_cvt_pk_bf16_f32 v170, v172, v173
 v_cvt_pk_bf16_f32 v171, v174, v175
 v_mfma_f32_16x16x32_bf16 v[184:187], v[104:107], a[168:171], v[184:187]
 v_permlane16_swap_b32 v168, v170
 v_permlane16_swap_b32 v169, v171
 v_mfma_f32_16x16x32_bf16 v[188:191], v[104:107], a[172:175], v[188:191]
 ds_read_b64_tr_b16 v[88:89], v13 offset:37024
 ds_read_b64_tr_b16 v[90:91], v13 offset:39328
 v_mfma_f32_16x16x32_bf16 v[176:179], v[108:111], a[176:179], v[176:179]
 buffer_store_dwordx4 v[168:171], v1, s[16:19], s46 offen offset:3072 sc1
 v_mfma_f32_16x16x32_bf16 v[180:183], v[108:111], a[180:183], v[180:183]
 v_cvt_pk_bf16_f32 v20, v20, v20
 v_and_b32 v20, 0xffff0000, v20
 v_mfma_f32_16x16x32_bf16 v[184:187], v[108:111], a[184:187], v[184:187]
 v_mul_f32 v20, 0xbfb8aa3b, v20
 v_add_f32 v21, v21, v25
 v_mfma_f32_16x16x32_bf16 v[188:191], v[108:111], a[188:191], v[188:191]
 ds_read_b64_tr_b16 v[92:93], v13 offset:46240
 s_waitcnt lgkmcnt(14)
 ds_read_b64_tr_b16 v[94:95], v13 offset:48544
 s_waitcnt lgkmcnt(4)
 v_mfma_f32_16x16x32_bf16 v[176:179], v[64:67], a[192:195], v[176:179]
 v_add_f32 v21, v21, v29
 v_cvt_pk_bf16_f32 v21, v21, v21
 v_mfma_f32_16x16x32_bf16 v[180:183], v[64:67], a[196:199], v[180:183]
 v_and_b32 v21, 0xffff0000, v21
 v_mul_f32 v21, 0xbfb8aa3b, v21
 v_mfma_f32_16x16x32_bf16 v[184:187], v[64:67], a[200:203], v[184:187]
 v_add_f32 v22, v22, v26
 v_add_f32 v22, v22, v30
 v_mfma_f32_16x16x32_bf16 v[188:191], v[64:67], a[204:207], v[188:191]
 ds_read_b64_tr_b16 v[96:97], v14 offset:160
 ds_read_b64_tr_b16 v[98:99], v14 offset:2464
 v_mfma_f32_16x16x32_bf16 v[176:179], v[68:71], a[208:211], v[176:179]
 v_cvt_pk_bf16_f32 v22, v22, v22
 v_and_b32 v22, 0xffff0000, v22
 v_mfma_f32_16x16x32_bf16 v[180:183], v[68:71], a[212:215], v[180:183]
 v_mul_f32 v22, 0xbfb8aa3b, v22
 v_add_f32 v23, v23, v27
 v_mfma_f32_16x16x32_bf16 v[184:187], v[68:71], a[216:219], v[184:187]
 v_add_f32 v23, v23, v31
 v_cvt_pk_bf16_f32 v23, v23, v23
 v_mfma_f32_16x16x32_bf16 v[188:191], v[68:71], a[220:223], v[188:191]
 ds_read_b64_tr_b16 v[100:101], v14 offset:9376
 ds_read_b64_tr_b16 v[102:103], v14 offset:11680
 v_mfma_f32_16x16x32_bf16 v[176:179], v[72:75], a[224:227], v[176:179]
 v_and_b32 v23, 0xffff0000, v23
 v_mul_f32 v23, 0xbfb8aa3b, v23
 v_mfma_f32_16x16x32_bf16 v[180:183], v[72:75], a[228:231], v[180:183]
 ds_write_b128 v19, v[20:23] offset:6144
 v_mfma_f32_16x16x32_bf16 v[184:187], v[72:75], a[232:235], v[184:187]
 v_mfma_f32_16x16x32_bf16 v[188:191], v[72:75], a[236:239], v[188:191]
 ds_read_b64_tr_b16 v[104:105], v14 offset:18592
 ds_read_b64_tr_b16 v[106:107], v14 offset:20896
 v_mfma_f32_16x16x32_bf16 v[176:179], v[76:79], a[240:243], v[176:179]
 v_mfma_f32_16x16x32_bf16 v[180:183], v[76:79], a[244:247], v[180:183]
 v_mfma_f32_16x16x32_bf16 v[184:187], v[76:79], a[248:251], v[184:187]
 v_mfma_f32_16x16x32_bf16 v[188:191], v[76:79], a[252:255], v[188:191]
 ds_read_b64_tr_b16 v[108:109], v14 offset:27808
 ds_read_b64_tr_b16 v[110:111], v14 offset:30112
 v_mfma_f32_16x16x32_bf16 v[192:195], v[80:83], a[128:131], v[192:195]
 v_mfma_f32_16x16x32_bf16 v[196:199], v[80:83], a[132:135], v[196:199]
 v_mfma_f32_16x16x32_bf16 v[200:203], v[80:83], a[136:139], v[200:203]
 v_cvt_pk_bf16_f32 v176, v176, v177
 v_cvt_pk_bf16_f32 v177, v178, v179
 v_mfma_f32_16x16x32_bf16 v[204:207], v[80:83], a[140:143], v[204:207]
 ds_read_b64_tr_b16 v[64:65], v13 offset:18624
 ds_read_b64_tr_b16 v[66:67], v13 offset:20928
 v_mfma_f32_16x16x32_bf16 v[192:195], v[84:87], a[144:147], v[192:195]
 v_cvt_pk_bf16_f32 v178, v180, v181
 v_cvt_pk_bf16_f32 v179, v182, v183
 v_mfma_f32_16x16x32_bf16 v[196:199], v[84:87], a[148:151], v[196:199]
 v_permlane16_swap_b32 v176, v178
 v_permlane16_swap_b32 v177, v179
 v_mfma_f32_16x16x32_bf16 v[200:203], v[84:87], a[152:155], v[200:203]
 s_add_u32 s91, s45, 0x1000
 v_mfma_f32_16x16x32_bf16 v[204:207], v[84:87], a[156:159], v[204:207]
 s_waitcnt lgkmcnt(14)
 ds_read_b64_tr_b16 v[68:69], v13 offset:27840
 s_waitcnt lgkmcnt(14)
 ds_read_b64_tr_b16 v[70:71], v13 offset:30144
 v_mfma_f32_16x16x32_bf16 v[192:195], v[88:91], a[160:163], v[192:195]
 buffer_store_dwordx4 v[176:179], v1, s[16:19], s91 offen sc1
 v_mfma_f32_16x16x32_bf16 v[196:199], v[88:91], a[164:167], v[196:199]
 v_cvt_pk_bf16_f32 v184, v184, v185
 v_cvt_pk_bf16_f32 v185, v186, v187
 v_mfma_f32_16x16x32_bf16 v[200:203], v[88:91], a[168:171], v[200:203]
 v_cvt_pk_bf16_f32 v186, v188, v189
 v_cvt_pk_bf16_f32 v187, v190, v191
 v_mfma_f32_16x16x32_bf16 v[204:207], v[88:91], a[172:175], v[204:207]
 s_waitcnt lgkmcnt(14)
 ds_read_b64_tr_b16 v[72:73], v13 offset:37056
 s_waitcnt lgkmcnt(14)
 ds_read_b64_tr_b16 v[74:75], v13 offset:39360
 v_mfma_f32_16x16x32_bf16 v[192:195], v[92:95], a[176:179], v[192:195]
 v_permlane16_swap_b32 v184, v186
 v_permlane16_swap_b32 v185, v187
 v_mfma_f32_16x16x32_bf16 v[196:199], v[92:95], a[180:183], v[196:199]
 s_add_u32 s91, s46, 0x1000
 v_mfma_f32_16x16x32_bf16 v[200:203], v[92:95], a[184:187], v[200:203]
 buffer_store_dwordx4 v[184:187], v1, s[16:19], s91 offen sc1
 v_mfma_f32_16x16x32_bf16 v[204:207], v[92:95], a[188:191], v[204:207]
 s_waitcnt lgkmcnt(14)
 ds_read_b64_tr_b16 v[76:77], v13 offset:46272
 s_waitcnt lgkmcnt(14)
 ds_read_b64_tr_b16 v[78:79], v13 offset:48576
 v_mfma_f32_16x16x32_bf16 v[192:195], v[96:99], a[192:195], v[192:195]
 s_waitcnt vmcnt(4)
 v_mfma_f32_16x16x32_bf16 v[196:199], v[96:99], a[196:199], v[196:199]
 buffer_atomic_add v16, v15, s[20:23], s92 offen sc1
 v_mfma_f32_16x16x32_bf16 v[200:203], v[96:99], a[200:203], v[200:203]
 v_mfma_f32_16x16x32_bf16 v[204:207], v[96:99], a[204:207], v[204:207]
 s_waitcnt lgkmcnt(14)
 ds_read_b64_tr_b16 v[80:81], v14 offset:192
 s_waitcnt lgkmcnt(14)
 ds_read_b64_tr_b16 v[82:83], v14 offset:2496
 v_mfma_f32_16x16x32_bf16 v[192:195], v[100:103], a[208:211], v[192:195]
 v_mfma_f32_16x16x32_bf16 v[196:199], v[100:103], a[212:215], v[196:199]
 v_mfma_f32_16x16x32_bf16 v[200:203], v[100:103], a[216:219], v[200:203]
 v_mfma_f32_16x16x32_bf16 v[204:207], v[100:103], a[220:223], v[204:207]
 s_waitcnt lgkmcnt(14)
 ds_read_b64_tr_b16 v[84:85], v14 offset:9408
 s_waitcnt lgkmcnt(14)
 ds_read_b64_tr_b16 v[86:87], v14 offset:11712
 s_waitcnt lgkmcnt(4)
 v_mfma_f32_16x16x32_bf16 v[192:195], v[104:107], a[224:227], v[192:195]
 v_mfma_f32_16x16x32_bf16 v[196:199], v[104:107], a[228:231], v[196:199]
 v_mfma_f32_16x16x32_bf16 v[200:203], v[104:107], a[232:235], v[200:203]
 v_mfma_f32_16x16x32_bf16 v[204:207], v[104:107], a[236:239], v[204:207]
 ds_read_b64_tr_b16 v[88:89], v14 offset:18624
 ds_read_b64_tr_b16 v[90:91], v14 offset:20928
 v_mfma_f32_16x16x32_bf16 v[192:195], v[108:111], a[240:243], v[192:195]
 v_mfma_f32_16x16x32_bf16 v[196:199], v[108:111], a[244:247], v[196:199]
 v_mfma_f32_16x16x32_bf16 v[200:203], v[108:111], a[248:251], v[200:203]
 v_mfma_f32_16x16x32_bf16 v[204:207], v[108:111], a[252:255], v[204:207]
 ds_read_b64_tr_b16 v[92:93], v14 offset:27840
 ds_read_b64_tr_b16 v[94:95], v14 offset:30144
 v_mfma_f32_16x16x32_bf16 v[208:211], v[64:67], a[128:131], v[208:211]
 v_mfma_f32_16x16x32_bf16 v[212:215], v[64:67], a[132:135], v[212:215]
 v_mfma_f32_16x16x32_bf16 v[216:219], v[64:67], a[136:139], v[216:219]
 v_cvt_pk_bf16_f32 v192, v192, v193
 v_cvt_pk_bf16_f32 v193, v194, v195
 v_mfma_f32_16x16x32_bf16 v[220:223], v[64:67], a[140:143], v[220:223]
 ds_read_b64_tr_b16 v[96:97], v13 offset:18656
 ds_read_b64_tr_b16 v[98:99], v13 offset:20960
 v_mfma_f32_16x16x32_bf16 v[208:211], v[68:71], a[144:147], v[208:211]
 v_cvt_pk_bf16_f32 v194, v196, v197
 v_cvt_pk_bf16_f32 v195, v198, v199
 v_mfma_f32_16x16x32_bf16 v[212:215], v[68:71], a[148:151], v[212:215]
 v_permlane16_swap_b32 v192, v194
 v_permlane16_swap_b32 v193, v195
 v_mfma_f32_16x16x32_bf16 v[216:219], v[68:71], a[152:155], v[216:219]
 s_add_u32 s91, s45, 0x1000
 v_mfma_f32_16x16x32_bf16 v[220:223], v[68:71], a[156:159], v[220:223]
 ds_read_b64_tr_b16 v[100:101], v13 offset:27872
 ds_read_b64_tr_b16 v[102:103], v13 offset:30176
 v_mfma_f32_16x16x32_bf16 v[208:211], v[72:75], a[160:163], v[208:211]
 buffer_store_dwordx4 v[192:195], v1, s[16:19], s91 offen offset:1024 sc1
 v_mfma_f32_16x16x32_bf16 v[212:215], v[72:75], a[164:167], v[212:215]
 v_cvt_pk_bf16_f32 v200, v200, v201
 v_cvt_pk_bf16_f32 v201, v202, v203
 v_mfma_f32_16x16x32_bf16 v[216:219], v[72:75], a[168:171], v[216:219]
 v_cvt_pk_bf16_f32 v202, v204, v205
 v_cvt_pk_bf16_f32 v203, v206, v207
 v_mfma_f32_16x16x32_bf16 v[220:223], v[72:75], a[172:175], v[220:223]
 ds_read_b64_tr_b16 v[104:105], v13 offset:37088
 ds_read_b64_tr_b16 v[106:107], v13 offset:39392
 v_mfma_f32_16x16x32_bf16 v[208:211], v[76:79], a[176:179], v[208:211]
 v_permlane16_swap_b32 v200, v202
 v_permlane16_swap_b32 v201, v203
 v_mfma_f32_16x16x32_bf16 v[212:215], v[76:79], a[180:183], v[212:215]
 s_add_u32 s91, s46, 0x1000
 v_mfma_f32_16x16x32_bf16 v[216:219], v[76:79], a[184:187], v[216:219]
 buffer_store_dwordx4 v[200:203], v1, s[16:19], s91 offen offset:1024 sc1
 v_mfma_f32_16x16x32_bf16 v[220:223], v[76:79], a[188:191], v[220:223]
 ds_read_b64_tr_b16 v[108:109], v13 offset:46304
 s_waitcnt lgkmcnt(14)
 ds_read_b64_tr_b16 v[110:111], v13 offset:48608
 s_waitcnt lgkmcnt(4)
 v_mfma_f32_16x16x32_bf16 v[208:211], v[80:83], a[192:195], v[208:211]
 v_mfma_f32_16x16x32_bf16 v[212:215], v[80:83], a[196:199], v[212:215]
 v_mfma_f32_16x16x32_bf16 v[216:219], v[80:83], a[200:203], v[216:219]
 v_mfma_f32_16x16x32_bf16 v[220:223], v[80:83], a[204:207], v[220:223]
 ds_read_b64_tr_b16 v[64:65], v14 offset:224
 ds_read_b64_tr_b16 v[66:67], v14 offset:2528
 v_mfma_f32_16x16x32_bf16 v[208:211], v[84:87], a[208:211], v[208:211]
 v_mfma_f32_16x16x32_bf16 v[212:215], v[84:87], a[212:215], v[212:215]
 v_mfma_f32_16x16x32_bf16 v[216:219], v[84:87], a[216:219], v[216:219]
 v_mfma_f32_16x16x32_bf16 v[220:223], v[84:87], a[220:223], v[220:223]
 ds_read_b64_tr_b16 v[68:69], v14 offset:9440
 ds_read_b64_tr_b16 v[70:71], v14 offset:11744
 v_mfma_f32_16x16x32_bf16 v[208:211], v[88:91], a[224:227], v[208:211]
 v_mfma_f32_16x16x32_bf16 v[212:215], v[88:91], a[228:231], v[212:215]
 v_mfma_f32_16x16x32_bf16 v[216:219], v[88:91], a[232:235], v[216:219]
 v_mfma_f32_16x16x32_bf16 v[220:223], v[88:91], a[236:239], v[220:223]
 ds_read_b64_tr_b16 v[72:73], v14 offset:18656
 ds_read_b64_tr_b16 v[74:75], v14 offset:20960
 v_mfma_f32_16x16x32_bf16 v[208:211], v[92:95], a[240:243], v[208:211]
 v_mfma_f32_16x16x32_bf16 v[212:215], v[92:95], a[244:247], v[212:215]
 v_mfma_f32_16x16x32_bf16 v[216:219], v[92:95], a[248:251], v[216:219]
 v_mfma_f32_16x16x32_bf16 v[220:223], v[92:95], a[252:255], v[220:223]
 ds_read_b64_tr_b16 v[76:77], v14 offset:27872
 ds_read_b64_tr_b16 v[78:79], v14 offset:30176
 v_mfma_f32_16x16x32_bf16 v[224:227], v[96:99], a[128:131], v[224:227]
 v_mfma_f32_16x16x32_bf16 v[228:231], v[96:99], a[132:135], v[228:231]
 v_mfma_f32_16x16x32_bf16 v[232:235], v[96:99], a[136:139], v[232:235]
 v_cvt_pk_bf16_f32 v208, v208, v209
 v_cvt_pk_bf16_f32 v209, v210, v211
 v_mfma_f32_16x16x32_bf16 v[236:239], v[96:99], a[140:143], v[236:239]
 ds_read_b64_tr_b16 v[80:81], v13 offset:18688
 ds_read_b64_tr_b16 v[82:83], v13 offset:20992
 v_mfma_f32_16x16x32_bf16 v[224:227], v[100:103], a[144:147], v[224:227]
 v_cvt_pk_bf16_f32 v210, v212, v213
 v_cvt_pk_bf16_f32 v211, v214, v215
 v_mfma_f32_16x16x32_bf16 v[228:231], v[100:103], a[148:151], v[228:231]
 v_permlane16_swap_b32 v208, v210
 v_permlane16_swap_b32 v209, v211
 v_mfma_f32_16x16x32_bf16 v[232:235], v[100:103], a[152:155], v[232:235]
 s_add_u32 s91, s45, 0x1000
 v_mfma_f32_16x16x32_bf16 v[236:239], v[100:103], a[156:159], v[236:239]
 ds_read_b64_tr_b16 v[84:85], v13 offset:27904
 s_waitcnt lgkmcnt(14)
 ds_read_b64_tr_b16 v[86:87], v13 offset:30208
 s_waitcnt lgkmcnt(4)
 v_mfma_f32_16x16x32_bf16 v[224:227], v[104:107], a[160:163], v[224:227]
 buffer_store_dwordx4 v[208:211], v1, s[16:19], s91 offen offset:2048 sc1
 v_mfma_f32_16x16x32_bf16 v[228:231], v[104:107], a[164:167], v[228:231]
 v_cvt_pk_bf16_f32 v216, v216, v217
 v_cvt_pk_bf16_f32 v217, v218, v219
 v_mfma_f32_16x16x32_bf16 v[232:235], v[104:107], a[168:171], v[232:235]
 v_cvt_pk_bf16_f32 v218, v220, v221
 v_cvt_pk_bf16_f32 v219, v222, v223
 v_mfma_f32_16x16x32_bf16 v[236:239], v[104:107], a[172:175], v[236:239]
 ds_read_b64_tr_b16 v[88:89], v13 offset:37120
 ds_read_b64_tr_b16 v[90:91], v13 offset:39424
 v_mfma_f32_16x16x32_bf16 v[224:227], v[108:111], a[176:179], v[224:227]
 v_permlane16_swap_b32 v216, v218
 v_permlane16_swap_b32 v217, v219
 v_mfma_f32_16x16x32_bf16 v[228:231], v[108:111], a[180:183], v[228:231]
 s_add_u32 s91, s46, 0x1000
 v_mfma_f32_16x16x32_bf16 v[232:235], v[108:111], a[184:187], v[232:235]
 buffer_store_dwordx4 v[216:219], v1, s[16:19], s91 offen offset:2048 sc1
 v_mfma_f32_16x16x32_bf16 v[236:239], v[108:111], a[188:191], v[236:239]
 ds_read_b64_tr_b16 v[92:93], v13 offset:46336
 ds_read_b64_tr_b16 v[94:95], v13 offset:48640
 v_mfma_f32_16x16x32_bf16 v[224:227], v[64:67], a[192:195], v[224:227]
 buffer_load_dword v17, off, s[20:23], s99 sc1
 v_mfma_f32_16x16x32_bf16 v[228:231], v[64:67], a[196:199], v[228:231]
 v_mfma_f32_16x16x32_bf16 v[232:235], v[64:67], a[200:203], v[232:235]
 v_mfma_f32_16x16x32_bf16 v[236:239], v[64:67], a[204:207], v[236:239]
 ds_read_b64_tr_b16 v[96:97], v14 offset:256
 ds_read_b64_tr_b16 v[98:99], v14 offset:2560
 v_mfma_f32_16x16x32_bf16 v[224:227], v[68:71], a[208:211], v[224:227]
 v_mfma_f32_16x16x32_bf16 v[228:231], v[68:71], a[212:215], v[228:231]
 v_mfma_f32_16x16x32_bf16 v[232:235], v[68:71], a[216:219], v[232:235]
 v_mfma_f32_16x16x32_bf16 v[236:239], v[68:71], a[220:223], v[236:239]
 ds_read_b64_tr_b16 v[100:101], v14 offset:9472
 ds_read_b64_tr_b16 v[102:103], v14 offset:11776
 v_mfma_f32_16x16x32_bf16 v[224:227], v[72:75], a[224:227], v[224:227]
 v_mfma_f32_16x16x32_bf16 v[228:231], v[72:75], a[228:231], v[228:231]
 v_mfma_f32_16x16x32_bf16 v[232:235], v[72:75], a[232:235], v[232:235]
 v_mfma_f32_16x16x32_bf16 v[236:239], v[72:75], a[236:239], v[236:239]
 ds_read_b64_tr_b16 v[104:105], v14 offset:18688
 ds_read_b64_tr_b16 v[106:107], v14 offset:20992
 v_mfma_f32_16x16x32_bf16 v[224:227], v[76:79], a[240:243], v[224:227]
 v_mfma_f32_16x16x32_bf16 v[228:231], v[76:79], a[244:247], v[228:231]
 v_mfma_f32_16x16x32_bf16 v[232:235], v[76:79], a[248:251], v[232:235]
 v_mfma_f32_16x16x32_bf16 v[236:239], v[76:79], a[252:255], v[236:239]
 ds_read_b64_tr_b16 v[108:109], v14 offset:27904
 s_waitcnt lgkmcnt(14)
 ds_read_b64_tr_b16 v[110:111], v14 offset:30208
 s_waitcnt lgkmcnt(4)
 v_mfma_f32_16x16x32_bf16 v[240:243], v[80:83], a[128:131], v[240:243]
 v_mfma_f32_16x16x32_bf16 v[244:247], v[80:83], a[132:135], v[244:247]
 v_mfma_f32_16x16x32_bf16 v[248:251], v[80:83], a[136:139], v[248:251]
 v_cvt_pk_bf16_f32 v224, v224, v225
 v_cvt_pk_bf16_f32 v225, v226, v227
 v_mfma_f32_16x16x32_bf16 v[252:255], v[80:83], a[140:143], v[252:255]
 v_cvt_pk_bf16_f32 v226, v228, v229
 v_cvt_pk_bf16_f32 v227, v230, v231
 v_mfma_f32_16x16x32_bf16 v[240:243], v[84:87], a[144:147], v[240:243]
 v_permlane16_swap_b32 v224, v226
 v_permlane16_swap_b32 v225, v227
 v_mfma_f32_16x16x32_bf16 v[244:247], v[84:87], a[148:151], v[244:247]
 s_add_u32 s91, s45, 0x1000
 v_mfma_f32_16x16x32_bf16 v[248:251], v[84:87], a[152:155], v[248:251]
 buffer_store_dwordx4 v[224:227], v1, s[16:19], s91 offen offset:3072 sc1
 v_mfma_f32_16x16x32_bf16 v[252:255], v[84:87], a[156:159], v[252:255]
 v_cvt_pk_bf16_f32 v232, v232, v233
 v_cvt_pk_bf16_f32 v233, v234, v235
 v_mfma_f32_16x16x32_bf16 v[240:243], v[88:91], a[160:163], v[240:243]
 v_cvt_pk_bf16_f32 v234, v236, v237
 v_cvt_pk_bf16_f32 v235, v238, v239
 v_mfma_f32_16x16x32_bf16 v[244:247], v[88:91], a[164:167], v[244:247]
 v_permlane16_swap_b32 v232, v234
 v_permlane16_swap_b32 v233, v235
 v_mfma_f32_16x16x32_bf16 v[248:251], v[88:91], a[168:171], v[248:251]
 s_add_u32 s91, s46, 0x1000
 v_mfma_f32_16x16x32_bf16 v[252:255], v[88:91], a[172:175], v[252:255]
 buffer_store_dwordx4 v[232:235], v1, s[16:19], s91 offen offset:3072 sc1
 v_mfma_f32_16x16x32_bf16 v[240:243], v[92:95], a[176:179], v[240:243]
 s_waitcnt vmcnt(4)
 v_mfma_f32_16x16x32_bf16 v[244:247], v[92:95], a[180:183], v[244:247]
 buffer_atomic_add v16, v15, s[20:23], s92 offen offset:128 sc1
 s_waitcnt vmcnt(3)
 v_cmp_ne_u32 vcc, 8, v17
 s_nop 1
 s_cbranch_vccz oproj_e0_ok
 s_mov_b32 s47, 0
oproj_e0:
 s_sleep 4
 buffer_load_dword v17, off, s[20:23], s99 sc1
 s_waitcnt vmcnt(0)
 v_cmp_ne_u32 vcc, 8, v17
 s_add_u32 s47, s47, 1
 s_cmp_ge_u32 s47, 0x100000
 s_cbranch_scc1 oproj_e0_ok
 s_cbranch_vccnz oproj_e0
oproj_e0_ok:
 s_mov_b32 s96, s98
 buffer_load_dwordx4 v[112:115], v2, s[16:19], s96 offen sc1
 s_add_u32 s96, s96, 0x240000
 buffer_load_dwordx4 v[116:119], v2, s[16:19], s96 offen sc1
 s_add_u32 s96, s96, 0x240000
 buffer_load_dwordx4 v[120:123], v2, s[16:19], s96 offen sc1
 s_add_u32 s96, s96, 0x240000
 buffer_load_dwordx4 v[124:127], v2, s[16:19], s96 offen sc1
 s_add_u32 s96, s96, 0x240000
 buffer_load_dwordx4 v[128:131], v2, s[16:19], s96 offen sc1
 s_add_u32 s96, s96, 0x240000
 buffer_load_dwordx4 v[132:135], v2, s[16:19], s96 offen sc1
 s_add_u32 s96, s96, 0x240000
 buffer_load_dwordx4 v[136:139], v2, s[16:19], s96 offen sc1
 s_add_u32 s96, s96, 0x240000
 buffer_load_dwordx4 v[140:143], v2, s[16:19], s96 offen sc1
 v_mfma_f32_16x16x32_bf16 v[248:251], v[92:95], a[184:187], v[248:251]
 v_mfma_f32_16x16x32_bf16 v[252:255], v[92:95], a[188:191], v[252:255]
 v_mfma_f32_16x16x32_bf16 v[240:243], v[96:99], a[192:195], v[240:243]
 v_mfma_f32_16x16x32_bf16 v[244:247], v[96:99], a[196:199], v[244:247]
 v_mfma_f32_16x16x32_bf16 v[248:251], v[96:99], a[200:203], v[248:251]
 v_mfma_f32_16x16x32_bf16 v[252:255], v[96:99], a[204:207], v[252:255]
 v_mfma_f32_16x16x32_bf16 v[240:243], v[100:103], a[208:211], v[240:243]
 v_mfma_f32_16x16x32_bf16 v[244:247], v[100:103], a[212:215], v[244:247]
 v_mfma_f32_16x16x32_bf16 v[248:251], v[100:103], a[216:219], v[248:251]
 v_mfma_f32_16x16x32_bf16 v[252:255], v[100:103], a[220:223], v[252:255]
 s_waitcnt lgkmcnt(0)
 v_mfma_f32_16x16x32_bf16 v[240:243], v[104:107], a[224:227], v[240:243]
 v_mfma_f32_16x16x32_bf16 v[244:247], v[104:107], a[228:231], v[244:247]
 v_mfma_f32_16x16x32_bf16 v[248:251], v[104:107], a[232:235], v[248:251]
 v_mfma_f32_16x16x32_bf16 v[252:255], v[104:107], a[236:239], v[252:255]
 v_mfma_f32_16x16x32_bf16 v[240:243], v[108:111], a[240:243], v[240:243]
 v_mfma_f32_16x16x32_bf16 v[244:247], v[108:111], a[244:247], v[244:247]
 v_mfma_f32_16x16x32_bf16 v[248:251], v[108:111], a[248:251], v[248:251]
 v_mfma_f32_16x16x32_bf16 v[252:255], v[108:111], a[252:255], v[252:255]
 s_nop 4
 v_cvt_pk_bf16_f32 v240, v240, v241
 v_cvt_pk_bf16_f32 v241, v242, v243
 v_cvt_pk_bf16_f32 v242, v244, v245
 v_cvt_pk_bf16_f32 v243, v246, v247
 s_nop 0
 v_permlane16_swap_b32 v240, v242
 v_permlane16_swap_b32 v241, v243
 s_add_u32 s91, s45, 0x2000
 buffer_store_dwordx4 v[240:243], v1, s[16:19], s91 offen sc1
 v_cvt_pk_bf16_f32 v248, v248, v249
 v_cvt_pk_bf16_f32 v249, v250, v251
 v_cvt_pk_bf16_f32 v250, v252, v253
 v_cvt_pk_bf16_f32 v251, v254, v255
 s_nop 0
 v_permlane16_swap_b32 v248, v250
 v_permlane16_swap_b32 v249, v251
 s_add_u32 s91, s46, 0x2000
 buffer_store_dwordx4 v[248:251], v1, s[16:19], s91 offen sc1
 v_and_b32 v30, 1, v0
 v_lshlrev_b32 v30, 7, v30
 s_barrier
 s_mov_b32 s47, 0
oproj_pa:
 buffer_load_dword v31, v30, s[20:23], s99 offen sc1
 s_waitcnt vmcnt(0)
 v_cmp_ne_u32 vcc, 8, v31
 s_add_u32 s47, s47, 1
 s_cmp_ge_u32 s47, 0x100000
 s_cbranch_scc1 oproj_pa_done
 s_cbranch_vccz oproj_pa_done
 s_sleep 4
 s_branch oproj_pa
oproj_pa_done:
 s_nop 3
 buffer_atomic_add v16, v15, s[20:23], s92 offen offset:256 sc1
 s_mov_b32 s96, s98
 buffer_load_dwordx4 v[144:147], v3, s[16:19], s96 offen sc1
 s_add_u32 s96, s96, 0x240000
 buffer_load_dwordx4 v[148:151], v3, s[16:19], s96 offen sc1
 s_add_u32 s96, s96, 0x240000
 buffer_load_dwordx4 v[152:155], v3, s[16:19], s96 offen sc1
 s_add_u32 s96, s96, 0x240000
 buffer_load_dwordx4 v[156:159], v3, s[16:19], s96 offen sc1
 s_add_u32 s96, s96, 0x240000
 buffer_load_dwordx4 v[160:163], v3, s[16:19], s96 offen sc1
 s_add_u32 s96, s96, 0x240000
 buffer_load_dwordx4 v[164:167], v3, s[16:19], s96 offen sc1
 s_add_u32 s96, s96, 0x240000
 buffer_load_dwordx4 v[168:171], v3, s[16:19], s96 offen sc1
 s_add_u32 s96, s96, 0x240000
 buffer_load_dwordx4 v[172:175], v3, s[16:19], s96 offen sc1
 buffer_load_dwordx4 v[64:67], v5, s[24:27], s97 offen
 buffer_load_dwordx4 v[68:71], v6, s[24:27], s97 offen
 buffer_load_dwordx4 v[72:75], v7, s[24:27], s97 offen
 ds_read_b128 v[208:211], v8
 ds_read_b128 v[212:215], v8 offset:16
 ds_read_b128 v[216:219], v9
 ds_read_b128 v[220:223], v9 offset:16
 ds_read_b128 v[224:227], v10
 ds_read_b128 v[228:231], v10 offset:16
 v_mov_b32 v30, 0x100
 s_mov_b32 s47, 0
oproj_pb:
 buffer_load_dword v31, v30, s[20:23], s99 offen sc1
 s_waitcnt vmcnt(0)
 v_cmp_ne_u32 vcc, 8, v31
 s_add_u32 s47, s47, 1
 s_cmp_ge_u32 s47, 0x100000
 s_cbranch_scc1 oproj_pb_done
 s_cbranch_vccz oproj_pb_done
 s_sleep 4
 s_branch oproj_pb
oproj_pb_done:
 s_nop 3
 s_mov_b32 s96, s98
 buffer_load_dwordx4 v[176:179], v4, s[16:19], s96 offen sc1
 s_add_u32 s96, s96, 0x240000
 buffer_load_dwordx4 v[180:183], v4, s[16:19], s96 offen sc1
 s_add_u32 s96, s96, 0x240000
 buffer_load_dwordx4 v[184:187], v4, s[16:19], s96 offen sc1
 s_add_u32 s96, s96, 0x240000
 buffer_load_dwordx4 v[188:191], v4, s[16:19], s96 offen sc1
 s_add_u32 s96, s96, 0x240000
 buffer_load_dwordx4 v[192:195], v4, s[16:19], s96 offen sc1
 s_add_u32 s96, s96, 0x240000
 buffer_load_dwordx4 v[196:199], v4, s[16:19], s96 offen sc1
 s_add_u32 s96, s96, 0x240000
 buffer_load_dwordx4 v[200:203], v4, s[16:19], s96 offen sc1
 s_add_u32 s96, s96, 0x240000
 buffer_load_dwordx4 v[204:207], v4, s[16:19], s96 offen sc1
 v_lshlrev_b32 v76, 16, v112
 v_and_b32 v77, 0xffff0000, v112
 v_lshlrev_b32 v78, 16, v113
 v_and_b32 v79, 0xffff0000, v113
 v_lshlrev_b32 v80, 16, v114
 v_and_b32 v81, 0xffff0000, v114
 v_lshlrev_b32 v82, 16, v115
 v_and_b32 v83, 0xffff0000, v115
 v_lshlrev_b32 v84, 16, v144
 v_and_b32 v85, 0xffff0000, v144
 v_lshlrev_b32 v86, 16, v145
 v_and_b32 v87, 0xffff0000, v145
 v_lshlrev_b32 v88, 16, v146
 v_and_b32 v89, 0xffff0000, v146
 v_lshlrev_b32 v90, 16, v147
 v_and_b32 v91, 0xffff0000, v147
 v_lshlrev_b32 v100, 16, v116
 v_and_b32 v101, 0xffff0000, v116
 v_pk_add_f32 v[76:77], v[76:77], v[100:101]
 v_lshlrev_b32 v100, 16, v117
 v_and_b32 v101, 0xffff0000, v117
 v_pk_add_f32 v[78:79], v[78:79], v[100:101]
 v_lshlrev_b32 v100, 16, v118
 v_and_b32 v101, 0xffff0000, v118
 v_pk_add_f32 v[80:81], v[80:81], v[100:101]
 v_lshlrev_b32 v100, 16, v119
 v_and_b32 v101, 0xffff0000, v119
 v_pk_add_f32 v[82:83], v[82:83], v[100:101]
 v_lshlrev_b32 v100, 16, v148
 v_and_b32 v101, 0xffff0000, v148
 v_pk_add_f32 v[84:85], v[84:85], v[100:101]
 v_lshlrev_b32 v100, 16, v149
 v_and_b32 v101, 0xffff0000, v149
 v_pk_add_f32 v[86:87], v[86:87], v[100:101]
 v_lshlrev_b32 v100, 16, v150
 v_and_b32 v101, 0xffff0000, v150
 v_pk_add_f32 v[88:89], v[88:89], v[100:101]
 v_lshlrev_b32 v100, 16, v151
 v_and_b32 v101, 0xffff0000, v151
 v_pk_add_f32 v[90:91], v[90:91], v[100:101]
 v_lshlrev_b32 v100, 16, v120
 v_and_b32 v101, 0xffff0000, v120
 v_pk_add_f32 v[76:77], v[76:77], v[100:101]
 v_lshlrev_b32 v100, 16, v121
 v_and_b32 v101, 0xffff0000, v121
 v_pk_add_f32 v[78:79], v[78:79], v[100:101]
 v_lshlrev_b32 v100, 16, v122
 v_and_b32 v101, 0xffff0000, v122
 v_pk_add_f32 v[80:81], v[80:81], v[100:101]
 v_lshlrev_b32 v100, 16, v123
 v_and_b32 v101, 0xffff0000, v123
 v_pk_add_f32 v[82:83], v[82:83], v[100:101]
 v_lshlrev_b32 v100, 16, v152
 v_and_b32 v101, 0xffff0000, v152
 v_pk_add_f32 v[84:85], v[84:85], v[100:101]
 v_lshlrev_b32 v100, 16, v153
 v_and_b32 v101, 0xffff0000, v153
 v_pk_add_f32 v[86:87], v[86:87], v[100:101]
 v_lshlrev_b32 v100, 16, v154
 v_and_b32 v101, 0xffff0000, v154
 v_pk_add_f32 v[88:89], v[88:89], v[100:101]
 v_lshlrev_b32 v100, 16, v155
 v_and_b32 v101, 0xffff0000, v155
 v_pk_add_f32 v[90:91], v[90:91], v[100:101]
 v_lshlrev_b32 v100, 16, v124
 v_and_b32 v101, 0xffff0000, v124
 v_pk_add_f32 v[76:77], v[76:77], v[100:101]
 v_lshlrev_b32 v100, 16, v125
 v_and_b32 v101, 0xffff0000, v125
 v_pk_add_f32 v[78:79], v[78:79], v[100:101]
 v_lshlrev_b32 v100, 16, v126
 v_and_b32 v101, 0xffff0000, v126
 v_pk_add_f32 v[80:81], v[80:81], v[100:101]
 v_lshlrev_b32 v100, 16, v127
 v_and_b32 v101, 0xffff0000, v127
 v_pk_add_f32 v[82:83], v[82:83], v[100:101]
 v_lshlrev_b32 v100, 16, v156
 v_and_b32 v101, 0xffff0000, v156
 v_pk_add_f32 v[84:85], v[84:85], v[100:101]
 v_lshlrev_b32 v100, 16, v157
 v_and_b32 v101, 0xffff0000, v157
 v_pk_add_f32 v[86:87], v[86:87], v[100:101]
 v_lshlrev_b32 v100, 16, v158
 v_and_b32 v101, 0xffff0000, v158
 v_pk_add_f32 v[88:89], v[88:89], v[100:101]
 v_lshlrev_b32 v100, 16, v159
 v_and_b32 v101, 0xffff0000, v159
 v_pk_add_f32 v[90:91], v[90:91], v[100:101]
 v_lshlrev_b32 v100, 16, v128
 v_and_b32 v101, 0xffff0000, v128
 v_pk_add_f32 v[76:77], v[76:77], v[100:101]
 v_lshlrev_b32 v100, 16, v129
 v_and_b32 v101, 0xffff0000, v129
 v_pk_add_f32 v[78:79], v[78:79], v[100:101]
 v_lshlrev_b32 v100, 16, v130
 v_and_b32 v101, 0xffff0000, v130
 v_pk_add_f32 v[80:81], v[80:81], v[100:101]
 v_lshlrev_b32 v100, 16, v131
 v_and_b32 v101, 0xffff0000, v131
 v_pk_add_f32 v[82:83], v[82:83], v[100:101]
 v_lshlrev_b32 v100, 16, v160
 v_and_b32 v101, 0xffff0000, v160
 v_pk_add_f32 v[84:85], v[84:85], v[100:101]
 v_lshlrev_b32 v100, 16, v161
 v_and_b32 v101, 0xffff0000, v161
 v_pk_add_f32 v[86:87], v[86:87], v[100:101]
 v_lshlrev_b32 v100, 16, v162
 v_and_b32 v101, 0xffff0000, v162
 v_pk_add_f32 v[88:89], v[88:89], v[100:101]
 v_lshlrev_b32 v100, 16, v163
 v_and_b32 v101, 0xffff0000, v163
 v_pk_add_f32 v[90:91], v[90:91], v[100:101]
 v_lshlrev_b32 v100, 16, v132
 v_and_b32 v101, 0xffff0000, v132
 v_pk_add_f32 v[76:77], v[76:77], v[100:101]
 v_lshlrev_b32 v100, 16, v133
 v_and_b32 v101, 0xffff0000, v133
 v_pk_add_f32 v[78:79], v[78:79], v[100:101]
 v_lshlrev_b32 v100, 16, v134
 v_and_b32 v101, 0xffff0000, v134
 v_pk_add_f32 v[80:81], v[80:81], v[100:101]
 v_lshlrev_b32 v100, 16, v135
 v_and_b32 v101, 0xffff0000, v135
 v_pk_add_f32 v[82:83], v[82:83], v[100:101]
 v_lshlrev_b32 v100, 16, v164
 v_and_b32 v101, 0xffff0000, v164
 v_pk_add_f32 v[84:85], v[84:85], v[100:101]
 v_lshlrev_b32 v100, 16, v165
 v_and_b32 v101, 0xffff0000, v165
 v_pk_add_f32 v[86:87], v[86:87], v[100:101]
 v_lshlrev_b32 v100, 16, v166
 v_and_b32 v101, 0xffff0000, v166
 v_pk_add_f32 v[88:89], v[88:89], v[100:101]
 v_lshlrev_b32 v100, 16, v167
 v_and_b32 v101, 0xffff0000, v167
 v_pk_add_f32 v[90:91], v[90:91], v[100:101]
 v_lshlrev_b32 v100, 16, v136
 v_and_b32 v101, 0xffff0000, v136
 v_pk_add_f32 v[76:77], v[76:77], v[100:101]
 v_lshlrev_b32 v100, 16, v137
 v_and_b32 v101, 0xffff0000, v137
 v_pk_add_f32 v[78:79], v[78:79], v[100:101]
 v_lshlrev_b32 v100, 16, v138
 v_and_b32 v101, 0xffff0000, v138
 v_pk_add_f32 v[80:81], v[80:81], v[100:101]
 v_lshlrev_b32 v100, 16, v139
 v_and_b32 v101, 0xffff0000, v139
 v_pk_add_f32 v[82:83], v[82:83], v[100:101]
 v_lshlrev_b32 v100, 16, v168
 v_and_b32 v101, 0xffff0000, v168
 v_pk_add_f32 v[84:85], v[84:85], v[100:101]
 v_lshlrev_b32 v100, 16, v169
 v_and_b32 v101, 0xffff0000, v169
 v_pk_add_f32 v[86:87], v[86:87], v[100:101]
 v_lshlrev_b32 v100, 16, v170
 v_and_b32 v101, 0xffff0000, v170
 v_pk_add_f32 v[88:89], v[88:89], v[100:101]
 v_lshlrev_b32 v100, 16, v171
 v_and_b32 v101, 0xffff0000, v171
 v_pk_add_f32 v[90:91], v[90:91], v[100:101]
 v_lshlrev_b32 v100, 16, v140
 v_and_b32 v101, 0xffff0000, v140
 v_pk_add_f32 v[76:77], v[76:77], v[100:101]
 v_lshlrev_b32 v100, 16, v141
 v_and_b32 v101, 0xffff0000, v141
 v_pk_add_f32 v[78:79], v[78:79], v[100:101]
 v_lshlrev_b32 v100, 16, v142
 v_and_b32 v101, 0xffff0000, v142
 v_pk_add_f32 v[80:81], v[80:81], v[100:101]
 v_lshlrev_b32 v100, 16, v143
 v_and_b32 v101, 0xffff0000, v143
 v_pk_add_f32 v[82:83], v[82:83], v[100:101]
 v_lshlrev_b32 v100, 16, v172
 v_and_b32 v101, 0xffff0000, v172
 v_pk_add_f32 v[84:85], v[84:85], v[100:101]
 v_lshlrev_b32 v100, 16, v173
 v_and_b32 v101, 0xffff0000, v173
 v_pk_add_f32 v[86:87], v[86:87], v[100:101]
 v_lshlrev_b32 v100, 16, v174
 v_and_b32 v101, 0xffff0000, v174
 v_pk_add_f32 v[88:89], v[88:89], v[100:101]
 v_lshlrev_b32 v100, 16, v175
 v_and_b32 v101, 0xffff0000, v175
 v_pk_add_f32 v[90:91], v[90:91], v[100:101]
 v_cvt_pk_bf16_f32 v232, v76, v77
 v_lshlrev_b32 v76, 16, v232
 v_and_b32 v77, 0xffff0000, v232
 s_waitcnt lgkmcnt(0)
 v_pk_mul_f32 v[76:77], v[76:77], v[208:209]
 v_cvt_pk_bf16_f32 v232, v76, v77
 v_lshlrev_b32 v76, 16, v232
 v_and_b32 v77, 0xffff0000, v232
 v_lshlrev_b32 v100, 16, v64
 v_and_b32 v101, 0xffff0000, v64
 v_pk_add_f32 v[76:77], v[76:77], v[100:101]
 v_cvt_pk_bf16_f32 v232, v76, v77
 v_cvt_pk_bf16_f32 v233, v78, v79
 v_lshlrev_b32 v78, 16, v233
 v_and_b32 v79, 0xffff0000, v233
 v_pk_mul_f32 v[78:79], v[78:79], v[210:211]
 v_cvt_pk_bf16_f32 v233, v78, v79
 v_lshlrev_b32 v78, 16, v233
 v_and_b32 v79, 0xffff0000, v233
 v_lshlrev_b32 v100, 16, v65
 v_and_b32 v101, 0xffff0000, v65
 v_pk_add_f32 v[78:79], v[78:79], v[100:101]
 v_cvt_pk_bf16_f32 v233, v78, v79
 v_cvt_pk_bf16_f32 v234, v80, v81
 v_lshlrev_b32 v80, 16, v234
 v_and_b32 v81, 0xffff0000, v234
 v_pk_mul_f32 v[80:81], v[80:81], v[212:213]
 v_cvt_pk_bf16_f32 v234, v80, v81
 v_lshlrev_b32 v80, 16, v234
 v_and_b32 v81, 0xffff0000, v234
 v_lshlrev_b32 v100, 16, v66
 v_and_b32 v101, 0xffff0000, v66
 v_pk_add_f32 v[80:81], v[80:81], v[100:101]
 v_cvt_pk_bf16_f32 v234, v80, v81
 v_cvt_pk_bf16_f32 v235, v82, v83
 v_lshlrev_b32 v82, 16, v235
 v_and_b32 v83, 0xffff0000, v235
 v_pk_mul_f32 v[82:83], v[82:83], v[214:215]
 v_cvt_pk_bf16_f32 v235, v82, v83
 v_lshlrev_b32 v82, 16, v235
 v_and_b32 v83, 0xffff0000, v235
 v_lshlrev_b32 v100, 16, v67
 v_and_b32 v101, 0xffff0000, v67
 v_pk_add_f32 v[82:83], v[82:83], v[100:101]
 v_cvt_pk_bf16_f32 v235, v82, v83
 buffer_store_dwordx4 v[232:235], v2, s[28:31], s98 offen sc1
 v_cvt_pk_bf16_f32 v236, v84, v85
 v_lshlrev_b32 v84, 16, v236
 v_and_b32 v85, 0xffff0000, v236
 v_pk_mul_f32 v[84:85], v[84:85], v[216:217]
 v_cvt_pk_bf16_f32 v236, v84, v85
 v_lshlrev_b32 v84, 16, v236
 v_and_b32 v85, 0xffff0000, v236
 v_lshlrev_b32 v100, 16, v68
 v_and_b32 v101, 0xffff0000, v68
 v_pk_add_f32 v[84:85], v[84:85], v[100:101]
 v_cvt_pk_bf16_f32 v236, v84, v85
 v_cvt_pk_bf16_f32 v237, v86, v87
 v_lshlrev_b32 v86, 16, v237
 v_and_b32 v87, 0xffff0000, v237
 v_pk_mul_f32 v[86:87], v[86:87], v[218:219]
 v_cvt_pk_bf16_f32 v237, v86, v87
 v_lshlrev_b32 v86, 16, v237
 v_and_b32 v87, 0xffff0000, v237
 v_lshlrev_b32 v100, 16, v69
 v_and_b32 v101, 0xffff0000, v69
 v_pk_add_f32 v[86:87], v[86:87], v[100:101]
 v_cvt_pk_bf16_f32 v237, v86, v87
 v_cvt_pk_bf16_f32 v238, v88, v89
 v_lshlrev_b32 v88, 16, v238
 v_and_b32 v89, 0xffff0000, v238
 v_pk_mul_f32 v[88:89], v[88:89], v[220:221]
 v_cvt_pk_bf16_f32 v238, v88, v89
 v_lshlrev_b32 v88, 16, v238
 v_and_b32 v89, 0xffff0000, v238
 v_lshlrev_b32 v100, 16, v70
 v_and_b32 v101, 0xffff0000, v70
 v_pk_add_f32 v[88:89], v[88:89], v[100:101]
 v_cvt_pk_bf16_f32 v238, v88, v89
 v_cvt_pk_bf16_f32 v239, v90, v91
 v_lshlrev_b32 v90, 16, v239
 v_and_b32 v91, 0xffff0000, v239
 v_pk_mul_f32 v[90:91], v[90:91], v[222:223]
 v_cvt_pk_bf16_f32 v239, v90, v91
 v_lshlrev_b32 v90, 16, v239
 v_and_b32 v91, 0xffff0000, v239
 v_lshlrev_b32 v100, 16, v71
 v_and_b32 v101, 0xffff0000, v71
 v_pk_add_f32 v[90:91], v[90:91], v[100:101]
 v_cvt_pk_bf16_f32 v239, v90, v91
 buffer_store_dwordx4 v[236:239], v3, s[28:31], s98 offen sc1
 s_waitcnt vmcnt(9)
 v_lshlrev_b32 v92, 16, v176
 v_and_b32 v93, 0xffff0000, v176
 v_lshlrev_b32 v94, 16, v177
 v_and_b32 v95, 0xffff0000, v177
 v_lshlrev_b32 v96, 16, v178
 v_and_b32 v97, 0xffff0000, v178
 v_lshlrev_b32 v98, 16, v179
 v_and_b32 v99, 0xffff0000, v179
 s_waitcnt vmcnt(8)
 v_lshlrev_b32 v100, 16, v180
 v_and_b32 v101, 0xffff0000, v180
 v_pk_add_f32 v[92:93], v[92:93], v[100:101]
 v_lshlrev_b32 v100, 16, v181
 v_and_b32 v101, 0xffff0000, v181
 v_pk_add_f32 v[94:95], v[94:95], v[100:101]
 v_lshlrev_b32 v100, 16, v182
 v_and_b32 v101, 0xffff0000, v182
 v_pk_add_f32 v[96:97], v[96:97], v[100:101]
 v_lshlrev_b32 v100, 16, v183
 v_and_b32 v101, 0xffff0000, v183
 v_pk_add_f32 v[98:99], v[98:99], v[100:101]
 s_waitcnt vmcnt(7)
 v_lshlrev_b32 v100, 16, v184
 v_and_b32 v101, 0xffff0000, v184
 v_pk_add_f32 v[92:93], v[92:93], v[100:101]
 v_lshlrev_b32 v100, 16, v185
 v_and_b32 v101, 0xffff0000, v185
 v_pk_add_f32 v[94:95], v[94:95], v[100:101]
 v_lshlrev_b32 v100, 16, v186
 v_and_b32 v101, 0xffff0000, v186
 v_pk_add_f32 v[96:97], v[96:97], v[100:101]
 v_lshlrev_b32 v100, 16, v187
 v_and_b32 v101, 0xffff0000, v187
 v_pk_add_f32 v[98:99], v[98:99], v[100:101]
 s_waitcnt vmcnt(6)
 v_lshlrev_b32 v100, 16, v188
 v_and_b32 v101, 0xffff0000, v188
 v_pk_add_f32 v[92:93], v[92:93], v[100:101]
 v_lshlrev_b32 v100, 16, v189
 v_and_b32 v101, 0xffff0000, v189
 v_pk_add_f32 v[94:95], v[94:95], v[100:101]
 v_lshlrev_b32 v100, 16, v190
 v_and_b32 v101, 0xffff0000, v190
 v_pk_add_f32 v[96:97], v[96:97], v[100:101]
 v_lshlrev_b32 v100, 16, v191
 v_and_b32 v101, 0xffff0000, v191
 v_pk_add_f32 v[98:99], v[98:99], v[100:101]
 s_waitcnt vmcnt(5)
 v_lshlrev_b32 v100, 16, v192
 v_and_b32 v101, 0xffff0000, v192
 v_pk_add_f32 v[92:93], v[92:93], v[100:101]
 v_lshlrev_b32 v100, 16, v193
 v_and_b32 v101, 0xffff0000, v193
 v_pk_add_f32 v[94:95], v[94:95], v[100:101]
 v_lshlrev_b32 v100, 16, v194
 v_and_b32 v101, 0xffff0000, v194
 v_pk_add_f32 v[96:97], v[96:97], v[100:101]
 v_lshlrev_b32 v100, 16, v195
 v_and_b32 v101, 0xffff0000, v195
 v_pk_add_f32 v[98:99], v[98:99], v[100:101]
 s_waitcnt vmcnt(4)
 v_lshlrev_b32 v100, 16, v196
 v_and_b32 v101, 0xffff0000, v196
 v_pk_add_f32 v[92:93], v[92:93], v[100:101]
 v_lshlrev_b32 v100, 16, v197
 v_and_b32 v101, 0xffff0000, v197
 v_pk_add_f32 v[94:95], v[94:95], v[100:101]
 v_lshlrev_b32 v100, 16, v198
 v_and_b32 v101, 0xffff0000, v198
 v_pk_add_f32 v[96:97], v[96:97], v[100:101]
 v_lshlrev_b32 v100, 16, v199
 v_and_b32 v101, 0xffff0000, v199
 v_pk_add_f32 v[98:99], v[98:99], v[100:101]
 s_waitcnt vmcnt(3)
 v_lshlrev_b32 v100, 16, v200
 v_and_b32 v101, 0xffff0000, v200
 v_pk_add_f32 v[92:93], v[92:93], v[100:101]
 v_lshlrev_b32 v100, 16, v201
 v_and_b32 v101, 0xffff0000, v201
 v_pk_add_f32 v[94:95], v[94:95], v[100:101]
 v_lshlrev_b32 v100, 16, v202
 v_and_b32 v101, 0xffff0000, v202
 v_pk_add_f32 v[96:97], v[96:97], v[100:101]
 v_lshlrev_b32 v100, 16, v203
 v_and_b32 v101, 0xffff0000, v203
 v_pk_add_f32 v[98:99], v[98:99], v[100:101]
 s_waitcnt vmcnt(2)
 v_lshlrev_b32 v100, 16, v204
 v_and_b32 v101, 0xffff0000, v204
 v_pk_add_f32 v[92:93], v[92:93], v[100:101]
 v_lshlrev_b32 v100, 16, v205
 v_and_b32 v101, 0xffff0000, v205
 v_pk_add_f32 v[94:95], v[94:95], v[100:101]
 v_lshlrev_b32 v100, 16, v206
 v_and_b32 v101, 0xffff0000, v206
 v_pk_add_f32 v[96:97], v[96:97], v[100:101]
 v_lshlrev_b32 v100, 16, v207
 v_and_b32 v101, 0xffff0000, v207
 v_pk_add_f32 v[98:99], v[98:99], v[100:101]
 v_cvt_pk_bf16_f32 v240, v92, v93
 v_lshlrev_b32 v92, 16, v240
 v_and_b32 v93, 0xffff0000, v240
 v_pk_mul_f32 v[92:93], v[92:93], v[224:225]
 v_cvt_pk_bf16_f32 v240, v92, v93
 v_lshlrev_b32 v92, 16, v240
 v_and_b32 v93, 0xffff0000, v240
 v_lshlrev_b32 v100, 16, v72
 v_and_b32 v101, 0xffff0000, v72
 v_pk_add_f32 v[92:93], v[92:93], v[100:101]
 v_cvt_pk_bf16_f32 v240, v92, v93
 v_cvt_pk_bf16_f32 v241, v94, v95
 v_lshlrev_b32 v94, 16, v241
 v_and_b32 v95, 0xffff0000, v241
 v_pk_mul_f32 v[94:95], v[94:95], v[226:227]
 v_cvt_pk_bf16_f32 v241, v94, v95
 v_lshlrev_b32 v94, 16, v241
 v_and_b32 v95, 0xffff0000, v241
 v_lshlrev_b32 v100, 16, v73
 v_and_b32 v101, 0xffff0000, v73
 v_pk_add_f32 v[94:95], v[94:95], v[100:101]
 v_cvt_pk_bf16_f32 v241, v94, v95
 v_cvt_pk_bf16_f32 v242, v96, v97
 v_lshlrev_b32 v96, 16, v242
 v_and_b32 v97, 0xffff0000, v242
 v_pk_mul_f32 v[96:97], v[96:97], v[228:229]
 v_cvt_pk_bf16_f32 v242, v96, v97
 v_lshlrev_b32 v96, 16, v242
 v_and_b32 v97, 0xffff0000, v242
 v_lshlrev_b32 v100, 16, v74
 v_and_b32 v101, 0xffff0000, v74
 v_pk_add_f32 v[96:97], v[96:97], v[100:101]
 v_cvt_pk_bf16_f32 v242, v96, v97
 v_cvt_pk_bf16_f32 v243, v98, v99
 v_lshlrev_b32 v98, 16, v243
 v_and_b32 v99, 0xffff0000, v243
 v_pk_mul_f32 v[98:99], v[98:99], v[230:231]
 v_cvt_pk_bf16_f32 v243, v98, v99
 v_lshlrev_b32 v98, 16, v243
 v_and_b32 v99, 0xffff0000, v243
 v_lshlrev_b32 v100, 16, v75
 v_and_b32 v101, 0xffff0000, v75
 v_pk_add_f32 v[98:99], v[98:99], v[100:101]
 v_cvt_pk_bf16_f32 v243, v98, v99
 buffer_store_dwordx4 v[240:243], v4, s[28:31], s98 offen sc1
 ds_read_b128 v[128:131], v8 offset:3072
 ds_read_b128 v[152:155], v8 offset:6144
 ds_read_b128 v[132:135], v8 offset:3088
 ds_read_b128 v[156:159], v8 offset:6160
 ds_read_b128 v[136:139], v9 offset:3072
 ds_read_b128 v[160:163], v9 offset:6144
 ds_read_b128 v[140:143], v9 offset:3088
 ds_read_b128 v[164:167], v9 offset:6160
 ds_read_b128 v[144:147], v10 offset:3072
 ds_read_b128 v[168:171], v10 offset:6144
 ds_read_b128 v[148:151], v10 offset:3088
 ds_read_b128 v[172:175], v10 offset:6160
 v_lshlrev_b32 v76, 16, v232
 v_and_b32 v77, 0xffff0000, v232
 v_add_f32 v102, v76, v77
 v_mul_f32 v103, v76, v76
 v_fmac_f32 v103, v77, v77
 v_lshlrev_b32 v78, 16, v233
 v_and_b32 v79, 0xffff0000, v233
 v_add_f32 v102, v102, v78
 v_add_f32 v102, v102, v79
 v_fmac_f32 v103, v78, v78
 v_fmac_f32 v103, v79, v79
 v_lshlrev_b32 v80, 16, v234
 v_and_b32 v81, 0xffff0000, v234
 v_add_f32 v102, v102, v80
 v_add_f32 v102, v102, v81
 v_fmac_f32 v103, v80, v80
 v_fmac_f32 v103, v81, v81
 v_lshlrev_b32 v82, 16, v235
 v_and_b32 v83, 0xffff0000, v235
 v_add_f32 v102, v102, v82
 v_add_f32 v102, v102, v83
 v_fmac_f32 v103, v82, v82
 v_fmac_f32 v103, v83, v83
 v_lshlrev_b32 v84, 16, v236
 v_and_b32 v85, 0xffff0000, v236
 v_add_f32 v102, v102, v84
 v_add_f32 v102, v102, v85
 v_fmac_f32 v103, v84, v84
 v_fmac_f32 v103, v85, v85
 v_lshlrev_b32 v86, 16, v237
 v_and_b32 v87, 0xffff0000, v237
 v_add_f32 v102, v102, v86
 v_add_f32 v102, v102, v87
 v_fmac_f32 v103, v86, v86
 v_fmac_f32 v103, v87, v87
 v_lshlrev_b32 v88, 16, v238
 v_and_b32 v89, 0xffff0000, v238
 v_add_f32 v102, v102, v88
 v_add_f32 v102, v102, v89
 v_fmac_f32 v103, v88, v88
 v_fmac_f32 v103, v89, v89
 v_lshlrev_b32 v90, 16, v239
 v_and_b32 v91, 0xffff0000, v239
 v_add_f32 v102, v102, v90
 v_add_f32 v102, v102, v91
 v_fmac_f32 v103, v90, v90
 v_fmac_f32 v103, v91, v91
 v_lshlrev_b32 v92, 16, v240
 v_and_b32 v93, 0xffff0000, v240
 v_add_f32 v102, v102, v92
 v_add_f32 v102, v102, v93
 v_fmac_f32 v103, v92, v92
 v_fmac_f32 v103, v93, v93
 v_lshlrev_b32 v94, 16, v241
 v_and_b32 v95, 0xffff0000, v241
 v_add_f32 v102, v102, v94
 v_add_f32 v102, v102, v95
 v_fmac_f32 v103, v94, v94
 v_fmac_f32 v103, v95, v95
 v_lshlrev_b32 v96, 16, v242
 v_and_b32 v97, 0xffff0000, v242
 v_add_f32 v102, v102, v96
 v_add_f32 v102, v102, v97
 v_fmac_f32 v103, v96, v96
 v_fmac_f32 v103, v97, v97
 v_lshlrev_b32 v98, 16, v243
 v_and_b32 v99, 0xffff0000, v243
 v_add_f32 v102, v102, v98
 v_add_f32 v102, v102, v99
 v_fmac_f32 v103, v98, v98
 v_fmac_f32 v103, v99, v99
 v_cmp_gt_u32 vcc, 48, v0
 s_nop 1
 v_cndmask_b32 v102, 0, v102, vcc
 v_cndmask_b32 v103, 0, v103, vcc
 s_nop 0
 v_add_f32_dpp v104, v102, v102 row_ror:8 row_mask:0xf bank_mask:0xf
 v_mov_b32 v105, v104
 s_nop 1
 v_permlane16_swap_b32 v104, v105
 v_add_f32 v104, v104, v105
 v_mov_b32 v105, v104
 s_nop 1
 v_permlane32_swap_b32 v104, v105
 v_add_f32 v102, v104, v105
 s_nop 0
 v_add_f32_dpp v104, v103, v103 row_ror:8 row_mask:0xf bank_mask:0xf
 v_mov_b32 v105, v104
 s_nop 1
 v_permlane16_swap_b32 v104, v105
 v_add_f32 v104, v104, v105
 v_mov_b32 v105, v104
 s_nop 1
 v_permlane32_swap_b32 v104, v105
 v_add_f32 v103, v104, v105
 v_lshlrev_b32 v104, 3, v11
 v_add_u32 v104, 0x26400, v104
 s_lshl_b32 s84, s36, 6
 v_add_u32 v105, s84, v104
 ds_write_b64 v105, v[102:103]
 s_waitcnt lgkmcnt(0)
 s_barrier
 ds_read_b64 v[176:177], v104
 ds_read_b64 v[178:179], v104 offset:64
 ds_read_b64 v[180:181], v104 offset:128
 ds_read_b64 v[182:183], v104 offset:192
 s_waitcnt lgkmcnt(2)
 v_add_f32 v176, v176, v178
 v_add_f32 v177, v177, v179
 s_waitcnt lgkmcnt(0)
 v_add_f32 v180, v180, v182
 v_add_f32 v181, v181, v183
 v_add_f32 v176, v176, v180
 v_add_f32 v177, v177, v181
 v_mul_f32 v176, 0x3ae38e39, v176
 v_mul_f32 v177, 0x3ae38e39, v177
 v_fma_f32 v177, -v176, v176, v177
 v_max_f32 v177, 0, v177
 v_add_f32 v177, 0x3727c5ac, v177
 v_rsq_f32 v177, v177
 v_sub_f32 v76, v76, v176
 v_sub_f32 v77, v77, v176
 v_sub_f32 v78, v78, v176
 v_sub_f32 v79, v79, v176
 v_sub_f32 v80, v80, v176
 v_sub_f32 v81, v81, v176
 v_sub_f32 v82, v82, v176
 v_sub_f32 v83, v83, v176
 v_mul_f32 v76, v76, v177
 v_mul_f32 v77, v77, v177
 v_mul_f32 v78, v78, v177
 v_mul_f32 v79, v79, v177
 v_mul_f32 v80, v80, v177
 v_mul_f32 v81, v81, v177
 v_mul_f32 v82, v82, v177
 v_mul_f32 v83, v83, v177
 v_fma_f32 v76, v76, v128, v152
 v_fma_f32 v77, v77, v129, v153
 v_fma_f32 v78, v78, v130, v154
 v_fma_f32 v79, v79, v131, v155
 v_fma_f32 v80, v80, v132, v156
 v_fma_f32 v81, v81, v133, v157
 v_fma_f32 v82, v82, v134, v158
 v_fma_f32 v83, v83, v135, v159
 v_cvt_pk_bf16_f32 v184, v76, v77
 v_cvt_pk_bf16_f32 v185, v78, v79
 v_cvt_pk_bf16_f32 v186, v80, v81
 v_cvt_pk_bf16_f32 v187, v82, v83
 buffer_store_dwordx4 v[184:187], v2, s[32:35], s98 offen sc1
 v_sub_f32 v84, v84, v176
 v_sub_f32 v85, v85, v176
 v_sub_f32 v86, v86, v176
 v_sub_f32 v87, v87, v176
 v_sub_f32 v88, v88, v176
 v_sub_f32 v89, v89, v176
 v_sub_f32 v90, v90, v176
 v_sub_f32 v91, v91, v176
 v_mul_f32 v84, v84, v177
 v_mul_f32 v85, v85, v177
 v_mul_f32 v86, v86, v177
 v_mul_f32 v87, v87, v177
 v_mul_f32 v88, v88, v177
 v_mul_f32 v89, v89, v177
 v_mul_f32 v90, v90, v177
 v_mul_f32 v91, v91, v177
 v_fma_f32 v84, v84, v136, v160
 v_fma_f32 v85, v85, v137, v161
 v_fma_f32 v86, v86, v138, v162
 v_fma_f32 v87, v87, v139, v163
 v_fma_f32 v88, v88, v140, v164
 v_fma_f32 v89, v89, v141, v165
 v_fma_f32 v90, v90, v142, v166
 v_fma_f32 v91, v91, v143, v167
 v_cvt_pk_bf16_f32 v188, v84, v85
 v_cvt_pk_bf16_f32 v189, v86, v87
 v_cvt_pk_bf16_f32 v190, v88, v89
 v_cvt_pk_bf16_f32 v191, v90, v91
 buffer_store_dwordx4 v[188:191], v3, s[32:35], s98 offen sc1
 v_sub_f32 v92, v92, v176
 v_sub_f32 v93, v93, v176
 v_sub_f32 v94, v94, v176
 v_sub_f32 v95, v95, v176
 v_sub_f32 v96, v96, v176
 v_sub_f32 v97, v97, v176
 v_sub_f32 v98, v98, v176
 v_sub_f32 v99, v99, v176
 v_mul_f32 v92, v92, v177
 v_mul_f32 v93, v93, v177
 v_mul_f32 v94, v94, v177
 v_mul_f32 v95, v95, v177
 v_mul_f32 v96, v96, v177
 v_mul_f32 v97, v97, v177
 v_mul_f32 v98, v98, v177
 v_mul_f32 v99, v99, v177
 v_fma_f32 v92, v92, v144, v168
 v_fma_f32 v93, v93, v145, v169
 v_fma_f32 v94, v94, v146, v170
 v_fma_f32 v95, v95, v147, v171
 v_fma_f32 v96, v96, v148, v172
 v_fma_f32 v97, v97, v149, v173
 v_fma_f32 v98, v98, v150, v174
 v_fma_f32 v99, v99, v151, v175
 v_cvt_pk_bf16_f32 v192, v92, v93
 v_cvt_pk_bf16_f32 v193, v94, v95
 v_cvt_pk_bf16_f32 v194, v96, v97
 v_cvt_pk_bf16_f32 v195, v98, v99
 buffer_store_dwordx4 v[192:195], v4, s[32:35], s98 offen sc1
 v_lshlrev_b32 v30, 20, v0
 v_mov_b32 v31, 1
 s_waitcnt vmcnt(0)
 s_waitcnt vmcnt(0)
 buffer_atomic_add v31, v30, s[20:23], s93 offen sc1
 v_mbcnt_lo_u32_b32 v0, -1, 0
 v_mbcnt_hi_u32_b32 v0, -1, v0
 v_lshl_add_u32 v0, s100, 6, v0
 s_load_dwordx2 s[8:9], s[0:1], 0x68
 s_load_dwordx2 s[12:13], s[0:1], 48
 s_load_dwordx2 s[16:17], s[0:1], 56
 s_load_dwordx2 s[20:21], s[0:1], 0x68
 s_load_dwordx2 s[4:5], s[0:1], 0x68
 s_load_dwordx2 s[84:85], s[0:1], 64
 v_mov_b32 v16, v0
 v_lshrrev_b32 v1, 6, v0
 s_nop 0
 v_readfirstlane_b32 s28, v1
 v_and_b32 v0, 63, v0
 v_lshlrev_b32 v1, 4, v0
 s_and_b32 s41, s2, 7
 s_lshl_b32 s41, s41, 2
 s_lshr_b32 s42, s2, 3
 s_and_b32 s43, s42, 3
 s_add_u32 s29, s41, s43
 s_lshr_b32 s42, s42, 2
 s_lshl_b32 s42, s42, 3
 s_lshl_b32 s41, s28, 1
 s_add_u32 s30, s42, s41
 s_and_b32 s41, s28, 1
 s_mul_i32 s31, s41, 0x48000
 s_mul_i32 s42, s29, 0x120
 s_add_u32 s31, s31, s42
 s_mul_i32 s34, s28, 0x2400
 s_mul_i32 s32, s30, 0x9000
 s_add_u32 s33, s32, 0x9000
 v_lshrrev_b32 v30, 5, v0
 v_lshlrev_b32 v11, 10, v30
 v_bfe_u32 v30, v0, 4, 1
 v_lshl_add_u32 v11, v30, 9, v11
 v_and_b32 v31, 15, v0
 v_lshl_add_u32 v11, v31, 4, v11
 s_movk_i32 s41, 0x2400
 s_movk_i32 s42, 0xe39
 v_add_u32 v30, 0, v0
 v_mul_u32_u24 v31, v30, s42
 v_lshrrev_b32 v31, 16, v31
 v_mul_u32_u24 v32, 18, v31
 v_sub_u32 v30, v30, v32
 v_and_b32 v32, 19, v31
 v_bfe_u32 v33, v31, 2, 1
 v_lshl_or_b32 v32, v33, 3, v32
 v_bfe_u32 v33, v31, 3, 1
 v_lshl_or_b32 v32, v33, 2, v32
 v_mul_u32_u24 v32, v32, s41
 v_lshl_add_u32 v2, v30, 4, v32
 v_add_u32 v30, 64, v0
 v_mul_u32_u24 v31, v30, s42
 v_lshrrev_b32 v31, 16, v31
 v_mul_u32_u24 v32, 18, v31
 v_sub_u32 v30, v30, v32
 v_and_b32 v32, 19, v31
 v_bfe_u32 v33, v31, 2, 1
 v_lshl_or_b32 v32, v33, 3, v32
 v_bfe_u32 v33, v31, 3, 1
 v_lshl_or_b32 v32, v33, 2, v32
 v_mul_u32_u24 v32, v32, s41
 v_lshl_add_u32 v3, v30, 4, v32
 v_subrev_u32 v3, 0x400, v3
 v_add_u32 v30, 0x80, v0
 v_mul_u32_u24 v31, v30, s42
 v_lshrrev_b32 v31, 16, v31
 v_mul_u32_u24 v32, 18, v31
 v_sub_u32 v30, v30, v32
 v_and_b32 v32, 19, v31
 v_bfe_u32 v33, v31, 2, 1
 v_lshl_or_b32 v32, v33, 3, v32
 v_bfe_u32 v33, v31, 3, 1
 v_lshl_or_b32 v32, v33, 2, v32
 v_mul_u32_u24 v32, v32, s41
 v_lshl_add_u32 v4, v30, 4, v32
 v_subrev_u32 v4, 0x800, v4
 v_add_u32 v30, 0xc0, v0
 v_mul_u32_u24 v31, v30, s42
 v_lshrrev_b32 v31, 16, v31
 v_mul_u32_u24 v32, 18, v31
 v_sub_u32 v30, v30, v32
 v_and_b32 v32, 19, v31
 v_bfe_u32 v33, v31, 2, 1
 v_lshl_or_b32 v32, v33, 3, v32
 v_bfe_u32 v33, v31, 3, 1
 v_lshl_or_b32 v32, v33, 2, v32
 v_mul_u32_u24 v32, v32, s41
 v_lshl_add_u32 v5, v30, 4, v32
 v_subrev_u32 v5, 0xc00, v5
 v_add_u32 v30, 0x100, v0
 v_mul_u32_u24 v31, v30, s42
 v_lshrrev_b32 v31, 16, v31
 v_mul_u32_u24 v32, 18, v31
 v_sub_u32 v30, v30, v32
 v_and_b32 v32, 19, v31
 v_bfe_u32 v33, v31, 2, 1
 v_lshl_or_b32 v32, v33, 3, v32
 v_bfe_u32 v33, v31, 3, 1
 v_lshl_or_b32 v32, v33, 2, v32
 v_mul_u32_u24 v32, v32, s41
 v_lshl_add_u32 v6, v30, 4, v32
 v_add_u32 v30, 0x140, v0
 v_mul_u32_u24 v31, v30, s42
 v_lshrrev_b32 v31, 16, v31
 v_mul_u32_u24 v32, 18, v31
 v_sub_u32 v30, v30, v32
 v_and_b32 v32, 19, v31
 v_bfe_u32 v33, v31, 2, 1
 v_lshl_or_b32 v32, v33, 3, v32
 v_bfe_u32 v33, v31, 3, 1
 v_lshl_or_b32 v32, v33, 2, v32
 v_mul_u32_u24 v32, v32, s41
 v_lshl_add_u32 v7, v30, 4, v32
 v_subrev_u32 v7, 0x400, v7
 v_add_u32 v30, 0x180, v0
 v_mul_u32_u24 v31, v30, s42
 v_lshrrev_b32 v31, 16, v31
 v_mul_u32_u24 v32, 18, v31
 v_sub_u32 v30, v30, v32
 v_and_b32 v32, 19, v31
 v_bfe_u32 v33, v31, 2, 1
 v_lshl_or_b32 v32, v33, 3, v32
 v_bfe_u32 v33, v31, 3, 1
 v_lshl_or_b32 v32, v33, 2, v32
 v_mul_u32_u24 v32, v32, s41
 v_lshl_add_u32 v8, v30, 4, v32
 v_subrev_u32 v8, 0x800, v8
 v_add_u32 v30, 0x1c0, v0
 v_mul_u32_u24 v31, v30, s42
 v_lshrrev_b32 v31, 16, v31
 v_mul_u32_u24 v32, 18, v31
 v_sub_u32 v30, v30, v32
 v_and_b32 v32, 19, v31
 v_bfe_u32 v33, v31, 2, 1
 v_lshl_or_b32 v32, v33, 3, v32
 v_bfe_u32 v33, v31, 3, 1
 v_lshl_or_b32 v32, v33, 2, v32
 v_mul_u32_u24 v32, v32, s41
 v_lshl_add_u32 v9, v30, 4, v32
 v_subrev_u32 v9, 0xc00, v9
 v_add_u32 v30, 0x200, v0
 v_mul_u32_u24 v31, v30, s42
 v_lshrrev_b32 v31, 16, v31
 v_mul_u32_u24 v32, 18, v31
 v_sub_u32 v30, v30, v32
 v_and_b32 v32, 19, v31
 v_bfe_u32 v33, v31, 2, 1
 v_lshl_or_b32 v32, v33, 3, v32
 v_bfe_u32 v33, v31, 3, 1
 v_lshl_or_b32 v32, v33, 2, v32
 v_mul_u32_u24 v32, v32, s41
 v_lshl_add_u32 v10, v30, 4, v32
 s_waitcnt lgkmcnt(0)
 s_add_u32 s8, s8, 0x4c0000
 s_addc_u32 s9, s9, 0
 s_mov_b32 s10, 0x240000
 s_mov_b32 s11, 0x20000
 s_mov_b32 s14, 0x510000
 s_mov_b32 s15, 0x20000
 s_mov_b32 s18, 0x510000
 s_mov_b32 s19, 0x20000
 s_add_u32 s20, s20, 0x1800000
 s_addc_u32 s21, s21, 0
 s_mov_b32 s22, 0x1200000
 s_mov_b32 s23, 0x20000
 s_add_u32 s4, s4, 0x2a00000
 s_addc_u32 s5, s5, 0
 s_mov_b32 s6, 0x40000
 s_mov_b32 s7, 0x20000
 s_mov_b32 s86, 0x510000
 s_mov_b32 s87, 0x20000
 s_cmp_lt_u32 s28, 2
 s_cselect_b32 s24, s12, s16
 s_cselect_b32 s25, s13, s17
 s_mov_b32 s26, 0x510000
 s_mov_b32 s27, 0x20000
 s_add_u32 s44, s31, 0
 s_add_u32 m0, s34, 0
 s_nop 0
 buffer_load_dwordx4 v2, s[24:27], s44 offen lds
 buffer_load_dwordx4 v3, s[24:27], s44 offen offset:1024 lds
 buffer_load_dwordx4 v4, s[24:27], s44 offen offset:2048 lds
 buffer_load_dwordx4 v5, s[24:27], s44 offen offset:3072 lds
 s_add_u32 m0, s34, 0x1000
 s_nop 0
 buffer_load_dwordx4 v6, s[24:27], s44 offen lds
 buffer_load_dwordx4 v7, s[24:27], s44 offen offset:1024 lds
 buffer_load_dwordx4 v8, s[24:27], s44 offen offset:2048 lds
 buffer_load_dwordx4 v9, s[24:27], s44 offen offset:3072 lds
 s_add_u32 m0, s34, 0x2000
 s_nop 0
 buffer_load_dwordx4 v10, s[24:27], s44 offen lds
 s_add_u32 s44, s31, 0x90000
 s_add_u32 m0, s34, 0x9000
 s_nop 0
 buffer_load_dwordx4 v2, s[24:27], s44 offen lds
 buffer_load_dwordx4 v3, s[24:27], s44 offen offset:1024 lds
 buffer_load_dwordx4 v4, s[24:27], s44 offen offset:2048 lds
 buffer_load_dwordx4 v5, s[24:27], s44 offen offset:3072 lds
 s_add_u32 m0, s34, 0xa000
 s_nop 0
 buffer_load_dwordx4 v6, s[24:27], s44 offen lds
 buffer_load_dwordx4 v7, s[24:27], s44 offen offset:1024 lds
 buffer_load_dwordx4 v8, s[24:27], s44 offen offset:2048 lds
 buffer_load_dwordx4 v9, s[24:27], s44 offen offset:3072 lds
 s_add_u32 m0, s34, 0xb000
 s_nop 0
 buffer_load_dwordx4 v10, s[24:27], s44 offen lds
 s_add_u32 s44, s31, 0x120000
 s_add_u32 m0, s34, 0x12000
 s_nop 0
 buffer_load_dwordx4 v2, s[24:27], s44 offen lds
 buffer_load_dwordx4 v3, s[24:27], s44 offen offset:1024 lds
 buffer_load_dwordx4 v4, s[24:27], s44 offen offset:2048 lds
 buffer_load_dwordx4 v5, s[24:27], s44 offen offset:3072 lds
 s_add_u32 m0, s34, 0x13000
 s_nop 0
 buffer_load_dwordx4 v6, s[24:27], s44 offen lds
 buffer_load_dwordx4 v7, s[24:27], s44 offen offset:1024 lds
 buffer_load_dwordx4 v8, s[24:27], s44 offen offset:2048 lds
 buffer_load_dwordx4 v9, s[24:27], s44 offen offset:3072 lds
 s_add_u32 m0, s34, 0x14000
 s_nop 0
 buffer_load_dwordx4 v10, s[24:27], s44 offen lds
 s_mul_i32 s41, s30, 0x48000
 s_mul_i32 s42, s29, 0x2400
 s_add_u32 s35, s41, s42
 s_add_u32 s36, s35, 0x48000
 v_bfe_u32 v31, v0, 2, 2
 v_lshrrev_b32 v32, 5, v0
 v_lshlrev_b32 v32, 4, v32
 v_bfe_u32 v35, v0, 4, 1
 v_lshl_add_u32 v32, v35, 2, v32
 v_add_u32 v32, v32, v31
 v_mul_u32_u24 v32, 0x120, v32
 v_and_b32 v33, 3, v0
 v_lshl_add_u32 v12, v33, 3, v32
 v_add_u32 v13, 0x9000, v12
 v_add_u32 v14, 0x12000, v12
 v_add_u32 v15, 0x1b000, v12
 s_lshr_b32 s41, s2, 5
 s_lshl_b32 s41, s41, 9
 s_add_u32 s41, s41, 0x28000
 v_and_b32 v30, 3, v0
 v_lshlrev_b32 v30, 7, v30
 s_mov_b32 s42, 0
 s_cmp_lg_u32 s28, 0
 s_cbranch_scc1 gateup_in_done
gateup_in:
 buffer_load_dword v31, v30, s[4:7], s41 offen sc1
 s_waitcnt vmcnt(0)
 v_cmp_ne_u32 vcc, 32, v31
 s_add_u32 s42, s42, 1
 s_cmp_ge_u32 s42, 0x100000
 s_cbranch_scc1 gateup_in_done
 s_cbranch_vccz gateup_in_done
 s_sleep 4
 s_branch gateup_in
gateup_in_done:
 s_nop 3
 s_waitcnt vmcnt(0) lgkmcnt(0)
 s_barrier
 s_add_u32 s46, s32, 0
 s_add_u32 s47, s33, 0
 buffer_load_dwordx4 a[80:83], v11, s[8:11], s46 offen sc1
 buffer_load_dwordx4 a[84:87], v11, s[8:11], s46 offen offset:256 sc1
 buffer_load_dwordx4 a[88:91], v11, s[8:11], s47 offen sc1
 buffer_load_dwordx4 a[92:95], v11, s[8:11], s47 offen offset:256 sc1
 buffer_load_dwordx4 a[96:99], v11, s[8:11], s46 offen offset:2048 sc1
 buffer_load_dwordx4 a[100:103], v11, s[8:11], s46 offen offset:2304 sc1
 buffer_load_dwordx4 a[104:107], v11, s[8:11], s47 offen offset:2048 sc1
 buffer_load_dwordx4 a[108:111], v11, s[8:11], s47 offen offset:2304 sc1
 s_mov_b32 s93, 0x40053526
 s_waitcnt vmcnt(0)
 s_barrier
 ds_read_b64_tr_b16 a[208:209], v12
 ds_read_b64_tr_b16 a[210:211], v12 offset:2304
 ds_read_b64_tr_b16 a[212:213], v12 offset:18432
 ds_read_b64_tr_b16 a[214:215], v12 offset:20736
 ds_read_b64_tr_b16 a[216:217], v12 offset:32
 ds_read_b64_tr_b16 a[218:219], v12 offset:2336
 s_waitcnt lgkmcnt(4)
 v_mfma_f32_16x16x32_bf16 v[48:51], a[208:211], a[80:83], 0
 s_add_u32 s46, s32, 0x1000
 ds_read_b64_tr_b16 a[220:221], v12 offset:18464
 v_mfma_f32_16x16x32_bf16 v[52:55], a[208:211], a[84:87], 0
 ds_read_b64_tr_b16 a[222:223], v12 offset:20768
 ds_read_b64_tr_b16 a[224:225], v12 offset:64
 v_mfma_f32_16x16x32_bf16 v[56:59], a[208:211], a[88:91], 0
 ds_read_b64_tr_b16 a[226:227], v12 offset:2368
 ds_read_b64_tr_b16 a[228:229], v12 offset:18496
 v_mfma_f32_16x16x32_bf16 v[60:63], a[208:211], a[92:95], 0
 s_add_u32 s47, s33, 0x1000
 ds_read_b64_tr_b16 a[230:231], v12 offset:20800
 s_waitcnt lgkmcnt(8)
 v_mfma_f32_16x16x32_bf16 v[64:67], a[212:215], a[80:83], 0
 ds_read_b64_tr_b16 a[232:233], v12 offset:96
 ds_read_b64_tr_b16 a[234:235], v12 offset:2400
 v_mfma_f32_16x16x32_bf16 v[68:71], a[212:215], a[84:87], 0
 ds_read_b64_tr_b16 a[236:237], v12 offset:18528
 ds_read_b64_tr_b16 a[238:239], v12 offset:20832
 v_mfma_f32_16x16x32_bf16 v[72:75], a[212:215], a[88:91], 0
 ds_read_b64_tr_b16 a[240:241], v12 offset:128
 ds_read_b64_tr_b16 a[242:243], v12 offset:2432
 v_mfma_f32_16x16x32_bf16 v[76:79], a[212:215], a[92:95], 0
 ds_read_b64_tr_b16 a[244:245], v12 offset:18560
 s_waitcnt lgkmcnt(14)
 ds_read_b64_tr_b16 a[246:247], v12 offset:20864
 s_waitcnt lgkmcnt(13)
 v_mfma_f32_16x16x32_bf16 v[80:83], a[216:219], a[80:83], 0
 buffer_load_dwordx4 a[112:115], v11, s[8:11], s46 offen sc1
 v_mfma_f32_16x16x32_bf16 v[84:87], a[216:219], a[84:87], 0
 v_mfma_f32_16x16x32_bf16 v[88:91], a[216:219], a[88:91], 0
 v_mfma_f32_16x16x32_bf16 v[92:95], a[216:219], a[92:95], 0
 ds_read_b64_tr_b16 a[248:249], v12 offset:160
 ds_read_b64_tr_b16 a[250:251], v12 offset:2464
 s_waitcnt lgkmcnt(8)
 v_mfma_f32_16x16x32_bf16 v[96:99], a[220:223], a[80:83], 0
 v_mfma_f32_16x16x32_bf16 v[100:103], a[220:223], a[84:87], 0
 buffer_load_dwordx4 a[116:119], v11, s[8:11], s46 offen offset:256 sc1
 v_mfma_f32_16x16x32_bf16 v[104:107], a[220:223], a[88:91], 0
 v_mfma_f32_16x16x32_bf16 v[108:111], a[220:223], a[92:95], 0
 ds_read_b64_tr_b16 a[252:253], v12 offset:18592
 ds_read_b64_tr_b16 a[254:255], v12 offset:20896
 v_mfma_f32_16x16x32_bf16 v[112:115], a[224:227], a[80:83], 0
 v_mfma_f32_16x16x32_bf16 v[116:119], a[224:227], a[84:87], 0
 v_mfma_f32_16x16x32_bf16 v[120:123], a[224:227], a[88:91], 0
 buffer_load_dwordx4 a[120:123], v11, s[8:11], s47 offen sc1
 v_mfma_f32_16x16x32_bf16 v[124:127], a[224:227], a[92:95], 0
 ds_read_b64_tr_b16 a[208:209], v12 offset:192
 ds_read_b64_tr_b16 a[210:211], v12 offset:2496
 v_mfma_f32_16x16x32_bf16 v[128:131], a[228:231], a[80:83], 0
 v_mfma_f32_16x16x32_bf16 v[132:135], a[228:231], a[84:87], 0
 v_mfma_f32_16x16x32_bf16 v[136:139], a[228:231], a[88:91], 0
 v_mfma_f32_16x16x32_bf16 v[140:143], a[228:231], a[92:95], 0
 buffer_load_dwordx4 a[124:127], v11, s[8:11], s47 offen offset:256 sc1
 v_mfma_f32_16x16x32_bf16 v[144:147], a[232:235], a[80:83], 0
 ds_read_b64_tr_b16 a[212:213], v12 offset:18624
 ds_read_b64_tr_b16 a[214:215], v12 offset:20928
 v_mfma_f32_16x16x32_bf16 v[148:151], a[232:235], a[84:87], 0
 v_mfma_f32_16x16x32_bf16 v[152:155], a[232:235], a[88:91], 0
 v_mfma_f32_16x16x32_bf16 v[156:159], a[232:235], a[92:95], 0
 buffer_load_dwordx4 a[128:131], v11, s[8:11], s46 offen offset:2048 sc1
 s_waitcnt lgkmcnt(2)
 v_mfma_f32_16x16x32_bf16 v[160:163], a[236:239], a[80:83], 0
 ds_read_b64_tr_b16 a[216:217], v12 offset:224
 ds_read_b64_tr_b16 a[218:219], v12 offset:2528
 v_mfma_f32_16x16x32_bf16 v[164:167], a[236:239], a[84:87], 0
 v_mfma_f32_16x16x32_bf16 v[168:171], a[236:239], a[88:91], 0
 v_mfma_f32_16x16x32_bf16 v[172:175], a[236:239], a[92:95], 0
 ds_read_b64_tr_b16 a[220:221], v12 offset:18656
 ds_read_b64_tr_b16 a[222:223], v12 offset:20960
 v_mfma_f32_16x16x32_bf16 v[176:179], a[240:243], a[80:83], 0
 buffer_load_dwordx4 a[132:135], v11, s[8:11], s46 offen offset:2304 sc1
 v_mfma_f32_16x16x32_bf16 v[180:183], a[240:243], a[84:87], 0
 v_mfma_f32_16x16x32_bf16 v[184:187], a[240:243], a[88:91], 0
 v_mfma_f32_16x16x32_bf16 v[188:191], a[240:243], a[92:95], 0
 ds_read_b64_tr_b16 a[224:225], v12 offset:256
 ds_read_b64_tr_b16 a[226:227], v12 offset:2560
 v_mfma_f32_16x16x32_bf16 v[192:195], a[244:247], a[80:83], 0
 v_mfma_f32_16x16x32_bf16 v[196:199], a[244:247], a[84:87], 0
 buffer_load_dwordx4 a[136:139], v11, s[8:11], s47 offen offset:2048 sc1
 v_mfma_f32_16x16x32_bf16 v[200:203], a[244:247], a[88:91], 0
 v_mfma_f32_16x16x32_bf16 v[204:207], a[244:247], a[92:95], 0
 ds_read_b64_tr_b16 a[228:229], v12 offset:18688
 ds_read_b64_tr_b16 a[230:231], v12 offset:20992
 v_mfma_f32_16x16x32_bf16 v[208:211], a[248:251], a[80:83], 0
 v_mfma_f32_16x16x32_bf16 v[212:215], a[248:251], a[84:87], 0
 v_mfma_f32_16x16x32_bf16 v[216:219], a[248:251], a[88:91], 0
 buffer_load_dwordx4 a[140:143], v11, s[8:11], s47 offen offset:2304 sc1
 v_mfma_f32_16x16x32_bf16 v[220:223], a[248:251], a[92:95], 0
 ds_read_b64_tr_b16 a[232:233], v12 offset:9216
 ds_read_b64_tr_b16 a[234:235], v12 offset:11520
 v_mfma_f32_16x16x32_bf16 v[224:227], a[252:255], a[80:83], 0
 v_mfma_f32_16x16x32_bf16 v[228:231], a[252:255], a[84:87], 0
 v_mfma_f32_16x16x32_bf16 v[232:235], a[252:255], a[88:91], 0
 v_mfma_f32_16x16x32_bf16 v[236:239], a[252:255], a[92:95], 0
 s_add_u32 s46, s32, 0x2000
 ds_read_b64_tr_b16 a[236:237], v12 offset:27648
 v_mfma_f32_16x16x32_bf16 v[240:243], a[208:211], a[80:83], 0
 ds_read_b64_tr_b16 a[238:239], v12 offset:29952
 v_mfma_f32_16x16x32_bf16 v[244:247], a[208:211], a[84:87], 0
 v_mfma_f32_16x16x32_bf16 v[248:251], a[208:211], a[88:91], 0
 v_mfma_f32_16x16x32_bf16 v[252:255], a[208:211], a[92:95], 0
 s_add_u32 s47, s33, 0x2000
 ds_read_b64_tr_b16 a[240:241], v12 offset:9248
 s_waitcnt lgkmcnt(3)
 v_mfma_f32_16x16x32_bf16 a[0:3], a[212:215], a[80:83], 0
 ds_read_b64_tr_b16 a[242:243], v12 offset:11552
 v_mfma_f32_16x16x32_bf16 a[4:7], a[212:215], a[84:87], 0
 v_mfma_f32_16x16x32_bf16 a[8:11], a[212:215], a[88:91], 0
 v_mfma_f32_16x16x32_bf16 a[12:15], a[212:215], a[92:95], 0
 ds_read_b64_tr_b16 a[244:245], v12 offset:27680
 ds_read_b64_tr_b16 a[246:247], v12 offset:29984
 v_mfma_f32_16x16x32_bf16 a[16:19], a[216:219], a[80:83], 0
 buffer_load_dwordx4 a[144:147], v11, s[8:11], s46 offen sc1
 v_mfma_f32_16x16x32_bf16 a[20:23], a[216:219], a[84:87], 0
 v_mfma_f32_16x16x32_bf16 a[24:27], a[216:219], a[88:91], 0
 v_mfma_f32_16x16x32_bf16 a[28:31], a[216:219], a[92:95], 0
 ds_read_b64_tr_b16 a[248:249], v12 offset:9280
 ds_read_b64_tr_b16 a[250:251], v12 offset:11584
 v_mfma_f32_16x16x32_bf16 a[32:35], a[220:223], a[80:83], 0
 v_mfma_f32_16x16x32_bf16 a[36:39], a[220:223], a[84:87], 0
 buffer_load_dwordx4 a[148:151], v11, s[8:11], s46 offen offset:256 sc1
 v_mfma_f32_16x16x32_bf16 a[40:43], a[220:223], a[88:91], 0
 v_mfma_f32_16x16x32_bf16 a[44:47], a[220:223], a[92:95], 0
 ds_read_b64_tr_b16 a[252:253], v12 offset:27712
 ds_read_b64_tr_b16 a[254:255], v12 offset:30016
 v_mfma_f32_16x16x32_bf16 a[48:51], a[224:227], a[80:83], 0
 v_mfma_f32_16x16x32_bf16 a[52:55], a[224:227], a[84:87], 0
 v_mfma_f32_16x16x32_bf16 a[56:59], a[224:227], a[88:91], 0
 buffer_load_dwordx4 a[152:155], v11, s[8:11], s47 offen sc1
 v_mfma_f32_16x16x32_bf16 a[60:63], a[224:227], a[92:95], 0
 ds_read_b64_tr_b16 a[208:209], v12 offset:9312
 ds_read_b64_tr_b16 a[210:211], v12 offset:11616
 v_mfma_f32_16x16x32_bf16 a[64:67], a[228:231], a[80:83], 0
 v_mfma_f32_16x16x32_bf16 a[68:71], a[228:231], a[84:87], 0
 v_mfma_f32_16x16x32_bf16 a[72:75], a[228:231], a[88:91], 0
 v_mfma_f32_16x16x32_bf16 a[76:79], a[228:231], a[92:95], 0
 buffer_load_dwordx4 a[156:159], v11, s[8:11], s47 offen offset:256 sc1
 v_mfma_f32_16x16x32_bf16 v[48:51], a[232:235], a[96:99], v[48:51]
 ds_read_b64_tr_b16 a[212:213], v12 offset:27744
 ds_read_b64_tr_b16 a[214:215], v12 offset:30048
 v_mfma_f32_16x16x32_bf16 v[52:55], a[232:235], a[100:103], v[52:55]
 v_mfma_f32_16x16x32_bf16 v[56:59], a[232:235], a[104:107], v[56:59]
 v_mfma_f32_16x16x32_bf16 v[60:63], a[232:235], a[108:111], v[60:63]
 buffer_load_dwordx4 a[160:163], v11, s[8:11], s46 offen offset:2048 sc1
 s_waitcnt lgkmcnt(2)
 v_mfma_f32_16x16x32_bf16 v[64:67], a[236:239], a[96:99], v[64:67]
 ds_read_b64_tr_b16 a[216:217], v12 offset:9344
 ds_read_b64_tr_b16 a[218:219], v12 offset:11648
 v_mfma_f32_16x16x32_bf16 v[68:71], a[236:239], a[100:103], v[68:71]
 v_mfma_f32_16x16x32_bf16 v[72:75], a[236:239], a[104:107], v[72:75]
 v_mfma_f32_16x16x32_bf16 v[76:79], a[236:239], a[108:111], v[76:79]
 ds_read_b64_tr_b16 a[220:221], v12 offset:27776
 ds_read_b64_tr_b16 a[222:223], v12 offset:30080
 v_mfma_f32_16x16x32_bf16 v[80:83], a[240:243], a[96:99], v[80:83]
 buffer_load_dwordx4 a[164:167], v11, s[8:11], s46 offen offset:2304 sc1
 v_mfma_f32_16x16x32_bf16 v[84:87], a[240:243], a[100:103], v[84:87]
 v_mfma_f32_16x16x32_bf16 v[88:91], a[240:243], a[104:107], v[88:91]
 v_mfma_f32_16x16x32_bf16 v[92:95], a[240:243], a[108:111], v[92:95]
 ds_read_b64_tr_b16 a[224:225], v12 offset:9376
 ds_read_b64_tr_b16 a[226:227], v12 offset:11680
 v_mfma_f32_16x16x32_bf16 v[96:99], a[244:247], a[96:99], v[96:99]
 v_mfma_f32_16x16x32_bf16 v[100:103], a[244:247], a[100:103], v[100:103]
 buffer_load_dwordx4 a[168:171], v11, s[8:11], s47 offen offset:2048 sc1
 v_mfma_f32_16x16x32_bf16 v[104:107], a[244:247], a[104:107], v[104:107]
 v_mfma_f32_16x16x32_bf16 v[108:111], a[244:247], a[108:111], v[108:111]
 ds_read_b64_tr_b16 a[228:229], v12 offset:27808
 ds_read_b64_tr_b16 a[230:231], v12 offset:30112
 v_mfma_f32_16x16x32_bf16 v[112:115], a[248:251], a[96:99], v[112:115]
 v_mfma_f32_16x16x32_bf16 v[116:119], a[248:251], a[100:103], v[116:119]
 v_mfma_f32_16x16x32_bf16 v[120:123], a[248:251], a[104:107], v[120:123]
 buffer_load_dwordx4 a[172:175], v11, s[8:11], s47 offen offset:2304 sc1
 v_mfma_f32_16x16x32_bf16 v[124:127], a[248:251], a[108:111], v[124:127]
 ds_read_b64_tr_b16 a[232:233], v12 offset:9408
 ds_read_b64_tr_b16 a[234:235], v12 offset:11712
 v_mfma_f32_16x16x32_bf16 v[128:131], a[252:255], a[96:99], v[128:131]
 v_mfma_f32_16x16x32_bf16 v[132:135], a[252:255], a[100:103], v[132:135]
 v_mfma_f32_16x16x32_bf16 v[136:139], a[252:255], a[104:107], v[136:139]
 v_mfma_f32_16x16x32_bf16 v[140:143], a[252:255], a[108:111], v[140:143]
 ds_read_b64_tr_b16 a[236:237], v12 offset:27840
 ds_read_b64_tr_b16 a[238:239], v12 offset:30144
 v_mfma_f32_16x16x32_bf16 v[144:147], a[208:211], a[96:99], v[144:147]
 v_mfma_f32_16x16x32_bf16 v[148:151], a[208:211], a[100:103], v[148:151]
 v_mfma_f32_16x16x32_bf16 v[152:155], a[208:211], a[104:107], v[152:155]
 v_mfma_f32_16x16x32_bf16 v[156:159], a[208:211], a[108:111], v[156:159]
 ds_read_b64_tr_b16 a[240:241], v12 offset:9440
 s_waitcnt lgkmcnt(14)
 ds_read_b64_tr_b16 a[242:243], v12 offset:11744
 s_waitcnt lgkmcnt(4)
 v_mfma_f32_16x16x32_bf16 v[160:163], a[212:215], a[96:99], v[160:163]
 v_mfma_f32_16x16x32_bf16 v[164:167], a[212:215], a[100:103], v[164:167]
 v_mfma_f32_16x16x32_bf16 v[168:171], a[212:215], a[104:107], v[168:171]
 v_mfma_f32_16x16x32_bf16 v[172:175], a[212:215], a[108:111], v[172:175]
 s_waitcnt vmcnt(8)
 s_barrier
 v_mfma_f32_16x16x32_bf16 v[176:179], a[216:219], a[96:99], v[176:179]
 s_add_u32 s44, s31, 0x1b0000
 ds_read_b64_tr_b16 a[244:245], v12 offset:27872
 v_mfma_f32_16x16x32_bf16 v[180:183], a[216:219], a[100:103], v[180:183]
 ds_read_b64_tr_b16 a[246:247], v12 offset:30176
 v_mfma_f32_16x16x32_bf16 v[184:187], a[216:219], a[104:107], v[184:187]
 v_mfma_f32_16x16x32_bf16 v[188:191], a[216:219], a[108:111], v[188:191]
 s_add_u32 s46, s32, 0x3000
 ds_read_b64_tr_b16 a[248:249], v12 offset:9472
 v_mfma_f32_16x16x32_bf16 v[192:195], a[220:223], a[96:99], v[192:195]
 ds_read_b64_tr_b16 a[250:251], v12 offset:11776
 v_mfma_f32_16x16x32_bf16 v[196:199], a[220:223], a[100:103], v[196:199]
 v_mfma_f32_16x16x32_bf16 v[200:203], a[220:223], a[104:107], v[200:203]
 v_mfma_f32_16x16x32_bf16 v[204:207], a[220:223], a[108:111], v[204:207]
 s_add_u32 s47, s33, 0x3000
 ds_read_b64_tr_b16 a[252:253], v12 offset:27904
 v_mfma_f32_16x16x32_bf16 v[208:211], a[224:227], a[96:99], v[208:211]
 ds_read_b64_tr_b16 a[254:255], v12 offset:30208
 v_mfma_f32_16x16x32_bf16 v[212:215], a[224:227], a[100:103], v[212:215]
 v_mfma_f32_16x16x32_bf16 v[216:219], a[224:227], a[104:107], v[216:219]
 v_mfma_f32_16x16x32_bf16 v[220:223], a[224:227], a[108:111], v[220:223]
 ds_read_b64_tr_b16 a[208:209], v13
 ds_read_b64_tr_b16 a[210:211], v13 offset:2304
 v_mfma_f32_16x16x32_bf16 v[224:227], a[228:231], a[96:99], v[224:227]
 s_add_u32 m0, s34, 0x1b000
 v_mfma_f32_16x16x32_bf16 v[228:231], a[228:231], a[100:103], v[228:231]
 v_mfma_f32_16x16x32_bf16 v[232:235], a[228:231], a[104:107], v[232:235]
 v_mfma_f32_16x16x32_bf16 v[236:239], a[228:231], a[108:111], v[236:239]
 ds_read_b64_tr_b16 a[212:213], v13 offset:18432
 ds_read_b64_tr_b16 a[214:215], v13 offset:20736
 v_mfma_f32_16x16x32_bf16 v[240:243], a[232:235], a[96:99], v[240:243]
 buffer_load_dwordx4 v2, s[24:27], s44 offen lds
 v_mfma_f32_16x16x32_bf16 v[244:247], a[232:235], a[100:103], v[244:247]
 v_mfma_f32_16x16x32_bf16 v[248:251], a[232:235], a[104:107], v[248:251]
 v_mfma_f32_16x16x32_bf16 v[252:255], a[232:235], a[108:111], v[252:255]
 ds_read_b64_tr_b16 a[216:217], v13 offset:32
 s_waitcnt lgkmcnt(14)
 ds_read_b64_tr_b16 a[218:219], v13 offset:2336
 s_waitcnt lgkmcnt(4)
 v_mfma_f32_16x16x32_bf16 a[0:3], a[236:239], a[96:99], a[0:3]
 buffer_load_dwordx4 a[176:179], v11, s[8:11], s46 offen sc1
 v_mfma_f32_16x16x32_bf16 a[4:7], a[236:239], a[100:103], a[4:7]
 v_mfma_f32_16x16x32_bf16 a[8:11], a[236:239], a[104:107], a[8:11]
 v_mfma_f32_16x16x32_bf16 a[12:15], a[236:239], a[108:111], a[12:15]
 ds_read_b64_tr_b16 a[220:221], v13 offset:18464
 ds_read_b64_tr_b16 a[222:223], v13 offset:20768
 v_mfma_f32_16x16x32_bf16 a[16:19], a[240:243], a[96:99], a[16:19]
 v_mfma_f32_16x16x32_bf16 a[20:23], a[240:243], a[100:103], a[20:23]
 buffer_load_dwordx4 v3, s[24:27], s44 offen offset:1024 lds
 v_mfma_f32_16x16x32_bf16 a[24:27], a[240:243], a[104:107], a[24:27]
 v_mfma_f32_16x16x32_bf16 a[28:31], a[240:243], a[108:111], a[28:31]
 ds_read_b64_tr_b16 a[224:225], v13 offset:64
 ds_read_b64_tr_b16 a[226:227], v13 offset:2368
 v_mfma_f32_16x16x32_bf16 a[32:35], a[244:247], a[96:99], a[32:35]
 v_mfma_f32_16x16x32_bf16 a[36:39], a[244:247], a[100:103], a[36:39]
 buffer_load_dwordx4 a[180:183], v11, s[8:11], s46 offen offset:256 sc1
 v_mfma_f32_16x16x32_bf16 a[40:43], a[244:247], a[104:107], a[40:43]
 v_mfma_f32_16x16x32_bf16 a[44:47], a[244:247], a[108:111], a[44:47]
 ds_read_b64_tr_b16 a[228:229], v13 offset:18496
 ds_read_b64_tr_b16 a[230:231], v13 offset:20800
 v_mfma_f32_16x16x32_bf16 a[48:51], a[248:251], a[96:99], a[48:51]
 v_mfma_f32_16x16x32_bf16 a[52:55], a[248:251], a[100:103], a[52:55]
 buffer_load_dwordx4 v4, s[24:27], s44 offen offset:2048 lds
 v_mfma_f32_16x16x32_bf16 a[56:59], a[248:251], a[104:107], a[56:59]
 v_mfma_f32_16x16x32_bf16 a[60:63], a[248:251], a[108:111], a[60:63]
 ds_read_b64_tr_b16 a[232:233], v13 offset:96
 ds_read_b64_tr_b16 a[234:235], v13 offset:2400
 v_mfma_f32_16x16x32_bf16 a[64:67], a[252:255], a[96:99], a[64:67]
 v_mfma_f32_16x16x32_bf16 a[68:71], a[252:255], a[100:103], a[68:71]
 v_mfma_f32_16x16x32_bf16 a[72:75], a[252:255], a[104:107], a[72:75]
 buffer_load_dwordx4 a[184:187], v11, s[8:11], s47 offen sc1
 v_mfma_f32_16x16x32_bf16 a[76:79], a[252:255], a[108:111], a[76:79]
 ds_read_b64_tr_b16 a[236:237], v13 offset:18528
 ds_read_b64_tr_b16 a[238:239], v13 offset:20832
 v_mfma_f32_16x16x32_bf16 v[48:51], a[208:211], a[112:115], v[48:51]
 v_mfma_f32_16x16x32_bf16 v[52:55], a[208:211], a[116:119], v[52:55]
 v_mfma_f32_16x16x32_bf16 v[56:59], a[208:211], a[120:123], v[56:59]
 buffer_load_dwordx4 v5, s[24:27], s44 offen offset:3072 lds
 v_mfma_f32_16x16x32_bf16 v[60:63], a[208:211], a[124:127], v[60:63]
 ds_read_b64_tr_b16 a[240:241], v13 offset:128
 s_waitcnt lgkmcnt(14)
 ds_read_b64_tr_b16 a[242:243], v13 offset:2432
 s_waitcnt lgkmcnt(4)
 v_mfma_f32_16x16x32_bf16 v[64:67], a[212:215], a[112:115], v[64:67]
 v_mfma_f32_16x16x32_bf16 v[68:71], a[212:215], a[116:119], v[68:71]
 v_mfma_f32_16x16x32_bf16 v[72:75], a[212:215], a[120:123], v[72:75]
 buffer_load_dwordx4 a[188:191], v11, s[8:11], s47 offen offset:256 sc1
 v_mfma_f32_16x16x32_bf16 v[76:79], a[212:215], a[124:127], v[76:79]
 ds_read_b64_tr_b16 a[244:245], v13 offset:18560
 ds_read_b64_tr_b16 a[246:247], v13 offset:20864
 v_mfma_f32_16x16x32_bf16 v[80:83], a[216:219], a[112:115], v[80:83]
 v_mfma_f32_16x16x32_bf16 v[84:87], a[216:219], a[116:119], v[84:87]
 v_mfma_f32_16x16x32_bf16 v[88:91], a[216:219], a[120:123], v[88:91]
 v_mfma_f32_16x16x32_bf16 v[92:95], a[216:219], a[124:127], v[92:95]
 s_add_u32 m0, s34, 0x1c000
 ds_read_b64_tr_b16 a[248:249], v13 offset:160
 v_mfma_f32_16x16x32_bf16 v[96:99], a[220:223], a[112:115], v[96:99]
 ds_read_b64_tr_b16 a[250:251], v13 offset:2464
 v_mfma_f32_16x16x32_bf16 v[100:103], a[220:223], a[116:119], v[100:103]
 v_mfma_f32_16x16x32_bf16 v[104:107], a[220:223], a[120:123], v[104:107]
 v_mfma_f32_16x16x32_bf16 v[108:111], a[220:223], a[124:127], v[108:111]
 buffer_load_dwordx4 v6, s[24:27], s44 offen lds
 v_mfma_f32_16x16x32_bf16 v[112:115], a[224:227], a[112:115], v[112:115]
 ds_read_b64_tr_b16 a[252:253], v13 offset:18592
 ds_read_b64_tr_b16 a[254:255], v13 offset:20896
 v_mfma_f32_16x16x32_bf16 v[116:119], a[224:227], a[116:119], v[116:119]
 v_mfma_f32_16x16x32_bf16 v[120:123], a[224:227], a[120:123], v[120:123]
 v_mfma_f32_16x16x32_bf16 v[124:127], a[224:227], a[124:127], v[124:127]
 buffer_load_dwordx4 a[192:195], v11, s[8:11], s46 offen offset:2048 sc1
 v_mfma_f32_16x16x32_bf16 v[128:131], a[228:231], a[112:115], v[128:131]
 ds_read_b64_tr_b16 a[208:209], v13 offset:192
 ds_read_b64_tr_b16 a[210:211], v13 offset:2496
 v_mfma_f32_16x16x32_bf16 v[132:135], a[228:231], a[116:119], v[132:135]
 v_mfma_f32_16x16x32_bf16 v[136:139], a[228:231], a[120:123], v[136:139]
 v_mfma_f32_16x16x32_bf16 v[140:143], a[228:231], a[124:127], v[140:143]
 ds_read_b64_tr_b16 a[212:213], v13 offset:18624
 ds_read_b64_tr_b16 a[214:215], v13 offset:20928
 v_mfma_f32_16x16x32_bf16 v[144:147], a[232:235], a[112:115], v[144:147]
 buffer_load_dwordx4 v7, s[24:27], s44 offen offset:1024 lds
 v_mfma_f32_16x16x32_bf16 v[148:151], a[232:235], a[116:119], v[148:151]
 v_mfma_f32_16x16x32_bf16 v[152:155], a[232:235], a[120:123], v[152:155]
 v_mfma_f32_16x16x32_bf16 v[156:159], a[232:235], a[124:127], v[156:159]
 ds_read_b64_tr_b16 a[216:217], v13 offset:224
 s_waitcnt lgkmcnt(14)
 ds_read_b64_tr_b16 a[218:219], v13 offset:2528
 s_waitcnt lgkmcnt(4)
 v_mfma_f32_16x16x32_bf16 v[160:163], a[236:239], a[112:115], v[160:163]
 buffer_load_dwordx4 a[196:199], v11, s[8:11], s46 offen offset:2304 sc1
 v_mfma_f32_16x16x32_bf16 v[164:167], a[236:239], a[116:119], v[164:167]
 v_mfma_f32_16x16x32_bf16 v[168:171], a[236:239], a[120:123], v[168:171]
 v_mfma_f32_16x16x32_bf16 v[172:175], a[236:239], a[124:127], v[172:175]
 ds_read_b64_tr_b16 a[220:221], v13 offset:18656
 ds_read_b64_tr_b16 a[222:223], v13 offset:20960
 v_mfma_f32_16x16x32_bf16 v[176:179], a[240:243], a[112:115], v[176:179]
 buffer_load_dwordx4 v8, s[24:27], s44 offen offset:2048 lds
 v_mfma_f32_16x16x32_bf16 v[180:183], a[240:243], a[116:119], v[180:183]
 v_mfma_f32_16x16x32_bf16 v[184:187], a[240:243], a[120:123], v[184:187]
 v_mfma_f32_16x16x32_bf16 v[188:191], a[240:243], a[124:127], v[188:191]
 ds_read_b64_tr_b16 a[224:225], v13 offset:256
 ds_read_b64_tr_b16 a[226:227], v13 offset:2560
 v_mfma_f32_16x16x32_bf16 v[192:195], a[244:247], a[112:115], v[192:195]
 v_mfma_f32_16x16x32_bf16 v[196:199], a[244:247], a[116:119], v[196:199]
 buffer_load_dwordx4 a[200:203], v11, s[8:11], s47 offen offset:2048 sc1
 v_mfma_f32_16x16x32_bf16 v[200:203], a[244:247], a[120:123], v[200:203]
 v_mfma_f32_16x16x32_bf16 v[204:207], a[244:247], a[124:127], v[204:207]
 ds_read_b64_tr_b16 a[228:229], v13 offset:18688
 ds_read_b64_tr_b16 a[230:231], v13 offset:20992
 v_mfma_f32_16x16x32_bf16 v[208:211], a[248:251], a[112:115], v[208:211]
 v_mfma_f32_16x16x32_bf16 v[212:215], a[248:251], a[116:119], v[212:215]
 buffer_load_dwordx4 v9, s[24:27], s44 offen offset:3072 lds
 v_mfma_f32_16x16x32_bf16 v[216:219], a[248:251], a[120:123], v[216:219]
 v_mfma_f32_16x16x32_bf16 v[220:223], a[248:251], a[124:127], v[220:223]
 ds_read_b64_tr_b16 a[232:233], v13 offset:9216
 ds_read_b64_tr_b16 a[234:235], v13 offset:11520
 v_mfma_f32_16x16x32_bf16 v[224:227], a[252:255], a[112:115], v[224:227]
 v_mfma_f32_16x16x32_bf16 v[228:231], a[252:255], a[116:119], v[228:231]
 buffer_load_dwordx4 a[204:207], v11, s[8:11], s47 offen offset:2304 sc1
 v_mfma_f32_16x16x32_bf16 v[232:235], a[252:255], a[120:123], v[232:235]
 v_mfma_f32_16x16x32_bf16 v[236:239], a[252:255], a[124:127], v[236:239]
 ds_read_b64_tr_b16 a[236:237], v13 offset:27648
 ds_read_b64_tr_b16 a[238:239], v13 offset:29952
 v_mfma_f32_16x16x32_bf16 v[240:243], a[208:211], a[112:115], v[240:243]
 v_mfma_f32_16x16x32_bf16 v[244:247], a[208:211], a[116:119], v[244:247]
 v_mfma_f32_16x16x32_bf16 v[248:251], a[208:211], a[120:123], v[248:251]
 s_add_u32 m0, s34, 0x1d000
 v_mfma_f32_16x16x32_bf16 v[252:255], a[208:211], a[124:127], v[252:255]
 ds_read_b64_tr_b16 a[240:241], v13 offset:9248
 s_waitcnt lgkmcnt(14)
 ds_read_b64_tr_b16 a[242:243], v13 offset:11552
 s_waitcnt lgkmcnt(4)
 v_mfma_f32_16x16x32_bf16 a[0:3], a[212:215], a[112:115], a[0:3]
 v_mfma_f32_16x16x32_bf16 a[4:7], a[212:215], a[116:119], a[4:7]
 v_mfma_f32_16x16x32_bf16 a[8:11], a[212:215], a[120:123], a[8:11]
 buffer_load_dwordx4 v10, s[24:27], s44 offen lds
 v_mfma_f32_16x16x32_bf16 a[12:15], a[212:215], a[124:127], a[12:15]
 ds_read_b64_tr_b16 a[244:245], v13 offset:27680
 ds_read_b64_tr_b16 a[246:247], v13 offset:29984
 v_mfma_f32_16x16x32_bf16 a[16:19], a[216:219], a[112:115], a[16:19]
 v_mfma_f32_16x16x32_bf16 a[20:23], a[216:219], a[116:119], a[20:23]
 v_mfma_f32_16x16x32_bf16 a[24:27], a[216:219], a[120:123], a[24:27]
 v_mfma_f32_16x16x32_bf16 a[28:31], a[216:219], a[124:127], a[28:31]
 ds_read_b64_tr_b16 a[248:249], v13 offset:9280
 ds_read_b64_tr_b16 a[250:251], v13 offset:11584
 v_mfma_f32_16x16x32_bf16 a[32:35], a[220:223], a[112:115], a[32:35]
 v_mfma_f32_16x16x32_bf16 a[36:39], a[220:223], a[116:119], a[36:39]
 v_mfma_f32_16x16x32_bf16 a[40:43], a[220:223], a[120:123], a[40:43]
 v_mfma_f32_16x16x32_bf16 a[44:47], a[220:223], a[124:127], a[44:47]
 ds_read_b64_tr_b16 a[252:253], v13 offset:27712
 ds_read_b64_tr_b16 a[254:255], v13 offset:30016
 v_mfma_f32_16x16x32_bf16 a[48:51], a[224:227], a[112:115], a[48:51]
 v_mfma_f32_16x16x32_bf16 a[52:55], a[224:227], a[116:119], a[52:55]
 v_mfma_f32_16x16x32_bf16 a[56:59], a[224:227], a[120:123], a[56:59]
 v_mfma_f32_16x16x32_bf16 a[60:63], a[224:227], a[124:127], a[60:63]
 ds_read_b64_tr_b16 a[208:209], v13 offset:9312
 ds_read_b64_tr_b16 a[210:211], v13 offset:11616
 v_mfma_f32_16x16x32_bf16 a[64:67], a[228:231], a[112:115], a[64:67]
 v_mfma_f32_16x16x32_bf16 a[68:71], a[228:231], a[116:119], a[68:71]
 v_mfma_f32_16x16x32_bf16 a[72:75], a[228:231], a[120:123], a[72:75]
 v_mfma_f32_16x16x32_bf16 a[76:79], a[228:231], a[124:127], a[76:79]
 ds_read_b64_tr_b16 a[212:213], v13 offset:27744
 ds_read_b64_tr_b16 a[214:215], v13 offset:30048
 v_mfma_f32_16x16x32_bf16 v[48:51], a[232:235], a[128:131], v[48:51]
 v_mfma_f32_16x16x32_bf16 v[52:55], a[232:235], a[132:135], v[52:55]
 v_mfma_f32_16x16x32_bf16 v[56:59], a[232:235], a[136:139], v[56:59]
 v_mfma_f32_16x16x32_bf16 v[60:63], a[232:235], a[140:143], v[60:63]
 ds_read_b64_tr_b16 a[216:217], v13 offset:9344
 s_waitcnt lgkmcnt(14)
 ds_read_b64_tr_b16 a[218:219], v13 offset:11648
 s_waitcnt lgkmcnt(4)
 v_mfma_f32_16x16x32_bf16 v[64:67], a[236:239], a[128:131], v[64:67]
 v_mfma_f32_16x16x32_bf16 v[68:71], a[236:239], a[132:135], v[68:71]
 v_mfma_f32_16x16x32_bf16 v[72:75], a[236:239], a[136:139], v[72:75]
 v_mfma_f32_16x16x32_bf16 v[76:79], a[236:239], a[140:143], v[76:79]
 ds_read_b64_tr_b16 a[220:221], v13 offset:27776
 ds_read_b64_tr_b16 a[222:223], v13 offset:30080
 v_mfma_f32_16x16x32_bf16 v[80:83], a[240:243], a[128:131], v[80:83]
 v_mfma_f32_16x16x32_bf16 v[84:87], a[240:243], a[132:135], v[84:87]
 v_mfma_f32_16x16x32_bf16 v[88:91], a[240:243], a[136:139], v[88:91]
 v_mfma_f32_16x16x32_bf16 v[92:95], a[240:243], a[140:143], v[92:95]
 ds_read_b64_tr_b16 a[224:225], v13 offset:9376
 ds_read_b64_tr_b16 a[226:227], v13 offset:11680
 v_mfma_f32_16x16x32_bf16 v[96:99], a[244:247], a[128:131], v[96:99]
 v_mfma_f32_16x16x32_bf16 v[100:103], a[244:247], a[132:135], v[100:103]
 v_mfma_f32_16x16x32_bf16 v[104:107], a[244:247], a[136:139], v[104:107]
 v_mfma_f32_16x16x32_bf16 v[108:111], a[244:247], a[140:143], v[108:111]
 ds_read_b64_tr_b16 a[228:229], v13 offset:27808
 ds_read_b64_tr_b16 a[230:231], v13 offset:30112
 v_mfma_f32_16x16x32_bf16 v[112:115], a[248:251], a[128:131], v[112:115]
 v_mfma_f32_16x16x32_bf16 v[116:119], a[248:251], a[132:135], v[116:119]
 v_mfma_f32_16x16x32_bf16 v[120:123], a[248:251], a[136:139], v[120:123]
 v_mfma_f32_16x16x32_bf16 v[124:127], a[248:251], a[140:143], v[124:127]
 ds_read_b64_tr_b16 a[232:233], v13 offset:9408
 ds_read_b64_tr_b16 a[234:235], v13 offset:11712
 v_mfma_f32_16x16x32_bf16 v[128:131], a[252:255], a[128:131], v[128:131]
 v_mfma_f32_16x16x32_bf16 v[132:135], a[252:255], a[132:135], v[132:135]
 v_mfma_f32_16x16x32_bf16 v[136:139], a[252:255], a[136:139], v[136:139]
 v_mfma_f32_16x16x32_bf16 v[140:143], a[252:255], a[140:143], v[140:143]
 ds_read_b64_tr_b16 a[236:237], v13 offset:27840
 ds_read_b64_tr_b16 a[238:239], v13 offset:30144
 v_mfma_f32_16x16x32_bf16 v[144:147], a[208:211], a[128:131], v[144:147]
 v_mfma_f32_16x16x32_bf16 v[148:151], a[208:211], a[132:135], v[148:151]
 v_mfma_f32_16x16x32_bf16 v[152:155], a[208:211], a[136:139], v[152:155]
 v_mfma_f32_16x16x32_bf16 v[156:159], a[208:211], a[140:143], v[156:159]
 ds_read_b64_tr_b16 a[240:241], v13 offset:9440
 s_waitcnt lgkmcnt(14)
 ds_read_b64_tr_b16 a[242:243], v13 offset:11744
 s_waitcnt lgkmcnt(4)
 v_mfma_f32_16x16x32_bf16 v[160:163], a[212:215], a[128:131], v[160:163]
 v_mfma_f32_16x16x32_bf16 v[164:167], a[212:215], a[132:135], v[164:167]
 v_mfma_f32_16x16x32_bf16 v[168:171], a[212:215], a[136:139], v[168:171]
 v_mfma_f32_16x16x32_bf16 v[172:175], a[212:215], a[140:143], v[172:175]
 s_waitcnt vmcnt(17)
 s_barrier
 v_mfma_f32_16x16x32_bf16 v[176:179], a[216:219], a[128:131], v[176:179]
 s_add_u32 s44, s31, 0x240000
 ds_read_b64_tr_b16 a[244:245], v13 offset:27872
 v_mfma_f32_16x16x32_bf16 v[180:183], a[216:219], a[132:135], v[180:183]
 ds_read_b64_tr_b16 a[246:247], v13 offset:30176
 v_mfma_f32_16x16x32_bf16 v[184:187], a[216:219], a[136:139], v[184:187]
 v_mfma_f32_16x16x32_bf16 v[188:191], a[216:219], a[140:143], v[188:191]
 s_add_u32 s46, s32, 0x4000
 ds_read_b64_tr_b16 a[248:249], v13 offset:9472
 v_mfma_f32_16x16x32_bf16 v[192:195], a[220:223], a[128:131], v[192:195]
 ds_read_b64_tr_b16 a[250:251], v13 offset:11776
 v_mfma_f32_16x16x32_bf16 v[196:199], a[220:223], a[132:135], v[196:199]
 v_mfma_f32_16x16x32_bf16 v[200:203], a[220:223], a[136:139], v[200:203]
 v_mfma_f32_16x16x32_bf16 v[204:207], a[220:223], a[140:143], v[204:207]
 s_add_u32 s47, s33, 0x4000
 ds_read_b64_tr_b16 a[252:253], v13 offset:27904
 v_mfma_f32_16x16x32_bf16 v[208:211], a[224:227], a[128:131], v[208:211]
 ds_read_b64_tr_b16 a[254:255], v13 offset:30208
 v_mfma_f32_16x16x32_bf16 v[212:215], a[224:227], a[132:135], v[212:215]
 v_mfma_f32_16x16x32_bf16 v[216:219], a[224:227], a[136:139], v[216:219]
 v_mfma_f32_16x16x32_bf16 v[220:223], a[224:227], a[140:143], v[220:223]
 ds_read_b64_tr_b16 a[208:209], v14
 ds_read_b64_tr_b16 a[210:211], v14 offset:2304
 v_mfma_f32_16x16x32_bf16 v[224:227], a[228:231], a[128:131], v[224:227]
 s_add_u32 m0, s34, 0
 v_mfma_f32_16x16x32_bf16 v[228:231], a[228:231], a[132:135], v[228:231]
 v_mfma_f32_16x16x32_bf16 v[232:235], a[228:231], a[136:139], v[232:235]
 v_mfma_f32_16x16x32_bf16 v[236:239], a[228:231], a[140:143], v[236:239]
 ds_read_b64_tr_b16 a[212:213], v14 offset:18432
 ds_read_b64_tr_b16 a[214:215], v14 offset:20736
 v_mfma_f32_16x16x32_bf16 v[240:243], a[232:235], a[128:131], v[240:243]
 buffer_load_dwordx4 v2, s[24:27], s44 offen lds
 v_mfma_f32_16x16x32_bf16 v[244:247], a[232:235], a[132:135], v[244:247]
 v_mfma_f32_16x16x32_bf16 v[248:251], a[232:235], a[136:139], v[248:251]
 v_mfma_f32_16x16x32_bf16 v[252:255], a[232:235], a[140:143], v[252:255]
 ds_read_b64_tr_b16 a[216:217], v14 offset:32
 s_waitcnt lgkmcnt(14)
 ds_read_b64_tr_b16 a[218:219], v14 offset:2336
 s_waitcnt lgkmcnt(4)
 v_mfma_f32_16x16x32_bf16 a[0:3], a[236:239], a[128:131], a[0:3]
 buffer_load_dwordx4 a[80:83], v11, s[8:11], s46 offen sc1
 v_mfma_f32_16x16x32_bf16 a[4:7], a[236:239], a[132:135], a[4:7]
 v_mfma_f32_16x16x32_bf16 a[8:11], a[236:239], a[136:139], a[8:11]
 v_mfma_f32_16x16x32_bf16 a[12:15], a[236:239], a[140:143], a[12:15]
 ds_read_b64_tr_b16 a[220:221], v14 offset:18464
 ds_read_b64_tr_b16 a[222:223], v14 offset:20768
 v_mfma_f32_16x16x32_bf16 a[16:19], a[240:243], a[128:131], a[16:19]
 v_mfma_f32_16x16x32_bf16 a[20:23], a[240:243], a[132:135], a[20:23]
 buffer_load_dwordx4 v3, s[24:27], s44 offen offset:1024 lds
 v_mfma_f32_16x16x32_bf16 a[24:27], a[240:243], a[136:139], a[24:27]
 v_mfma_f32_16x16x32_bf16 a[28:31], a[240:243], a[140:143], a[28:31]
 ds_read_b64_tr_b16 a[224:225], v14 offset:64
 ds_read_b64_tr_b16 a[226:227], v14 offset:2368
 v_mfma_f32_16x16x32_bf16 a[32:35], a[244:247], a[128:131], a[32:35]
 v_mfma_f32_16x16x32_bf16 a[36:39], a[244:247], a[132:135], a[36:39]
 buffer_load_dwordx4 a[84:87], v11, s[8:11], s46 offen offset:256 sc1
 v_mfma_f32_16x16x32_bf16 a[40:43], a[244:247], a[136:139], a[40:43]
 v_mfma_f32_16x16x32_bf16 a[44:47], a[244:247], a[140:143], a[44:47]
 ds_read_b64_tr_b16 a[228:229], v14 offset:18496
 ds_read_b64_tr_b16 a[230:231], v14 offset:20800
 v_mfma_f32_16x16x32_bf16 a[48:51], a[248:251], a[128:131], a[48:51]
 v_mfma_f32_16x16x32_bf16 a[52:55], a[248:251], a[132:135], a[52:55]
 buffer_load_dwordx4 v4, s[24:27], s44 offen offset:2048 lds
 v_mfma_f32_16x16x32_bf16 a[56:59], a[248:251], a[136:139], a[56:59]
 v_mfma_f32_16x16x32_bf16 a[60:63], a[248:251], a[140:143], a[60:63]
 ds_read_b64_tr_b16 a[232:233], v14 offset:96
 ds_read_b64_tr_b16 a[234:235], v14 offset:2400
 v_mfma_f32_16x16x32_bf16 a[64:67], a[252:255], a[128:131], a[64:67]
 v_mfma_f32_16x16x32_bf16 a[68:71], a[252:255], a[132:135], a[68:71]
 v_mfma_f32_16x16x32_bf16 a[72:75], a[252:255], a[136:139], a[72:75]
 buffer_load_dwordx4 a[88:91], v11, s[8:11], s47 offen sc1
 v_mfma_f32_16x16x32_bf16 a[76:79], a[252:255], a[140:143], a[76:79]
 ds_read_b64_tr_b16 a[236:237], v14 offset:18528
 ds_read_b64_tr_b16 a[238:239], v14 offset:20832
 v_mfma_f32_16x16x32_bf16 v[48:51], a[208:211], a[144:147], v[48:51]
 v_mfma_f32_16x16x32_bf16 v[52:55], a[208:211], a[148:151], v[52:55]
 v_mfma_f32_16x16x32_bf16 v[56:59], a[208:211], a[152:155], v[56:59]
 buffer_load_dwordx4 v5, s[24:27], s44 offen offset:3072 lds
 v_mfma_f32_16x16x32_bf16 v[60:63], a[208:211], a[156:159], v[60:63]
 ds_read_b64_tr_b16 a[240:241], v14 offset:128
 s_waitcnt lgkmcnt(14)
 ds_read_b64_tr_b16 a[242:243], v14 offset:2432
 s_waitcnt lgkmcnt(4)
 v_mfma_f32_16x16x32_bf16 v[64:67], a[212:215], a[144:147], v[64:67]
 v_mfma_f32_16x16x32_bf16 v[68:71], a[212:215], a[148:151], v[68:71]
 v_mfma_f32_16x16x32_bf16 v[72:75], a[212:215], a[152:155], v[72:75]
 buffer_load_dwordx4 a[92:95], v11, s[8:11], s47 offen offset:256 sc1
 v_mfma_f32_16x16x32_bf16 v[76:79], a[212:215], a[156:159], v[76:79]
 ds_read_b64_tr_b16 a[244:245], v14 offset:18560
 ds_read_b64_tr_b16 a[246:247], v14 offset:20864
 v_mfma_f32_16x16x32_bf16 v[80:83], a[216:219], a[144:147], v[80:83]
 v_mfma_f32_16x16x32_bf16 v[84:87], a[216:219], a[148:151], v[84:87]
 v_mfma_f32_16x16x32_bf16 v[88:91], a[216:219], a[152:155], v[88:91]
 v_mfma_f32_16x16x32_bf16 v[92:95], a[216:219], a[156:159], v[92:95]
 s_add_u32 m0, s34, 0x1000
 ds_read_b64_tr_b16 a[248:249], v14 offset:160
 v_mfma_f32_16x16x32_bf16 v[96:99], a[220:223], a[144:147], v[96:99]
 ds_read_b64_tr_b16 a[250:251], v14 offset:2464
 v_mfma_f32_16x16x32_bf16 v[100:103], a[220:223], a[148:151], v[100:103]
 v_mfma_f32_16x16x32_bf16 v[104:107], a[220:223], a[152:155], v[104:107]
 v_mfma_f32_16x16x32_bf16 v[108:111], a[220:223], a[156:159], v[108:111]
 buffer_load_dwordx4 v6, s[24:27], s44 offen lds
 v_mfma_f32_16x16x32_bf16 v[112:115], a[224:227], a[144:147], v[112:115]
 ds_read_b64_tr_b16 a[252:253], v14 offset:18592
 ds_read_b64_tr_b16 a[254:255], v14 offset:20896
 v_mfma_f32_16x16x32_bf16 v[116:119], a[224:227], a[148:151], v[116:119]
 v_mfma_f32_16x16x32_bf16 v[120:123], a[224:227], a[152:155], v[120:123]
 v_mfma_f32_16x16x32_bf16 v[124:127], a[224:227], a[156:159], v[124:127]
 buffer_load_dwordx4 a[96:99], v11, s[8:11], s46 offen offset:2048 sc1
 v_mfma_f32_16x16x32_bf16 v[128:131], a[228:231], a[144:147], v[128:131]
 ds_read_b64_tr_b16 a[208:209], v14 offset:192
 ds_read_b64_tr_b16 a[210:211], v14 offset:2496
 v_mfma_f32_16x16x32_bf16 v[132:135], a[228:231], a[148:151], v[132:135]
 v_mfma_f32_16x16x32_bf16 v[136:139], a[228:231], a[152:155], v[136:139]
 v_mfma_f32_16x16x32_bf16 v[140:143], a[228:231], a[156:159], v[140:143]
 ds_read_b64_tr_b16 a[212:213], v14 offset:18624
 ds_read_b64_tr_b16 a[214:215], v14 offset:20928
 v_mfma_f32_16x16x32_bf16 v[144:147], a[232:235], a[144:147], v[144:147]
 buffer_load_dwordx4 v7, s[24:27], s44 offen offset:1024 lds
 v_mfma_f32_16x16x32_bf16 v[148:151], a[232:235], a[148:151], v[148:151]
 v_mfma_f32_16x16x32_bf16 v[152:155], a[232:235], a[152:155], v[152:155]
 v_mfma_f32_16x16x32_bf16 v[156:159], a[232:235], a[156:159], v[156:159]
 ds_read_b64_tr_b16 a[216:217], v14 offset:224
 s_waitcnt lgkmcnt(14)
 ds_read_b64_tr_b16 a[218:219], v14 offset:2528
 s_waitcnt lgkmcnt(4)
 v_mfma_f32_16x16x32_bf16 v[160:163], a[236:239], a[144:147], v[160:163]
 buffer_load_dwordx4 a[100:103], v11, s[8:11], s46 offen offset:2304 sc1
 v_mfma_f32_16x16x32_bf16 v[164:167], a[236:239], a[148:151], v[164:167]
 v_mfma_f32_16x16x32_bf16 v[168:171], a[236:239], a[152:155], v[168:171]
 v_mfma_f32_16x16x32_bf16 v[172:175], a[236:239], a[156:159], v[172:175]
 ds_read_b64_tr_b16 a[220:221], v14 offset:18656
 ds_read_b64_tr_b16 a[222:223], v14 offset:20960
 v_mfma_f32_16x16x32_bf16 v[176:179], a[240:243], a[144:147], v[176:179]
 buffer_load_dwordx4 v8, s[24:27], s44 offen offset:2048 lds
 v_mfma_f32_16x16x32_bf16 v[180:183], a[240:243], a[148:151], v[180:183]
 v_mfma_f32_16x16x32_bf16 v[184:187], a[240:243], a[152:155], v[184:187]
 v_mfma_f32_16x16x32_bf16 v[188:191], a[240:243], a[156:159], v[188:191]
 ds_read_b64_tr_b16 a[224:225], v14 offset:256
 ds_read_b64_tr_b16 a[226:227], v14 offset:2560
 v_mfma_f32_16x16x32_bf16 v[192:195], a[244:247], a[144:147], v[192:195]
 v_mfma_f32_16x16x32_bf16 v[196:199], a[244:247], a[148:151], v[196:199]
 buffer_load_dwordx4 a[104:107], v11, s[8:11], s47 offen offset:2048 sc1
 v_mfma_f32_16x16x32_bf16 v[200:203], a[244:247], a[152:155], v[200:203]
 v_mfma_f32_16x16x32_bf16 v[204:207], a[244:247], a[156:159], v[204:207]
 ds_read_b64_tr_b16 a[228:229], v14 offset:18688
 ds_read_b64_tr_b16 a[230:231], v14 offset:20992
 v_mfma_f32_16x16x32_bf16 v[208:211], a[248:251], a[144:147], v[208:211]
 v_mfma_f32_16x16x32_bf16 v[212:215], a[248:251], a[148:151], v[212:215]
 buffer_load_dwordx4 v9, s[24:27], s44 offen offset:3072 lds
 v_mfma_f32_16x16x32_bf16 v[216:219], a[248:251], a[152:155], v[216:219]
 v_mfma_f32_16x16x32_bf16 v[220:223], a[248:251], a[156:159], v[220:223]
 ds_read_b64_tr_b16 a[232:233], v14 offset:9216
 ds_read_b64_tr_b16 a[234:235], v14 offset:11520
 v_mfma_f32_16x16x32_bf16 v[224:227], a[252:255], a[144:147], v[224:227]
 v_mfma_f32_16x16x32_bf16 v[228:231], a[252:255], a[148:151], v[228:231]
 buffer_load_dwordx4 a[108:111], v11, s[8:11], s47 offen offset:2304 sc1
 v_mfma_f32_16x16x32_bf16 v[232:235], a[252:255], a[152:155], v[232:235]
 v_mfma_f32_16x16x32_bf16 v[236:239], a[252:255], a[156:159], v[236:239]
 ds_read_b64_tr_b16 a[236:237], v14 offset:27648
 ds_read_b64_tr_b16 a[238:239], v14 offset:29952
 v_mfma_f32_16x16x32_bf16 v[240:243], a[208:211], a[144:147], v[240:243]
 v_mfma_f32_16x16x32_bf16 v[244:247], a[208:211], a[148:151], v[244:247]
 v_mfma_f32_16x16x32_bf16 v[248:251], a[208:211], a[152:155], v[248:251]
 s_add_u32 m0, s34, 0x2000
 v_mfma_f32_16x16x32_bf16 v[252:255], a[208:211], a[156:159], v[252:255]
 ds_read_b64_tr_b16 a[240:241], v14 offset:9248
 s_waitcnt lgkmcnt(14)
 ds_read_b64_tr_b16 a[242:243], v14 offset:11552
 s_waitcnt lgkmcnt(4)
 v_mfma_f32_16x16x32_bf16 a[0:3], a[212:215], a[144:147], a[0:3]
 v_mfma_f32_16x16x32_bf16 a[4:7], a[212:215], a[148:151], a[4:7]
 v_mfma_f32_16x16x32_bf16 a[8:11], a[212:215], a[152:155], a[8:11]
 buffer_load_dwordx4 v10, s[24:27], s44 offen lds
 v_mfma_f32_16x16x32_bf16 a[12:15], a[212:215], a[156:159], a[12:15]
 ds_read_b64_tr_b16 a[244:245], v14 offset:27680
 ds_read_b64_tr_b16 a[246:247], v14 offset:29984
 v_mfma_f32_16x16x32_bf16 a[16:19], a[216:219], a[144:147], a[16:19]
 v_mfma_f32_16x16x32_bf16 a[20:23], a[216:219], a[148:151], a[20:23]
 v_mfma_f32_16x16x32_bf16 a[24:27], a[216:219], a[152:155], a[24:27]
 v_mfma_f32_16x16x32_bf16 a[28:31], a[216:219], a[156:159], a[28:31]
 ds_read_b64_tr_b16 a[248:249], v14 offset:9280
 ds_read_b64_tr_b16 a[250:251], v14 offset:11584
 v_mfma_f32_16x16x32_bf16 a[32:35], a[220:223], a[144:147], a[32:35]
 v_mfma_f32_16x16x32_bf16 a[36:39], a[220:223], a[148:151], a[36:39]
 v_mfma_f32_16x16x32_bf16 a[40:43], a[220:223], a[152:155], a[40:43]
 v_mfma_f32_16x16x32_bf16 a[44:47], a[220:223], a[156:159], a[44:47]
 ds_read_b64_tr_b16 a[252:253], v14 offset:27712
 ds_read_b64_tr_b16 a[254:255], v14 offset:30016
 v_mfma_f32_16x16x32_bf16 a[48:51], a[224:227], a[144:147], a[48:51]
 v_mfma_f32_16x16x32_bf16 a[52:55], a[224:227], a[148:151], a[52:55]
 v_mfma_f32_16x16x32_bf16 a[56:59], a[224:227], a[152:155], a[56:59]
 v_mfma_f32_16x16x32_bf16 a[60:63], a[224:227], a[156:159], a[60:63]
 ds_read_b64_tr_b16 a[208:209], v14 offset:9312
 ds_read_b64_tr_b16 a[210:211], v14 offset:11616
 v_mfma_f32_16x16x32_bf16 a[64:67], a[228:231], a[144:147], a[64:67]
 v_mfma_f32_16x16x32_bf16 a[68:71], a[228:231], a[148:151], a[68:71]
 v_mfma_f32_16x16x32_bf16 a[72:75], a[228:231], a[152:155], a[72:75]
 v_mfma_f32_16x16x32_bf16 a[76:79], a[228:231], a[156:159], a[76:79]
 ds_read_b64_tr_b16 a[212:213], v14 offset:27744
 ds_read_b64_tr_b16 a[214:215], v14 offset:30048
 v_mfma_f32_16x16x32_bf16 v[48:51], a[232:235], a[160:163], v[48:51]
 v_mfma_f32_16x16x32_bf16 v[52:55], a[232:235], a[164:167], v[52:55]
 v_mfma_f32_16x16x32_bf16 v[56:59], a[232:235], a[168:171], v[56:59]
 v_mfma_f32_16x16x32_bf16 v[60:63], a[232:235], a[172:175], v[60:63]
 ds_read_b64_tr_b16 a[216:217], v14 offset:9344
 s_waitcnt lgkmcnt(14)
 ds_read_b64_tr_b16 a[218:219], v14 offset:11648
 s_waitcnt lgkmcnt(4)
 v_mfma_f32_16x16x32_bf16 v[64:67], a[236:239], a[160:163], v[64:67]
 v_mfma_f32_16x16x32_bf16 v[68:71], a[236:239], a[164:167], v[68:71]
 v_mfma_f32_16x16x32_bf16 v[72:75], a[236:239], a[168:171], v[72:75]
 v_mfma_f32_16x16x32_bf16 v[76:79], a[236:239], a[172:175], v[76:79]
 ds_read_b64_tr_b16 a[220:221], v14 offset:27776
 ds_read_b64_tr_b16 a[222:223], v14 offset:30080
 v_mfma_f32_16x16x32_bf16 v[80:83], a[240:243], a[160:163], v[80:83]
 v_mfma_f32_16x16x32_bf16 v[84:87], a[240:243], a[164:167], v[84:87]
 v_mfma_f32_16x16x32_bf16 v[88:91], a[240:243], a[168:171], v[88:91]
 v_mfma_f32_16x16x32_bf16 v[92:95], a[240:243], a[172:175], v[92:95]
 ds_read_b64_tr_b16 a[224:225], v14 offset:9376
 ds_read_b64_tr_b16 a[226:227], v14 offset:11680
 v_mfma_f32_16x16x32_bf16 v[96:99], a[244:247], a[160:163], v[96:99]
 v_mfma_f32_16x16x32_bf16 v[100:103], a[244:247], a[164:167], v[100:103]
 v_mfma_f32_16x16x32_bf16 v[104:107], a[244:247], a[168:171], v[104:107]
 v_mfma_f32_16x16x32_bf16 v[108:111], a[244:247], a[172:175], v[108:111]
 ds_read_b64_tr_b16 a[228:229], v14 offset:27808
 ds_read_b64_tr_b16 a[230:231], v14 offset:30112
 v_mfma_f32_16x16x32_bf16 v[112:115], a[248:251], a[160:163], v[112:115]
 v_mfma_f32_16x16x32_bf16 v[116:119], a[248:251], a[164:167], v[116:119]
 v_mfma_f32_16x16x32_bf16 v[120:123], a[248:251], a[168:171], v[120:123]
 v_mfma_f32_16x16x32_bf16 v[124:127], a[248:251], a[172:175], v[124:127]
 ds_read_b64_tr_b16 a[232:233], v14 offset:9408
 ds_read_b64_tr_b16 a[234:235], v14 offset:11712
 v_mfma_f32_16x16x32_bf16 v[128:131], a[252:255], a[160:163], v[128:131]
 v_mfma_f32_16x16x32_bf16 v[132:135], a[252:255], a[164:167], v[132:135]
 v_mfma_f32_16x16x32_bf16 v[136:139], a[252:255], a[168:171], v[136:139]
 v_mfma_f32_16x16x32_bf16 v[140:143], a[252:255], a[172:175], v[140:143]
 ds_read_b64_tr_b16 a[236:237], v14 offset:27840
 ds_read_b64_tr_b16 a[238:239], v14 offset:30144
 v_mfma_f32_16x16x32_bf16 v[144:147], a[208:211], a[160:163], v[144:147]
 v_mfma_f32_16x16x32_bf16 v[148:151], a[208:211], a[164:167], v[148:151]
 v_mfma_f32_16x16x32_bf16 v[152:155], a[208:211], a[168:171], v[152:155]
 v_mfma_f32_16x16x32_bf16 v[156:159], a[208:211], a[172:175], v[156:159]
 ds_read_b64_tr_b16 a[240:241], v14 offset:9440
 s_waitcnt lgkmcnt(14)
 ds_read_b64_tr_b16 a[242:243], v14 offset:11744
 s_waitcnt lgkmcnt(4)
 v_mfma_f32_16x16x32_bf16 v[160:163], a[212:215], a[160:163], v[160:163]
 v_mfma_f32_16x16x32_bf16 v[164:167], a[212:215], a[164:167], v[164:167]
 v_mfma_f32_16x16x32_bf16 v[168:171], a[212:215], a[168:171], v[168:171]
 v_mfma_f32_16x16x32_bf16 v[172:175], a[212:215], a[172:175], v[172:175]
 s_waitcnt vmcnt(17)
 s_barrier
 v_mfma_f32_16x16x32_bf16 v[176:179], a[216:219], a[160:163], v[176:179]
 s_add_u32 s44, s31, 0x2d0000
 ds_read_b64_tr_b16 a[244:245], v14 offset:27872
 v_mfma_f32_16x16x32_bf16 v[180:183], a[216:219], a[164:167], v[180:183]
 ds_read_b64_tr_b16 a[246:247], v14 offset:30176
 v_mfma_f32_16x16x32_bf16 v[184:187], a[216:219], a[168:171], v[184:187]
 v_mfma_f32_16x16x32_bf16 v[188:191], a[216:219], a[172:175], v[188:191]
 s_add_u32 s46, s32, 0x5000
 ds_read_b64_tr_b16 a[248:249], v14 offset:9472
 v_mfma_f32_16x16x32_bf16 v[192:195], a[220:223], a[160:163], v[192:195]
 ds_read_b64_tr_b16 a[250:251], v14 offset:11776
 v_mfma_f32_16x16x32_bf16 v[196:199], a[220:223], a[164:167], v[196:199]
 v_mfma_f32_16x16x32_bf16 v[200:203], a[220:223], a[168:171], v[200:203]
 v_mfma_f32_16x16x32_bf16 v[204:207], a[220:223], a[172:175], v[204:207]
 s_add_u32 s47, s33, 0x5000
 ds_read_b64_tr_b16 a[252:253], v14 offset:27904
 v_mfma_f32_16x16x32_bf16 v[208:211], a[224:227], a[160:163], v[208:211]
 ds_read_b64_tr_b16 a[254:255], v14 offset:30208
 v_mfma_f32_16x16x32_bf16 v[212:215], a[224:227], a[164:167], v[212:215]
 v_mfma_f32_16x16x32_bf16 v[216:219], a[224:227], a[168:171], v[216:219]
 v_mfma_f32_16x16x32_bf16 v[220:223], a[224:227], a[172:175], v[220:223]
 ds_read_b64_tr_b16 a[208:209], v15
 ds_read_b64_tr_b16 a[210:211], v15 offset:2304
 v_mfma_f32_16x16x32_bf16 v[224:227], a[228:231], a[160:163], v[224:227]
 s_add_u32 m0, s34, 0x9000
 v_mfma_f32_16x16x32_bf16 v[228:231], a[228:231], a[164:167], v[228:231]
 v_mfma_f32_16x16x32_bf16 v[232:235], a[228:231], a[168:171], v[232:235]
 v_mfma_f32_16x16x32_bf16 v[236:239], a[228:231], a[172:175], v[236:239]
 ds_read_b64_tr_b16 a[212:213], v15 offset:18432
 ds_read_b64_tr_b16 a[214:215], v15 offset:20736
 v_mfma_f32_16x16x32_bf16 v[240:243], a[232:235], a[160:163], v[240:243]
 buffer_load_dwordx4 v2, s[24:27], s44 offen lds
 v_mfma_f32_16x16x32_bf16 v[244:247], a[232:235], a[164:167], v[244:247]
 v_mfma_f32_16x16x32_bf16 v[248:251], a[232:235], a[168:171], v[248:251]
 v_mfma_f32_16x16x32_bf16 v[252:255], a[232:235], a[172:175], v[252:255]
 ds_read_b64_tr_b16 a[216:217], v15 offset:32
 s_waitcnt lgkmcnt(14)
 ds_read_b64_tr_b16 a[218:219], v15 offset:2336
 s_waitcnt lgkmcnt(4)
 v_mfma_f32_16x16x32_bf16 a[0:3], a[236:239], a[160:163], a[0:3]
 buffer_load_dwordx4 a[112:115], v11, s[8:11], s46 offen sc1
 v_mfma_f32_16x16x32_bf16 a[4:7], a[236:239], a[164:167], a[4:7]
 v_mfma_f32_16x16x32_bf16 a[8:11], a[236:239], a[168:171], a[8:11]
 v_mfma_f32_16x16x32_bf16 a[12:15], a[236:239], a[172:175], a[12:15]
 ds_read_b64_tr_b16 a[220:221], v15 offset:18464
 ds_read_b64_tr_b16 a[222:223], v15 offset:20768
 v_mfma_f32_16x16x32_bf16 a[16:19], a[240:243], a[160:163], a[16:19]
 v_mfma_f32_16x16x32_bf16 a[20:23], a[240:243], a[164:167], a[20:23]
 buffer_load_dwordx4 v3, s[24:27], s44 offen offset:1024 lds
 v_mfma_f32_16x16x32_bf16 a[24:27], a[240:243], a[168:171], a[24:27]
 v_mfma_f32_16x16x32_bf16 a[28:31], a[240:243], a[172:175], a[28:31]
 ds_read_b64_tr_b16 a[224:225], v15 offset:64
 ds_read_b64_tr_b16 a[226:227], v15 offset:2368
 v_mfma_f32_16x16x32_bf16 a[32:35], a[244:247], a[160:163], a[32:35]
 v_mfma_f32_16x16x32_bf16 a[36:39], a[244:247], a[164:167], a[36:39]
 buffer_load_dwordx4 a[116:119], v11, s[8:11], s46 offen offset:256 sc1
 v_mfma_f32_16x16x32_bf16 a[40:43], a[244:247], a[168:171], a[40:43]
 v_mfma_f32_16x16x32_bf16 a[44:47], a[244:247], a[172:175], a[44:47]
 ds_read_b64_tr_b16 a[228:229], v15 offset:18496
 ds_read_b64_tr_b16 a[230:231], v15 offset:20800
 v_mfma_f32_16x16x32_bf16 a[48:51], a[248:251], a[160:163], a[48:51]
 v_mfma_f32_16x16x32_bf16 a[52:55], a[248:251], a[164:167], a[52:55]
 buffer_load_dwordx4 v4, s[24:27], s44 offen offset:2048 lds
 v_mfma_f32_16x16x32_bf16 a[56:59], a[248:251], a[168:171], a[56:59]
 v_mfma_f32_16x16x32_bf16 a[60:63], a[248:251], a[172:175], a[60:63]
 ds_read_b64_tr_b16 a[232:233], v15 offset:96
 ds_read_b64_tr_b16 a[234:235], v15 offset:2400
 v_mfma_f32_16x16x32_bf16 a[64:67], a[252:255], a[160:163], a[64:67]
 v_mfma_f32_16x16x32_bf16 a[68:71], a[252:255], a[164:167], a[68:71]
 v_mfma_f32_16x16x32_bf16 a[72:75], a[252:255], a[168:171], a[72:75]
 buffer_load_dwordx4 a[120:123], v11, s[8:11], s47 offen sc1
 v_mfma_f32_16x16x32_bf16 a[76:79], a[252:255], a[172:175], a[76:79]
 ds_read_b64_tr_b16 a[236:237], v15 offset:18528
 ds_read_b64_tr_b16 a[238:239], v15 offset:20832
 v_mfma_f32_16x16x32_bf16 v[48:51], a[208:211], a[176:179], v[48:51]
 v_mfma_f32_16x16x32_bf16 v[52:55], a[208:211], a[180:183], v[52:55]
 v_mfma_f32_16x16x32_bf16 v[56:59], a[208:211], a[184:187], v[56:59]
 buffer_load_dwordx4 v5, s[24:27], s44 offen offset:3072 lds
 v_mfma_f32_16x16x32_bf16 v[60:63], a[208:211], a[188:191], v[60:63]
 ds_read_b64_tr_b16 a[240:241], v15 offset:128
 s_waitcnt lgkmcnt(14)
 ds_read_b64_tr_b16 a[242:243], v15 offset:2432
 s_waitcnt lgkmcnt(4)
 v_mfma_f32_16x16x32_bf16 v[64:67], a[212:215], a[176:179], v[64:67]
 v_mfma_f32_16x16x32_bf16 v[68:71], a[212:215], a[180:183], v[68:71]
 v_mfma_f32_16x16x32_bf16 v[72:75], a[212:215], a[184:187], v[72:75]
 buffer_load_dwordx4 a[124:127], v11, s[8:11], s47 offen offset:256 sc1
 v_mfma_f32_16x16x32_bf16 v[76:79], a[212:215], a[188:191], v[76:79]
 ds_read_b64_tr_b16 a[244:245], v15 offset:18560
 ds_read_b64_tr_b16 a[246:247], v15 offset:20864
 v_mfma_f32_16x16x32_bf16 v[80:83], a[216:219], a[176:179], v[80:83]
 v_mfma_f32_16x16x32_bf16 v[84:87], a[216:219], a[180:183], v[84:87]
 v_mfma_f32_16x16x32_bf16 v[88:91], a[216:219], a[184:187], v[88:91]
 v_mfma_f32_16x16x32_bf16 v[92:95], a[216:219], a[188:191], v[92:95]
 s_add_u32 m0, s34, 0xa000
 ds_read_b64_tr_b16 a[248:249], v15 offset:160
 v_mfma_f32_16x16x32_bf16 v[96:99], a[220:223], a[176:179], v[96:99]
 ds_read_b64_tr_b16 a[250:251], v15 offset:2464
 v_mfma_f32_16x16x32_bf16 v[100:103], a[220:223], a[180:183], v[100:103]
 v_mfma_f32_16x16x32_bf16 v[104:107], a[220:223], a[184:187], v[104:107]
 v_mfma_f32_16x16x32_bf16 v[108:111], a[220:223], a[188:191], v[108:111]
 buffer_load_dwordx4 v6, s[24:27], s44 offen lds
 v_mfma_f32_16x16x32_bf16 v[112:115], a[224:227], a[176:179], v[112:115]
 ds_read_b64_tr_b16 a[252:253], v15 offset:18592
 ds_read_b64_tr_b16 a[254:255], v15 offset:20896
 v_mfma_f32_16x16x32_bf16 v[116:119], a[224:227], a[180:183], v[116:119]
 v_mfma_f32_16x16x32_bf16 v[120:123], a[224:227], a[184:187], v[120:123]
 v_mfma_f32_16x16x32_bf16 v[124:127], a[224:227], a[188:191], v[124:127]
 buffer_load_dwordx4 a[128:131], v11, s[8:11], s46 offen offset:2048 sc1
 v_mfma_f32_16x16x32_bf16 v[128:131], a[228:231], a[176:179], v[128:131]
 ds_read_b64_tr_b16 a[208:209], v15 offset:192
 ds_read_b64_tr_b16 a[210:211], v15 offset:2496
 v_mfma_f32_16x16x32_bf16 v[132:135], a[228:231], a[180:183], v[132:135]
 v_mfma_f32_16x16x32_bf16 v[136:139], a[228:231], a[184:187], v[136:139]
 v_mfma_f32_16x16x32_bf16 v[140:143], a[228:231], a[188:191], v[140:143]
 ds_read_b64_tr_b16 a[212:213], v15 offset:18624
 ds_read_b64_tr_b16 a[214:215], v15 offset:20928
 v_mfma_f32_16x16x32_bf16 v[144:147], a[232:235], a[176:179], v[144:147]
 buffer_load_dwordx4 v7, s[24:27], s44 offen offset:1024 lds
 v_mfma_f32_16x16x32_bf16 v[148:151], a[232:235], a[180:183], v[148:151]
 v_mfma_f32_16x16x32_bf16 v[152:155], a[232:235], a[184:187], v[152:155]
 v_mfma_f32_16x16x32_bf16 v[156:159], a[232:235], a[188:191], v[156:159]
 ds_read_b64_tr_b16 a[216:217], v15 offset:224
 s_waitcnt lgkmcnt(14)
 ds_read_b64_tr_b16 a[218:219], v15 offset:2528
 s_waitcnt lgkmcnt(4)
 v_mfma_f32_16x16x32_bf16 v[160:163], a[236:239], a[176:179], v[160:163]
 buffer_load_dwordx4 a[132:135], v11, s[8:11], s46 offen offset:2304 sc1
 v_mfma_f32_16x16x32_bf16 v[164:167], a[236:239], a[180:183], v[164:167]
 v_mfma_f32_16x16x32_bf16 v[168:171], a[236:239], a[184:187], v[168:171]
 v_mfma_f32_16x16x32_bf16 v[172:175], a[236:239], a[188:191], v[172:175]
 ds_read_b64_tr_b16 a[220:221], v15 offset:18656
 ds_read_b64_tr_b16 a[222:223], v15 offset:20960
 v_mfma_f32_16x16x32_bf16 v[176:179], a[240:243], a[176:179], v[176:179]
 buffer_load_dwordx4 v8, s[24:27], s44 offen offset:2048 lds
 v_mfma_f32_16x16x32_bf16 v[180:183], a[240:243], a[180:183], v[180:183]
 v_mfma_f32_16x16x32_bf16 v[184:187], a[240:243], a[184:187], v[184:187]
 v_mfma_f32_16x16x32_bf16 v[188:191], a[240:243], a[188:191], v[188:191]
 ds_read_b64_tr_b16 a[224:225], v15 offset:256
 ds_read_b64_tr_b16 a[226:227], v15 offset:2560
 v_mfma_f32_16x16x32_bf16 v[192:195], a[244:247], a[176:179], v[192:195]
 v_mfma_f32_16x16x32_bf16 v[196:199], a[244:247], a[180:183], v[196:199]
 buffer_load_dwordx4 a[136:139], v11, s[8:11], s47 offen offset:2048 sc1
 v_mfma_f32_16x16x32_bf16 v[200:203], a[244:247], a[184:187], v[200:203]
 v_mfma_f32_16x16x32_bf16 v[204:207], a[244:247], a[188:191], v[204:207]
 ds_read_b64_tr_b16 a[228:229], v15 offset:18688
 ds_read_b64_tr_b16 a[230:231], v15 offset:20992
 v_mfma_f32_16x16x32_bf16 v[208:211], a[248:251], a[176:179], v[208:211]
 v_mfma_f32_16x16x32_bf16 v[212:215], a[248:251], a[180:183], v[212:215]
 buffer_load_dwordx4 v9, s[24:27], s44 offen offset:3072 lds
 v_mfma_f32_16x16x32_bf16 v[216:219], a[248:251], a[184:187], v[216:219]
 v_mfma_f32_16x16x32_bf16 v[220:223], a[248:251], a[188:191], v[220:223]
 ds_read_b64_tr_b16 a[232:233], v15 offset:9216
 ds_read_b64_tr_b16 a[234:235], v15 offset:11520
 v_mfma_f32_16x16x32_bf16 v[224:227], a[252:255], a[176:179], v[224:227]
 v_mfma_f32_16x16x32_bf16 v[228:231], a[252:255], a[180:183], v[228:231]
 buffer_load_dwordx4 a[140:143], v11, s[8:11], s47 offen offset:2304 sc1
 v_mfma_f32_16x16x32_bf16 v[232:235], a[252:255], a[184:187], v[232:235]
 v_mfma_f32_16x16x32_bf16 v[236:239], a[252:255], a[188:191], v[236:239]
 ds_read_b64_tr_b16 a[236:237], v15 offset:27648
 ds_read_b64_tr_b16 a[238:239], v15 offset:29952
 v_mfma_f32_16x16x32_bf16 v[240:243], a[208:211], a[176:179], v[240:243]
 v_mfma_f32_16x16x32_bf16 v[244:247], a[208:211], a[180:183], v[244:247]
 v_mfma_f32_16x16x32_bf16 v[248:251], a[208:211], a[184:187], v[248:251]
 s_add_u32 m0, s34, 0xb000
 v_mfma_f32_16x16x32_bf16 v[252:255], a[208:211], a[188:191], v[252:255]
 ds_read_b64_tr_b16 a[240:241], v15 offset:9248
 s_waitcnt lgkmcnt(14)
 ds_read_b64_tr_b16 a[242:243], v15 offset:11552
 s_waitcnt lgkmcnt(4)
 v_mfma_f32_16x16x32_bf16 a[0:3], a[212:215], a[176:179], a[0:3]
 v_mfma_f32_16x16x32_bf16 a[4:7], a[212:215], a[180:183], a[4:7]
 v_mfma_f32_16x16x32_bf16 a[8:11], a[212:215], a[184:187], a[8:11]
 buffer_load_dwordx4 v10, s[24:27], s44 offen lds
 v_mfma_f32_16x16x32_bf16 a[12:15], a[212:215], a[188:191], a[12:15]
 ds_read_b64_tr_b16 a[244:245], v15 offset:27680
 ds_read_b64_tr_b16 a[246:247], v15 offset:29984
 v_mfma_f32_16x16x32_bf16 a[16:19], a[216:219], a[176:179], a[16:19]
 v_mfma_f32_16x16x32_bf16 a[20:23], a[216:219], a[180:183], a[20:23]
 v_mfma_f32_16x16x32_bf16 a[24:27], a[216:219], a[184:187], a[24:27]
 v_mfma_f32_16x16x32_bf16 a[28:31], a[216:219], a[188:191], a[28:31]
 ds_read_b64_tr_b16 a[248:249], v15 offset:9280
 ds_read_b64_tr_b16 a[250:251], v15 offset:11584
 v_mfma_f32_16x16x32_bf16 a[32:35], a[220:223], a[176:179], a[32:35]
 v_mfma_f32_16x16x32_bf16 a[36:39], a[220:223], a[180:183], a[36:39]
 v_mfma_f32_16x16x32_bf16 a[40:43], a[220:223], a[184:187], a[40:43]
 v_mfma_f32_16x16x32_bf16 a[44:47], a[220:223], a[188:191], a[44:47]
 ds_read_b64_tr_b16 a[252:253], v15 offset:27712
 ds_read_b64_tr_b16 a[254:255], v15 offset:30016
 v_mfma_f32_16x16x32_bf16 a[48:51], a[224:227], a[176:179], a[48:51]
 v_mfma_f32_16x16x32_bf16 a[52:55], a[224:227], a[180:183], a[52:55]
 v_mfma_f32_16x16x32_bf16 a[56:59], a[224:227], a[184:187], a[56:59]
 v_mfma_f32_16x16x32_bf16 a[60:63], a[224:227], a[188:191], a[60:63]
 ds_read_b64_tr_b16 a[208:209], v15 offset:9312
 ds_read_b64_tr_b16 a[210:211], v15 offset:11616
 v_mfma_f32_16x16x32_bf16 a[64:67], a[228:231], a[176:179], a[64:67]
 v_add_u32 v28, 0, v2
 v_lshrrev_b32 v29, 10, v28
 v_mfma_f32_16x16x32_bf16 a[68:71], a[228:231], a[180:183], a[68:71]
 v_mul_u32_u24 v29, 0x1c72, v29
 v_lshrrev_b32 v29, 16, v29
 v_mfma_f32_16x16x32_bf16 a[72:75], a[228:231], a[184:187], a[72:75]
 v_mul_u32_u24 v29, 0x1f80, v29
 v_sub_u32 v19, v2, v29
 v_mfma_f32_16x16x32_bf16 a[76:79], a[228:231], a[188:191], a[76:79]
 ds_read_b64_tr_b16 a[212:213], v15 offset:27744
 ds_read_b64_tr_b16 a[214:215], v15 offset:30048
 v_mfma_f32_16x16x32_bf16 v[48:51], a[232:235], a[192:195], v[48:51]
 v_add_u32 v28, 0x400, v3
 v_lshrrev_b32 v29, 10, v28
 v_mfma_f32_16x16x32_bf16 v[52:55], a[232:235], a[196:199], v[52:55]
 v_mul_u32_u24 v29, 0x1c72, v29
 v_lshrrev_b32 v29, 16, v29
 v_mfma_f32_16x16x32_bf16 v[56:59], a[232:235], a[200:203], v[56:59]
 v_mul_u32_u24 v29, 0x1f80, v29
 v_sub_u32 v20, v3, v29
 v_mfma_f32_16x16x32_bf16 v[60:63], a[232:235], a[204:207], v[60:63]
 ds_read_b64_tr_b16 a[216:217], v15 offset:9344
 s_waitcnt lgkmcnt(14)
 ds_read_b64_tr_b16 a[218:219], v15 offset:11648
 s_waitcnt lgkmcnt(4)
 v_mfma_f32_16x16x32_bf16 v[64:67], a[236:239], a[192:195], v[64:67]
 v_add_u32 v28, 0x800, v4
 v_lshrrev_b32 v29, 10, v28
 v_mfma_f32_16x16x32_bf16 v[68:71], a[236:239], a[196:199], v[68:71]
 v_mul_u32_u24 v29, 0x1c72, v29
 v_lshrrev_b32 v29, 16, v29
 v_mfma_f32_16x16x32_bf16 v[72:75], a[236:239], a[200:203], v[72:75]
 v_mul_u32_u24 v29, 0x1f80, v29
 v_sub_u32 v21, v4, v29
 v_mfma_f32_16x16x32_bf16 v[76:79], a[236:239], a[204:207], v[76:79]
 ds_read_b64_tr_b16 a[220:221], v15 offset:27776
 ds_read_b64_tr_b16 a[222:223], v15 offset:30080
 v_mfma_f32_16x16x32_bf16 v[80:83], a[240:243], a[192:195], v[80:83]
 v_add_u32 v28, 0xc00, v5
 v_lshrrev_b32 v29, 10, v28
 v_mfma_f32_16x16x32_bf16 v[84:87], a[240:243], a[196:199], v[84:87]
 v_mul_u32_u24 v29, 0x1c72, v29
 v_lshrrev_b32 v29, 16, v29
 v_mfma_f32_16x16x32_bf16 v[88:91], a[240:243], a[200:203], v[88:91]
 v_mul_u32_u24 v29, 0x1f80, v29
 v_sub_u32 v22, v5, v29
 v_mfma_f32_16x16x32_bf16 v[92:95], a[240:243], a[204:207], v[92:95]
 ds_read_b64_tr_b16 a[224:225], v15 offset:9376
 ds_read_b64_tr_b16 a[226:227], v15 offset:11680
 v_mfma_f32_16x16x32_bf16 v[96:99], a[244:247], a[192:195], v[96:99]
 v_add_u32 v28, 0, v6
 v_lshrrev_b32 v29, 10, v28
 v_mfma_f32_16x16x32_bf16 v[100:103], a[244:247], a[196:199], v[100:103]
 v_mul_u32_u24 v29, 0x1c72, v29
 v_lshrrev_b32 v29, 16, v29
 v_mfma_f32_16x16x32_bf16 v[104:107], a[244:247], a[200:203], v[104:107]
 v_mul_u32_u24 v29, 0x1f80, v29
 v_sub_u32 v23, v6, v29
 v_mfma_f32_16x16x32_bf16 v[108:111], a[244:247], a[204:207], v[108:111]
 ds_read_b64_tr_b16 a[228:229], v15 offset:27808
 ds_read_b64_tr_b16 a[230:231], v15 offset:30112
 v_mfma_f32_16x16x32_bf16 v[112:115], a[248:251], a[192:195], v[112:115]
 v_add_u32 v28, 0x400, v7
 v_lshrrev_b32 v29, 10, v28
 v_mfma_f32_16x16x32_bf16 v[116:119], a[248:251], a[196:199], v[116:119]
 v_mul_u32_u24 v29, 0x1c72, v29
 v_lshrrev_b32 v29, 16, v29
 v_mfma_f32_16x16x32_bf16 v[120:123], a[248:251], a[200:203], v[120:123]
 v_mul_u32_u24 v29, 0x1f80, v29
 v_sub_u32 v24, v7, v29
 v_mfma_f32_16x16x32_bf16 v[124:127], a[248:251], a[204:207], v[124:127]
 ds_read_b64_tr_b16 a[232:233], v15 offset:9408
 ds_read_b64_tr_b16 a[234:235], v15 offset:11712
 v_mfma_f32_16x16x32_bf16 v[128:131], a[252:255], a[192:195], v[128:131]
 v_add_u32 v28, 0x800, v8
 v_lshrrev_b32 v29, 10, v28
 v_mfma_f32_16x16x32_bf16 v[132:135], a[252:255], a[196:199], v[132:135]
 v_mul_u32_u24 v29, 0x1c72, v29
 v_lshrrev_b32 v29, 16, v29
 v_mfma_f32_16x16x32_bf16 v[136:139], a[252:255], a[200:203], v[136:139]
 v_mul_u32_u24 v29, 0x1f80, v29
 v_sub_u32 v25, v8, v29
 v_mfma_f32_16x16x32_bf16 v[140:143], a[252:255], a[204:207], v[140:143]
 ds_read_b64_tr_b16 a[236:237], v15 offset:27840
 ds_read_b64_tr_b16 a[238:239], v15 offset:30144
 v_mfma_f32_16x16x32_bf16 v[144:147], a[208:211], a[192:195], v[144:147]
 v_add_u32 v28, 0xc00, v9
 v_lshrrev_b32 v29, 10, v28
 v_mfma_f32_16x16x32_bf16 v[148:151], a[208:211], a[196:199], v[148:151]
 v_mul_u32_u24 v29, 0x1c72, v29
 v_lshrrev_b32 v29, 16, v29
 v_mfma_f32_16x16x32_bf16 v[152:155], a[208:211], a[200:203], v[152:155]
 v_mul_u32_u24 v29, 0x1f80, v29
 v_sub_u32 v26, v9, v29
 v_mfma_f32_16x16x32_bf16 v[156:159], a[208:211], a[204:207], v[156:159]
 ds_read_b64_tr_b16 a[240:241], v15 offset:9440
 s_waitcnt lgkmcnt(14)
 ds_read_b64_tr_b16 a[242:243], v15 offset:11744
 s_waitcnt lgkmcnt(4)
 v_mfma_f32_16x16x32_bf16 v[160:163], a[212:215], a[192:195], v[160:163]
 v_add_u32 v28, 0, v10
 v_lshrrev_b32 v29, 10, v28
 v_mfma_f32_16x16x32_bf16 v[164:167], a[212:215], a[196:199], v[164:167]
 v_mul_u32_u24 v29, 0x1c72, v29
 v_lshrrev_b32 v29, 16, v29
 v_mfma_f32_16x16x32_bf16 v[168:171], a[212:215], a[200:203], v[168:171]
 v_mul_u32_u24 v29, 0x1f80, v29
 v_sub_u32 v27, v10, v29
 v_mfma_f32_16x16x32_bf16 v[172:175], a[212:215], a[204:207], v[172:175]
 s_waitcnt vmcnt(17)
 s_barrier
 v_mfma_f32_16x16x32_bf16 v[176:179], a[216:219], a[192:195], v[176:179]
 s_add_u32 s44, s31, 0x360000
 ds_read_b64_tr_b16 a[244:245], v15 offset:27872
 v_mfma_f32_16x16x32_bf16 v[180:183], a[216:219], a[196:199], v[180:183]
 ds_read_b64_tr_b16 a[246:247], v15 offset:30176
 s_and_b32 s89, s29, 3
 v_mfma_f32_16x16x32_bf16 v[184:187], a[216:219], a[200:203], v[184:187]
 s_mul_i32 s90, s89, 9
 s_add_u32 s90, s90, 1
 v_mfma_f32_16x16x32_bf16 v[188:191], a[216:219], a[204:207], v[188:191]
 s_add_u32 s46, s32, 0x6000
 ds_read_b64_tr_b16 a[248:249], v15 offset:9472
 v_mfma_f32_16x16x32_bf16 v[192:195], a[220:223], a[192:195], v[192:195]
 ds_read_b64_tr_b16 a[250:251], v15 offset:11776
 s_lshr_b32 s90, s90, 1
 v_mfma_f32_16x16x32_bf16 v[196:199], a[220:223], a[196:199], v[196:199]
 v_mfma_f32_16x16x32_bf16 v[200:203], a[220:223], a[200:203], v[200:203]
 v_mfma_f32_16x16x32_bf16 v[204:207], a[220:223], a[204:207], v[204:207]
 s_add_u32 s47, s33, 0x6000
 ds_read_b64_tr_b16 a[252:253], v15 offset:27904
 v_mfma_f32_16x16x32_bf16 v[208:211], a[224:227], a[192:195], v[208:211]
 ds_read_b64_tr_b16 a[254:255], v15 offset:30208
 v_mfma_f32_16x16x32_bf16 v[212:215], a[224:227], a[196:199], v[212:215]
 v_mfma_f32_16x16x32_bf16 v[216:219], a[224:227], a[200:203], v[216:219]
 v_mfma_f32_16x16x32_bf16 v[220:223], a[224:227], a[204:207], v[220:223]
 ds_read_b64_tr_b16 a[208:209], v12
 ds_read_b64_tr_b16 a[210:211], v12 offset:2304
 v_mfma_f32_16x16x32_bf16 v[224:227], a[228:231], a[192:195], v[224:227]
 s_add_u32 m0, s34, 0x12000
 v_mfma_f32_16x16x32_bf16 v[228:231], a[228:231], a[196:199], v[228:231]
 v_mfma_f32_16x16x32_bf16 v[232:235], a[228:231], a[200:203], v[232:235]
 v_mfma_f32_16x16x32_bf16 v[236:239], a[228:231], a[204:207], v[236:239]
 ds_read_b64_tr_b16 a[212:213], v12 offset:18432
 ds_read_b64_tr_b16 a[214:215], v12 offset:20736
 v_mfma_f32_16x16x32_bf16 v[240:243], a[232:235], a[192:195], v[240:243]
 buffer_load_dwordx4 v2, s[24:27], s44 offen lds
 v_mfma_f32_16x16x32_bf16 v[244:247], a[232:235], a[196:199], v[244:247]
 v_mfma_f32_16x16x32_bf16 v[248:251], a[232:235], a[200:203], v[248:251]
 v_mfma_f32_16x16x32_bf16 v[252:255], a[232:235], a[204:207], v[252:255]
 ds_read_b64_tr_b16 a[216:217], v12 offset:32
 s_waitcnt lgkmcnt(14)
 ds_read_b64_tr_b16 a[218:219], v12 offset:2336
 s_waitcnt lgkmcnt(4)
 v_mfma_f32_16x16x32_bf16 a[0:3], a[236:239], a[192:195], a[0:3]
 buffer_load_dwordx4 a[144:147], v11, s[8:11], s46 offen sc1
 v_mfma_f32_16x16x32_bf16 a[4:7], a[236:239], a[196:199], a[4:7]
 v_mfma_f32_16x16x32_bf16 a[8:11], a[236:239], a[200:203], a[8:11]
 v_mfma_f32_16x16x32_bf16 a[12:15], a[236:239], a[204:207], a[12:15]
 ds_read_b64_tr_b16 a[220:221], v12 offset:18464
 ds_read_b64_tr_b16 a[222:223], v12 offset:20768
 v_mfma_f32_16x16x32_bf16 a[16:19], a[240:243], a[192:195], a[16:19]
 v_mfma_f32_16x16x32_bf16 a[20:23], a[240:243], a[196:199], a[20:23]
 buffer_load_dwordx4 v3, s[24:27], s44 offen offset:1024 lds
 v_mfma_f32_16x16x32_bf16 a[24:27], a[240:243], a[200:203], a[24:27]
 v_mfma_f32_16x16x32_bf16 a[28:31], a[240:243], a[204:207], a[28:31]
 ds_read_b64_tr_b16 a[224:225], v12 offset:64
 ds_read_b64_tr_b16 a[226:227], v12 offset:2368
 v_mfma_f32_16x16x32_bf16 a[32:35], a[244:247], a[192:195], a[32:35]
 v_mfma_f32_16x16x32_bf16 a[36:39], a[244:247], a[196:199], a[36:39]
 buffer_load_dwordx4 a[148:151], v11, s[8:11], s46 offen offset:256 sc1
 v_mfma_f32_16x16x32_bf16 a[40:43], a[244:247], a[200:203], a[40:43]
 v_mfma_f32_16x16x32_bf16 a[44:47], a[244:247], a[204:207], a[44:47]
 ds_read_b64_tr_b16 a[228:229], v12 offset:18496
 ds_read_b64_tr_b16 a[230:231], v12 offset:20800
 v_mfma_f32_16x16x32_bf16 a[48:51], a[248:251], a[192:195], a[48:51]
 v_mfma_f32_16x16x32_bf16 a[52:55], a[248:251], a[196:199], a[52:55]
 buffer_load_dwordx4 v4, s[24:27], s44 offen offset:2048 lds
 v_mfma_f32_16x16x32_bf16 a[56:59], a[248:251], a[200:203], a[56:59]
 v_mfma_f32_16x16x32_bf16 a[60:63], a[248:251], a[204:207], a[60:63]
 ds_read_b64_tr_b16 a[232:233], v12 offset:96
 ds_read_b64_tr_b16 a[234:235], v12 offset:2400
 v_mfma_f32_16x16x32_bf16 a[64:67], a[252:255], a[192:195], a[64:67]
 v_mfma_f32_16x16x32_bf16 a[68:71], a[252:255], a[196:199], a[68:71]
 v_mfma_f32_16x16x32_bf16 a[72:75], a[252:255], a[200:203], a[72:75]
 buffer_load_dwordx4 a[152:155], v11, s[8:11], s47 offen sc1
 v_mfma_f32_16x16x32_bf16 a[76:79], a[252:255], a[204:207], a[76:79]
 ds_read_b64_tr_b16 a[236:237], v12 offset:18528
 ds_read_b64_tr_b16 a[238:239], v12 offset:20832
 v_mfma_f32_16x16x32_bf16 v[48:51], a[208:211], a[80:83], v[48:51]
 v_mfma_f32_16x16x32_bf16 v[52:55], a[208:211], a[84:87], v[52:55]
 v_mfma_f32_16x16x32_bf16 v[56:59], a[208:211], a[88:91], v[56:59]
 buffer_load_dwordx4 v5, s[24:27], s44 offen offset:3072 lds
 v_mfma_f32_16x16x32_bf16 v[60:63], a[208:211], a[92:95], v[60:63]
 ds_read_b64_tr_b16 a[240:241], v12 offset:128
 s_waitcnt lgkmcnt(14)
 ds_read_b64_tr_b16 a[242:243], v12 offset:2432
 s_waitcnt lgkmcnt(4)
 v_mfma_f32_16x16x32_bf16 v[64:67], a[212:215], a[80:83], v[64:67]
 v_mfma_f32_16x16x32_bf16 v[68:71], a[212:215], a[84:87], v[68:71]
 v_mfma_f32_16x16x32_bf16 v[72:75], a[212:215], a[88:91], v[72:75]
 buffer_load_dwordx4 a[156:159], v11, s[8:11], s47 offen offset:256 sc1
 v_mfma_f32_16x16x32_bf16 v[76:79], a[212:215], a[92:95], v[76:79]
 ds_read_b64_tr_b16 a[244:245], v12 offset:18560
 ds_read_b64_tr_b16 a[246:247], v12 offset:20864
 v_mfma_f32_16x16x32_bf16 v[80:83], a[216:219], a[80:83], v[80:83]
 v_mfma_f32_16x16x32_bf16 v[84:87], a[216:219], a[84:87], v[84:87]
 v_mfma_f32_16x16x32_bf16 v[88:91], a[216:219], a[88:91], v[88:91]
 v_mfma_f32_16x16x32_bf16 v[92:95], a[216:219], a[92:95], v[92:95]
 s_add_u32 m0, s34, 0x13000
 ds_read_b64_tr_b16 a[248:249], v12 offset:160
 v_mfma_f32_16x16x32_bf16 v[96:99], a[220:223], a[80:83], v[96:99]
 ds_read_b64_tr_b16 a[250:251], v12 offset:2464
 v_mfma_f32_16x16x32_bf16 v[100:103], a[220:223], a[84:87], v[100:103]
 v_mfma_f32_16x16x32_bf16 v[104:107], a[220:223], a[88:91], v[104:107]
 v_mfma_f32_16x16x32_bf16 v[108:111], a[220:223], a[92:95], v[108:111]
 buffer_load_dwordx4 v6, s[24:27], s44 offen lds
 v_mfma_f32_16x16x32_bf16 v[112:115], a[224:227], a[80:83], v[112:115]
 ds_read_b64_tr_b16 a[252:253], v12 offset:18592
 ds_read_b64_tr_b16 a[254:255], v12 offset:20896
 v_mfma_f32_16x16x32_bf16 v[116:119], a[224:227], a[84:87], v[116:119]
 v_mfma_f32_16x16x32_bf16 v[120:123], a[224:227], a[88:91], v[120:123]
 v_mfma_f32_16x16x32_bf16 v[124:127], a[224:227], a[92:95], v[124:127]
 buffer_load_dwordx4 a[160:163], v11, s[8:11], s46 offen offset:2048 sc1
 v_mfma_f32_16x16x32_bf16 v[128:131], a[228:231], a[80:83], v[128:131]
 ds_read_b64_tr_b16 a[208:209], v12 offset:192
 ds_read_b64_tr_b16 a[210:211], v12 offset:2496
 v_mfma_f32_16x16x32_bf16 v[132:135], a[228:231], a[84:87], v[132:135]
 v_mfma_f32_16x16x32_bf16 v[136:139], a[228:231], a[88:91], v[136:139]
 v_mfma_f32_16x16x32_bf16 v[140:143], a[228:231], a[92:95], v[140:143]
 ds_read_b64_tr_b16 a[212:213], v12 offset:18624
 ds_read_b64_tr_b16 a[214:215], v12 offset:20928
 v_mfma_f32_16x16x32_bf16 v[144:147], a[232:235], a[80:83], v[144:147]
 buffer_load_dwordx4 v7, s[24:27], s44 offen offset:1024 lds
 v_mfma_f32_16x16x32_bf16 v[148:151], a[232:235], a[84:87], v[148:151]
 v_mfma_f32_16x16x32_bf16 v[152:155], a[232:235], a[88:91], v[152:155]
 v_mfma_f32_16x16x32_bf16 v[156:159], a[232:235], a[92:95], v[156:159]
 ds_read_b64_tr_b16 a[216:217], v12 offset:224
 s_waitcnt lgkmcnt(14)
 ds_read_b64_tr_b16 a[218:219], v12 offset:2528
 s_waitcnt lgkmcnt(4)
 v_mfma_f32_16x16x32_bf16 v[160:163], a[236:239], a[80:83], v[160:163]
 buffer_load_dwordx4 a[164:167], v11, s[8:11], s46 offen offset:2304 sc1
 v_mfma_f32_16x16x32_bf16 v[164:167], a[236:239], a[84:87], v[164:167]
 v_mfma_f32_16x16x32_bf16 v[168:171], a[236:239], a[88:91], v[168:171]
 v_mfma_f32_16x16x32_bf16 v[172:175], a[236:239], a[92:95], v[172:175]
 ds_read_b64_tr_b16 a[220:221], v12 offset:18656
 ds_read_b64_tr_b16 a[222:223], v12 offset:20960
 v_mfma_f32_16x16x32_bf16 v[176:179], a[240:243], a[80:83], v[176:179]
 buffer_load_dwordx4 v8, s[24:27], s44 offen offset:2048 lds
 v_mfma_f32_16x16x32_bf16 v[180:183], a[240:243], a[84:87], v[180:183]
 v_mfma_f32_16x16x32_bf16 v[184:187], a[240:243], a[88:91], v[184:187]
 v_mfma_f32_16x16x32_bf16 v[188:191], a[240:243], a[92:95], v[188:191]
 ds_read_b64_tr_b16 a[224:225], v12 offset:256
 ds_read_b64_tr_b16 a[226:227], v12 offset:2560
 v_mfma_f32_16x16x32_bf16 v[192:195], a[244:247], a[80:83], v[192:195]
 v_mfma_f32_16x16x32_bf16 v[196:199], a[244:247], a[84:87], v[196:199]
 buffer_load_dwordx4 a[168:171], v11, s[8:11], s47 offen offset:2048 sc1
 v_mfma_f32_16x16x32_bf16 v[200:203], a[244:247], a[88:91], v[200:203]
 v_mfma_f32_16x16x32_bf16 v[204:207], a[244:247], a[92:95], v[204:207]
 ds_read_b64_tr_b16 a[228:229], v12 offset:18688
 ds_read_b64_tr_b16 a[230:231], v12 offset:20992
 v_mfma_f32_16x16x32_bf16 v[208:211], a[248:251], a[80:83], v[208:211]
 v_mfma_f32_16x16x32_bf16 v[212:215], a[248:251], a[84:87], v[212:215]
 buffer_load_dwordx4 v9, s[24:27], s44 offen offset:3072 lds
 v_mfma_f32_16x16x32_bf16 v[216:219], a[248:251], a[88:91], v[216:219]
 v_mfma_f32_16x16x32_bf16 v[220:223], a[248:251], a[92:95], v[220:223]
 ds_read_b64_tr_b16 a[232:233], v12 offset:9216
 ds_read_b64_tr_b16 a[234:235], v12 offset:11520
 v_mfma_f32_16x16x32_bf16 v[224:227], a[252:255], a[80:83], v[224:227]
 v_mfma_f32_16x16x32_bf16 v[228:231], a[252:255], a[84:87], v[228:231]
 buffer_load_dwordx4 a[172:175], v11, s[8:11], s47 offen offset:2304 sc1
 v_mfma_f32_16x16x32_bf16 v[232:235], a[252:255], a[88:91], v[232:235]
 v_mfma_f32_16x16x32_bf16 v[236:239], a[252:255], a[92:95], v[236:239]
 ds_read_b64_tr_b16 a[236:237], v12 offset:27648
 ds_read_b64_tr_b16 a[238:239], v12 offset:29952
 v_mfma_f32_16x16x32_bf16 v[240:243], a[208:211], a[80:83], v[240:243]
 v_mfma_f32_16x16x32_bf16 v[244:247], a[208:211], a[84:87], v[244:247]
 v_mfma_f32_16x16x32_bf16 v[248:251], a[208:211], a[88:91], v[248:251]
 s_add_u32 m0, s34, 0x14000
 v_mfma_f32_16x16x32_bf16 v[252:255], a[208:211], a[92:95], v[252:255]
 ds_read_b64_tr_b16 a[240:241], v12 offset:9248
 s_waitcnt lgkmcnt(14)
 ds_read_b64_tr_b16 a[242:243], v12 offset:11552
 s_waitcnt lgkmcnt(4)
 v_mfma_f32_16x16x32_bf16 a[0:3], a[212:215], a[80:83], a[0:3]
 v_mfma_f32_16x16x32_bf16 a[4:7], a[212:215], a[84:87], a[4:7]
 v_mfma_f32_16x16x32_bf16 a[8:11], a[212:215], a[88:91], a[8:11]
 buffer_load_dwordx4 v10, s[24:27], s44 offen lds
 v_mfma_f32_16x16x32_bf16 a[12:15], a[212:215], a[92:95], a[12:15]
 ds_read_b64_tr_b16 a[244:245], v12 offset:27680
 ds_read_b64_tr_b16 a[246:247], v12 offset:29984
 v_mfma_f32_16x16x32_bf16 a[16:19], a[216:219], a[80:83], a[16:19]
 v_mfma_f32_16x16x32_bf16 a[20:23], a[216:219], a[84:87], a[20:23]
 v_mfma_f32_16x16x32_bf16 a[24:27], a[216:219], a[88:91], a[24:27]
 v_mfma_f32_16x16x32_bf16 a[28:31], a[216:219], a[92:95], a[28:31]
 ds_read_b64_tr_b16 a[248:249], v12 offset:9280
 ds_read_b64_tr_b16 a[250:251], v12 offset:11584
 v_mfma_f32_16x16x32_bf16 a[32:35], a[220:223], a[80:83], a[32:35]
 v_mfma_f32_16x16x32_bf16 a[36:39], a[220:223], a[84:87], a[36:39]
 v_mfma_f32_16x16x32_bf16 a[40:43], a[220:223], a[88:91], a[40:43]
 v_mfma_f32_16x16x32_bf16 a[44:47], a[220:223], a[92:95], a[44:47]
 ds_read_b64_tr_b16 a[252:253], v12 offset:27712
 ds_read_b64_tr_b16 a[254:255], v12 offset:30016
 v_mfma_f32_16x16x32_bf16 a[48:51], a[224:227], a[80:83], a[48:51]
 v_mfma_f32_16x16x32_bf16 a[52:55], a[224:227], a[84:87], a[52:55]
 v_mfma_f32_16x16x32_bf16 a[56:59], a[224:227], a[88:91], a[56:59]
 v_mfma_f32_16x16x32_bf16 a[60:63], a[224:227], a[92:95], a[60:63]
 ds_read_b64_tr_b16 a[208:209], v12 offset:9312
 ds_read_b64_tr_b16 a[210:211], v12 offset:11616
 v_mfma_f32_16x16x32_bf16 a[64:67], a[228:231], a[80:83], a[64:67]
 v_mfma_f32_16x16x32_bf16 a[68:71], a[228:231], a[84:87], a[68:71]
 v_mfma_f32_16x16x32_bf16 a[72:75], a[228:231], a[88:91], a[72:75]
 v_mfma_f32_16x16x32_bf16 a[76:79], a[228:231], a[92:95], a[76:79]
 ds_read_b64_tr_b16 a[212:213], v12 offset:27744
 ds_read_b64_tr_b16 a[214:215], v12 offset:30048
 v_mfma_f32_16x16x32_bf16 v[48:51], a[232:235], a[96:99], v[48:51]
 v_mfma_f32_16x16x32_bf16 v[52:55], a[232:235], a[100:103], v[52:55]
 v_mfma_f32_16x16x32_bf16 v[56:59], a[232:235], a[104:107], v[56:59]
 v_mfma_f32_16x16x32_bf16 v[60:63], a[232:235], a[108:111], v[60:63]
 ds_read_b64_tr_b16 a[216:217], v12 offset:9344
 s_waitcnt lgkmcnt(14)
 ds_read_b64_tr_b16 a[218:219], v12 offset:11648
 s_waitcnt lgkmcnt(4)
 v_mfma_f32_16x16x32_bf16 v[64:67], a[236:239], a[96:99], v[64:67]
 v_mfma_f32_16x16x32_bf16 v[68:71], a[236:239], a[100:103], v[68:71]
 v_mfma_f32_16x16x32_bf16 v[72:75], a[236:239], a[104:107], v[72:75]
 v_mfma_f32_16x16x32_bf16 v[76:79], a[236:239], a[108:111], v[76:79]
 ds_read_b64_tr_b16 a[220:221], v12 offset:27776
 ds_read_b64_tr_b16 a[222:223], v12 offset:30080
 v_mfma_f32_16x16x32_bf16 v[80:83], a[240:243], a[96:99], v[80:83]
 v_mfma_f32_16x16x32_bf16 v[84:87], a[240:243], a[100:103], v[84:87]
 v_mfma_f32_16x16x32_bf16 v[88:91], a[240:243], a[104:107], v[88:91]
 v_mfma_f32_16x16x32_bf16 v[92:95], a[240:243], a[108:111], v[92:95]
 ds_read_b64_tr_b16 a[224:225], v12 offset:9376
 ds_read_b64_tr_b16 a[226:227], v12 offset:11680
 v_mfma_f32_16x16x32_bf16 v[96:99], a[244:247], a[96:99], v[96:99]
 v_mfma_f32_16x16x32_bf16 v[100:103], a[244:247], a[100:103], v[100:103]
 v_mfma_f32_16x16x32_bf16 v[104:107], a[244:247], a[104:107], v[104:107]
 v_mfma_f32_16x16x32_bf16 v[108:111], a[244:247], a[108:111], v[108:111]
 ds_read_b64_tr_b16 a[228:229], v12 offset:27808
 ds_read_b64_tr_b16 a[230:231], v12 offset:30112
 v_mfma_f32_16x16x32_bf16 v[112:115], a[248:251], a[96:99], v[112:115]
 v_mfma_f32_16x16x32_bf16 v[116:119], a[248:251], a[100:103], v[116:119]
 v_mfma_f32_16x16x32_bf16 v[120:123], a[248:251], a[104:107], v[120:123]
 v_mfma_f32_16x16x32_bf16 v[124:127], a[248:251], a[108:111], v[124:127]
 ds_read_b64_tr_b16 a[232:233], v12 offset:9408
 ds_read_b64_tr_b16 a[234:235], v12 offset:11712
 v_mfma_f32_16x16x32_bf16 v[128:131], a[252:255], a[96:99], v[128:131]
 v_mfma_f32_16x16x32_bf16 v[132:135], a[252:255], a[100:103], v[132:135]
 v_mfma_f32_16x16x32_bf16 v[136:139], a[252:255], a[104:107], v[136:139]
 v_mfma_f32_16x16x32_bf16 v[140:143], a[252:255], a[108:111], v[140:143]
 ds_read_b64_tr_b16 a[236:237], v12 offset:27840
 ds_read_b64_tr_b16 a[238:239], v12 offset:30144
 v_mfma_f32_16x16x32_bf16 v[144:147], a[208:211], a[96:99], v[144:147]
 v_mfma_f32_16x16x32_bf16 v[148:151], a[208:211], a[100:103], v[148:151]
 v_mfma_f32_16x16x32_bf16 v[152:155], a[208:211], a[104:107], v[152:155]
 v_mfma_f32_16x16x32_bf16 v[156:159], a[208:211], a[108:111], v[156:159]
 ds_read_b64_tr_b16 a[240:241], v12 offset:9440
 s_waitcnt lgkmcnt(14)
 ds_read_b64_tr_b16 a[242:243], v12 offset:11744
 s_waitcnt lgkmcnt(4)
 v_mfma_f32_16x16x32_bf16 v[160:163], a[212:215], a[96:99], v[160:163]
 v_mfma_f32_16x16x32_bf16 v[164:167], a[212:215], a[100:103], v[164:167]
 v_mfma_f32_16x16x32_bf16 v[168:171], a[212:215], a[104:107], v[168:171]
 v_mfma_f32_16x16x32_bf16 v[172:175], a[212:215], a[108:111], v[172:175]
 s_waitcnt vmcnt(17)
 s_barrier
 v_mfma_f32_16x16x32_bf16 v[176:179], a[216:219], a[96:99], v[176:179]
 s_add_u32 s44, s31, 0x3f0000
 ds_read_b64_tr_b16 a[244:245], v12 offset:27872
 v_mfma_f32_16x16x32_bf16 v[180:183], a[216:219], a[100:103], v[180:183]
 ds_read_b64_tr_b16 a[246:247], v12 offset:30176
 v_mfma_f32_16x16x32_bf16 v[184:187], a[216:219], a[104:107], v[184:187]
 v_mfma_f32_16x16x32_bf16 v[188:191], a[216:219], a[108:111], v[188:191]
 s_add_u32 s46, s32, 0x7000
 ds_read_b64_tr_b16 a[248:249], v12 offset:9472
 v_mfma_f32_16x16x32_bf16 v[192:195], a[220:223], a[96:99], v[192:195]
 ds_read_b64_tr_b16 a[250:251], v12 offset:11776
 v_mfma_f32_16x16x32_bf16 v[196:199], a[220:223], a[100:103], v[196:199]
 v_mfma_f32_16x16x32_bf16 v[200:203], a[220:223], a[104:107], v[200:203]
 v_mfma_f32_16x16x32_bf16 v[204:207], a[220:223], a[108:111], v[204:207]
 s_add_u32 s47, s33, 0x7000
 ds_read_b64_tr_b16 a[252:253], v12 offset:27904
 v_mfma_f32_16x16x32_bf16 v[208:211], a[224:227], a[96:99], v[208:211]
 ds_read_b64_tr_b16 a[254:255], v12 offset:30208
 v_mfma_f32_16x16x32_bf16 v[212:215], a[224:227], a[100:103], v[212:215]
 v_mfma_f32_16x16x32_bf16 v[216:219], a[224:227], a[104:107], v[216:219]
 v_mfma_f32_16x16x32_bf16 v[220:223], a[224:227], a[108:111], v[220:223]
 ds_read_b64_tr_b16 a[208:209], v13
 ds_read_b64_tr_b16 a[210:211], v13 offset:2304
 v_mfma_f32_16x16x32_bf16 v[224:227], a[228:231], a[96:99], v[224:227]
 s_add_u32 m0, s34, 0x1b000
 v_mfma_f32_16x16x32_bf16 v[228:231], a[228:231], a[100:103], v[228:231]
 v_mfma_f32_16x16x32_bf16 v[232:235], a[228:231], a[104:107], v[232:235]
 v_mfma_f32_16x16x32_bf16 v[236:239], a[228:231], a[108:111], v[236:239]
 ds_read_b64_tr_b16 a[212:213], v13 offset:18432
 ds_read_b64_tr_b16 a[214:215], v13 offset:20736
 v_mfma_f32_16x16x32_bf16 v[240:243], a[232:235], a[96:99], v[240:243]
 buffer_load_dwordx4 v2, s[24:27], s44 offen lds
 v_mfma_f32_16x16x32_bf16 v[244:247], a[232:235], a[100:103], v[244:247]
 v_mfma_f32_16x16x32_bf16 v[248:251], a[232:235], a[104:107], v[248:251]
 v_mfma_f32_16x16x32_bf16 v[252:255], a[232:235], a[108:111], v[252:255]
 ds_read_b64_tr_b16 a[216:217], v13 offset:32
 s_waitcnt lgkmcnt(14)
 ds_read_b64_tr_b16 a[218:219], v13 offset:2336
 s_waitcnt lgkmcnt(4)
 v_mfma_f32_16x16x32_bf16 a[0:3], a[236:239], a[96:99], a[0:3]
 buffer_load_dwordx4 a[176:179], v11, s[8:11], s46 offen sc1
 v_mfma_f32_16x16x32_bf16 a[4:7], a[236:239], a[100:103], a[4:7]
 v_mfma_f32_16x16x32_bf16 a[8:11], a[236:239], a[104:107], a[8:11]
 v_mfma_f32_16x16x32_bf16 a[12:15], a[236:239], a[108:111], a[12:15]
 ds_read_b64_tr_b16 a[220:221], v13 offset:18464
 ds_read_b64_tr_b16 a[222:223], v13 offset:20768
 v_mfma_f32_16x16x32_bf16 a[16:19], a[240:243], a[96:99], a[16:19]
 v_mfma_f32_16x16x32_bf16 a[20:23], a[240:243], a[100:103], a[20:23]
 buffer_load_dwordx4 v3, s[24:27], s44 offen offset:1024 lds
 v_mfma_f32_16x16x32_bf16 a[24:27], a[240:243], a[104:107], a[24:27]
 v_mfma_f32_16x16x32_bf16 a[28:31], a[240:243], a[108:111], a[28:31]
 ds_read_b64_tr_b16 a[224:225], v13 offset:64
 ds_read_b64_tr_b16 a[226:227], v13 offset:2368
 v_mfma_f32_16x16x32_bf16 a[32:35], a[244:247], a[96:99], a[32:35]
 v_mfma_f32_16x16x32_bf16 a[36:39], a[244:247], a[100:103], a[36:39]
 buffer_load_dwordx4 a[180:183], v11, s[8:11], s46 offen offset:256 sc1
 v_mfma_f32_16x16x32_bf16 a[40:43], a[244:247], a[104:107], a[40:43]
 v_mfma_f32_16x16x32_bf16 a[44:47], a[244:247], a[108:111], a[44:47]
 ds_read_b64_tr_b16 a[228:229], v13 offset:18496
 ds_read_b64_tr_b16 a[230:231], v13 offset:20800
 v_mfma_f32_16x16x32_bf16 a[48:51], a[248:251], a[96:99], a[48:51]
 v_mfma_f32_16x16x32_bf16 a[52:55], a[248:251], a[100:103], a[52:55]
 buffer_load_dwordx4 v4, s[24:27], s44 offen offset:2048 lds
 v_mfma_f32_16x16x32_bf16 a[56:59], a[248:251], a[104:107], a[56:59]
 v_mfma_f32_16x16x32_bf16 a[60:63], a[248:251], a[108:111], a[60:63]
 ds_read_b64_tr_b16 a[232:233], v13 offset:96
 ds_read_b64_tr_b16 a[234:235], v13 offset:2400
 v_mfma_f32_16x16x32_bf16 a[64:67], a[252:255], a[96:99], a[64:67]
 v_mfma_f32_16x16x32_bf16 a[68:71], a[252:255], a[100:103], a[68:71]
 v_mfma_f32_16x16x32_bf16 a[72:75], a[252:255], a[104:107], a[72:75]
 buffer_load_dwordx4 a[184:187], v11, s[8:11], s47 offen sc1
 v_mfma_f32_16x16x32_bf16 a[76:79], a[252:255], a[108:111], a[76:79]
 ds_read_b64_tr_b16 a[236:237], v13 offset:18528
 ds_read_b64_tr_b16 a[238:239], v13 offset:20832
 v_mfma_f32_16x16x32_bf16 v[48:51], a[208:211], a[112:115], v[48:51]
 v_mfma_f32_16x16x32_bf16 v[52:55], a[208:211], a[116:119], v[52:55]
 v_mfma_f32_16x16x32_bf16 v[56:59], a[208:211], a[120:123], v[56:59]
 buffer_load_dwordx4 v5, s[24:27], s44 offen offset:3072 lds
 v_mfma_f32_16x16x32_bf16 v[60:63], a[208:211], a[124:127], v[60:63]
 ds_read_b64_tr_b16 a[240:241], v13 offset:128
 s_waitcnt lgkmcnt(14)
 ds_read_b64_tr_b16 a[242:243], v13 offset:2432
 s_waitcnt lgkmcnt(4)
 v_mfma_f32_16x16x32_bf16 v[64:67], a[212:215], a[112:115], v[64:67]
 v_mfma_f32_16x16x32_bf16 v[68:71], a[212:215], a[116:119], v[68:71]
 v_mfma_f32_16x16x32_bf16 v[72:75], a[212:215], a[120:123], v[72:75]
 buffer_load_dwordx4 a[188:191], v11, s[8:11], s47 offen offset:256 sc1
 v_mfma_f32_16x16x32_bf16 v[76:79], a[212:215], a[124:127], v[76:79]
 ds_read_b64_tr_b16 a[244:245], v13 offset:18560
 ds_read_b64_tr_b16 a[246:247], v13 offset:20864
 v_mfma_f32_16x16x32_bf16 v[80:83], a[216:219], a[112:115], v[80:83]
 v_mfma_f32_16x16x32_bf16 v[84:87], a[216:219], a[116:119], v[84:87]
 v_mfma_f32_16x16x32_bf16 v[88:91], a[216:219], a[120:123], v[88:91]
 v_mfma_f32_16x16x32_bf16 v[92:95], a[216:219], a[124:127], v[92:95]
 s_add_u32 m0, s34, 0x1c000
 ds_read_b64_tr_b16 a[248:249], v13 offset:160
 v_mfma_f32_16x16x32_bf16 v[96:99], a[220:223], a[112:115], v[96:99]
 ds_read_b64_tr_b16 a[250:251], v13 offset:2464
 v_mfma_f32_16x16x32_bf16 v[100:103], a[220:223], a[116:119], v[100:103]
 v_mfma_f32_16x16x32_bf16 v[104:107], a[220:223], a[120:123], v[104:107]
 v_mfma_f32_16x16x32_bf16 v[108:111], a[220:223], a[124:127], v[108:111]
 buffer_load_dwordx4 v6, s[24:27], s44 offen lds
 v_mfma_f32_16x16x32_bf16 v[112:115], a[224:227], a[112:115], v[112:115]
 ds_read_b64_tr_b16 a[252:253], v13 offset:18592
 ds_read_b64_tr_b16 a[254:255], v13 offset:20896
 v_mfma_f32_16x16x32_bf16 v[116:119], a[224:227], a[116:119], v[116:119]
 v_mfma_f32_16x16x32_bf16 v[120:123], a[224:227], a[120:123], v[120:123]
 v_mfma_f32_16x16x32_bf16 v[124:127], a[224:227], a[124:127], v[124:127]
 buffer_load_dwordx4 a[192:195], v11, s[8:11], s46 offen offset:2048 sc1
 v_mfma_f32_16x16x32_bf16 v[128:131], a[228:231], a[112:115], v[128:131]
 ds_read_b64_tr_b16 a[208:209], v13 offset:192
 ds_read_b64_tr_b16 a[210:211], v13 offset:2496
 v_mfma_f32_16x16x32_bf16 v[132:135], a[228:231], a[116:119], v[132:135]
 v_mfma_f32_16x16x32_bf16 v[136:139], a[228:231], a[120:123], v[136:139]
 v_mfma_f32_16x16x32_bf16 v[140:143], a[228:231], a[124:127], v[140:143]
 ds_read_b64_tr_b16 a[212:213], v13 offset:18624
 ds_read_b64_tr_b16 a[214:215], v13 offset:20928
 v_mfma_f32_16x16x32_bf16 v[144:147], a[232:235], a[112:115], v[144:147]
 buffer_load_dwordx4 v7, s[24:27], s44 offen offset:1024 lds
 v_mfma_f32_16x16x32_bf16 v[148:151], a[232:235], a[116:119], v[148:151]
 v_mfma_f32_16x16x32_bf16 v[152:155], a[232:235], a[120:123], v[152:155]
 v_mfma_f32_16x16x32_bf16 v[156:159], a[232:235], a[124:127], v[156:159]
 ds_read_b64_tr_b16 a[216:217], v13 offset:224
 s_waitcnt lgkmcnt(14)
 ds_read_b64_tr_b16 a[218:219], v13 offset:2528
 s_waitcnt lgkmcnt(4)
 v_mfma_f32_16x16x32_bf16 v[160:163], a[236:239], a[112:115], v[160:163]
 buffer_load_dwordx4 a[196:199], v11, s[8:11], s46 offen offset:2304 sc1
 v_mfma_f32_16x16x32_bf16 v[164:167], a[236:239], a[116:119], v[164:167]
 v_mfma_f32_16x16x32_bf16 v[168:171], a[236:239], a[120:123], v[168:171]
 v_mfma_f32_16x16x32_bf16 v[172:175], a[236:239], a[124:127], v[172:175]
 ds_read_b64_tr_b16 a[220:221], v13 offset:18656
 ds_read_b64_tr_b16 a[222:223], v13 offset:20960
 v_mfma_f32_16x16x32_bf16 v[176:179], a[240:243], a[112:115], v[176:179]
 buffer_load_dwordx4 v8, s[24:27], s44 offen offset:2048 lds
 v_mfma_f32_16x16x32_bf16 v[180:183], a[240:243], a[116:119], v[180:183]
 v_mfma_f32_16x16x32_bf16 v[184:187], a[240:243], a[120:123], v[184:187]
 v_mfma_f32_16x16x32_bf16 v[188:191], a[240:243], a[124:127], v[188:191]
 ds_read_b64_tr_b16 a[224:225], v13 offset:256
 ds_read_b64_tr_b16 a[226:227], v13 offset:2560
 v_mfma_f32_16x16x32_bf16 v[192:195], a[244:247], a[112:115], v[192:195]
 v_mfma_f32_16x16x32_bf16 v[196:199], a[244:247], a[116:119], v[196:199]
 buffer_load_dwordx4 a[200:203], v11, s[8:11], s47 offen offset:2048 sc1
 v_mfma_f32_16x16x32_bf16 v[200:203], a[244:247], a[120:123], v[200:203]
 v_mfma_f32_16x16x32_bf16 v[204:207], a[244:247], a[124:127], v[204:207]
 ds_read_b64_tr_b16 a[228:229], v13 offset:18688
 ds_read_b64_tr_b16 a[230:231], v13 offset:20992
 v_mfma_f32_16x16x32_bf16 v[208:211], a[248:251], a[112:115], v[208:211]
 v_mfma_f32_16x16x32_bf16 v[212:215], a[248:251], a[116:119], v[212:215]
 buffer_load_dwordx4 v9, s[24:27], s44 offen offset:3072 lds
 v_mfma_f32_16x16x32_bf16 v[216:219], a[248:251], a[120:123], v[216:219]
 v_mfma_f32_16x16x32_bf16 v[220:223], a[248:251], a[124:127], v[220:223]
 ds_read_b64_tr_b16 a[232:233], v13 offset:9216
 ds_read_b64_tr_b16 a[234:235], v13 offset:11520
 v_mfma_f32_16x16x32_bf16 v[224:227], a[252:255], a[112:115], v[224:227]
 v_mfma_f32_16x16x32_bf16 v[228:231], a[252:255], a[116:119], v[228:231]
 buffer_load_dwordx4 a[204:207], v11, s[8:11], s47 offen offset:2304 sc1
 v_mfma_f32_16x16x32_bf16 v[232:235], a[252:255], a[120:123], v[232:235]
 v_mfma_f32_16x16x32_bf16 v[236:239], a[252:255], a[124:127], v[236:239]
 ds_read_b64_tr_b16 a[236:237], v13 offset:27648
 ds_read_b64_tr_b16 a[238:239], v13 offset:29952
 v_mfma_f32_16x16x32_bf16 v[240:243], a[208:211], a[112:115], v[240:243]
 v_mfma_f32_16x16x32_bf16 v[244:247], a[208:211], a[116:119], v[244:247]
 v_mfma_f32_16x16x32_bf16 v[248:251], a[208:211], a[120:123], v[248:251]
 s_add_u32 m0, s34, 0x1d000
 v_mfma_f32_16x16x32_bf16 v[252:255], a[208:211], a[124:127], v[252:255]
 ds_read_b64_tr_b16 a[240:241], v13 offset:9248
 s_waitcnt lgkmcnt(14)
 ds_read_b64_tr_b16 a[242:243], v13 offset:11552
 s_waitcnt lgkmcnt(4)
 v_mfma_f32_16x16x32_bf16 a[0:3], a[212:215], a[112:115], a[0:3]
 v_mfma_f32_16x16x32_bf16 a[4:7], a[212:215], a[116:119], a[4:7]
 v_mfma_f32_16x16x32_bf16 a[8:11], a[212:215], a[120:123], a[8:11]
 buffer_load_dwordx4 v10, s[24:27], s44 offen lds
 v_mfma_f32_16x16x32_bf16 a[12:15], a[212:215], a[124:127], a[12:15]
 ds_read_b64_tr_b16 a[244:245], v13 offset:27680
 ds_read_b64_tr_b16 a[246:247], v13 offset:29984
 v_mfma_f32_16x16x32_bf16 a[16:19], a[216:219], a[112:115], a[16:19]
 v_mfma_f32_16x16x32_bf16 a[20:23], a[216:219], a[116:119], a[20:23]
 v_mfma_f32_16x16x32_bf16 a[24:27], a[216:219], a[120:123], a[24:27]
 v_mfma_f32_16x16x32_bf16 a[28:31], a[216:219], a[124:127], a[28:31]
 ds_read_b64_tr_b16 a[248:249], v13 offset:9280
 ds_read_b64_tr_b16 a[250:251], v13 offset:11584
 v_mfma_f32_16x16x32_bf16 a[32:35], a[220:223], a[112:115], a[32:35]
 v_mfma_f32_16x16x32_bf16 a[36:39], a[220:223], a[116:119], a[36:39]
 v_mfma_f32_16x16x32_bf16 a[40:43], a[220:223], a[120:123], a[40:43]
 v_mfma_f32_16x16x32_bf16 a[44:47], a[220:223], a[124:127], a[44:47]
 ds_read_b64_tr_b16 a[252:253], v13 offset:27712
 ds_read_b64_tr_b16 a[254:255], v13 offset:30016
 v_mfma_f32_16x16x32_bf16 a[48:51], a[224:227], a[112:115], a[48:51]
 v_mfma_f32_16x16x32_bf16 a[52:55], a[224:227], a[116:119], a[52:55]
 v_mfma_f32_16x16x32_bf16 a[56:59], a[224:227], a[120:123], a[56:59]
 v_mfma_f32_16x16x32_bf16 a[60:63], a[224:227], a[124:127], a[60:63]
 ds_read_b64_tr_b16 a[208:209], v13 offset:9312
 ds_read_b64_tr_b16 a[210:211], v13 offset:11616
 v_mfma_f32_16x16x32_bf16 a[64:67], a[228:231], a[112:115], a[64:67]
 v_mfma_f32_16x16x32_bf16 a[68:71], a[228:231], a[116:119], a[68:71]
 v_mfma_f32_16x16x32_bf16 a[72:75], a[228:231], a[120:123], a[72:75]
 v_mfma_f32_16x16x32_bf16 a[76:79], a[228:231], a[124:127], a[76:79]
 ds_read_b64_tr_b16 a[212:213], v13 offset:27744
 ds_read_b64_tr_b16 a[214:215], v13 offset:30048
 v_mfma_f32_16x16x32_bf16 v[48:51], a[232:235], a[128:131], v[48:51]
 v_mfma_f32_16x16x32_bf16 v[52:55], a[232:235], a[132:135], v[52:55]
 v_mfma_f32_16x16x32_bf16 v[56:59], a[232:235], a[136:139], v[56:59]
 v_mfma_f32_16x16x32_bf16 v[60:63], a[232:235], a[140:143], v[60:63]
 ds_read_b64_tr_b16 a[216:217], v13 offset:9344
 s_waitcnt lgkmcnt(14)
 ds_read_b64_tr_b16 a[218:219], v13 offset:11648
 s_waitcnt lgkmcnt(4)
 v_mfma_f32_16x16x32_bf16 v[64:67], a[236:239], a[128:131], v[64:67]
 v_mfma_f32_16x16x32_bf16 v[68:71], a[236:239], a[132:135], v[68:71]
 v_mfma_f32_16x16x32_bf16 v[72:75], a[236:239], a[136:139], v[72:75]
 v_mfma_f32_16x16x32_bf16 v[76:79], a[236:239], a[140:143], v[76:79]
 ds_read_b64_tr_b16 a[220:221], v13 offset:27776
 ds_read_b64_tr_b16 a[222:223], v13 offset:30080
 v_mfma_f32_16x16x32_bf16 v[80:83], a[240:243], a[128:131], v[80:83]
 v_mfma_f32_16x16x32_bf16 v[84:87], a[240:243], a[132:135], v[84:87]
 v_mfma_f32_16x16x32_bf16 v[88:91], a[240:243], a[136:139], v[88:91]
 v_mfma_f32_16x16x32_bf16 v[92:95], a[240:243], a[140:143], v[92:95]
 ds_read_b64_tr_b16 a[224:225], v13 offset:9376
 ds_read_b64_tr_b16 a[226:227], v13 offset:11680
 v_mfma_f32_16x16x32_bf16 v[96:99], a[244:247], a[128:131], v[96:99]
 v_mfma_f32_16x16x32_bf16 v[100:103], a[244:247], a[132:135], v[100:103]
 v_mfma_f32_16x16x32_bf16 v[104:107], a[244:247], a[136:139], v[104:107]
 v_mfma_f32_16x16x32_bf16 v[108:111], a[244:247], a[140:143], v[108:111]
 ds_read_b64_tr_b16 a[228:229], v13 offset:27808
 ds_read_b64_tr_b16 a[230:231], v13 offset:30112
 v_mfma_f32_16x16x32_bf16 v[112:115], a[248:251], a[128:131], v[112:115]
 v_mfma_f32_16x16x32_bf16 v[116:119], a[248:251], a[132:135], v[116:119]
 v_mfma_f32_16x16x32_bf16 v[120:123], a[248:251], a[136:139], v[120:123]
 v_mfma_f32_16x16x32_bf16 v[124:127], a[248:251], a[140:143], v[124:127]
 ds_read_b64_tr_b16 a[232:233], v13 offset:9408
 ds_read_b64_tr_b16 a[234:235], v13 offset:11712
 v_mfma_f32_16x16x32_bf16 v[128:131], a[252:255], a[128:131], v[128:131]
 v_mfma_f32_16x16x32_bf16 v[132:135], a[252:255], a[132:135], v[132:135]
 v_mfma_f32_16x16x32_bf16 v[136:139], a[252:255], a[136:139], v[136:139]
 v_mfma_f32_16x16x32_bf16 v[140:143], a[252:255], a[140:143], v[140:143]
 ds_read_b64_tr_b16 a[236:237], v13 offset:27840
 ds_read_b64_tr_b16 a[238:239], v13 offset:30144
 v_mfma_f32_16x16x32_bf16 v[144:147], a[208:211], a[128:131], v[144:147]
 v_mfma_f32_16x16x32_bf16 v[148:151], a[208:211], a[132:135], v[148:151]
 v_mfma_f32_16x16x32_bf16 v[152:155], a[208:211], a[136:139], v[152:155]
 v_mfma_f32_16x16x32_bf16 v[156:159], a[208:211], a[140:143], v[156:159]
 ds_read_b64_tr_b16 a[240:241], v13 offset:9440
 s_waitcnt lgkmcnt(14)
 ds_read_b64_tr_b16 a[242:243], v13 offset:11744
 s_waitcnt lgkmcnt(4)
 v_mfma_f32_16x16x32_bf16 v[160:163], a[212:215], a[128:131], v[160:163]
 v_mfma_f32_16x16x32_bf16 v[164:167], a[212:215], a[132:135], v[164:167]
 v_mfma_f32_16x16x32_bf16 v[168:171], a[212:215], a[136:139], v[168:171]
 v_mfma_f32_16x16x32_bf16 v[172:175], a[212:215], a[140:143], v[172:175]
 s_waitcnt vmcnt(17)
 s_barrier
 v_mfma_f32_16x16x32_bf16 v[176:179], a[216:219], a[128:131], v[176:179]
 s_add_u32 s44, s31, 0x480000
 ds_read_b64_tr_b16 a[244:245], v13 offset:27872
 v_mfma_f32_16x16x32_bf16 v[180:183], a[216:219], a[132:135], v[180:183]
 ds_read_b64_tr_b16 a[246:247], v13 offset:30176
 v_mfma_f32_16x16x32_bf16 v[184:187], a[216:219], a[136:139], v[184:187]
 v_mfma_f32_16x16x32_bf16 v[188:191], a[216:219], a[140:143], v[188:191]
 s_add_u32 s46, s32, 0x8000
 ds_read_b64_tr_b16 a[248:249], v13 offset:9472
 v_mfma_f32_16x16x32_bf16 v[192:195], a[220:223], a[128:131], v[192:195]
 ds_read_b64_tr_b16 a[250:251], v13 offset:11776
 v_mfma_f32_16x16x32_bf16 v[196:199], a[220:223], a[132:135], v[196:199]
 v_mfma_f32_16x16x32_bf16 v[200:203], a[220:223], a[136:139], v[200:203]
 v_mfma_f32_16x16x32_bf16 v[204:207], a[220:223], a[140:143], v[204:207]
 s_add_u32 s47, s33, 0x8000
 ds_read_b64_tr_b16 a[252:253], v13 offset:27904
 v_mfma_f32_16x16x32_bf16 v[208:211], a[224:227], a[128:131], v[208:211]
 ds_read_b64_tr_b16 a[254:255], v13 offset:30208
 v_mfma_f32_16x16x32_bf16 v[212:215], a[224:227], a[132:135], v[212:215]
 v_mfma_f32_16x16x32_bf16 v[216:219], a[224:227], a[136:139], v[216:219]
 v_mfma_f32_16x16x32_bf16 v[220:223], a[224:227], a[140:143], v[220:223]
 ds_read_b64_tr_b16 a[208:209], v14
 ds_read_b64_tr_b16 a[210:211], v14 offset:2304
 v_mfma_f32_16x16x32_bf16 v[224:227], a[228:231], a[128:131], v[224:227]
 s_add_u32 m0, s34, 0
 v_mfma_f32_16x16x32_bf16 v[228:231], a[228:231], a[132:135], v[228:231]
 v_mfma_f32_16x16x32_bf16 v[232:235], a[228:231], a[136:139], v[232:235]
 v_mfma_f32_16x16x32_bf16 v[236:239], a[228:231], a[140:143], v[236:239]
 ds_read_b64_tr_b16 a[212:213], v14 offset:18432
 ds_read_b64_tr_b16 a[214:215], v14 offset:20736
 v_mfma_f32_16x16x32_bf16 v[240:243], a[232:235], a[128:131], v[240:243]
 buffer_load_dwordx4 v2, s[24:27], s44 offen lds
 v_mfma_f32_16x16x32_bf16 v[244:247], a[232:235], a[132:135], v[244:247]
 v_mfma_f32_16x16x32_bf16 v[248:251], a[232:235], a[136:139], v[248:251]
 v_mfma_f32_16x16x32_bf16 v[252:255], a[232:235], a[140:143], v[252:255]
 ds_read_b64_tr_b16 a[216:217], v14 offset:32
 s_waitcnt lgkmcnt(14)
 ds_read_b64_tr_b16 a[218:219], v14 offset:2336
 s_waitcnt lgkmcnt(4)
 v_mfma_f32_16x16x32_bf16 a[0:3], a[236:239], a[128:131], a[0:3]
 buffer_load_dwordx4 a[80:83], v11, s[8:11], s46 offen sc1
 v_mfma_f32_16x16x32_bf16 a[4:7], a[236:239], a[132:135], a[4:7]
 v_mfma_f32_16x16x32_bf16 a[8:11], a[236:239], a[136:139], a[8:11]
 v_mfma_f32_16x16x32_bf16 a[12:15], a[236:239], a[140:143], a[12:15]
 ds_read_b64_tr_b16 a[220:221], v14 offset:18464
 ds_read_b64_tr_b16 a[222:223], v14 offset:20768
 v_mfma_f32_16x16x32_bf16 a[16:19], a[240:243], a[128:131], a[16:19]
 v_mfma_f32_16x16x32_bf16 a[20:23], a[240:243], a[132:135], a[20:23]
 buffer_load_dwordx4 v3, s[24:27], s44 offen offset:1024 lds
 v_mfma_f32_16x16x32_bf16 a[24:27], a[240:243], a[136:139], a[24:27]
 v_mfma_f32_16x16x32_bf16 a[28:31], a[240:243], a[140:143], a[28:31]
 ds_read_b64_tr_b16 a[224:225], v14 offset:64
 ds_read_b64_tr_b16 a[226:227], v14 offset:2368
 v_mfma_f32_16x16x32_bf16 a[32:35], a[244:247], a[128:131], a[32:35]
 v_mfma_f32_16x16x32_bf16 a[36:39], a[244:247], a[132:135], a[36:39]
 buffer_load_dwordx4 a[84:87], v11, s[8:11], s46 offen offset:256 sc1
 v_mfma_f32_16x16x32_bf16 a[40:43], a[244:247], a[136:139], a[40:43]
 v_mfma_f32_16x16x32_bf16 a[44:47], a[244:247], a[140:143], a[44:47]
 ds_read_b64_tr_b16 a[228:229], v14 offset:18496
 ds_read_b64_tr_b16 a[230:231], v14 offset:20800
 v_mfma_f32_16x16x32_bf16 a[48:51], a[248:251], a[128:131], a[48:51]
 v_mfma_f32_16x16x32_bf16 a[52:55], a[248:251], a[132:135], a[52:55]
 buffer_load_dwordx4 v4, s[24:27], s44 offen offset:2048 lds
 v_mfma_f32_16x16x32_bf16 a[56:59], a[248:251], a[136:139], a[56:59]
 v_mfma_f32_16x16x32_bf16 a[60:63], a[248:251], a[140:143], a[60:63]
 ds_read_b64_tr_b16 a[232:233], v14 offset:96
 ds_read_b64_tr_b16 a[234:235], v14 offset:2400
 v_mfma_f32_16x16x32_bf16 a[64:67], a[252:255], a[128:131], a[64:67]
 v_mfma_f32_16x16x32_bf16 a[68:71], a[252:255], a[132:135], a[68:71]
 v_mfma_f32_16x16x32_bf16 a[72:75], a[252:255], a[136:139], a[72:75]
 buffer_load_dwordx4 a[88:91], v11, s[8:11], s47 offen sc1
 v_mfma_f32_16x16x32_bf16 a[76:79], a[252:255], a[140:143], a[76:79]
 ds_read_b64_tr_b16 a[236:237], v14 offset:18528
 ds_read_b64_tr_b16 a[238:239], v14 offset:20832
 v_mfma_f32_16x16x32_bf16 v[48:51], a[208:211], a[144:147], v[48:51]
 v_mfma_f32_16x16x32_bf16 v[52:55], a[208:211], a[148:151], v[52:55]
 v_mfma_f32_16x16x32_bf16 v[56:59], a[208:211], a[152:155], v[56:59]
 buffer_load_dwordx4 v5, s[24:27], s44 offen offset:3072 lds
 v_mfma_f32_16x16x32_bf16 v[60:63], a[208:211], a[156:159], v[60:63]
 ds_read_b64_tr_b16 a[240:241], v14 offset:128
 s_waitcnt lgkmcnt(14)
 ds_read_b64_tr_b16 a[242:243], v14 offset:2432
 s_waitcnt lgkmcnt(4)
 v_mfma_f32_16x16x32_bf16 v[64:67], a[212:215], a[144:147], v[64:67]
 v_mfma_f32_16x16x32_bf16 v[68:71], a[212:215], a[148:151], v[68:71]
 v_mfma_f32_16x16x32_bf16 v[72:75], a[212:215], a[152:155], v[72:75]
 buffer_load_dwordx4 a[92:95], v11, s[8:11], s47 offen offset:256 sc1
 v_mfma_f32_16x16x32_bf16 v[76:79], a[212:215], a[156:159], v[76:79]
 ds_read_b64_tr_b16 a[244:245], v14 offset:18560
 ds_read_b64_tr_b16 a[246:247], v14 offset:20864
 v_mfma_f32_16x16x32_bf16 v[80:83], a[216:219], a[144:147], v[80:83]
 v_mfma_f32_16x16x32_bf16 v[84:87], a[216:219], a[148:151], v[84:87]
 v_mfma_f32_16x16x32_bf16 v[88:91], a[216:219], a[152:155], v[88:91]
 v_mfma_f32_16x16x32_bf16 v[92:95], a[216:219], a[156:159], v[92:95]
 s_add_u32 m0, s34, 0x1000
 ds_read_b64_tr_b16 a[248:249], v14 offset:160
 v_mfma_f32_16x16x32_bf16 v[96:99], a[220:223], a[144:147], v[96:99]
 ds_read_b64_tr_b16 a[250:251], v14 offset:2464
 v_mfma_f32_16x16x32_bf16 v[100:103], a[220:223], a[148:151], v[100:103]
 v_mfma_f32_16x16x32_bf16 v[104:107], a[220:223], a[152:155], v[104:107]
 v_mfma_f32_16x16x32_bf16 v[108:111], a[220:223], a[156:159], v[108:111]
 buffer_load_dwordx4 v6, s[24:27], s44 offen lds
 v_mfma_f32_16x16x32_bf16 v[112:115], a[224:227], a[144:147], v[112:115]
 ds_read_b64_tr_b16 a[252:253], v14 offset:18592
 ds_read_b64_tr_b16 a[254:255], v14 offset:20896
 v_mfma_f32_16x16x32_bf16 v[116:119], a[224:227], a[148:151], v[116:119]
 v_mfma_f32_16x16x32_bf16 v[120:123], a[224:227], a[152:155], v[120:123]
 v_mfma_f32_16x16x32_bf16 v[124:127], a[224:227], a[156:159], v[124:127]
 buffer_load_dwordx4 a[96:99], v11, s[8:11], s46 offen offset:2048 sc1
 v_mfma_f32_16x16x32_bf16 v[128:131], a[228:231], a[144:147], v[128:131]
 ds_read_b64_tr_b16 a[208:209], v14 offset:192
 ds_read_b64_tr_b16 a[210:211], v14 offset:2496
 v_mfma_f32_16x16x32_bf16 v[132:135], a[228:231], a[148:151], v[132:135]
 v_mfma_f32_16x16x32_bf16 v[136:139], a[228:231], a[152:155], v[136:139]
 v_mfma_f32_16x16x32_bf16 v[140:143], a[228:231], a[156:159], v[140:143]
 ds_read_b64_tr_b16 a[212:213], v14 offset:18624
 ds_read_b64_tr_b16 a[214:215], v14 offset:20928
 v_mfma_f32_16x16x32_bf16 v[144:147], a[232:235], a[144:147], v[144:147]
 buffer_load_dwordx4 v7, s[24:27], s44 offen offset:1024 lds
 v_mfma_f32_16x16x32_bf16 v[148:151], a[232:235], a[148:151], v[148:151]
 v_mfma_f32_16x16x32_bf16 v[152:155], a[232:235], a[152:155], v[152:155]
 v_mfma_f32_16x16x32_bf16 v[156:159], a[232:235], a[156:159], v[156:159]
 ds_read_b64_tr_b16 a[216:217], v14 offset:224
 s_waitcnt lgkmcnt(14)
 ds_read_b64_tr_b16 a[218:219], v14 offset:2528
 s_waitcnt lgkmcnt(4)
 v_mfma_f32_16x16x32_bf16 v[160:163], a[236:239], a[144:147], v[160:163]
 buffer_load_dwordx4 a[100:103], v11, s[8:11], s46 offen offset:2304 sc1
 v_mfma_f32_16x16x32_bf16 v[164:167], a[236:239], a[148:151], v[164:167]
 v_mfma_f32_16x16x32_bf16 v[168:171], a[236:239], a[152:155], v[168:171]
 v_mfma_f32_16x16x32_bf16 v[172:175], a[236:239], a[156:159], v[172:175]
 ds_read_b64_tr_b16 a[220:221], v14 offset:18656
 ds_read_b64_tr_b16 a[222:223], v14 offset:20960
 v_mfma_f32_16x16x32_bf16 v[176:179], a[240:243], a[144:147], v[176:179]
 buffer_load_dwordx4 v8, s[24:27], s44 offen offset:2048 lds
 v_mfma_f32_16x16x32_bf16 v[180:183], a[240:243], a[148:151], v[180:183]
 v_mfma_f32_16x16x32_bf16 v[184:187], a[240:243], a[152:155], v[184:187]
 v_mfma_f32_16x16x32_bf16 v[188:191], a[240:243], a[156:159], v[188:191]
 ds_read_b64_tr_b16 a[224:225], v14 offset:256
 ds_read_b64_tr_b16 a[226:227], v14 offset:2560
 v_mfma_f32_16x16x32_bf16 v[192:195], a[244:247], a[144:147], v[192:195]
 v_mfma_f32_16x16x32_bf16 v[196:199], a[244:247], a[148:151], v[196:199]
 buffer_load_dwordx4 a[104:107], v11, s[8:11], s47 offen offset:2048 sc1
 v_mfma_f32_16x16x32_bf16 v[200:203], a[244:247], a[152:155], v[200:203]
 v_mfma_f32_16x16x32_bf16 v[204:207], a[244:247], a[156:159], v[204:207]
 ds_read_b64_tr_b16 a[228:229], v14 offset:18688
 ds_read_b64_tr_b16 a[230:231], v14 offset:20992
 v_mfma_f32_16x16x32_bf16 v[208:211], a[248:251], a[144:147], v[208:211]
 v_mfma_f32_16x16x32_bf16 v[212:215], a[248:251], a[148:151], v[212:215]
 buffer_load_dwordx4 v9, s[24:27], s44 offen offset:3072 lds
 v_mfma_f32_16x16x32_bf16 v[216:219], a[248:251], a[152:155], v[216:219]
 v_mfma_f32_16x16x32_bf16 v[220:223], a[248:251], a[156:159], v[220:223]
 ds_read_b64_tr_b16 a[232:233], v14 offset:9216
 ds_read_b64_tr_b16 a[234:235], v14 offset:11520
 v_mfma_f32_16x16x32_bf16 v[224:227], a[252:255], a[144:147], v[224:227]
 v_mfma_f32_16x16x32_bf16 v[228:231], a[252:255], a[148:151], v[228:231]
 buffer_load_dwordx4 a[108:111], v11, s[8:11], s47 offen offset:2304 sc1
 v_mfma_f32_16x16x32_bf16 v[232:235], a[252:255], a[152:155], v[232:235]
 v_mfma_f32_16x16x32_bf16 v[236:239], a[252:255], a[156:159], v[236:239]
 ds_read_b64_tr_b16 a[236:237], v14 offset:27648
 ds_read_b64_tr_b16 a[238:239], v14 offset:29952
 v_mfma_f32_16x16x32_bf16 v[240:243], a[208:211], a[144:147], v[240:243]
 v_mfma_f32_16x16x32_bf16 v[244:247], a[208:211], a[148:151], v[244:247]
 v_mfma_f32_16x16x32_bf16 v[248:251], a[208:211], a[152:155], v[248:251]
 s_add_u32 m0, s34, 0x2000
 v_mfma_f32_16x16x32_bf16 v[252:255], a[208:211], a[156:159], v[252:255]
 ds_read_b64_tr_b16 a[240:241], v14 offset:9248
 s_waitcnt lgkmcnt(14)
 ds_read_b64_tr_b16 a[242:243], v14 offset:11552
 s_waitcnt lgkmcnt(4)
 v_mfma_f32_16x16x32_bf16 a[0:3], a[212:215], a[144:147], a[0:3]
 v_mfma_f32_16x16x32_bf16 a[4:7], a[212:215], a[148:151], a[4:7]
 v_mfma_f32_16x16x32_bf16 a[8:11], a[212:215], a[152:155], a[8:11]
 buffer_load_dwordx4 v10, s[24:27], s44 offen lds
 v_mfma_f32_16x16x32_bf16 a[12:15], a[212:215], a[156:159], a[12:15]
 ds_read_b64_tr_b16 a[244:245], v14 offset:27680
 ds_read_b64_tr_b16 a[246:247], v14 offset:29984
 v_mfma_f32_16x16x32_bf16 a[16:19], a[216:219], a[144:147], a[16:19]
 v_mfma_f32_16x16x32_bf16 a[20:23], a[216:219], a[148:151], a[20:23]
 v_mfma_f32_16x16x32_bf16 a[24:27], a[216:219], a[152:155], a[24:27]
 v_mfma_f32_16x16x32_bf16 a[28:31], a[216:219], a[156:159], a[28:31]
 ds_read_b64_tr_b16 a[248:249], v14 offset:9280
 ds_read_b64_tr_b16 a[250:251], v14 offset:11584
 v_mfma_f32_16x16x32_bf16 a[32:35], a[220:223], a[144:147], a[32:35]
 v_mfma_f32_16x16x32_bf16 a[36:39], a[220:223], a[148:151], a[36:39]
 v_mfma_f32_16x16x32_bf16 a[40:43], a[220:223], a[152:155], a[40:43]
 v_mfma_f32_16x16x32_bf16 a[44:47], a[220:223], a[156:159], a[44:47]
 ds_read_b64_tr_b16 a[252:253], v14 offset:27712
 ds_read_b64_tr_b16 a[254:255], v14 offset:30016
 v_mfma_f32_16x16x32_bf16 a[48:51], a[224:227], a[144:147], a[48:51]
 v_mfma_f32_16x16x32_bf16 a[52:55], a[224:227], a[148:151], a[52:55]
 v_mfma_f32_16x16x32_bf16 a[56:59], a[224:227], a[152:155], a[56:59]
 v_mfma_f32_16x16x32_bf16 a[60:63], a[224:227], a[156:159], a[60:63]
 ds_read_b64_tr_b16 a[208:209], v14 offset:9312
 ds_read_b64_tr_b16 a[210:211], v14 offset:11616
 v_mfma_f32_16x16x32_bf16 a[64:67], a[228:231], a[144:147], a[64:67]
 v_mfma_f32_16x16x32_bf16 a[68:71], a[228:231], a[148:151], a[68:71]
 v_mfma_f32_16x16x32_bf16 a[72:75], a[228:231], a[152:155], a[72:75]
 v_mfma_f32_16x16x32_bf16 a[76:79], a[228:231], a[156:159], a[76:79]
 ds_read_b64_tr_b16 a[212:213], v14 offset:27744
 ds_read_b64_tr_b16 a[214:215], v14 offset:30048
 v_mfma_f32_16x16x32_bf16 v[48:51], a[232:235], a[160:163], v[48:51]
 v_mfma_f32_16x16x32_bf16 v[52:55], a[232:235], a[164:167], v[52:55]
 v_mfma_f32_16x16x32_bf16 v[56:59], a[232:235], a[168:171], v[56:59]
 v_mfma_f32_16x16x32_bf16 v[60:63], a[232:235], a[172:175], v[60:63]
 ds_read_b64_tr_b16 a[216:217], v14 offset:9344
 s_waitcnt lgkmcnt(14)
 ds_read_b64_tr_b16 a[218:219], v14 offset:11648
 s_waitcnt lgkmcnt(4)
 v_mfma_f32_16x16x32_bf16 v[64:67], a[236:239], a[160:163], v[64:67]
 v_mfma_f32_16x16x32_bf16 v[68:71], a[236:239], a[164:167], v[68:71]
 v_mfma_f32_16x16x32_bf16 v[72:75], a[236:239], a[168:171], v[72:75]
 v_mfma_f32_16x16x32_bf16 v[76:79], a[236:239], a[172:175], v[76:79]
 ds_read_b64_tr_b16 a[220:221], v14 offset:27776
 ds_read_b64_tr_b16 a[222:223], v14 offset:30080
 v_mfma_f32_16x16x32_bf16 v[80:83], a[240:243], a[160:163], v[80:83]
 v_mfma_f32_16x16x32_bf16 v[84:87], a[240:243], a[164:167], v[84:87]
 v_mfma_f32_16x16x32_bf16 v[88:91], a[240:243], a[168:171], v[88:91]
 v_mfma_f32_16x16x32_bf16 v[92:95], a[240:243], a[172:175], v[92:95]
 ds_read_b64_tr_b16 a[224:225], v14 offset:9376
 ds_read_b64_tr_b16 a[226:227], v14 offset:11680
 v_mfma_f32_16x16x32_bf16 v[96:99], a[244:247], a[160:163], v[96:99]
 v_mfma_f32_16x16x32_bf16 v[100:103], a[244:247], a[164:167], v[100:103]
 v_mfma_f32_16x16x32_bf16 v[104:107], a[244:247], a[168:171], v[104:107]
 v_mfma_f32_16x16x32_bf16 v[108:111], a[244:247], a[172:175], v[108:111]
 ds_read_b64_tr_b16 a[228:229], v14 offset:27808
 ds_read_b64_tr_b16 a[230:231], v14 offset:30112
 v_mfma_f32_16x16x32_bf16 v[112:115], a[248:251], a[160:163], v[112:115]
 v_mfma_f32_16x16x32_bf16 v[116:119], a[248:251], a[164:167], v[116:119]
 v_mfma_f32_16x16x32_bf16 v[120:123], a[248:251], a[168:171], v[120:123]
 v_mfma_f32_16x16x32_bf16 v[124:127], a[248:251], a[172:175], v[124:127]
 ds_read_b64_tr_b16 a[232:233], v14 offset:9408
 ds_read_b64_tr_b16 a[234:235], v14 offset:11712
 v_mfma_f32_16x16x32_bf16 v[128:131], a[252:255], a[160:163], v[128:131]
 v_mfma_f32_16x16x32_bf16 v[132:135], a[252:255], a[164:167], v[132:135]
 v_mfma_f32_16x16x32_bf16 v[136:139], a[252:255], a[168:171], v[136:139]
 v_mfma_f32_16x16x32_bf16 v[140:143], a[252:255], a[172:175], v[140:143]
 ds_read_b64_tr_b16 a[236:237], v14 offset:27840
 ds_read_b64_tr_b16 a[238:239], v14 offset:30144
 v_mfma_f32_16x16x32_bf16 v[144:147], a[208:211], a[160:163], v[144:147]
 v_mfma_f32_16x16x32_bf16 v[148:151], a[208:211], a[164:167], v[148:151]
 v_mfma_f32_16x16x32_bf16 v[152:155], a[208:211], a[168:171], v[152:155]
 v_mfma_f32_16x16x32_bf16 v[156:159], a[208:211], a[172:175], v[156:159]
 ds_read_b64_tr_b16 a[240:241], v14 offset:9440
 s_waitcnt lgkmcnt(14)
 ds_read_b64_tr_b16 a[242:243], v14 offset:11744
 s_waitcnt lgkmcnt(4)
 v_mfma_f32_16x16x32_bf16 v[160:163], a[212:215], a[160:163], v[160:163]
 v_mfma_f32_16x16x32_bf16 v[164:167], a[212:215], a[164:167], v[164:167]
 v_mfma_f32_16x16x32_bf16 v[168:171], a[212:215], a[168:171], v[168:171]
 v_mfma_f32_16x16x32_bf16 v[172:175], a[212:215], a[172:175], v[172:175]
 s_waitcnt vmcnt(17)
 s_barrier
 v_mfma_f32_16x16x32_bf16 v[176:179], a[216:219], a[160:163], v[176:179]
 ds_read_b64_tr_b16 a[244:245], v14 offset:27872
 ds_read_b64_tr_b16 a[246:247], v14 offset:30176
 v_mfma_f32_16x16x32_bf16 v[180:183], a[216:219], a[164:167], v[180:183]
 v_mfma_f32_16x16x32_bf16 v[184:187], a[216:219], a[168:171], v[184:187]
 v_mfma_f32_16x16x32_bf16 v[188:191], a[216:219], a[172:175], v[188:191]
 ds_read_b64_tr_b16 a[248:249], v14 offset:9472
 ds_read_b64_tr_b16 a[250:251], v14 offset:11776
 v_mfma_f32_16x16x32_bf16 v[192:195], a[220:223], a[160:163], v[192:195]
 v_mfma_f32_16x16x32_bf16 v[196:199], a[220:223], a[164:167], v[196:199]
 s_waitcnt vmcnt(0)
 s_barrier
 v_mfma_f32_16x16x32_bf16 v[200:203], a[220:223], a[168:171], v[200:203]
 v_mfma_f32_16x16x32_bf16 v[204:207], a[220:223], a[172:175], v[204:207]
 ds_read_b64_tr_b16 a[252:253], v14 offset:27904
 ds_read_b64_tr_b16 a[254:255], v14 offset:30208
 v_mfma_f32_16x16x32_bf16 v[208:211], a[224:227], a[160:163], v[208:211]
 v_mfma_f32_16x16x32_bf16 v[212:215], a[224:227], a[164:167], v[212:215]
 s_lshl_b32 s88, s28, 3
 s_lshr_b32 s88, 0x8070302, s88
 v_mfma_f32_16x16x32_bf16 v[216:219], a[224:227], a[168:171], v[216:219]
 s_and_b32 s88, s88, 0xff
 s_lshr_b32 s89, s29, 2
 v_mfma_f32_16x16x32_bf16 v[220:223], a[224:227], a[172:175], v[220:223]
 s_mul_i32 s89, s89, 18
 s_add_u32 s88, s88, s89
 v_mfma_f32_16x16x32_bf16 v[224:227], a[228:231], a[160:163], v[224:227]
 s_mul_i32 s88, s88, 0x9000
 s_and_b32 s89, s29, 3
 v_mfma_f32_16x16x32_bf16 v[228:231], a[228:231], a[164:167], v[228:231]
 s_mul_i32 s89, s89, 0x120
 s_add_u32 s88, s88, s89
 v_mfma_f32_16x16x32_bf16 v[232:235], a[228:231], a[168:171], v[232:235]
 ds_read_b64_tr_b16 a[208:209], v15 offset:256
 ds_read_b64_tr_b16 a[210:211], v15 offset:2560
 v_mfma_f32_16x16x32_bf16 v[236:239], a[228:231], a[172:175], v[236:239]
 ds_read_b64_tr_b16 a[212:213], v15 offset:18688
 ds_read_b64_tr_b16 a[214:215], v15 offset:20992
 v_mfma_f32_16x16x32_bf16 v[240:243], a[232:235], a[160:163], v[240:243]
 v_mfma_f32_16x16x32_bf16 v[244:247], a[232:235], a[164:167], v[244:247]
 s_add_u32 m0, s34, 0x9000
 s_nop 0
 buffer_load_dwordx4 v19, s[84:87], s88 offen lds
 v_mfma_f32_16x16x32_bf16 v[248:251], a[232:235], a[168:171], v[248:251]
 v_mfma_f32_16x16x32_bf16 v[252:255], a[232:235], a[172:175], v[252:255]
 ds_read_b64_tr_b16 a[216:217], v15 offset:9472
 s_waitcnt lgkmcnt(14)
 ds_read_b64_tr_b16 a[218:219], v15 offset:11776
 s_waitcnt lgkmcnt(6)
 v_mfma_f32_16x16x32_bf16 a[0:3], a[236:239], a[160:163], a[0:3]
 v_mfma_f32_16x16x32_bf16 a[4:7], a[236:239], a[164:167], a[4:7]
 s_add_u32 m0, s34, 0x9000
 s_nop 0
 buffer_load_dwordx4 v20, s[84:87], s88 offen offset:1024 lds
 v_mfma_f32_16x16x32_bf16 a[8:11], a[236:239], a[168:171], a[8:11]
 v_mfma_f32_16x16x32_bf16 a[12:15], a[236:239], a[172:175], a[12:15]
 ds_read_b64_tr_b16 a[220:221], v15 offset:27904
 ds_read_b64_tr_b16 a[222:223], v15 offset:30208
 v_mfma_f32_16x16x32_bf16 a[16:19], a[240:243], a[160:163], a[16:19]
 v_mfma_f32_16x16x32_bf16 a[20:23], a[240:243], a[164:167], a[20:23]
 s_add_u32 m0, s34, 0x9000
 s_nop 0
 buffer_load_dwordx4 v21, s[84:87], s88 offen offset:2048 lds
 v_mfma_f32_16x16x32_bf16 a[24:27], a[240:243], a[168:171], a[24:27]
 v_mfma_f32_16x16x32_bf16 a[28:31], a[240:243], a[172:175], a[28:31]
 ds_read_b64_tr_b16 a[224:225], v12 offset:256
 ds_read_b64_tr_b16 a[226:227], v12 offset:2560
 v_mfma_f32_16x16x32_bf16 a[32:35], a[244:247], a[160:163], a[32:35]
 v_mfma_f32_16x16x32_bf16 a[36:39], a[244:247], a[164:167], a[36:39]
 s_add_u32 m0, s34, 0x9000
 s_nop 0
 buffer_load_dwordx4 v22, s[84:87], s88 offen offset:3072 lds
 v_mfma_f32_16x16x32_bf16 a[40:43], a[244:247], a[168:171], a[40:43]
 v_mfma_f32_16x16x32_bf16 a[44:47], a[244:247], a[172:175], a[44:47]
 ds_read_b64_tr_b16 a[228:229], v12 offset:18688
 ds_read_b64_tr_b16 a[230:231], v12 offset:20992
 v_mfma_f32_16x16x32_bf16 a[48:51], a[248:251], a[160:163], a[48:51]
 v_mfma_f32_16x16x32_bf16 a[52:55], a[248:251], a[164:167], a[52:55]
 s_add_u32 m0, s34, 0xa000
 s_nop 0
 buffer_load_dwordx4 v23, s[84:87], s88 offen lds
 v_mfma_f32_16x16x32_bf16 a[56:59], a[248:251], a[168:171], a[56:59]
 v_mfma_f32_16x16x32_bf16 a[60:63], a[248:251], a[172:175], a[60:63]
 ds_read_b64_tr_b16 a[232:233], v12 offset:9472
 ds_read_b64_tr_b16 a[234:235], v12 offset:11776
 v_mfma_f32_16x16x32_bf16 a[64:67], a[252:255], a[160:163], a[64:67]
 v_mfma_f32_16x16x32_bf16 a[68:71], a[252:255], a[164:167], a[68:71]
 s_add_u32 m0, s34, 0xa000
 s_nop 0
 buffer_load_dwordx4 v24, s[84:87], s88 offen offset:1024 lds
 v_mfma_f32_16x16x32_bf16 a[72:75], a[252:255], a[168:171], a[72:75]
 v_mfma_f32_16x16x32_bf16 a[76:79], a[252:255], a[172:175], a[76:79]
 ds_read_b64_tr_b16 a[236:237], v12 offset:27904
 s_waitcnt lgkmcnt(14)
 ds_read_b64_tr_b16 a[238:239], v12 offset:30208
 s_waitcnt lgkmcnt(4)
 v_mfma_f32_16x16x32_bf16 a[48:51], a[208:211], a[176:179], a[48:51]
 v_mfma_f32_16x16x32_bf16 a[52:55], a[208:211], a[180:183], a[52:55]
 s_add_u32 m0, s34, 0xa000
 s_nop 0
 buffer_load_dwordx4 v25, s[84:87], s88 offen offset:2048 lds
 v_mfma_f32_16x16x32_bf16 a[56:59], a[208:211], a[184:187], a[56:59]
 v_mfma_f32_16x16x32_bf16 a[60:63], a[208:211], a[188:191], a[60:63]
 ds_read_b64_tr_b16 a[240:241], v15 offset:224
 ds_read_b64_tr_b16 a[242:243], v15 offset:2528
 v_mfma_f32_16x16x32_bf16 a[64:67], a[212:215], a[176:179], a[64:67]
 v_mfma_f32_16x16x32_bf16 a[68:71], a[212:215], a[180:183], a[68:71]
 s_add_u32 m0, s34, 0xa000
 s_nop 0
 buffer_load_dwordx4 v26, s[84:87], s88 offen offset:3072 lds
 v_mfma_f32_16x16x32_bf16 a[72:75], a[212:215], a[184:187], a[72:75]
 v_mfma_f32_16x16x32_bf16 a[76:79], a[212:215], a[188:191], a[76:79]
 ds_read_b64_tr_b16 a[244:245], v15 offset:18656
 ds_read_b64_tr_b16 a[246:247], v15 offset:20960
 v_mfma_f32_16x16x32_bf16 a[48:51], a[216:219], a[192:195], a[48:51]
 v_mfma_f32_16x16x32_bf16 a[52:55], a[216:219], a[196:199], a[52:55]
 s_add_u32 m0, s34, 0xb000
 s_nop 0
 buffer_load_dwordx4 v27, s[84:87], s88 offen lds
 v_mfma_f32_16x16x32_bf16 a[56:59], a[216:219], a[200:203], a[56:59]
 v_mfma_f32_16x16x32_bf16 a[60:63], a[216:219], a[204:207], a[60:63]
 s_barrier
 ds_read_b64_tr_b16 a[248:249], v15 offset:9440
 v_mfma_f32_16x16x32_bf16 a[64:67], a[220:223], a[192:195], a[64:67]
 ds_read_b64_tr_b16 a[250:251], v15 offset:11744
 v_mfma_f32_16x16x32_bf16 a[68:71], a[220:223], a[196:199], a[68:71]
 s_lshl_b32 s88, s28, 3
 s_lshr_b32 s88, 0x11100c0b, s88
 v_mfma_f32_16x16x32_bf16 a[72:75], a[220:223], a[200:203], a[72:75]
 s_and_b32 s88, s88, 0xff
 s_lshr_b32 s89, s29, 2
 v_mfma_f32_16x16x32_bf16 a[76:79], a[220:223], a[204:207], a[76:79]
 s_mul_i32 s89, s89, 18
 s_add_u32 s88, s88, s89
 v_mfma_f32_16x16x32_bf16 a[48:51], a[224:227], a[80:83], a[48:51]
 s_mul_i32 s88, s88, 0x9000
 s_and_b32 s89, s29, 3
 v_mfma_f32_16x16x32_bf16 a[52:55], a[224:227], a[84:87], a[52:55]
 s_mul_i32 s89, s89, 0x120
 s_add_u32 s88, s88, s89
 v_mfma_f32_16x16x32_bf16 a[56:59], a[224:227], a[88:91], a[56:59]
 ds_read_b64_tr_b16 a[252:253], v15 offset:27872
 ds_read_b64_tr_b16 a[254:255], v15 offset:30176
 v_mfma_f32_16x16x32_bf16 a[60:63], a[224:227], a[92:95], a[60:63]
 ds_read_b64_tr_b16 a[208:209], v12 offset:224
 ds_read_b64_tr_b16 a[210:211], v12 offset:2528
 v_mfma_f32_16x16x32_bf16 a[64:67], a[228:231], a[80:83], a[64:67]
 v_mfma_f32_16x16x32_bf16 a[68:71], a[228:231], a[84:87], a[68:71]
 s_add_u32 m0, s34, 0x12000
 s_nop 0
 buffer_load_dwordx4 v19, s[84:87], s88 offen lds
 v_mfma_f32_16x16x32_bf16 a[72:75], a[228:231], a[88:91], a[72:75]
 v_mfma_f32_16x16x32_bf16 a[76:79], a[228:231], a[92:95], a[76:79]
 ds_read_b64_tr_b16 a[212:213], v12 offset:18656
 s_waitcnt lgkmcnt(14)
 ds_read_b64_tr_b16 a[214:215], v12 offset:20960
 s_waitcnt lgkmcnt(6)
 v_mfma_f32_16x16x32_bf16 a[48:51], a[232:235], a[96:99], a[48:51]
 v_mfma_f32_16x16x32_bf16 a[52:55], a[232:235], a[100:103], a[52:55]
 v_mfma_f32_16x16x32_bf16 a[56:59], a[232:235], a[104:107], a[56:59]
 v_mfma_f32_16x16x32_bf16 a[60:63], a[232:235], a[108:111], a[60:63]
 ds_read_b64_tr_b16 a[216:217], v12 offset:9440
 ds_read_b64_tr_b16 a[218:219], v12 offset:11744
 v_mfma_f32_16x16x32_bf16 a[64:67], a[236:239], a[96:99], a[64:67]
 v_mfma_f32_16x16x32_bf16 a[68:71], a[236:239], a[100:103], a[68:71]
 v_mfma_f32_16x16x32_bf16 a[72:75], a[236:239], a[104:107], a[72:75]
 v_mfma_f32_16x16x32_bf16 a[76:79], a[236:239], a[108:111], a[76:79]
 ds_read_b64_tr_b16 a[220:221], v12 offset:27872
 ds_read_b64_tr_b16 a[222:223], v12 offset:30176
 v_mfma_f32_16x16x32_bf16 a[16:19], a[240:243], a[176:179], a[16:19]
 v_mfma_f32_16x16x32_bf16 a[20:23], a[240:243], a[180:183], a[20:23]
 s_add_u32 m0, s34, 0x12000
 s_nop 0
 buffer_load_dwordx4 v20, s[84:87], s88 offen offset:1024 lds
 v_mfma_f32_16x16x32_bf16 a[24:27], a[240:243], a[184:187], a[24:27]
 v_accvgpr_read_b32 v38, a48
 v_accvgpr_read_b32 v39, a49
 v_mfma_f32_16x16x32_bf16 a[28:31], a[240:243], a[188:191], a[28:31]
 ds_read_b64_tr_b16 a[224:225], v15 offset:192
 ds_read_b64_tr_b16 a[226:227], v15 offset:2496
 v_mfma_f32_16x16x32_bf16 a[32:35], a[244:247], a[176:179], a[32:35]
 v_accvgpr_read_b32 v40, a50
 v_accvgpr_read_b32 v41, a51
 v_mfma_f32_16x16x32_bf16 a[36:39], a[244:247], a[180:183], a[36:39]
 v_exp_f32 v30, v38
 v_mfma_f32_16x16x32_bf16 a[40:43], a[244:247], a[184:187], a[40:43]
 v_exp_f32 v31, v39
 v_mfma_f32_16x16x32_bf16 a[44:47], a[244:247], a[188:191], a[44:47]
 ds_read_b64_tr_b16 a[228:229], v15 offset:18624
 ds_read_b64_tr_b16 a[230:231], v15 offset:20928
 v_mfma_f32_16x16x32_bf16 a[16:19], a[248:251], a[192:195], a[16:19]
 v_exp_f32 v32, v40
 v_mfma_f32_16x16x32_bf16 a[20:23], a[248:251], a[196:199], a[20:23]
 v_exp_f32 v33, v41
 v_mfma_f32_16x16x32_bf16 a[24:27], a[248:251], a[200:203], a[24:27]
 v_accvgpr_read_b32 v46, a64
 v_mul_f32 v38, v38, v46
 v_mfma_f32_16x16x32_bf16 a[28:31], a[248:251], a[204:207], a[28:31]
 ds_read_b64_tr_b16 a[232:233], v15 offset:9408
 s_waitcnt lgkmcnt(14)
 ds_read_b64_tr_b16 a[234:235], v15 offset:11712
 s_waitcnt lgkmcnt(4)
 v_mfma_f32_16x16x32_bf16 a[32:35], a[252:255], a[192:195], a[32:35]
 v_accvgpr_read_b32 v47, a65
 v_mul_f32 v39, v39, v47
 v_mfma_f32_16x16x32_bf16 a[36:39], a[252:255], a[196:199], a[36:39]
 s_add_u32 m0, s34, 0x12000
 s_nop 0
 buffer_load_dwordx4 v21, s[84:87], s88 offen offset:2048 lds
 v_mfma_f32_16x16x32_bf16 a[40:43], a[252:255], a[200:203], a[40:43]
 v_accvgpr_read_b32 v46, a66
 v_mul_f32 v40, v40, v46
 v_mfma_f32_16x16x32_bf16 a[44:47], a[252:255], a[204:207], a[44:47]
 ds_read_b64_tr_b16 a[236:237], v15 offset:27840
 ds_read_b64_tr_b16 a[238:239], v15 offset:30144
 v_mfma_f32_16x16x32_bf16 a[16:19], a[208:211], a[80:83], a[16:19]
 v_accvgpr_read_b32 v47, a67
 v_mul_f32 v41, v41, v47
 v_mfma_f32_16x16x32_bf16 a[20:23], a[208:211], a[84:87], a[20:23]
 v_fma_f32 v30, v30, s93, s93
 v_fma_f32 v31, v31, s93, s93
 v_mfma_f32_16x16x32_bf16 a[24:27], a[208:211], a[88:91], a[24:27]
 v_fma_f32 v32, v32, s93, s93
 v_fma_f32 v33, v33, s93, s93
 v_mfma_f32_16x16x32_bf16 a[28:31], a[208:211], a[92:95], a[28:31]
 ds_read_b64_tr_b16 a[240:241], v12 offset:192
 ds_read_b64_tr_b16 a[242:243], v12 offset:2496
 v_mfma_f32_16x16x32_bf16 a[32:35], a[212:215], a[80:83], a[32:35]
 v_rcp_f32 v30, v30
 v_mfma_f32_16x16x32_bf16 a[36:39], a[212:215], a[84:87], a[36:39]
 v_rcp_f32 v31, v31
 v_mfma_f32_16x16x32_bf16 a[40:43], a[212:215], a[88:91], a[40:43]
 v_rcp_f32 v32, v32
 v_mfma_f32_16x16x32_bf16 a[44:47], a[212:215], a[92:95], a[44:47]
 ds_read_b64_tr_b16 a[244:245], v12 offset:18624
 ds_read_b64_tr_b16 a[246:247], v12 offset:20928
 v_mfma_f32_16x16x32_bf16 a[16:19], a[216:219], a[96:99], a[16:19]
 v_rcp_f32 v33, v33
 v_mfma_f32_16x16x32_bf16 a[20:23], a[216:219], a[100:103], a[20:23]
 s_add_u32 m0, s34, 0x12000
 s_nop 0
 buffer_load_dwordx4 v22, s[84:87], s88 offen offset:3072 lds
 v_mfma_f32_16x16x32_bf16 a[24:27], a[216:219], a[104:107], a[24:27]
 v_mul_f32 v38, v38, v30
 v_mul_f32 v39, v39, v31
 v_mfma_f32_16x16x32_bf16 a[28:31], a[216:219], a[108:111], a[28:31]
 ds_read_b64_tr_b16 a[248:249], v12 offset:9408
 ds_read_b64_tr_b16 a[250:251], v12 offset:11712
 v_mfma_f32_16x16x32_bf16 a[32:35], a[220:223], a[96:99], a[32:35]
 v_mul_f32 v40, v40, v32
 v_mul_f32 v41, v41, v33
 v_mfma_f32_16x16x32_bf16 a[36:39], a[220:223], a[100:103], a[36:39]
 v_accvgpr_read_b32 v42, a52
 v_accvgpr_read_b32 v43, a53
 v_mfma_f32_16x16x32_bf16 a[40:43], a[220:223], a[104:107], a[40:43]
 v_accvgpr_read_b32 v44, a54
 v_accvgpr_read_b32 v45, a55
 v_mfma_f32_16x16x32_bf16 a[44:47], a[220:223], a[108:111], a[44:47]
 ds_read_b64_tr_b16 a[252:253], v12 offset:27840
 ds_read_b64_tr_b16 a[254:255], v12 offset:30144
 v_mfma_f32_16x16x32_bf16 v[240:243], a[224:227], a[176:179], v[240:243]
 v_exp_f32 v34, v42
 v_mfma_f32_16x16x32_bf16 v[244:247], a[224:227], a[180:183], v[244:247]
 v_exp_f32 v35, v43
 v_mfma_f32_16x16x32_bf16 v[248:251], a[224:227], a[184:187], v[248:251]
 v_exp_f32 v36, v44
 v_mfma_f32_16x16x32_bf16 v[252:255], a[224:227], a[188:191], v[252:255]
 ds_read_b64_tr_b16 a[208:209], v15 offset:160
 s_waitcnt lgkmcnt(14)
 ds_read_b64_tr_b16 a[210:211], v15 offset:2464
 s_waitcnt lgkmcnt(4)
 v_mfma_f32_16x16x32_bf16 a[0:3], a[228:231], a[176:179], a[0:3]
 v_exp_f32 v37, v45
 v_mfma_f32_16x16x32_bf16 a[4:7], a[228:231], a[180:183], a[4:7]
 s_add_u32 m0, s34, 0x13000
 s_nop 0
 buffer_load_dwordx4 v23, s[84:87], s88 offen lds
 v_mfma_f32_16x16x32_bf16 a[8:11], a[228:231], a[184:187], a[8:11]
 v_accvgpr_read_b32 v46, a68
 v_mul_f32 v42, v42, v46
 v_mfma_f32_16x16x32_bf16 a[12:15], a[228:231], a[188:191], a[12:15]
 ds_read_b64_tr_b16 a[212:213], v15 offset:18592
 ds_read_b64_tr_b16 a[214:215], v15 offset:20896
 v_mfma_f32_16x16x32_bf16 v[240:243], a[232:235], a[192:195], v[240:243]
 v_accvgpr_read_b32 v47, a69
 v_mul_f32 v43, v43, v47
 v_mfma_f32_16x16x32_bf16 v[244:247], a[232:235], a[196:199], v[244:247]
 v_accvgpr_read_b32 v46, a70
 v_mul_f32 v44, v44, v46
 v_mfma_f32_16x16x32_bf16 v[248:251], a[232:235], a[200:203], v[248:251]
 v_accvgpr_read_b32 v47, a71
 v_mul_f32 v45, v45, v47
 v_mfma_f32_16x16x32_bf16 v[252:255], a[232:235], a[204:207], v[252:255]
 ds_read_b64_tr_b16 a[216:217], v15 offset:9376
 ds_read_b64_tr_b16 a[218:219], v15 offset:11680
 v_mfma_f32_16x16x32_bf16 a[0:3], a[236:239], a[192:195], a[0:3]
 v_fma_f32 v34, v34, s93, s93
 v_fma_f32 v35, v35, s93, s93
 v_mfma_f32_16x16x32_bf16 a[4:7], a[236:239], a[196:199], a[4:7]
 v_fma_f32 v36, v36, s93, s93
 v_fma_f32 v37, v37, s93, s93
 v_mfma_f32_16x16x32_bf16 a[8:11], a[236:239], a[200:203], a[8:11]
 v_rcp_f32 v34, v34
 v_mfma_f32_16x16x32_bf16 a[12:15], a[236:239], a[204:207], a[12:15]
 ds_read_b64_tr_b16 a[220:221], v15 offset:27808
 ds_read_b64_tr_b16 a[222:223], v15 offset:30112
 v_mfma_f32_16x16x32_bf16 v[240:243], a[240:243], a[80:83], v[240:243]
 v_rcp_f32 v35, v35
 v_mfma_f32_16x16x32_bf16 v[244:247], a[240:243], a[84:87], v[244:247]
 s_add_u32 m0, s34, 0x13000
 s_nop 0
 buffer_load_dwordx4 v24, s[84:87], s88 offen offset:1024 lds
 v_mfma_f32_16x16x32_bf16 v[248:251], a[240:243], a[88:91], v[248:251]
 v_rcp_f32 v36, v36
 v_mfma_f32_16x16x32_bf16 v[252:255], a[240:243], a[92:95], v[252:255]
 ds_read_b64_tr_b16 a[224:225], v12 offset:160
 ds_read_b64_tr_b16 a[226:227], v12 offset:2464
 v_mfma_f32_16x16x32_bf16 a[0:3], a[244:247], a[80:83], a[0:3]
 v_rcp_f32 v37, v37
 v_mfma_f32_16x16x32_bf16 a[4:7], a[244:247], a[84:87], a[4:7]
 v_mul_f32 v42, v42, v34
 v_mul_f32 v43, v43, v35
 v_mfma_f32_16x16x32_bf16 a[8:11], a[244:247], a[88:91], a[8:11]
 v_mul_f32 v44, v44, v36
 v_mul_f32 v45, v45, v37
 v_mfma_f32_16x16x32_bf16 a[12:15], a[244:247], a[92:95], a[12:15]
 ds_read_b64_tr_b16 a[228:229], v12 offset:18592
 ds_read_b64_tr_b16 a[230:231], v12 offset:20896
 v_mfma_f32_16x16x32_bf16 v[240:243], a[248:251], a[96:99], v[240:243]
 v_cvt_pk_bf16_f32 v38, v38, v39
 v_cvt_pk_bf16_f32 v39, v40, v41
 v_mfma_f32_16x16x32_bf16 v[244:247], a[248:251], a[100:103], v[244:247]
 v_cvt_pk_bf16_f32 v40, v42, v43
 v_cvt_pk_bf16_f32 v41, v44, v45
 v_mfma_f32_16x16x32_bf16 v[248:251], a[248:251], a[104:107], v[248:251]
 v_permlane16_swap_b32 v38, v40
 v_permlane16_swap_b32 v39, v41
 v_mfma_f32_16x16x32_bf16 v[252:255], a[248:251], a[108:111], v[252:255]
 ds_read_b64_tr_b16 a[232:233], v12 offset:9376
 s_waitcnt lgkmcnt(14)
 ds_read_b64_tr_b16 a[234:235], v12 offset:11680
 s_waitcnt lgkmcnt(4)
 v_mfma_f32_16x16x32_bf16 a[0:3], a[252:255], a[96:99], a[0:3]
 s_add_u32 s43, s35, 0x2000
 v_mfma_f32_16x16x32_bf16 a[4:7], a[252:255], a[100:103], a[4:7]
 s_add_u32 m0, s34, 0x13000
 s_nop 0
 buffer_load_dwordx4 v25, s[84:87], s88 offen offset:2048 lds
 v_mfma_f32_16x16x32_bf16 a[8:11], a[252:255], a[104:107], a[8:11]
 buffer_store_dwordx4 v[38:41], v1, s[20:23], s43 offen sc1
 v_mfma_f32_16x16x32_bf16 a[12:15], a[252:255], a[108:111], a[12:15]
 ds_read_b64_tr_b16 a[236:237], v12 offset:27808
 ds_read_b64_tr_b16 a[238:239], v12 offset:30112
 v_mfma_f32_16x16x32_bf16 v[208:211], a[208:211], a[176:179], v[208:211]
 v_accvgpr_read_b32 v38, a56
 v_accvgpr_read_b32 v39, a57
 v_mfma_f32_16x16x32_bf16 v[212:215], a[208:211], a[180:183], v[212:215]
 v_accvgpr_read_b32 v40, a58
 v_accvgpr_read_b32 v41, a59
 v_mfma_f32_16x16x32_bf16 v[216:219], a[208:211], a[184:187], v[216:219]
 v_exp_f32 v30, v38
 v_mfma_f32_16x16x32_bf16 v[220:223], a[208:211], a[188:191], v[220:223]
 ds_read_b64_tr_b16 a[240:241], v15 offset:128
 ds_read_b64_tr_b16 a[242:243], v15 offset:2432
 v_mfma_f32_16x16x32_bf16 v[224:227], a[212:215], a[176:179], v[224:227]
 v_exp_f32 v31, v39
 v_mfma_f32_16x16x32_bf16 v[228:231], a[212:215], a[180:183], v[228:231]
 v_exp_f32 v32, v40
 v_mfma_f32_16x16x32_bf16 v[232:235], a[212:215], a[184:187], v[232:235]
 v_exp_f32 v33, v41
 v_mfma_f32_16x16x32_bf16 v[236:239], a[212:215], a[188:191], v[236:239]
 ds_read_b64_tr_b16 a[244:245], v15 offset:18560
 ds_read_b64_tr_b16 a[246:247], v15 offset:20864
 v_mfma_f32_16x16x32_bf16 v[208:211], a[216:219], a[192:195], v[208:211]
 v_accvgpr_read_b32 v46, a72
 v_mul_f32 v38, v38, v46
 v_mfma_f32_16x16x32_bf16 v[212:215], a[216:219], a[196:199], v[212:215]
 s_add_u32 m0, s34, 0x13000
 s_nop 0
 buffer_load_dwordx4 v26, s[84:87], s88 offen offset:3072 lds
 v_mfma_f32_16x16x32_bf16 v[216:219], a[216:219], a[200:203], v[216:219]
 v_accvgpr_read_b32 v47, a73
 v_mul_f32 v39, v39, v47
 v_mfma_f32_16x16x32_bf16 v[220:223], a[216:219], a[204:207], v[220:223]
 ds_read_b64_tr_b16 a[248:249], v15 offset:9344
 ds_read_b64_tr_b16 a[250:251], v15 offset:11648
 v_mfma_f32_16x16x32_bf16 v[224:227], a[220:223], a[192:195], v[224:227]
 v_accvgpr_read_b32 v46, a74
 v_mul_f32 v40, v40, v46
 v_mfma_f32_16x16x32_bf16 v[228:231], a[220:223], a[196:199], v[228:231]
 v_accvgpr_read_b32 v47, a75
 v_mul_f32 v41, v41, v47
 v_mfma_f32_16x16x32_bf16 v[232:235], a[220:223], a[200:203], v[232:235]
 v_fma_f32 v30, v30, s93, s93
 v_fma_f32 v31, v31, s93, s93
 v_mfma_f32_16x16x32_bf16 v[236:239], a[220:223], a[204:207], v[236:239]
 ds_read_b64_tr_b16 a[252:253], v15 offset:27776
 ds_read_b64_tr_b16 a[254:255], v15 offset:30080
 v_mfma_f32_16x16x32_bf16 v[208:211], a[224:227], a[80:83], v[208:211]
 v_fma_f32 v32, v32, s93, s93
 v_fma_f32 v33, v33, s93, s93
 v_mfma_f32_16x16x32_bf16 v[212:215], a[224:227], a[84:87], v[212:215]
 v_rcp_f32 v30, v30
 v_mfma_f32_16x16x32_bf16 v[216:219], a[224:227], a[88:91], v[216:219]
 v_rcp_f32 v31, v31
 v_mfma_f32_16x16x32_bf16 v[220:223], a[224:227], a[92:95], v[220:223]
 ds_read_b64_tr_b16 a[208:209], v12 offset:128
 s_waitcnt lgkmcnt(14)
 ds_read_b64_tr_b16 a[210:211], v12 offset:2432
 s_waitcnt lgkmcnt(4)
 v_mfma_f32_16x16x32_bf16 v[224:227], a[228:231], a[80:83], v[224:227]
 v_rcp_f32 v32, v32
 v_mfma_f32_16x16x32_bf16 v[228:231], a[228:231], a[84:87], v[228:231]
 s_add_u32 m0, s34, 0x14000
 s_nop 0
 buffer_load_dwordx4 v27, s[84:87], s88 offen lds
 v_mfma_f32_16x16x32_bf16 v[232:235], a[228:231], a[88:91], v[232:235]
 v_rcp_f32 v33, v33
 v_mfma_f32_16x16x32_bf16 v[236:239], a[228:231], a[92:95], v[236:239]
 ds_read_b64_tr_b16 a[212:213], v12 offset:18560
 ds_read_b64_tr_b16 a[214:215], v12 offset:20864
 v_mfma_f32_16x16x32_bf16 v[208:211], a[232:235], a[96:99], v[208:211]
 v_mul_f32 v38, v38, v30
 v_mul_f32 v39, v39, v31
 v_mfma_f32_16x16x32_bf16 v[212:215], a[232:235], a[100:103], v[212:215]
 v_mul_f32 v40, v40, v32
 v_mul_f32 v41, v41, v33
 v_mfma_f32_16x16x32_bf16 v[216:219], a[232:235], a[104:107], v[216:219]
 v_accvgpr_read_b32 v42, a60
 v_accvgpr_read_b32 v43, a61
 v_mfma_f32_16x16x32_bf16 v[220:223], a[232:235], a[108:111], v[220:223]
 ds_read_b64_tr_b16 a[216:217], v12 offset:9344
 ds_read_b64_tr_b16 a[218:219], v12 offset:11648
 v_mfma_f32_16x16x32_bf16 v[224:227], a[236:239], a[96:99], v[224:227]
 v_accvgpr_read_b32 v44, a62
 v_accvgpr_read_b32 v45, a63
 v_mfma_f32_16x16x32_bf16 v[228:231], a[236:239], a[100:103], v[228:231]
 v_exp_f32 v34, v42
 v_mfma_f32_16x16x32_bf16 v[232:235], a[236:239], a[104:107], v[232:235]
 v_exp_f32 v35, v43
 v_mfma_f32_16x16x32_bf16 v[236:239], a[236:239], a[108:111], v[236:239]
 ds_read_b64_tr_b16 a[220:221], v12 offset:27776
 ds_read_b64_tr_b16 a[222:223], v12 offset:30080
 v_mfma_f32_16x16x32_bf16 v[176:179], a[240:243], a[176:179], v[176:179]
 v_exp_f32 v36, v44
 v_mfma_f32_16x16x32_bf16 v[180:183], a[240:243], a[180:183], v[180:183]
 v_exp_f32 v37, v45
 v_mfma_f32_16x16x32_bf16 v[184:187], a[240:243], a[184:187], v[184:187]
 v_accvgpr_read_b32 v46, a76
 v_mul_f32 v42, v42, v46
 v_mfma_f32_16x16x32_bf16 v[188:191], a[240:243], a[188:191], v[188:191]
 ds_read_b64_tr_b16 a[224:225], v15 offset:96
 ds_read_b64_tr_b16 a[226:227], v15 offset:2400
 v_mfma_f32_16x16x32_bf16 v[192:195], a[244:247], a[176:179], v[192:195]
 v_accvgpr_read_b32 v47, a77
 v_mul_f32 v43, v43, v47
 v_mfma_f32_16x16x32_bf16 v[196:199], a[244:247], a[180:183], v[196:199]
 v_accvgpr_read_b32 v46, a78
 v_mul_f32 v44, v44, v46
 v_mfma_f32_16x16x32_bf16 v[200:203], a[244:247], a[184:187], v[200:203]
 v_accvgpr_read_b32 v47, a79
 v_mul_f32 v45, v45, v47
 v_mfma_f32_16x16x32_bf16 v[204:207], a[244:247], a[188:191], v[204:207]
 ds_read_b64_tr_b16 a[228:229], v15 offset:18528
 ds_read_b64_tr_b16 a[230:231], v15 offset:20832
 v_mfma_f32_16x16x32_bf16 v[176:179], a[248:251], a[192:195], v[176:179]
 v_fma_f32 v34, v34, s93, s93
 v_fma_f32 v35, v35, s93, s93
 v_mfma_f32_16x16x32_bf16 v[180:183], a[248:251], a[196:199], v[180:183]
 v_fma_f32 v36, v36, s93, s93
 v_fma_f32 v37, v37, s93, s93
 v_mfma_f32_16x16x32_bf16 v[184:187], a[248:251], a[200:203], v[184:187]
 v_rcp_f32 v34, v34
 v_mfma_f32_16x16x32_bf16 v[188:191], a[248:251], a[204:207], v[188:191]
 ds_read_b64_tr_b16 a[232:233], v15 offset:9312
 s_waitcnt lgkmcnt(14)
 ds_read_b64_tr_b16 a[234:235], v15 offset:11616
 s_waitcnt lgkmcnt(4)
 v_mfma_f32_16x16x32_bf16 v[192:195], a[252:255], a[192:195], v[192:195]
 v_rcp_f32 v35, v35
 v_mfma_f32_16x16x32_bf16 v[196:199], a[252:255], a[196:199], v[196:199]
 v_rcp_f32 v36, v36
 v_mfma_f32_16x16x32_bf16 v[200:203], a[252:255], a[200:203], v[200:203]
 v_rcp_f32 v37, v37
 v_mfma_f32_16x16x32_bf16 v[204:207], a[252:255], a[204:207], v[204:207]
 ds_read_b64_tr_b16 a[236:237], v15 offset:27744
 ds_read_b64_tr_b16 a[238:239], v15 offset:30048
 v_mfma_f32_16x16x32_bf16 v[176:179], a[208:211], a[80:83], v[176:179]
 v_mul_f32 v42, v42, v34
 v_mul_f32 v43, v43, v35
 v_mfma_f32_16x16x32_bf16 v[180:183], a[208:211], a[84:87], v[180:183]
 v_mul_f32 v44, v44, v36
 v_mul_f32 v45, v45, v37
 v_mfma_f32_16x16x32_bf16 v[184:187], a[208:211], a[88:91], v[184:187]
 v_cvt_pk_bf16_f32 v38, v38, v39
 v_cvt_pk_bf16_f32 v39, v40, v41
 v_mfma_f32_16x16x32_bf16 v[188:191], a[208:211], a[92:95], v[188:191]
 ds_read_b64_tr_b16 a[240:241], v12 offset:96
 ds_read_b64_tr_b16 a[242:243], v12 offset:2400
 v_mfma_f32_16x16x32_bf16 v[192:195], a[212:215], a[80:83], v[192:195]
 v_cvt_pk_bf16_f32 v40, v42, v43
 v_cvt_pk_bf16_f32 v41, v44, v45
 v_mfma_f32_16x16x32_bf16 v[196:199], a[212:215], a[84:87], v[196:199]
 v_permlane16_swap_b32 v38, v40
 v_permlane16_swap_b32 v39, v41
 v_mfma_f32_16x16x32_bf16 v[200:203], a[212:215], a[88:91], v[200:203]
 s_add_u32 s43, s36, 0x2000
 v_mfma_f32_16x16x32_bf16 v[204:207], a[212:215], a[92:95], v[204:207]
 ds_read_b64_tr_b16 a[244:245], v12 offset:18528
 ds_read_b64_tr_b16 a[246:247], v12 offset:20832
 v_mfma_f32_16x16x32_bf16 v[176:179], a[216:219], a[96:99], v[176:179]
 buffer_store_dwordx4 v[38:41], v1, s[20:23], s43 offen sc1
 v_mfma_f32_16x16x32_bf16 v[180:183], a[216:219], a[100:103], v[180:183]
 s_nop 0
 v_accvgpr_read_b32 v38, a16
 v_accvgpr_read_b32 v39, a17
 v_mfma_f32_16x16x32_bf16 v[184:187], a[216:219], a[104:107], v[184:187]
 v_accvgpr_read_b32 v40, a18
 v_accvgpr_read_b32 v41, a19
 v_mfma_f32_16x16x32_bf16 v[188:191], a[216:219], a[108:111], v[188:191]
 ds_read_b64_tr_b16 a[248:249], v12 offset:9312
 ds_read_b64_tr_b16 a[250:251], v12 offset:11616
 v_mfma_f32_16x16x32_bf16 v[192:195], a[220:223], a[96:99], v[192:195]
 v_exp_f32 v30, v38
 v_mfma_f32_16x16x32_bf16 v[196:199], a[220:223], a[100:103], v[196:199]
 v_exp_f32 v31, v39
 v_mfma_f32_16x16x32_bf16 v[200:203], a[220:223], a[104:107], v[200:203]
 v_exp_f32 v32, v40
 v_mfma_f32_16x16x32_bf16 v[204:207], a[220:223], a[108:111], v[204:207]
 ds_read_b64_tr_b16 a[252:253], v12 offset:27744
 ds_read_b64_tr_b16 a[254:255], v12 offset:30048
 v_mfma_f32_16x16x32_bf16 v[144:147], a[224:227], a[176:179], v[144:147]
 v_exp_f32 v33, v41
 v_mfma_f32_16x16x32_bf16 v[148:151], a[224:227], a[180:183], v[148:151]
 v_accvgpr_read_b32 v46, a32
 v_mul_f32 v38, v38, v46
 v_mfma_f32_16x16x32_bf16 v[152:155], a[224:227], a[184:187], v[152:155]
 v_accvgpr_read_b32 v47, a33
 v_mul_f32 v39, v39, v47
 v_mfma_f32_16x16x32_bf16 v[156:159], a[224:227], a[188:191], v[156:159]
 ds_read_b64_tr_b16 a[208:209], v15 offset:64
 s_waitcnt lgkmcnt(14)
 ds_read_b64_tr_b16 a[210:211], v15 offset:2368
 s_waitcnt lgkmcnt(4)
 v_mfma_f32_16x16x32_bf16 v[160:163], a[228:231], a[176:179], v[160:163]
 v_accvgpr_read_b32 v46, a34
 v_mul_f32 v40, v40, v46
 v_mfma_f32_16x16x32_bf16 v[164:167], a[228:231], a[180:183], v[164:167]
 v_accvgpr_read_b32 v47, a35
 v_mul_f32 v41, v41, v47
 v_mfma_f32_16x16x32_bf16 v[168:171], a[228:231], a[184:187], v[168:171]
 v_fma_f32 v30, v30, s93, s93
 v_fma_f32 v31, v31, s93, s93
 v_mfma_f32_16x16x32_bf16 v[172:175], a[228:231], a[188:191], v[172:175]
 ds_read_b64_tr_b16 a[212:213], v15 offset:18496
 ds_read_b64_tr_b16 a[214:215], v15 offset:20800
 v_mfma_f32_16x16x32_bf16 v[144:147], a[232:235], a[192:195], v[144:147]
 v_fma_f32 v32, v32, s93, s93
 v_fma_f32 v33, v33, s93, s93
 v_mfma_f32_16x16x32_bf16 v[148:151], a[232:235], a[196:199], v[148:151]
 v_rcp_f32 v30, v30
 v_mfma_f32_16x16x32_bf16 v[152:155], a[232:235], a[200:203], v[152:155]
 v_rcp_f32 v31, v31
 v_mfma_f32_16x16x32_bf16 v[156:159], a[232:235], a[204:207], v[156:159]
 ds_read_b64_tr_b16 a[216:217], v15 offset:9280
 ds_read_b64_tr_b16 a[218:219], v15 offset:11584
 v_mfma_f32_16x16x32_bf16 v[160:163], a[236:239], a[192:195], v[160:163]
 v_rcp_f32 v32, v32
 v_mfma_f32_16x16x32_bf16 v[164:167], a[236:239], a[196:199], v[164:167]
 v_rcp_f32 v33, v33
 v_mfma_f32_16x16x32_bf16 v[168:171], a[236:239], a[200:203], v[168:171]
 v_mul_f32 v38, v38, v30
 v_mul_f32 v39, v39, v31
 v_mfma_f32_16x16x32_bf16 v[172:175], a[236:239], a[204:207], v[172:175]
 ds_read_b64_tr_b16 a[220:221], v15 offset:27712
 ds_read_b64_tr_b16 a[222:223], v15 offset:30016
 v_mfma_f32_16x16x32_bf16 v[144:147], a[240:243], a[80:83], v[144:147]
 v_mul_f32 v40, v40, v32
 v_mul_f32 v41, v41, v33
 v_mfma_f32_16x16x32_bf16 v[148:151], a[240:243], a[84:87], v[148:151]
 v_accvgpr_read_b32 v42, a20
 v_accvgpr_read_b32 v43, a21
 v_mfma_f32_16x16x32_bf16 v[152:155], a[240:243], a[88:91], v[152:155]
 v_accvgpr_read_b32 v44, a22
 v_accvgpr_read_b32 v45, a23
 v_mfma_f32_16x16x32_bf16 v[156:159], a[240:243], a[92:95], v[156:159]
 ds_read_b64_tr_b16 a[224:225], v12 offset:64
 ds_read_b64_tr_b16 a[226:227], v12 offset:2368
 v_mfma_f32_16x16x32_bf16 v[160:163], a[244:247], a[80:83], v[160:163]
 v_exp_f32 v34, v42
 v_mfma_f32_16x16x32_bf16 v[164:167], a[244:247], a[84:87], v[164:167]
 v_exp_f32 v35, v43
 v_mfma_f32_16x16x32_bf16 v[168:171], a[244:247], a[88:91], v[168:171]
 v_exp_f32 v36, v44
 v_mfma_f32_16x16x32_bf16 v[172:175], a[244:247], a[92:95], v[172:175]
 ds_read_b64_tr_b16 a[228:229], v12 offset:18496
 ds_read_b64_tr_b16 a[230:231], v12 offset:20800
 v_mfma_f32_16x16x32_bf16 v[144:147], a[248:251], a[96:99], v[144:147]
 v_exp_f32 v37, v45
 v_mfma_f32_16x16x32_bf16 v[148:151], a[248:251], a[100:103], v[148:151]
 v_accvgpr_read_b32 v46, a36
 v_mul_f32 v42, v42, v46
 v_mfma_f32_16x16x32_bf16 v[152:155], a[248:251], a[104:107], v[152:155]
 v_accvgpr_read_b32 v47, a37
 v_mul_f32 v43, v43, v47
 v_mfma_f32_16x16x32_bf16 v[156:159], a[248:251], a[108:111], v[156:159]
 ds_read_b64_tr_b16 a[232:233], v12 offset:9280
 s_waitcnt lgkmcnt(14)
 ds_read_b64_tr_b16 a[234:235], v12 offset:11584
 s_waitcnt lgkmcnt(4)
 v_mfma_f32_16x16x32_bf16 v[160:163], a[252:255], a[96:99], v[160:163]
 v_accvgpr_read_b32 v46, a38
 v_mul_f32 v44, v44, v46
 v_mfma_f32_16x16x32_bf16 v[164:167], a[252:255], a[100:103], v[164:167]
 v_accvgpr_read_b32 v47, a39
 v_mul_f32 v45, v45, v47
 v_mfma_f32_16x16x32_bf16 v[168:171], a[252:255], a[104:107], v[168:171]
 v_fma_f32 v34, v34, s93, s93
 v_fma_f32 v35, v35, s93, s93
 v_mfma_f32_16x16x32_bf16 v[172:175], a[252:255], a[108:111], v[172:175]
 ds_read_b64_tr_b16 a[236:237], v12 offset:27712
 ds_read_b64_tr_b16 a[238:239], v12 offset:30016
 v_mfma_f32_16x16x32_bf16 v[112:115], a[208:211], a[176:179], v[112:115]
 v_fma_f32 v36, v36, s93, s93
 v_fma_f32 v37, v37, s93, s93
 v_mfma_f32_16x16x32_bf16 v[116:119], a[208:211], a[180:183], v[116:119]
 v_rcp_f32 v34, v34
 v_mfma_f32_16x16x32_bf16 v[120:123], a[208:211], a[184:187], v[120:123]
 v_rcp_f32 v35, v35
 v_mfma_f32_16x16x32_bf16 v[124:127], a[208:211], a[188:191], v[124:127]
 ds_read_b64_tr_b16 a[240:241], v15 offset:32
 ds_read_b64_tr_b16 a[242:243], v15 offset:2336
 v_mfma_f32_16x16x32_bf16 v[128:131], a[212:215], a[176:179], v[128:131]
 v_rcp_f32 v36, v36
 v_mfma_f32_16x16x32_bf16 v[132:135], a[212:215], a[180:183], v[132:135]
 v_rcp_f32 v37, v37
 v_mfma_f32_16x16x32_bf16 v[136:139], a[212:215], a[184:187], v[136:139]
 v_mul_f32 v42, v42, v34
 v_mul_f32 v43, v43, v35
 v_mfma_f32_16x16x32_bf16 v[140:143], a[212:215], a[188:191], v[140:143]
 ds_read_b64_tr_b16 a[244:245], v15 offset:18464
 ds_read_b64_tr_b16 a[246:247], v15 offset:20768
 v_mfma_f32_16x16x32_bf16 v[112:115], a[216:219], a[192:195], v[112:115]
 v_mul_f32 v44, v44, v36
 v_mul_f32 v45, v45, v37
 v_mfma_f32_16x16x32_bf16 v[116:119], a[216:219], a[196:199], v[116:119]
 v_cvt_pk_bf16_f32 v38, v38, v39
 v_cvt_pk_bf16_f32 v39, v40, v41
 v_mfma_f32_16x16x32_bf16 v[120:123], a[216:219], a[200:203], v[120:123]
 v_cvt_pk_bf16_f32 v40, v42, v43
 v_cvt_pk_bf16_f32 v41, v44, v45
 v_mfma_f32_16x16x32_bf16 v[124:127], a[216:219], a[204:207], v[124:127]
 ds_read_b64_tr_b16 a[248:249], v15 offset:9248
 ds_read_b64_tr_b16 a[250:251], v15 offset:11552
 v_mfma_f32_16x16x32_bf16 v[128:131], a[220:223], a[192:195], v[128:131]
 v_permlane16_swap_b32 v38, v40
 v_permlane16_swap_b32 v39, v41
 v_mfma_f32_16x16x32_bf16 v[132:135], a[220:223], a[196:199], v[132:135]
 s_add_u32 s43, s35, 0x1000
 v_mfma_f32_16x16x32_bf16 v[136:139], a[220:223], a[200:203], v[136:139]
 buffer_store_dwordx4 v[38:41], v1, s[20:23], s43 offen offset:3072 sc1
 v_mfma_f32_16x16x32_bf16 v[140:143], a[220:223], a[204:207], v[140:143]
 ds_read_b64_tr_b16 a[252:253], v15 offset:27680
 ds_read_b64_tr_b16 a[254:255], v15 offset:29984
 v_mfma_f32_16x16x32_bf16 v[112:115], a[224:227], a[80:83], v[112:115]
 v_accvgpr_read_b32 v38, a24
 v_accvgpr_read_b32 v39, a25
 v_mfma_f32_16x16x32_bf16 v[116:119], a[224:227], a[84:87], v[116:119]
 v_accvgpr_read_b32 v40, a26
 v_accvgpr_read_b32 v41, a27
 v_mfma_f32_16x16x32_bf16 v[120:123], a[224:227], a[88:91], v[120:123]
 v_exp_f32 v30, v38
 v_mfma_f32_16x16x32_bf16 v[124:127], a[224:227], a[92:95], v[124:127]
 ds_read_b64_tr_b16 a[208:209], v12 offset:32
 s_waitcnt lgkmcnt(14)
 ds_read_b64_tr_b16 a[210:211], v12 offset:2336
 s_waitcnt lgkmcnt(4)
 v_mfma_f32_16x16x32_bf16 v[128:131], a[228:231], a[80:83], v[128:131]
 v_exp_f32 v31, v39
 v_mfma_f32_16x16x32_bf16 v[132:135], a[228:231], a[84:87], v[132:135]
 v_exp_f32 v32, v40
 v_mfma_f32_16x16x32_bf16 v[136:139], a[228:231], a[88:91], v[136:139]
 v_exp_f32 v33, v41
 v_mfma_f32_16x16x32_bf16 v[140:143], a[228:231], a[92:95], v[140:143]
 ds_read_b64_tr_b16 a[212:213], v12 offset:18464
 ds_read_b64_tr_b16 a[214:215], v12 offset:20768
 v_mfma_f32_16x16x32_bf16 v[112:115], a[232:235], a[96:99], v[112:115]
 v_accvgpr_read_b32 v46, a40
 v_mul_f32 v38, v38, v46
 v_mfma_f32_16x16x32_bf16 v[116:119], a[232:235], a[100:103], v[116:119]
 v_accvgpr_read_b32 v47, a41
 v_mul_f32 v39, v39, v47
 v_mfma_f32_16x16x32_bf16 v[120:123], a[232:235], a[104:107], v[120:123]
 v_accvgpr_read_b32 v46, a42
 v_mul_f32 v40, v40, v46
 v_mfma_f32_16x16x32_bf16 v[124:127], a[232:235], a[108:111], v[124:127]
 ds_read_b64_tr_b16 a[216:217], v12 offset:9248
 ds_read_b64_tr_b16 a[218:219], v12 offset:11552
 v_mfma_f32_16x16x32_bf16 v[128:131], a[236:239], a[96:99], v[128:131]
 v_accvgpr_read_b32 v47, a43
 v_mul_f32 v41, v41, v47
 v_mfma_f32_16x16x32_bf16 v[132:135], a[236:239], a[100:103], v[132:135]
 v_fma_f32 v30, v30, s93, s93
 v_fma_f32 v31, v31, s93, s93
 v_mfma_f32_16x16x32_bf16 v[136:139], a[236:239], a[104:107], v[136:139]
 v_fma_f32 v32, v32, s93, s93
 v_fma_f32 v33, v33, s93, s93
 v_mfma_f32_16x16x32_bf16 v[140:143], a[236:239], a[108:111], v[140:143]
 ds_read_b64_tr_b16 a[220:221], v12 offset:27680
 ds_read_b64_tr_b16 a[222:223], v12 offset:29984
 v_mfma_f32_16x16x32_bf16 v[80:83], a[240:243], a[176:179], v[80:83]
 v_rcp_f32 v30, v30
 v_mfma_f32_16x16x32_bf16 v[84:87], a[240:243], a[180:183], v[84:87]
 v_rcp_f32 v31, v31
 v_mfma_f32_16x16x32_bf16 v[88:91], a[240:243], a[184:187], v[88:91]
 v_rcp_f32 v32, v32
 v_mfma_f32_16x16x32_bf16 v[92:95], a[240:243], a[188:191], v[92:95]
 ds_read_b64_tr_b16 a[224:225], v15
 ds_read_b64_tr_b16 a[226:227], v15 offset:2304
 v_mfma_f32_16x16x32_bf16 v[96:99], a[244:247], a[176:179], v[96:99]
 v_rcp_f32 v33, v33
 v_mfma_f32_16x16x32_bf16 v[100:103], a[244:247], a[180:183], v[100:103]
 v_mul_f32 v38, v38, v30
 v_mul_f32 v39, v39, v31
 v_mfma_f32_16x16x32_bf16 v[104:107], a[244:247], a[184:187], v[104:107]
 v_mul_f32 v40, v40, v32
 v_mul_f32 v41, v41, v33
 v_mfma_f32_16x16x32_bf16 v[108:111], a[244:247], a[188:191], v[108:111]
 ds_read_b64_tr_b16 a[228:229], v15 offset:18432
 ds_read_b64_tr_b16 a[230:231], v15 offset:20736
 v_mfma_f32_16x16x32_bf16 v[80:83], a[248:251], a[192:195], v[80:83]
 v_accvgpr_read_b32 v42, a28
 v_accvgpr_read_b32 v43, a29
 v_mfma_f32_16x16x32_bf16 v[84:87], a[248:251], a[196:199], v[84:87]
 v_accvgpr_read_b32 v44, a30
 v_accvgpr_read_b32 v45, a31
 v_mfma_f32_16x16x32_bf16 v[88:91], a[248:251], a[200:203], v[88:91]
 v_exp_f32 v34, v42
 v_mfma_f32_16x16x32_bf16 v[92:95], a[248:251], a[204:207], v[92:95]
 ds_read_b64_tr_b16 a[232:233], v15 offset:9216
 s_waitcnt lgkmcnt(14)
 ds_read_b64_tr_b16 a[234:235], v15 offset:11520
 s_waitcnt lgkmcnt(4)
 v_mfma_f32_16x16x32_bf16 v[96:99], a[252:255], a[192:195], v[96:99]
 v_exp_f32 v35, v43
 v_mfma_f32_16x16x32_bf16 v[100:103], a[252:255], a[196:199], v[100:103]
 v_exp_f32 v36, v44
 v_mfma_f32_16x16x32_bf16 v[104:107], a[252:255], a[200:203], v[104:107]
 v_exp_f32 v37, v45
 v_mfma_f32_16x16x32_bf16 v[108:111], a[252:255], a[204:207], v[108:111]
 ds_read_b64_tr_b16 a[236:237], v15 offset:27648
 ds_read_b64_tr_b16 a[238:239], v15 offset:29952
 v_mfma_f32_16x16x32_bf16 v[80:83], a[208:211], a[80:83], v[80:83]
 v_accvgpr_read_b32 v46, a44
 v_mul_f32 v42, v42, v46
 v_mfma_f32_16x16x32_bf16 v[84:87], a[208:211], a[84:87], v[84:87]
 v_accvgpr_read_b32 v47, a45
 v_mul_f32 v43, v43, v47
 v_mfma_f32_16x16x32_bf16 v[88:91], a[208:211], a[88:91], v[88:91]
 v_accvgpr_read_b32 v46, a46
 v_mul_f32 v44, v44, v46
 v_mfma_f32_16x16x32_bf16 v[92:95], a[208:211], a[92:95], v[92:95]
 ds_read_b64_tr_b16 a[240:241], v12
 ds_read_b64_tr_b16 a[242:243], v12 offset:2304
 v_mfma_f32_16x16x32_bf16 v[96:99], a[212:215], a[80:83], v[96:99]
 v_accvgpr_read_b32 v47, a47
 v_mul_f32 v45, v45, v47
 v_mfma_f32_16x16x32_bf16 v[100:103], a[212:215], a[84:87], v[100:103]
 v_fma_f32 v34, v34, s93, s93
 v_fma_f32 v35, v35, s93, s93
 v_mfma_f32_16x16x32_bf16 v[104:107], a[212:215], a[88:91], v[104:107]
 v_fma_f32 v36, v36, s93, s93
 v_fma_f32 v37, v37, s93, s93
 v_mfma_f32_16x16x32_bf16 v[108:111], a[212:215], a[92:95], v[108:111]
 ds_read_b64_tr_b16 a[244:245], v12 offset:18432
 ds_read_b64_tr_b16 a[246:247], v12 offset:20736
 v_mfma_f32_16x16x32_bf16 v[80:83], a[216:219], a[96:99], v[80:83]
 v_rcp_f32 v34, v34
 v_mfma_f32_16x16x32_bf16 v[84:87], a[216:219], a[100:103], v[84:87]
 v_rcp_f32 v35, v35
 v_mfma_f32_16x16x32_bf16 v[88:91], a[216:219], a[104:107], v[88:91]
 v_rcp_f32 v36, v36
 v_mfma_f32_16x16x32_bf16 v[92:95], a[216:219], a[108:111], v[92:95]
 ds_read_b64_tr_b16 a[248:249], v12 offset:9216
 ds_read_b64_tr_b16 a[250:251], v12 offset:11520
 v_mfma_f32_16x16x32_bf16 v[96:99], a[220:223], a[96:99], v[96:99]
 v_rcp_f32 v37, v37
 v_mfma_f32_16x16x32_bf16 v[100:103], a[220:223], a[100:103], v[100:103]
 v_mul_f32 v42, v42, v34
 v_mul_f32 v43, v43, v35
 v_mfma_f32_16x16x32_bf16 v[104:107], a[220:223], a[104:107], v[104:107]
 v_mul_f32 v44, v44, v36
 v_mul_f32 v45, v45, v37
 v_mfma_f32_16x16x32_bf16 v[108:111], a[220:223], a[108:111], v[108:111]
 ds_read_b64_tr_b16 a[252:253], v12 offset:27648
 ds_read_b64_tr_b16 a[254:255], v12 offset:29952
 v_mfma_f32_16x16x32_bf16 v[48:51], a[224:227], a[176:179], v[48:51]
 v_cvt_pk_bf16_f32 v38, v38, v39
 v_cvt_pk_bf16_f32 v39, v40, v41
 v_mfma_f32_16x16x32_bf16 v[52:55], a[224:227], a[180:183], v[52:55]
 v_cvt_pk_bf16_f32 v40, v42, v43
 v_cvt_pk_bf16_f32 v41, v44, v45
 v_mfma_f32_16x16x32_bf16 v[56:59], a[224:227], a[184:187], v[56:59]
 v_permlane16_swap_b32 v38, v40
 v_permlane16_swap_b32 v39, v41
 v_mfma_f32_16x16x32_bf16 v[60:63], a[224:227], a[188:191], v[60:63]
 s_add_u32 s43, s36, 0x1000
 s_waitcnt lgkmcnt(2)
 v_mfma_f32_16x16x32_bf16 v[64:67], a[228:231], a[176:179], v[64:67]
 buffer_store_dwordx4 v[38:41], v1, s[20:23], s43 offen offset:3072 sc1
 v_mfma_f32_16x16x32_bf16 v[68:71], a[228:231], a[180:183], v[68:71]
 v_exp_f32 v30, v240
 v_mfma_f32_16x16x32_bf16 v[72:75], a[228:231], a[184:187], v[72:75]
 v_exp_f32 v31, v241
 v_mfma_f32_16x16x32_bf16 v[76:79], a[228:231], a[188:191], v[76:79]
 v_exp_f32 v32, v242
 v_mfma_f32_16x16x32_bf16 v[48:51], a[232:235], a[192:195], v[48:51]
 v_exp_f32 v33, v243
 v_mfma_f32_16x16x32_bf16 v[52:55], a[232:235], a[196:199], v[52:55]
 v_accvgpr_read_b32 v46, a0
 v_mul_f32 v240, v240, v46
 v_mfma_f32_16x16x32_bf16 v[56:59], a[232:235], a[200:203], v[56:59]
 v_accvgpr_read_b32 v47, a1
 v_mul_f32 v241, v241, v47
 v_mfma_f32_16x16x32_bf16 v[60:63], a[232:235], a[204:207], v[60:63]
 v_accvgpr_read_b32 v46, a2
 v_mul_f32 v242, v242, v46
 v_mfma_f32_16x16x32_bf16 v[64:67], a[236:239], a[192:195], v[64:67]
 v_accvgpr_read_b32 v47, a3
 v_mul_f32 v243, v243, v47
 v_mfma_f32_16x16x32_bf16 v[68:71], a[236:239], a[196:199], v[68:71]
 v_fma_f32 v30, v30, s93, s93
 v_fma_f32 v31, v31, s93, s93
 v_mfma_f32_16x16x32_bf16 v[72:75], a[236:239], a[200:203], v[72:75]
 v_fma_f32 v32, v32, s93, s93
 v_fma_f32 v33, v33, s93, s93
 v_mfma_f32_16x16x32_bf16 v[76:79], a[236:239], a[204:207], v[76:79]
 v_rcp_f32 v30, v30
 v_mfma_f32_16x16x32_bf16 v[48:51], a[240:243], a[80:83], v[48:51]
 v_rcp_f32 v31, v31
 v_mfma_f32_16x16x32_bf16 v[52:55], a[240:243], a[84:87], v[52:55]
 v_rcp_f32 v32, v32
 v_mfma_f32_16x16x32_bf16 v[56:59], a[240:243], a[88:91], v[56:59]
 v_rcp_f32 v33, v33
 v_mfma_f32_16x16x32_bf16 v[60:63], a[240:243], a[92:95], v[60:63]
 v_mul_f32 v240, v240, v30
 v_mul_f32 v241, v241, v31
 v_mfma_f32_16x16x32_bf16 v[64:67], a[244:247], a[80:83], v[64:67]
 v_mul_f32 v242, v242, v32
 v_mul_f32 v243, v243, v33
 v_mfma_f32_16x16x32_bf16 v[68:71], a[244:247], a[84:87], v[68:71]
 v_exp_f32 v34, v244
 v_mfma_f32_16x16x32_bf16 v[72:75], a[244:247], a[88:91], v[72:75]
 v_exp_f32 v35, v245
 v_mfma_f32_16x16x32_bf16 v[76:79], a[244:247], a[92:95], v[76:79]
 v_exp_f32 v36, v246
 v_mfma_f32_16x16x32_bf16 v[48:51], a[248:251], a[96:99], v[48:51]
 v_exp_f32 v37, v247
 v_mfma_f32_16x16x32_bf16 v[52:55], a[248:251], a[100:103], v[52:55]
 v_accvgpr_read_b32 v46, a4
 v_mul_f32 v244, v244, v46
 v_mfma_f32_16x16x32_bf16 v[56:59], a[248:251], a[104:107], v[56:59]
 v_accvgpr_read_b32 v47, a5
 v_mul_f32 v245, v245, v47
 v_mfma_f32_16x16x32_bf16 v[60:63], a[248:251], a[108:111], v[60:63]
 v_accvgpr_read_b32 v46, a6
 v_mul_f32 v246, v246, v46
 s_waitcnt lgkmcnt(0)
 v_mfma_f32_16x16x32_bf16 v[64:67], a[252:255], a[96:99], v[64:67]
 v_accvgpr_read_b32 v47, a7
 v_mul_f32 v247, v247, v47
 v_mfma_f32_16x16x32_bf16 v[68:71], a[252:255], a[100:103], v[68:71]
 v_fma_f32 v34, v34, s93, s93
 v_fma_f32 v35, v35, s93, s93
 v_mfma_f32_16x16x32_bf16 v[72:75], a[252:255], a[104:107], v[72:75]
 v_fma_f32 v36, v36, s93, s93
 v_fma_f32 v37, v37, s93, s93
 v_mfma_f32_16x16x32_bf16 v[76:79], a[252:255], a[108:111], v[76:79]
 v_rcp_f32 v34, v34
 v_rcp_f32 v35, v35
 v_rcp_f32 v36, v36
 v_rcp_f32 v37, v37
 v_mul_f32 v244, v244, v34
 v_mul_f32 v245, v245, v35
 v_mul_f32 v246, v246, v36
 v_mul_f32 v247, v247, v37
 v_cvt_pk_bf16_f32 v240, v240, v241
 v_cvt_pk_bf16_f32 v241, v242, v243
 v_cvt_pk_bf16_f32 v242, v244, v245
 v_cvt_pk_bf16_f32 v243, v246, v247
 s_nop 0
 v_permlane16_swap_b32 v240, v242
 v_permlane16_swap_b32 v241, v243
 s_add_u32 s43, s35, 0x1000
 buffer_store_dwordx4 v[240:243], v1, s[20:23], s43 offen offset:2048 sc1
 v_exp_f32 v30, v248
 v_exp_f32 v31, v249
 v_exp_f32 v32, v250
 v_exp_f32 v33, v251
 v_accvgpr_read_b32 v46, a8
 v_mul_f32 v248, v248, v46
 v_accvgpr_read_b32 v47, a9
 v_mul_f32 v249, v249, v47
 v_accvgpr_read_b32 v46, a10
 v_mul_f32 v250, v250, v46
 v_accvgpr_read_b32 v47, a11
 v_mul_f32 v251, v251, v47
 v_fma_f32 v30, v30, s93, s93
 v_fma_f32 v31, v31, s93, s93
 v_fma_f32 v32, v32, s93, s93
 v_fma_f32 v33, v33, s93, s93
 v_rcp_f32 v30, v30
 v_rcp_f32 v31, v31
 v_rcp_f32 v32, v32
 v_rcp_f32 v33, v33
 v_mul_f32 v248, v248, v30
 v_mul_f32 v249, v249, v31
 v_mul_f32 v250, v250, v32
 v_mul_f32 v251, v251, v33
 v_exp_f32 v34, v252
 v_exp_f32 v35, v253
 v_exp_f32 v36, v254
 v_exp_f32 v37, v255
 v_accvgpr_read_b32 v46, a12
 v_mul_f32 v252, v252, v46
 v_accvgpr_read_b32 v47, a13
 v_mul_f32 v253, v253, v47
 v_accvgpr_read_b32 v46, a14
 v_mul_f32 v254, v254, v46
 v_accvgpr_read_b32 v47, a15
 v_mul_f32 v255, v255, v47
 v_fma_f32 v34, v34, s93, s93
 v_fma_f32 v35, v35, s93, s93
 v_fma_f32 v36, v36, s93, s93
 v_fma_f32 v37, v37, s93, s93
 v_rcp_f32 v34, v34
 v_rcp_f32 v35, v35
 v_rcp_f32 v36, v36
 v_rcp_f32 v37, v37
 v_mul_f32 v252, v252, v34
 v_mul_f32 v253, v253, v35
 v_mul_f32 v254, v254, v36
 v_mul_f32 v255, v255, v37
 v_cvt_pk_bf16_f32 v248, v248, v249
 v_cvt_pk_bf16_f32 v249, v250, v251
 v_cvt_pk_bf16_f32 v250, v252, v253
 v_cvt_pk_bf16_f32 v251, v254, v255
 s_nop 0
 v_permlane16_swap_b32 v248, v250
 v_permlane16_swap_b32 v249, v251
 s_add_u32 s43, s36, 0x1000
 buffer_store_dwordx4 v[248:251], v1, s[20:23], s43 offen offset:2048 sc1
 v_exp_f32 v30, v208
 v_exp_f32 v31, v209
 v_exp_f32 v32, v210
 v_exp_f32 v33, v211
 v_mul_f32 v208, v208, v224
 v_mul_f32 v209, v209, v225
 v_mul_f32 v210, v210, v226
 v_mul_f32 v211, v211, v227
 v_fma_f32 v30, v30, s93, s93
 v_fma_f32 v31, v31, s93, s93
 v_fma_f32 v32, v32, s93, s93
 v_fma_f32 v33, v33, s93, s93
 v_rcp_f32 v30, v30
 v_rcp_f32 v31, v31
 v_rcp_f32 v32, v32
 v_rcp_f32 v33, v33
 v_mul_f32 v208, v208, v30
 v_mul_f32 v209, v209, v31
 v_mul_f32 v210, v210, v32
 v_mul_f32 v211, v211, v33
 v_exp_f32 v34, v212
 v_exp_f32 v35, v213
 v_exp_f32 v36, v214
 v_exp_f32 v37, v215
 v_mul_f32 v212, v212, v228
 v_mul_f32 v213, v213, v229
 v_mul_f32 v214, v214, v230
 v_mul_f32 v215, v215, v231
 v_fma_f32 v34, v34, s93, s93
 v_fma_f32 v35, v35, s93, s93
 v_fma_f32 v36, v36, s93, s93
 v_fma_f32 v37, v37, s93, s93
 v_rcp_f32 v34, v34
 v_rcp_f32 v35, v35
 v_rcp_f32 v36, v36
 v_rcp_f32 v37, v37
 v_mul_f32 v212, v212, v34
 v_mul_f32 v213, v213, v35
 v_mul_f32 v214, v214, v36
 v_mul_f32 v215, v215, v37
 v_cvt_pk_bf16_f32 v208, v208, v209
 v_cvt_pk_bf16_f32 v209, v210, v211
 v_cvt_pk_bf16_f32 v210, v212, v213
 v_cvt_pk_bf16_f32 v211, v214, v215
 s_nop 0
 v_permlane16_swap_b32 v208, v210
 v_permlane16_swap_b32 v209, v211
 s_add_u32 s43, s35, 0x1000
 buffer_store_dwordx4 v[208:211], v1, s[20:23], s43 offen offset:1024 sc1
 v_exp_f32 v30, v216
 v_exp_f32 v31, v217
 v_exp_f32 v32, v218
 v_exp_f32 v33, v219
 v_mul_f32 v216, v216, v232
 v_mul_f32 v217, v217, v233
 v_mul_f32 v218, v218, v234
 v_mul_f32 v219, v219, v235
 v_fma_f32 v30, v30, s93, s93
 v_fma_f32 v31, v31, s93, s93
 v_fma_f32 v32, v32, s93, s93
 v_fma_f32 v33, v33, s93, s93
 v_rcp_f32 v30, v30
 v_rcp_f32 v31, v31
 v_rcp_f32 v32, v32
 v_rcp_f32 v33, v33
 v_mul_f32 v216, v216, v30
 v_mul_f32 v217, v217, v31
 v_mul_f32 v218, v218, v32
 v_mul_f32 v219, v219, v33
 v_exp_f32 v34, v220
 v_exp_f32 v35, v221
 v_exp_f32 v36, v222
 v_exp_f32 v37, v223
 v_mul_f32 v220, v220, v236
 v_mul_f32 v221, v221, v237
 v_mul_f32 v222, v222, v238
 v_mul_f32 v223, v223, v239
 v_fma_f32 v34, v34, s93, s93
 v_fma_f32 v35, v35, s93, s93
 v_fma_f32 v36, v36, s93, s93
 v_fma_f32 v37, v37, s93, s93
 v_rcp_f32 v34, v34
 v_rcp_f32 v35, v35
 v_rcp_f32 v36, v36
 v_rcp_f32 v37, v37
 v_mul_f32 v220, v220, v34
 v_mul_f32 v221, v221, v35
 v_mul_f32 v222, v222, v36
 v_mul_f32 v223, v223, v37
 v_cvt_pk_bf16_f32 v216, v216, v217
 v_cvt_pk_bf16_f32 v217, v218, v219
 v_cvt_pk_bf16_f32 v218, v220, v221
 v_cvt_pk_bf16_f32 v219, v222, v223
 s_nop 0
 v_permlane16_swap_b32 v216, v218
 v_permlane16_swap_b32 v217, v219
 s_add_u32 s43, s36, 0x1000
 buffer_store_dwordx4 v[216:219], v1, s[20:23], s43 offen offset:1024 sc1
 v_exp_f32 v30, v176
 v_exp_f32 v31, v177
 v_exp_f32 v32, v178
 v_exp_f32 v33, v179
 v_mul_f32 v176, v176, v192
 v_mul_f32 v177, v177, v193
 v_mul_f32 v178, v178, v194
 v_mul_f32 v179, v179, v195
 v_fma_f32 v30, v30, s93, s93
 v_fma_f32 v31, v31, s93, s93
 v_fma_f32 v32, v32, s93, s93
 v_fma_f32 v33, v33, s93, s93
 v_rcp_f32 v30, v30
 v_rcp_f32 v31, v31
 v_rcp_f32 v32, v32
 v_rcp_f32 v33, v33
 v_mul_f32 v176, v176, v30
 v_mul_f32 v177, v177, v31
 v_mul_f32 v178, v178, v32
 v_mul_f32 v179, v179, v33
 v_exp_f32 v34, v180
 v_exp_f32 v35, v181
 v_exp_f32 v36, v182
 v_exp_f32 v37, v183
 v_mul_f32 v180, v180, v196
 v_mul_f32 v181, v181, v197
 v_mul_f32 v182, v182, v198
 v_mul_f32 v183, v183, v199
 v_fma_f32 v34, v34, s93, s93
 v_fma_f32 v35, v35, s93, s93
 v_fma_f32 v36, v36, s93, s93
 v_fma_f32 v37, v37, s93, s93
 v_rcp_f32 v34, v34
 v_rcp_f32 v35, v35
 v_rcp_f32 v36, v36
 v_rcp_f32 v37, v37
 v_mul_f32 v180, v180, v34
 v_mul_f32 v181, v181, v35
 v_mul_f32 v182, v182, v36
 v_mul_f32 v183, v183, v37
 v_cvt_pk_bf16_f32 v176, v176, v177
 v_cvt_pk_bf16_f32 v177, v178, v179
 v_cvt_pk_bf16_f32 v178, v180, v181
 v_cvt_pk_bf16_f32 v179, v182, v183
 s_nop 0
 v_permlane16_swap_b32 v176, v178
 v_permlane16_swap_b32 v177, v179
 s_add_u32 s43, s35, 0x1000
 buffer_store_dwordx4 v[176:179], v1, s[20:23], s43 offen sc1
 v_exp_f32 v30, v184
 v_exp_f32 v31, v185
 v_exp_f32 v32, v186
 v_exp_f32 v33, v187
 v_mul_f32 v184, v184, v200
 v_mul_f32 v185, v185, v201
 v_mul_f32 v186, v186, v202
 v_mul_f32 v187, v187, v203
 v_fma_f32 v30, v30, s93, s93
 v_fma_f32 v31, v31, s93, s93
 v_fma_f32 v32, v32, s93, s93
 v_fma_f32 v33, v33, s93, s93
 v_rcp_f32 v30, v30
 v_rcp_f32 v31, v31
 v_rcp_f32 v32, v32
 v_rcp_f32 v33, v33
 v_mul_f32 v184, v184, v30
 v_mul_f32 v185, v185, v31
 v_mul_f32 v186, v186, v32
 v_mul_f32 v187, v187, v33
 v_exp_f32 v34, v188
 v_exp_f32 v35, v189
 v_exp_f32 v36, v190
 v_exp_f32 v37, v191
 v_mul_f32 v188, v188, v204
 v_mul_f32 v189, v189, v205
 v_mul_f32 v190, v190, v206
 v_mul_f32 v191, v191, v207
 v_fma_f32 v34, v34, s93, s93
 v_fma_f32 v35, v35, s93, s93
 v_fma_f32 v36, v36, s93, s93
 v_fma_f32 v37, v37, s93, s93
 v_rcp_f32 v34, v34
 v_rcp_f32 v35, v35
 v_rcp_f32 v36, v36
 v_rcp_f32 v37, v37
 v_mul_f32 v188, v188, v34
 v_mul_f32 v189, v189, v35
 v_mul_f32 v190, v190, v36
 v_mul_f32 v191, v191, v37
 v_cvt_pk_bf16_f32 v184, v184, v185
 v_cvt_pk_bf16_f32 v185, v186, v187
 v_cvt_pk_bf16_f32 v186, v188, v189
 v_cvt_pk_bf16_f32 v187, v190, v191
 s_nop 0
 v_permlane16_swap_b32 v184, v186
 v_permlane16_swap_b32 v185, v187
 s_add_u32 s43, s36, 0x1000
 buffer_store_dwordx4 v[184:187], v1, s[20:23], s43 offen sc1
 v_exp_f32 v30, v144
 v_exp_f32 v31, v145
 v_exp_f32 v32, v146
 v_exp_f32 v33, v147
 v_mul_f32 v144, v144, v160
 v_mul_f32 v145, v145, v161
 v_mul_f32 v146, v146, v162
 v_mul_f32 v147, v147, v163
 v_fma_f32 v30, v30, s93, s93
 v_fma_f32 v31, v31, s93, s93
 v_fma_f32 v32, v32, s93, s93
 v_fma_f32 v33, v33, s93, s93
 v_rcp_f32 v30, v30
 v_rcp_f32 v31, v31
 v_rcp_f32 v32, v32
 v_rcp_f32 v33, v33
 v_mul_f32 v144, v144, v30
 v_mul_f32 v145, v145, v31
 v_mul_f32 v146, v146, v32
 v_mul_f32 v147, v147, v33
 v_exp_f32 v34, v148
 v_exp_f32 v35, v149
 v_exp_f32 v36, v150
 v_exp_f32 v37, v151
 v_mul_f32 v148, v148, v164
 v_mul_f32 v149, v149, v165
 v_mul_f32 v150, v150, v166
 v_mul_f32 v151, v151, v167
 v_fma_f32 v34, v34, s93, s93
 v_fma_f32 v35, v35, s93, s93
 v_fma_f32 v36, v36, s93, s93
 v_fma_f32 v37, v37, s93, s93
 v_rcp_f32 v34, v34
 v_rcp_f32 v35, v35
 v_rcp_f32 v36, v36
 v_rcp_f32 v37, v37
 v_mul_f32 v148, v148, v34
 v_mul_f32 v149, v149, v35
 v_mul_f32 v150, v150, v36
 v_mul_f32 v151, v151, v37
 v_cvt_pk_bf16_f32 v144, v144, v145
 v_cvt_pk_bf16_f32 v145, v146, v147
 v_cvt_pk_bf16_f32 v146, v148, v149
 v_cvt_pk_bf16_f32 v147, v150, v151
 s_nop 0
 v_permlane16_swap_b32 v144, v146
 v_permlane16_swap_b32 v145, v147
 buffer_store_dwordx4 v[144:147], v1, s[20:23], s35 offen offset:3072 sc1
 v_exp_f32 v30, v152
 v_exp_f32 v31, v153
 v_exp_f32 v32, v154
 v_exp_f32 v33, v155
 v_mul_f32 v152, v152, v168
 v_mul_f32 v153, v153, v169
 v_mul_f32 v154, v154, v170
 v_mul_f32 v155, v155, v171
 v_fma_f32 v30, v30, s93, s93
 v_fma_f32 v31, v31, s93, s93
 v_fma_f32 v32, v32, s93, s93
 v_fma_f32 v33, v33, s93, s93
 v_rcp_f32 v30, v30
 v_rcp_f32 v31, v31
 v_rcp_f32 v32, v32
 v_rcp_f32 v33, v33
 v_mul_f32 v152, v152, v30
 v_mul_f32 v153, v153, v31
 v_mul_f32 v154, v154, v32
 v_mul_f32 v155, v155, v33
 v_exp_f32 v34, v156
 v_exp_f32 v35, v157
 v_exp_f32 v36, v158
 v_exp_f32 v37, v159
 v_mul_f32 v156, v156, v172
 v_mul_f32 v157, v157, v173
 v_mul_f32 v158, v158, v174
 v_mul_f32 v159, v159, v175
 v_fma_f32 v34, v34, s93, s93
 v_fma_f32 v35, v35, s93, s93
 v_fma_f32 v36, v36, s93, s93
 v_fma_f32 v37, v37, s93, s93
 v_rcp_f32 v34, v34
 v_rcp_f32 v35, v35
 v_rcp_f32 v36, v36
 v_rcp_f32 v37, v37
 v_mul_f32 v156, v156, v34
 v_mul_f32 v157, v157, v35
 v_mul_f32 v158, v158, v36
 v_mul_f32 v159, v159, v37
 v_cvt_pk_bf16_f32 v152, v152, v153
 v_cvt_pk_bf16_f32 v153, v154, v155
 v_cvt_pk_bf16_f32 v154, v156, v157
 v_cvt_pk_bf16_f32 v155, v158, v159
 s_nop 0
 v_permlane16_swap_b32 v152, v154
 v_permlane16_swap_b32 v153, v155
 buffer_store_dwordx4 v[152:155], v1, s[20:23], s36 offen offset:3072 sc1
 s_lshr_b32 s91, s2, 5
 s_lshl_b32 s91, s91, 3
 s_and_b32 s92, s2, 7
 s_add_u32 s91, s91, s92
 s_lshl_b32 s91, s91, 2
 s_add_u32 s91, s91, s28
 s_lshl_b32 s91, s91, 7
 s_add_u32 s91, s91, 0x30000
 v_mov_b32 v17, 1
 v_lshlrev_b32 v18, 20, v0
 s_waitcnt vmcnt(2)
 buffer_atomic_add v17, v18, s[4:7], s91 offen sc1
 v_exp_f32 v30, v112
 v_exp_f32 v31, v113
 v_exp_f32 v32, v114
 v_exp_f32 v33, v115
 v_mul_f32 v112, v112, v128
 v_mul_f32 v113, v113, v129
 v_mul_f32 v114, v114, v130
 v_mul_f32 v115, v115, v131
 v_fma_f32 v30, v30, s93, s93
 v_fma_f32 v31, v31, s93, s93
 v_fma_f32 v32, v32, s93, s93
 v_fma_f32 v33, v33, s93, s93
 v_rcp_f32 v30, v30
 v_rcp_f32 v31, v31
 v_rcp_f32 v32, v32
 v_rcp_f32 v33, v33
 v_mul_f32 v112, v112, v30
 v_mul_f32 v113, v113, v31
 v_mul_f32 v114, v114, v32
 v_mul_f32 v115, v115, v33
 v_exp_f32 v34, v116
 v_exp_f32 v35, v117
 v_exp_f32 v36, v118
 v_exp_f32 v37, v119
 v_mul_f32 v116, v116, v132
 v_mul_f32 v117, v117, v133
 v_mul_f32 v118, v118, v134
 v_mul_f32 v119, v119, v135
 v_fma_f32 v34, v34, s93, s93
 v_fma_f32 v35, v35, s93, s93
 v_fma_f32 v36, v36, s93, s93
 v_fma_f32 v37, v37, s93, s93
 v_rcp_f32 v34, v34
 v_rcp_f32 v35, v35
 v_rcp_f32 v36, v36
 v_rcp_f32 v37, v37
 v_mul_f32 v116, v116, v34
 v_mul_f32 v117, v117, v35
 v_mul_f32 v118, v118, v36
 v_mul_f32 v119, v119, v37
 v_cvt_pk_bf16_f32 v112, v112, v113
 v_cvt_pk_bf16_f32 v113, v114, v115
 v_cvt_pk_bf16_f32 v114, v116, v117
 v_cvt_pk_bf16_f32 v115, v118, v119
 s_nop 0
 v_permlane16_swap_b32 v112, v114
 v_permlane16_swap_b32 v113, v115
 buffer_store_dwordx4 v[112:115], v1, s[20:23], s35 offen offset:2048 sc1
 v_exp_f32 v30, v120
 v_exp_f32 v31, v121
 v_exp_f32 v32, v122
 v_exp_f32 v33, v123
 v_mul_f32 v120, v120, v136
 v_mul_f32 v121, v121, v137
 v_mul_f32 v122, v122, v138
 v_mul_f32 v123, v123, v139
 v_fma_f32 v30, v30, s93, s93
 v_fma_f32 v31, v31, s93, s93
 v_fma_f32 v32, v32, s93, s93
 v_fma_f32 v33, v33, s93, s93
 v_rcp_f32 v30, v30
 v_rcp_f32 v31, v31
 v_rcp_f32 v32, v32
 v_rcp_f32 v33, v33
 v_mul_f32 v120, v120, v30
 v_mul_f32 v121, v121, v31
 v_mul_f32 v122, v122, v32
 v_mul_f32 v123, v123, v33
 v_exp_f32 v34, v124
 v_exp_f32 v35, v125
 v_exp_f32 v36, v126
 v_exp_f32 v37, v127
 v_mul_f32 v124, v124, v140
 v_mul_f32 v125, v125, v141
 v_mul_f32 v126, v126, v142
 v_mul_f32 v127, v127, v143
 v_fma_f32 v34, v34, s93, s93
 v_fma_f32 v35, v35, s93, s93
 v_fma_f32 v36, v36, s93, s93
 v_fma_f32 v37, v37, s93, s93
 v_rcp_f32 v34, v34
 v_rcp_f32 v35, v35
 v_rcp_f32 v36, v36
 v_rcp_f32 v37, v37
 v_mul_f32 v124, v124, v34
 v_mul_f32 v125, v125, v35
 v_mul_f32 v126, v126, v36
 v_mul_f32 v127, v127, v37
 v_cvt_pk_bf16_f32 v120, v120, v121
 v_cvt_pk_bf16_f32 v121, v122, v123
 v_cvt_pk_bf16_f32 v122, v124, v125
 v_cvt_pk_bf16_f32 v123, v126, v127
 s_nop 0
 v_permlane16_swap_b32 v120, v122
 v_permlane16_swap_b32 v121, v123
 buffer_store_dwordx4 v[120:123], v1, s[20:23], s36 offen offset:2048 sc1
 buffer_load_dword v16, off, s[4:7], s91 sc1
 v_exp_f32 v30, v80
 v_exp_f32 v31, v81
 v_exp_f32 v32, v82
 v_exp_f32 v33, v83
 v_mul_f32 v80, v80, v96
 v_mul_f32 v81, v81, v97
 v_mul_f32 v82, v82, v98
 v_mul_f32 v83, v83, v99
 v_fma_f32 v30, v30, s93, s93
 v_fma_f32 v31, v31, s93, s93
 v_fma_f32 v32, v32, s93, s93
 v_fma_f32 v33, v33, s93, s93
 v_rcp_f32 v30, v30
 v_rcp_f32 v31, v31
 v_rcp_f32 v32, v32
 v_rcp_f32 v33, v33
 v_mul_f32 v80, v80, v30
 v_mul_f32 v81, v81, v31
 v_mul_f32 v82, v82, v32
 v_mul_f32 v83, v83, v33
 v_exp_f32 v34, v84
 v_exp_f32 v35, v85
 v_exp_f32 v36, v86
 v_exp_f32 v37, v87
 v_mul_f32 v84, v84, v100
 v_mul_f32 v85, v85, v101
 v_mul_f32 v86, v86, v102
 v_mul_f32 v87, v87, v103
 v_fma_f32 v34, v34, s93, s93
 v_fma_f32 v35, v35, s93, s93
 v_fma_f32 v36, v36, s93, s93
 v_fma_f32 v37, v37, s93, s93
 v_rcp_f32 v34, v34
 v_rcp_f32 v35, v35
 v_rcp_f32 v36, v36
 v_rcp_f32 v37, v37
 v_mul_f32 v84, v84, v34
 v_mul_f32 v85, v85, v35
 v_mul_f32 v86, v86, v36
 v_mul_f32 v87, v87, v37
 v_cvt_pk_bf16_f32 v80, v80, v81
 v_cvt_pk_bf16_f32 v81, v82, v83
 v_cvt_pk_bf16_f32 v82, v84, v85
 v_cvt_pk_bf16_f32 v83, v86, v87
 s_nop 0
 v_permlane16_swap_b32 v80, v82
 v_permlane16_swap_b32 v81, v83
 buffer_store_dwordx4 v[80:83], v1, s[20:23], s35 offen offset:1024 sc1
 v_exp_f32 v30, v88
 v_exp_f32 v31, v89
 v_exp_f32 v32, v90
 v_exp_f32 v33, v91
 v_mul_f32 v88, v88, v104
 v_mul_f32 v89, v89, v105
 v_mul_f32 v90, v90, v106
 v_mul_f32 v91, v91, v107
 v_fma_f32 v30, v30, s93, s93
 v_fma_f32 v31, v31, s93, s93
 v_fma_f32 v32, v32, s93, s93
 v_fma_f32 v33, v33, s93, s93
 v_rcp_f32 v30, v30
 v_rcp_f32 v31, v31
 v_rcp_f32 v32, v32
 v_rcp_f32 v33, v33
 v_mul_f32 v88, v88, v30
 v_mul_f32 v89, v89, v31
 v_mul_f32 v90, v90, v32
 v_mul_f32 v91, v91, v33
 v_exp_f32 v34, v92
 v_exp_f32 v35, v93
 v_exp_f32 v36, v94
 v_exp_f32 v37, v95
 v_mul_f32 v92, v92, v108
 v_mul_f32 v93, v93, v109
 v_mul_f32 v94, v94, v110
 v_mul_f32 v95, v95, v111
 v_fma_f32 v34, v34, s93, s93
 v_fma_f32 v35, v35, s93, s93
 v_fma_f32 v36, v36, s93, s93
 v_fma_f32 v37, v37, s93, s93
 v_rcp_f32 v34, v34
 v_rcp_f32 v35, v35
 v_rcp_f32 v36, v36
 v_rcp_f32 v37, v37
 v_mul_f32 v92, v92, v34
 v_mul_f32 v93, v93, v35
 v_mul_f32 v94, v94, v36
 v_mul_f32 v95, v95, v37
 v_cvt_pk_bf16_f32 v88, v88, v89
 v_cvt_pk_bf16_f32 v89, v90, v91
 v_cvt_pk_bf16_f32 v90, v92, v93
 v_cvt_pk_bf16_f32 v91, v94, v95
 s_nop 0
 v_permlane16_swap_b32 v88, v90
 v_permlane16_swap_b32 v89, v91
 buffer_store_dwordx4 v[88:91], v1, s[20:23], s36 offen offset:1024 sc1
 s_waitcnt vmcnt(2)
 v_cmp_ne_u32 vcc, 4, v16
 s_nop 1
 s_cbranch_vccz gateup_eb_ok
 s_mov_b32 s92, 0
gateup_eb:
 s_sleep 2
 buffer_load_dword v16, off, s[4:7], s91 sc1
 s_waitcnt vmcnt(0)
 v_cmp_ne_u32 vcc, 4, v16
 s_add_u32 s92, s92, 1
 s_cmp_ge_u32 s92, 0x100000
 s_cbranch_scc1 gateup_eb_ok
 s_cbranch_vccnz gateup_eb
gateup_eb_ok:
 s_and_b32 s92, s29, 3
 s_mul_i32 s92, s92, 0x2400
 s_sub_u32 s92, s35, s92
 s_add_u32 s94, s92, 0x1000
 s_add_u32 s95, s92, 0x49000
 buffer_load_dwordx4 a[0:3], v11, s[20:23], s94 offen sc1
 buffer_load_dwordx4 a[4:7], v11, s[20:23], s94 offen offset:256 sc1
 buffer_load_dwordx4 a[8:11], v11, s[20:23], s95 offen sc1
 buffer_load_dwordx4 a[12:15], v11, s[20:23], s95 offen offset:256 sc1
 s_add_u32 s94, s92, 0x1800
 s_add_u32 s95, s92, 0x49800
 buffer_load_dwordx4 a[16:19], v11, s[20:23], s94 offen sc1
 buffer_load_dwordx4 a[20:23], v11, s[20:23], s94 offen offset:256 sc1
 buffer_load_dwordx4 a[24:27], v11, s[20:23], s95 offen sc1
 buffer_load_dwordx4 a[28:31], v11, s[20:23], s95 offen offset:256 sc1
 s_add_u32 s94, s92, 0x3800
 s_add_u32 s95, s92, 0x4b800
 buffer_load_dwordx4 a[32:35], v11, s[20:23], s94 offen sc1
 buffer_load_dwordx4 a[36:39], v11, s[20:23], s94 offen offset:256 sc1
 buffer_load_dwordx4 a[40:43], v11, s[20:23], s95 offen sc1
 buffer_load_dwordx4 a[44:47], v11, s[20:23], s95 offen offset:256 sc1
 s_add_u32 s94, s92, 0x4000
 s_add_u32 s95, s92, 0x4c000
 buffer_load_dwordx4 a[48:51], v11, s[20:23], s94 offen sc1
 buffer_load_dwordx4 a[52:55], v11, s[20:23], s94 offen offset:256 sc1
 buffer_load_dwordx4 a[56:59], v11, s[20:23], s95 offen sc1
 buffer_load_dwordx4 a[60:63], v11, s[20:23], s95 offen offset:256 sc1
 s_add_u32 s94, s92, 0x5800
 s_add_u32 s95, s92, 0x4d800
 buffer_load_dwordx4 a[64:67], v11, s[20:23], s94 offen sc1
 buffer_load_dwordx4 a[68:71], v11, s[20:23], s94 offen offset:256 sc1
 buffer_load_dwordx4 a[72:75], v11, s[20:23], s95 offen sc1
 buffer_load_dwordx4 a[76:79], v11, s[20:23], s95 offen offset:256 sc1
 s_add_u32 s94, s92, 0x6000
 s_add_u32 s95, s92, 0x4e000
 buffer_load_dwordx4 a[80:83], v11, s[20:23], s94 offen sc1
 buffer_load_dwordx4 a[84:87], v11, s[20:23], s94 offen offset:256 sc1
 buffer_load_dwordx4 a[88:91], v11, s[20:23], s95 offen sc1
 buffer_load_dwordx4 a[92:95], v11, s[20:23], s95 offen offset:256 sc1
 s_add_u32 s94, s92, 0x8000
 s_add_u32 s95, s92, 0x50000
 buffer_load_dwordx4 a[96:99], v11, s[20:23], s94 offen sc1
 buffer_load_dwordx4 a[100:103], v11, s[20:23], s94 offen offset:256 sc1
 buffer_load_dwordx4 a[104:107], v11, s[20:23], s95 offen sc1
 buffer_load_dwordx4 a[108:111], v11, s[20:23], s95 offen offset:256 sc1
 s_add_u32 s94, s92, 0x8800
 s_add_u32 s95, s92, 0x50800
 buffer_load_dwordx4 a[112:115], v11, s[20:23], s94 offen sc1
 buffer_load_dwordx4 a[116:119], v11, s[20:23], s94 offen offset:256 sc1
 buffer_load_dwordx4 a[120:123], v11, s[20:23], s95 offen sc1
 buffer_load_dwordx4 a[124:127], v11, s[20:23], s95 offen offset:256 sc1
 v_exp_f32 v30, v48
 v_exp_f32 v31, v49
 v_exp_f32 v32, v50
 v_exp_f32 v33, v51
 v_mul_f32 v48, v48, v64
 v_mul_f32 v49, v49, v65
 v_mul_f32 v50, v50, v66
 v_mul_f32 v51, v51, v67
 v_fma_f32 v30, v30, s93, s93
 v_fma_f32 v31, v31, s93, s93
 v_fma_f32 v32, v32, s93, s93
 v_fma_f32 v33, v33, s93, s93
 v_rcp_f32 v30, v30
 v_rcp_f32 v31, v31
 v_rcp_f32 v32, v32
 v_rcp_f32 v33, v33
 v_mul_f32 v48, v48, v30
 v_mul_f32 v49, v49, v31
 v_mul_f32 v50, v50, v32
 v_mul_f32 v51, v51, v33
 v_exp_f32 v34, v52
 v_exp_f32 v35, v53
 v_exp_f32 v36, v54
 v_exp_f32 v37, v55
 v_mul_f32 v52, v52, v68
 v_mul_f32 v53, v53, v69
 v_mul_f32 v54, v54, v70
 v_mul_f32 v55, v55, v71
 v_fma_f32 v34, v34, s93, s93
 v_fma_f32 v35, v35, s93, s93
 v_fma_f32 v36, v36, s93, s93
 v_fma_f32 v37, v37, s93, s93
 v_rcp_f32 v34, v34
 v_rcp_f32 v35, v35
 v_rcp_f32 v36, v36
 v_rcp_f32 v37, v37
 v_mul_f32 v52, v52, v34
 v_mul_f32 v53, v53, v35
 v_mul_f32 v54, v54, v36
 v_mul_f32 v55, v55, v37
 v_cvt_pk_bf16_f32 v48, v48, v49
 v_cvt_pk_bf16_f32 v49, v50, v51
 v_cvt_pk_bf16_f32 v50, v52, v53
 v_cvt_pk_bf16_f32 v51, v54, v55
 s_nop 0
 v_permlane16_swap_b32 v48, v50
 v_permlane16_swap_b32 v49, v51
 buffer_store_dwordx4 v[48:51], v1, s[20:23], s35 offen sc1
 v_exp_f32 v30, v56
 v_exp_f32 v31, v57
 v_exp_f32 v32, v58
 v_exp_f32 v33, v59
 v_mul_f32 v56, v56, v72
 v_mul_f32 v57, v57, v73
 v_mul_f32 v58, v58, v74
 v_mul_f32 v59, v59, v75
 v_fma_f32 v30, v30, s93, s93
 v_fma_f32 v31, v31, s93, s93
 v_fma_f32 v32, v32, s93, s93
 v_fma_f32 v33, v33, s93, s93
 v_rcp_f32 v30, v30
 v_rcp_f32 v31, v31
 v_rcp_f32 v32, v32
 v_rcp_f32 v33, v33
 v_mul_f32 v56, v56, v30
 v_mul_f32 v57, v57, v31
 v_mul_f32 v58, v58, v32
 v_mul_f32 v59, v59, v33
 v_exp_f32 v34, v60
 v_exp_f32 v35, v61
 v_exp_f32 v36, v62
 v_exp_f32 v37, v63
 v_mul_f32 v60, v60, v76
 v_mul_f32 v61, v61, v77
 v_mul_f32 v62, v62, v78
 v_mul_f32 v63, v63, v79
 v_fma_f32 v34, v34, s93, s93
 v_fma_f32 v35, v35, s93, s93
 v_fma_f32 v36, v36, s93, s93
 v_fma_f32 v37, v37, s93, s93
 v_rcp_f32 v34, v34
 v_rcp_f32 v35, v35
 v_rcp_f32 v36, v36
 v_rcp_f32 v37, v37
 v_mul_f32 v60, v60, v34
 v_mul_f32 v61, v61, v35
 v_mul_f32 v62, v62, v36
 v_mul_f32 v63, v63, v37
 v_cvt_pk_bf16_f32 v56, v56, v57
 v_cvt_pk_bf16_f32 v57, v58, v59
 v_cvt_pk_bf16_f32 v58, v60, v61
 v_cvt_pk_bf16_f32 v59, v62, v63
 s_nop 0
 v_permlane16_swap_b32 v56, v58
 v_permlane16_swap_b32 v57, v59
 buffer_store_dwordx4 v[56:59], v1, s[20:23], s36 offen sc1
ph_down:
 v_mov_b32 v2, v19
 v_mov_b32 v3, v20
 v_mov_b32 v4, v21
 v_mov_b32 v5, v22
 v_mov_b32 v6, v23
 v_mov_b32 v7, v24
 v_mov_b32 v8, v25
 v_mov_b32 v9, v26
 v_mov_b32 v10, v27
 v_mbcnt_lo_u32_b32 v0, -1, 0
 v_mbcnt_hi_u32_b32 v0, -1, v0
 v_lshl_add_u32 v0, s100, 6, v0
 s_load_dwordx2 s[4:5], s[0:1], 0x68
 s_load_dwordx2 s[8:9], s[0:1], 64
 s_load_dwordx2 s[12:13], s[0:1], 0x68
 s_load_dwordx2 s[16:17], s[0:1], 0x68
 s_load_dwordx2 s[20:21], s[0:1], 0x68
 s_load_dwordx2 s[24:25], s[0:1], 0x68
 s_load_dwordx2 s[28:29], s[0:1], 0x58
 v_mov_b32 v17, v0
 v_lshrrev_b32 v1, 6, v0
 s_nop 0
 v_readfirstlane_b32 s36, v1
 v_and_b32 v0, 63, v0
 v_lshlrev_b32 v1, 4, v0
 s_and_b32 s37, s2, 7
 s_lshr_b32 s84, s2, 3
 s_and_b32 s39, s84, 3
 s_lshr_b32 s38, s84, 2
 s_lshl_b32 s84, s38, 3
 s_lshl_b32 s85, s36, 1
 s_add_u32 s86, s84, s85
 s_mul_i32 s42, s86, 0x48000
 s_mul_i32 s84, s37, 0x9000
 s_add_u32 s42, s42, s84
 s_add_u32 s43, s42, 0x48000
 s_mul_i32 s45, s37, 0x240000
 s_mul_i32 s84, s86, 0x9000
 s_add_u32 s45, s45, s84
 s_mul_i32 s84, s39, 0x2400
 s_add_u32 s45, s45, s84
 s_add_u32 s46, s45, 0x9000
 s_mul_i32 s41, s37, 0xa2000
 s_mul_i32 s84, s36, 0x9000
 s_add_u32 s41, s41, s84
 s_mul_i32 s84, s39, 0x120
 s_add_u32 s41, s41, s84
 s_mul_i32 s44, s36, 0x2400
 v_lshrrev_b32 v18, 5, v0
 v_lshlrev_b32 v11, 10, v18
 v_bfe_u32 v18, v0, 4, 1
 v_lshl_add_u32 v11, v18, 9, v11
 v_and_b32 v19, 15, v0
 v_lshl_add_u32 v11, v19, 4, v11
 s_movk_i32 s85, 0xe39
 s_waitcnt lgkmcnt(0)
 s_add_u32 s4, s4, 0x1800000
 s_addc_u32 s5, s5, 0
 s_mov_b32 s6, 0x1200000
 s_mov_b32 s7, 0x20000
 s_mov_b32 s10, 0x510000
 s_mov_b32 s11, 0x20000
 s_mul_i32 s83, s39, 9
 s_add_u32 s83, s83, 1
 s_lshr_b32 s83, s83, 1
 s_mov_b32 s14, 0xa200
 s_mov_b32 s15, 0x20000
 s_add_u32 s16, s16, 0x3200000
 s_addc_u32 s17, s17, 0
 s_mov_b32 s18, 0x1200000
 s_mov_b32 s19, 0x20000
 s_add_u32 s20, s20, 0x2a00000
 s_addc_u32 s21, s21, 0
 s_mov_b32 s22, 0x40000
 s_mov_b32 s23, 0x20000
 s_add_u32 s24, s24, 0x280000
 s_addc_u32 s25, s25, 0
 s_mov_b32 s26, 0x240000
 s_mov_b32 s27, 0x20000
 s_mov_b32 s30, 0x240000
 s_mov_b32 s31, 0x20000
 s_lshl_b32 s84, s38, 3
 s_add_u32 s84, s84, s37
 s_lshl_b32 s84, s84, 2
 s_add_u32 s84, s84, s36
 s_lshl_b32 s84, s84, 7
 s_add_u32 s93, s84, 0x20000
 v_lshlrev_b32 v18, 20, v0
 v_mov_b32 v19, 1
 s_waitcnt vmcnt(0)
 s_waitcnt vmcnt(0)
 buffer_atomic_add v19, v18, s[20:23], s93 offen sc1
 s_barrier
 v_bfe_u32 v19, v0, 2, 2
 v_lshrrev_b32 v20, 5, v0
 v_lshlrev_b32 v20, 4, v20
 v_bfe_u32 v23, v0, 4, 1
 v_lshl_add_u32 v20, v23, 2, v20
 v_add_u32 v20, v20, v19
 v_mul_u32_u24 v20, 0x120, v20
 v_and_b32 v21, 3, v0
 v_lshl_add_u32 v12, v21, 3, v20
 v_add_u32 v13, 0xd800, v12
 v_add_u32 v14, 0x1b000, v12
 v_mov_b32 v16, 1
 v_lshlrev_b32 v15, 20, v0
 s_lshl_b32 s84, s38, 2
 s_add_u32 s84, s84, s36
 s_lshl_b32 s84, s84, 2
 s_add_u32 s84, s84, s39
 s_mul_i32 s92, s84, 0x180
 s_add_u32 s92, s92, 0xc000
 ds_read_b64_tr_b16 v[64:65], v12 offset:36864
 ds_read_b64_tr_b16 v[66:67], v12 offset:39168
 ds_read_b64_tr_b16 v[68:69], v12 offset:36896
 ds_read_b64_tr_b16 v[70:71], v12 offset:39200
 ds_read_b64_tr_b16 v[72:73], v12 offset:36928
 ds_read_b64_tr_b16 v[74:75], v12 offset:39232
 s_waitcnt lgkmcnt(4)
 v_mfma_f32_16x16x32_bf16 v[112:115], v[64:67], a[0:3], 0
 ds_read_b64_tr_b16 v[76:77], v12 offset:36960
 ds_read_b64_tr_b16 v[78:79], v12 offset:39264
 v_mfma_f32_16x16x32_bf16 v[116:119], v[64:67], a[4:7], 0
 ds_read_b64_tr_b16 v[80:81], v12 offset:36992
 ds_read_b64_tr_b16 v[82:83], v12 offset:39296
 v_mfma_f32_16x16x32_bf16 v[120:123], v[64:67], a[8:11], 0
 ds_read_b64_tr_b16 v[84:85], v12 offset:37024
 ds_read_b64_tr_b16 v[86:87], v12 offset:39328
 v_mfma_f32_16x16x32_bf16 v[124:127], v[64:67], a[12:15], 0
 s_lshl_b32 s87, s36, 3
 ds_read_b64_tr_b16 v[88:89], v12 offset:37056
 s_waitcnt lgkmcnt(9)
 v_mfma_f32_16x16x32_bf16 v[128:131], v[68:71], a[0:3], 0
 s_lshr_b32 s87, 0x5040100, s87
 ds_read_b64_tr_b16 v[90:91], v12 offset:39360
 v_mfma_f32_16x16x32_bf16 v[132:135], v[68:71], a[4:7], 0
 ds_read_b64_tr_b16 v[92:93], v12 offset:37088
 ds_read_b64_tr_b16 v[94:95], v12 offset:39392
 v_mfma_f32_16x16x32_bf16 v[136:139], v[68:71], a[8:11], 0
 s_and_b32 s87, s87, 0xff
 ds_read_b64_tr_b16 v[96:97], v12 offset:37120
 v_mfma_f32_16x16x32_bf16 v[140:143], v[68:71], a[12:15], 0
 ds_read_b64_tr_b16 v[98:99], v12 offset:39424
 ds_read_b64_tr_b16 v[100:101], v12 offset:46080
 s_waitcnt lgkmcnt(11)
 v_mfma_f32_16x16x32_bf16 v[144:147], v[72:75], a[0:3], 0
 s_sub_u32 s87, s87, s36
 ds_read_b64_tr_b16 v[102:103], v12 offset:48384
 v_mfma_f32_16x16x32_bf16 v[148:151], v[72:75], a[4:7], 0
 v_mfma_f32_16x16x32_bf16 v[152:155], v[72:75], a[8:11], 0
 s_mul_i32 s87, s87, 0x9000
 v_mfma_f32_16x16x32_bf16 v[156:159], v[72:75], a[12:15], 0
 ds_read_b64_tr_b16 v[104:105], v12 offset:46112
 ds_read_b64_tr_b16 v[106:107], v12 offset:48416
 v_mfma_f32_16x16x32_bf16 v[160:163], v[76:79], a[0:3], 0
 s_add_u32 s87, s87, s41
 v_mfma_f32_16x16x32_bf16 v[164:167], v[76:79], a[4:7], 0
 v_mfma_f32_16x16x32_bf16 v[168:171], v[76:79], a[8:11], 0
 s_add_u32 m0, s44, 0x1b000
 v_mfma_f32_16x16x32_bf16 v[172:175], v[76:79], a[12:15], 0
 ds_read_b64_tr_b16 v[108:109], v12 offset:46144
 s_waitcnt lgkmcnt(14)
 ds_read_b64_tr_b16 v[110:111], v12 offset:48448
 s_waitcnt lgkmcnt(4)
 v_mfma_f32_16x16x32_bf16 v[176:179], v[80:83], a[0:3], 0
 buffer_load_dwordx4 v2, s[8:11], s87 offen lds
 v_mfma_f32_16x16x32_bf16 v[180:183], v[80:83], a[4:7], 0
 v_mfma_f32_16x16x32_bf16 v[184:187], v[80:83], a[8:11], 0
 buffer_load_dwordx4 v3, s[8:11], s87 offen offset:1024 lds
 v_mfma_f32_16x16x32_bf16 v[188:191], v[80:83], a[12:15], 0
 ds_read_b64_tr_b16 v[64:65], v12 offset:46176
 ds_read_b64_tr_b16 v[66:67], v12 offset:48480
 v_mfma_f32_16x16x32_bf16 v[192:195], v[84:87], a[0:3], 0
 buffer_load_dwordx4 v4, s[8:11], s87 offen offset:2048 lds
 v_mfma_f32_16x16x32_bf16 v[196:199], v[84:87], a[4:7], 0
 v_mfma_f32_16x16x32_bf16 v[200:203], v[84:87], a[8:11], 0
 buffer_load_dwordx4 v5, s[8:11], s87 offen offset:3072 lds
 v_mfma_f32_16x16x32_bf16 v[204:207], v[84:87], a[12:15], 0
 ds_read_b64_tr_b16 v[68:69], v12 offset:46208
 ds_read_b64_tr_b16 v[70:71], v12 offset:48512
 v_mfma_f32_16x16x32_bf16 v[208:211], v[88:91], a[0:3], 0
 s_add_u32 m0, s44, 0x1c000
 v_mfma_f32_16x16x32_bf16 v[212:215], v[88:91], a[4:7], 0
 v_mfma_f32_16x16x32_bf16 v[216:219], v[88:91], a[8:11], 0
 buffer_load_dwordx4 v6, s[8:11], s87 offen lds
 v_mfma_f32_16x16x32_bf16 v[220:223], v[88:91], a[12:15], 0
 ds_read_b64_tr_b16 v[72:73], v12 offset:46240
 ds_read_b64_tr_b16 v[74:75], v12 offset:48544
 v_mfma_f32_16x16x32_bf16 v[224:227], v[92:95], a[0:3], 0
 buffer_load_dwordx4 v7, s[8:11], s87 offen offset:1024 lds
 v_mfma_f32_16x16x32_bf16 v[228:231], v[92:95], a[4:7], 0
 v_mfma_f32_16x16x32_bf16 v[232:235], v[92:95], a[8:11], 0
 buffer_load_dwordx4 v8, s[8:11], s87 offen offset:2048 lds
 v_mfma_f32_16x16x32_bf16 v[236:239], v[92:95], a[12:15], 0
 ds_read_b64_tr_b16 v[76:77], v12 offset:46272
 ds_read_b64_tr_b16 v[78:79], v12 offset:48576
 v_mfma_f32_16x16x32_bf16 v[240:243], v[96:99], a[0:3], 0
 buffer_load_dwordx4 v9, s[8:11], s87 offen offset:3072 lds
 v_mfma_f32_16x16x32_bf16 v[244:247], v[96:99], a[4:7], 0
 v_mfma_f32_16x16x32_bf16 v[248:251], v[96:99], a[8:11], 0
 s_add_u32 m0, s44, 0x1d000
 v_mfma_f32_16x16x32_bf16 v[252:255], v[96:99], a[12:15], 0
 ds_read_b64_tr_b16 v[80:81], v12 offset:46304
 ds_read_b64_tr_b16 v[82:83], v12 offset:48608
 v_mfma_f32_16x16x32_bf16 v[112:115], v[100:103], a[16:19], v[112:115]
 buffer_load_dwordx4 v10, s[8:11], s87 offen lds
 v_mfma_f32_16x16x32_bf16 v[116:119], v[100:103], a[20:23], v[116:119]
 v_mfma_f32_16x16x32_bf16 v[120:123], v[100:103], a[24:27], v[120:123]
 s_lshl_b32 s87, s36, 3
 v_mfma_f32_16x16x32_bf16 v[124:127], v[100:103], a[28:31], v[124:127]
 s_lshr_b32 s87, 0xd0a0906, s87
 ds_read_b64_tr_b16 v[84:85], v12 offset:46336
 s_waitcnt lgkmcnt(3)
 v_mfma_f32_16x16x32_bf16 v[128:131], v[104:107], a[16:19], v[128:131]
 ds_read_b64_tr_b16 v[86:87], v12 offset:48640
 v_mfma_f32_16x16x32_bf16 v[132:135], v[104:107], a[20:23], v[132:135]
 s_and_b32 s87, s87, 0xff
 v_mfma_f32_16x16x32_bf16 v[136:139], v[104:107], a[24:27], v[136:139]
 v_mfma_f32_16x16x32_bf16 v[140:143], v[104:107], a[28:31], v[140:143]
 s_sub_u32 s87, s87, s36
 ds_read_b64_tr_b16 v[88:89], v13
 v_mfma_f32_16x16x32_bf16 v[144:147], v[108:111], a[16:19], v[144:147]
 ds_read_b64_tr_b16 v[90:91], v13 offset:2304
 v_mfma_f32_16x16x32_bf16 v[148:151], v[108:111], a[20:23], v[148:151]
 s_mul_i32 s87, s87, 0x9000
 v_mfma_f32_16x16x32_bf16 v[152:155], v[108:111], a[24:27], v[152:155]
 v_mfma_f32_16x16x32_bf16 v[156:159], v[108:111], a[28:31], v[156:159]
 s_add_u32 s87, s87, s41
 ds_read_b64_tr_b16 v[92:93], v13 offset:32
 v_mfma_f32_16x16x32_bf16 v[160:163], v[64:67], a[16:19], v[160:163]
 ds_read_b64_tr_b16 v[94:95], v13 offset:2336
 v_mfma_f32_16x16x32_bf16 v[164:167], v[64:67], a[20:23], v[164:167]
 s_add_u32 m0, s44, 0
 v_mfma_f32_16x16x32_bf16 v[168:171], v[64:67], a[24:27], v[168:171]
 v_mfma_f32_16x16x32_bf16 v[172:175], v[64:67], a[28:31], v[172:175]
 buffer_load_dwordx4 v2, s[8:11], s87 offen lds
 v_mfma_f32_16x16x32_bf16 v[176:179], v[68:71], a[16:19], v[176:179]
 ds_read_b64_tr_b16 v[96:97], v13 offset:64
 ds_read_b64_tr_b16 v[98:99], v13 offset:2368
 v_mfma_f32_16x16x32_bf16 v[180:183], v[68:71], a[20:23], v[180:183]
 buffer_load_dwordx4 v3, s[8:11], s87 offen offset:1024 lds
 v_mfma_f32_16x16x32_bf16 v[184:187], v[68:71], a[24:27], v[184:187]
 v_mfma_f32_16x16x32_bf16 v[188:191], v[68:71], a[28:31], v[188:191]
 buffer_load_dwordx4 v4, s[8:11], s87 offen offset:2048 lds
 v_mfma_f32_16x16x32_bf16 v[192:195], v[72:75], a[16:19], v[192:195]
 ds_read_b64_tr_b16 v[100:101], v13 offset:96
 ds_read_b64_tr_b16 v[102:103], v13 offset:2400
 v_mfma_f32_16x16x32_bf16 v[196:199], v[72:75], a[20:23], v[196:199]
 buffer_load_dwordx4 v5, s[8:11], s87 offen offset:3072 lds
 v_mfma_f32_16x16x32_bf16 v[200:203], v[72:75], a[24:27], v[200:203]
 v_mfma_f32_16x16x32_bf16 v[204:207], v[72:75], a[28:31], v[204:207]
 s_add_u32 m0, s44, 0x1000
 ds_read_b64_tr_b16 v[104:105], v13 offset:128
 v_mfma_f32_16x16x32_bf16 v[208:211], v[76:79], a[16:19], v[208:211]
 ds_read_b64_tr_b16 v[106:107], v13 offset:2432
 v_mfma_f32_16x16x32_bf16 v[212:215], v[76:79], a[20:23], v[212:215]
 buffer_load_dwordx4 v6, s[8:11], s87 offen lds
 v_mfma_f32_16x16x32_bf16 v[216:219], v[76:79], a[24:27], v[216:219]
 v_mfma_f32_16x16x32_bf16 v[220:223], v[76:79], a[28:31], v[220:223]
 buffer_load_dwordx4 v7, s[8:11], s87 offen offset:1024 lds
 s_waitcnt lgkmcnt(2)
 v_mfma_f32_16x16x32_bf16 v[224:227], v[80:83], a[16:19], v[224:227]
 ds_read_b64_tr_b16 v[108:109], v13 offset:160
 ds_read_b64_tr_b16 v[110:111], v13 offset:2464
 v_mfma_f32_16x16x32_bf16 v[228:231], v[80:83], a[20:23], v[228:231]
 buffer_load_dwordx4 v8, s[8:11], s87 offen offset:2048 lds
 v_mfma_f32_16x16x32_bf16 v[232:235], v[80:83], a[24:27], v[232:235]
 v_mfma_f32_16x16x32_bf16 v[236:239], v[80:83], a[28:31], v[236:239]
 buffer_load_dwordx4 v9, s[8:11], s87 offen offset:3072 lds
 v_mfma_f32_16x16x32_bf16 v[240:243], v[84:87], a[16:19], v[240:243]
 ds_read_b64_tr_b16 v[64:65], v13 offset:192
 ds_read_b64_tr_b16 v[66:67], v13 offset:2496
 v_mfma_f32_16x16x32_bf16 v[244:247], v[84:87], a[20:23], v[244:247]
 s_add_u32 m0, s44, 0x2000
 v_mfma_f32_16x16x32_bf16 v[248:251], v[84:87], a[24:27], v[248:251]
 v_mfma_f32_16x16x32_bf16 v[252:255], v[84:87], a[28:31], v[252:255]
 buffer_load_dwordx4 v10, s[8:11], s87 offen lds
 v_mfma_f32_16x16x32_bf16 v[112:115], v[88:91], a[32:35], v[112:115]
 ds_read_b64_tr_b16 v[68:69], v13 offset:224
 ds_read_b64_tr_b16 v[70:71], v13 offset:2528
 v_mfma_f32_16x16x32_bf16 v[116:119], v[88:91], a[36:39], v[116:119]
 v_mfma_f32_16x16x32_bf16 v[120:123], v[88:91], a[40:43], v[120:123]
 v_mfma_f32_16x16x32_bf16 v[124:127], v[88:91], a[44:47], v[124:127]
 ds_read_b64_tr_b16 v[72:73], v13 offset:256
 ds_read_b64_tr_b16 v[74:75], v13 offset:2560
 v_mfma_f32_16x16x32_bf16 v[128:131], v[92:95], a[32:35], v[128:131]
 v_mfma_f32_16x16x32_bf16 v[132:135], v[92:95], a[36:39], v[132:135]
 v_mfma_f32_16x16x32_bf16 v[136:139], v[92:95], a[40:43], v[136:139]
 v_mfma_f32_16x16x32_bf16 v[140:143], v[92:95], a[44:47], v[140:143]
 ds_read_b64_tr_b16 v[76:77], v13 offset:9216
 ds_read_b64_tr_b16 v[78:79], v13 offset:11520
 v_mfma_f32_16x16x32_bf16 v[144:147], v[96:99], a[32:35], v[144:147]
 v_mfma_f32_16x16x32_bf16 v[148:151], v[96:99], a[36:39], v[148:151]
 v_mfma_f32_16x16x32_bf16 v[152:155], v[96:99], a[40:43], v[152:155]
 v_mfma_f32_16x16x32_bf16 v[156:159], v[96:99], a[44:47], v[156:159]
 ds_read_b64_tr_b16 v[80:81], v13 offset:9248
 ds_read_b64_tr_b16 v[82:83], v13 offset:11552
 v_mfma_f32_16x16x32_bf16 v[160:163], v[100:103], a[32:35], v[160:163]
 v_mfma_f32_16x16x32_bf16 v[164:167], v[100:103], a[36:39], v[164:167]
 v_mfma_f32_16x16x32_bf16 v[168:171], v[100:103], a[40:43], v[168:171]
 v_mfma_f32_16x16x32_bf16 v[172:175], v[100:103], a[44:47], v[172:175]
 ds_read_b64_tr_b16 v[84:85], v13 offset:9280
 s_waitcnt lgkmcnt(14)
 ds_read_b64_tr_b16 v[86:87], v13 offset:11584
 s_waitcnt lgkmcnt(4)
 v_mfma_f32_16x16x32_bf16 v[176:179], v[104:107], a[32:35], v[176:179]
 v_mfma_f32_16x16x32_bf16 v[180:183], v[104:107], a[36:39], v[180:183]
 v_mfma_f32_16x16x32_bf16 v[184:187], v[104:107], a[40:43], v[184:187]
 v_mfma_f32_16x16x32_bf16 v[188:191], v[104:107], a[44:47], v[188:191]
 ds_read_b64_tr_b16 v[88:89], v13 offset:9312
 ds_read_b64_tr_b16 v[90:91], v13 offset:11616
 v_mfma_f32_16x16x32_bf16 v[192:195], v[108:111], a[32:35], v[192:195]
 v_mfma_f32_16x16x32_bf16 v[196:199], v[108:111], a[36:39], v[196:199]
 v_mfma_f32_16x16x32_bf16 v[200:203], v[108:111], a[40:43], v[200:203]
 v_mfma_f32_16x16x32_bf16 v[204:207], v[108:111], a[44:47], v[204:207]
 ds_read_b64_tr_b16 v[92:93], v13 offset:9344
 ds_read_b64_tr_b16 v[94:95], v13 offset:11648
 v_mfma_f32_16x16x32_bf16 v[208:211], v[64:67], a[32:35], v[208:211]
 v_mfma_f32_16x16x32_bf16 v[212:215], v[64:67], a[36:39], v[212:215]
 v_mfma_f32_16x16x32_bf16 v[216:219], v[64:67], a[40:43], v[216:219]
 v_mfma_f32_16x16x32_bf16 v[220:223], v[64:67], a[44:47], v[220:223]
 v_mov_b32 v18, 0
 s_mov_b32 s47, 0
down_in:
 buffer_load_dword v19, v18, s[20:23], s93 offen sc1
 s_waitcnt vmcnt(0)
 v_cmp_ne_u32 vcc, 4, v19
 s_add_u32 s47, s47, 1
 s_cmp_ge_u32 s47, 0x100000
 s_cbranch_scc1 down_in_done
 s_cbranch_vccz down_in_done
 s_sleep 4
 s_branch down_in
down_in_done:
 s_nop 3
 s_add_u32 s88, s42, 0
 s_add_u32 s89, s43, 0
 v_mfma_f32_16x16x32_bf16 v[224:227], v[68:71], a[32:35], v[224:227]
 buffer_load_dwordx4 a[128:131], v11, s[4:7], s88 offen sc1
 v_mfma_f32_16x16x32_bf16 v[228:231], v[68:71], a[36:39], v[228:231]
 buffer_load_dwordx4 a[132:135], v11, s[4:7], s88 offen offset:256 sc1
 v_mfma_f32_16x16x32_bf16 v[232:235], v[68:71], a[40:43], v[232:235]
 buffer_load_dwordx4 a[136:139], v11, s[4:7], s89 offen sc1
 v_mfma_f32_16x16x32_bf16 v[236:239], v[68:71], a[44:47], v[236:239]
 buffer_load_dwordx4 a[140:143], v11, s[4:7], s89 offen offset:256 sc1
 v_mfma_f32_16x16x32_bf16 v[240:243], v[72:75], a[32:35], v[240:243]
 s_add_u32 s88, s42, 0x800
 s_add_u32 s89, s43, 0x800
 v_mfma_f32_16x16x32_bf16 v[244:247], v[72:75], a[36:39], v[244:247]
 buffer_load_dwordx4 a[144:147], v11, s[4:7], s88 offen sc1
 buffer_load_dwordx4 a[148:151], v11, s[4:7], s88 offen offset:256 sc1
 buffer_load_dwordx4 a[152:155], v11, s[4:7], s89 offen sc1
 buffer_load_dwordx4 a[156:159], v11, s[4:7], s89 offen offset:256 sc1
 s_add_u32 s88, s42, 0x2000
 s_add_u32 s89, s43, 0x2000
 buffer_load_dwordx4 a[160:163], v11, s[4:7], s88 offen sc1
 buffer_load_dwordx4 a[164:167], v11, s[4:7], s88 offen offset:256 sc1
 buffer_load_dwordx4 a[168:171], v11, s[4:7], s89 offen sc1
 buffer_load_dwordx4 a[172:175], v11, s[4:7], s89 offen offset:256 sc1
 s_add_u32 s88, s42, 0x2800
 s_add_u32 s89, s43, 0x2800
 buffer_load_dwordx4 a[176:179], v11, s[4:7], s88 offen sc1
 buffer_load_dwordx4 a[180:183], v11, s[4:7], s88 offen offset:256 sc1
 buffer_load_dwordx4 a[184:187], v11, s[4:7], s89 offen sc1
 buffer_load_dwordx4 a[188:191], v11, s[4:7], s89 offen offset:256 sc1
 v_mfma_f32_16x16x32_bf16 v[248:251], v[72:75], a[40:43], v[248:251]
 ds_read_b64_tr_b16 v[96:97], v13 offset:9376
 ds_read_b64_tr_b16 v[98:99], v13 offset:11680
 v_mfma_f32_16x16x32_bf16 v[252:255], v[72:75], a[44:47], v[252:255]
 s_add_u32 s88, s42, 0x3000
 ds_read_b64_tr_b16 v[100:101], v13 offset:9408
 v_mfma_f32_16x16x32_bf16 v[112:115], v[76:79], a[48:51], v[112:115]
 ds_read_b64_tr_b16 v[102:103], v13 offset:11712
 ds_read_b64_tr_b16 v[104:105], v13 offset:9440
 v_mfma_f32_16x16x32_bf16 v[116:119], v[76:79], a[52:55], v[116:119]
 s_add_u32 s89, s43, 0x3000
 ds_read_b64_tr_b16 v[106:107], v13 offset:11744
 v_mfma_f32_16x16x32_bf16 v[120:123], v[76:79], a[56:59], v[120:123]
 v_mfma_f32_16x16x32_bf16 v[124:127], v[76:79], a[60:63], v[124:127]
 ds_read_b64_tr_b16 v[108:109], v13 offset:9472
 s_waitcnt lgkmcnt(14)
 ds_read_b64_tr_b16 v[110:111], v13 offset:11776
 s_waitcnt lgkmcnt(0)
 v_mfma_f32_16x16x32_bf16 v[128:131], v[80:83], a[48:51], v[128:131]
 buffer_load_dwordx4 a[192:195], v11, s[4:7], s88 offen sc1
 v_mfma_f32_16x16x32_bf16 v[132:135], v[80:83], a[52:55], v[132:135]
 v_mfma_f32_16x16x32_bf16 v[136:139], v[80:83], a[56:59], v[136:139]
 buffer_load_dwordx4 a[196:199], v11, s[4:7], s88 offen offset:256 sc1
 v_mfma_f32_16x16x32_bf16 v[140:143], v[80:83], a[60:63], v[140:143]
 ds_read_b64_tr_b16 v[64:65], v13 offset:18432
 ds_read_b64_tr_b16 v[66:67], v13 offset:20736
 v_mfma_f32_16x16x32_bf16 v[144:147], v[84:87], a[48:51], v[144:147]
 v_mfma_f32_16x16x32_bf16 v[148:151], v[84:87], a[52:55], v[148:151]
 buffer_load_dwordx4 a[200:203], v11, s[4:7], s89 offen sc1
 v_mfma_f32_16x16x32_bf16 v[152:155], v[84:87], a[56:59], v[152:155]
 v_mfma_f32_16x16x32_bf16 v[156:159], v[84:87], a[60:63], v[156:159]
 buffer_load_dwordx4 a[204:207], v11, s[4:7], s89 offen offset:256 sc1
 v_mfma_f32_16x16x32_bf16 v[160:163], v[88:91], a[48:51], v[160:163]
 ds_read_b64_tr_b16 v[68:69], v13 offset:18464
 ds_read_b64_tr_b16 v[70:71], v13 offset:20768
 v_mfma_f32_16x16x32_bf16 v[164:167], v[88:91], a[52:55], v[164:167]
 v_mfma_f32_16x16x32_bf16 v[168:171], v[88:91], a[56:59], v[168:171]
 s_add_u32 s88, s42, 0x4800
 v_mfma_f32_16x16x32_bf16 v[172:175], v[88:91], a[60:63], v[172:175]
 ds_read_b64_tr_b16 v[72:73], v13 offset:18496
 ds_read_b64_tr_b16 v[74:75], v13 offset:20800
 v_mfma_f32_16x16x32_bf16 v[176:179], v[92:95], a[48:51], v[176:179]
 v_mfma_f32_16x16x32_bf16 v[180:183], v[92:95], a[52:55], v[180:183]
 s_add_u32 s89, s43, 0x4800
 v_mfma_f32_16x16x32_bf16 v[184:187], v[92:95], a[56:59], v[184:187]
 v_mfma_f32_16x16x32_bf16 v[188:191], v[92:95], a[60:63], v[188:191]
 buffer_load_dwordx4 a[208:211], v11, s[4:7], s88 offen sc1
 v_mfma_f32_16x16x32_bf16 v[192:195], v[96:99], a[48:51], v[192:195]
 ds_read_b64_tr_b16 v[76:77], v13 offset:18528
 ds_read_b64_tr_b16 v[78:79], v13 offset:20832
 v_mfma_f32_16x16x32_bf16 v[196:199], v[96:99], a[52:55], v[196:199]
 v_mfma_f32_16x16x32_bf16 v[200:203], v[96:99], a[56:59], v[200:203]
 buffer_load_dwordx4 a[212:215], v11, s[4:7], s88 offen offset:256 sc1
 v_mfma_f32_16x16x32_bf16 v[204:207], v[96:99], a[60:63], v[204:207]
 ds_read_b64_tr_b16 v[80:81], v13 offset:18560
 ds_read_b64_tr_b16 v[82:83], v13 offset:20864
 v_mfma_f32_16x16x32_bf16 v[208:211], v[100:103], a[48:51], v[208:211]
 buffer_load_dwordx4 a[216:219], v11, s[4:7], s89 offen sc1
 v_mfma_f32_16x16x32_bf16 v[212:215], v[100:103], a[52:55], v[212:215]
 v_mfma_f32_16x16x32_bf16 v[216:219], v[100:103], a[56:59], v[216:219]
 v_mfma_f32_16x16x32_bf16 v[220:223], v[100:103], a[60:63], v[220:223]
 buffer_load_dwordx4 a[220:223], v11, s[4:7], s89 offen offset:256 sc1
 v_mfma_f32_16x16x32_bf16 v[224:227], v[104:107], a[48:51], v[224:227]
 ds_read_b64_tr_b16 v[84:85], v13 offset:18592
 ds_read_b64_tr_b16 v[86:87], v13 offset:20896
 v_mfma_f32_16x16x32_bf16 v[228:231], v[104:107], a[52:55], v[228:231]
 s_add_u32 s88, s42, 0x5000
 v_mfma_f32_16x16x32_bf16 v[232:235], v[104:107], a[56:59], v[232:235]
 v_mfma_f32_16x16x32_bf16 v[236:239], v[104:107], a[60:63], v[236:239]
 ds_read_b64_tr_b16 v[88:89], v13 offset:18624
 ds_read_b64_tr_b16 v[90:91], v13 offset:20928
 v_mfma_f32_16x16x32_bf16 v[240:243], v[108:111], a[48:51], v[240:243]
 s_add_u32 s89, s43, 0x5000
 v_mfma_f32_16x16x32_bf16 v[244:247], v[108:111], a[52:55], v[244:247]
 v_mfma_f32_16x16x32_bf16 v[248:251], v[108:111], a[56:59], v[248:251]
 v_mfma_f32_16x16x32_bf16 v[252:255], v[108:111], a[60:63], v[252:255]
 buffer_load_dwordx4 a[224:227], v11, s[4:7], s88 offen sc1
 s_waitcnt lgkmcnt(2)
 v_mfma_f32_16x16x32_bf16 v[112:115], v[64:67], a[64:67], v[112:115]
 ds_read_b64_tr_b16 v[92:93], v13 offset:18656
 ds_read_b64_tr_b16 v[94:95], v13 offset:20960
 v_mfma_f32_16x16x32_bf16 v[116:119], v[64:67], a[68:71], v[116:119]
 buffer_load_dwordx4 a[228:231], v11, s[4:7], s88 offen offset:256 sc1
 v_mfma_f32_16x16x32_bf16 v[120:123], v[64:67], a[72:75], v[120:123]
 v_mfma_f32_16x16x32_bf16 v[124:127], v[64:67], a[76:79], v[124:127]
 ds_read_b64_tr_b16 v[96:97], v13 offset:18688
 ds_read_b64_tr_b16 v[98:99], v13 offset:20992
 v_mfma_f32_16x16x32_bf16 v[128:131], v[68:71], a[64:67], v[128:131]
 buffer_load_dwordx4 a[232:235], v11, s[4:7], s89 offen sc1
 v_mfma_f32_16x16x32_bf16 v[132:135], v[68:71], a[68:71], v[132:135]
 v_mfma_f32_16x16x32_bf16 v[136:139], v[68:71], a[72:75], v[136:139]
 buffer_load_dwordx4 a[236:239], v11, s[4:7], s89 offen offset:256 sc1
 v_mfma_f32_16x16x32_bf16 v[140:143], v[68:71], a[76:79], v[140:143]
 ds_read_b64_tr_b16 v[100:101], v13 offset:27648
 ds_read_b64_tr_b16 v[102:103], v13 offset:29952
 v_mfma_f32_16x16x32_bf16 v[144:147], v[72:75], a[64:67], v[144:147]
 v_mfma_f32_16x16x32_bf16 v[148:151], v[72:75], a[68:71], v[148:151]
 s_add_u32 s88, s42, 0x6800
 v_mfma_f32_16x16x32_bf16 v[152:155], v[72:75], a[72:75], v[152:155]
 v_mfma_f32_16x16x32_bf16 v[156:159], v[72:75], a[76:79], v[156:159]
 s_add_u32 s89, s43, 0x6800
 ds_read_b64_tr_b16 v[104:105], v13 offset:27680
 v_mfma_f32_16x16x32_bf16 v[160:163], v[76:79], a[64:67], v[160:163]
 ds_read_b64_tr_b16 v[106:107], v13 offset:29984
 v_mfma_f32_16x16x32_bf16 v[164:167], v[76:79], a[68:71], v[164:167]
 v_mfma_f32_16x16x32_bf16 v[168:171], v[76:79], a[72:75], v[168:171]
 buffer_load_dwordx4 a[240:243], v11, s[4:7], s88 offen sc1
 v_mfma_f32_16x16x32_bf16 v[172:175], v[76:79], a[76:79], v[172:175]
 ds_read_b64_tr_b16 v[108:109], v13 offset:27712
 ds_read_b64_tr_b16 v[110:111], v13 offset:30016
 v_mfma_f32_16x16x32_bf16 v[176:179], v[80:83], a[64:67], v[176:179]
 v_mfma_f32_16x16x32_bf16 v[180:183], v[80:83], a[68:71], v[180:183]
 buffer_load_dwordx4 a[244:247], v11, s[4:7], s88 offen offset:256 sc1
 v_mfma_f32_16x16x32_bf16 v[184:187], v[80:83], a[72:75], v[184:187]
 v_mfma_f32_16x16x32_bf16 v[188:191], v[80:83], a[76:79], v[188:191]
 buffer_load_dwordx4 a[248:251], v11, s[4:7], s89 offen sc1
 v_mfma_f32_16x16x32_bf16 v[192:195], v[84:87], a[64:67], v[192:195]
 ds_read_b64_tr_b16 v[64:65], v13 offset:27744
 ds_read_b64_tr_b16 v[66:67], v13 offset:30048
 v_mfma_f32_16x16x32_bf16 v[196:199], v[84:87], a[68:71], v[196:199]
 v_mfma_f32_16x16x32_bf16 v[200:203], v[84:87], a[72:75], v[200:203]
 buffer_load_dwordx4 a[252:255], v11, s[4:7], s89 offen offset:256 sc1
 v_mfma_f32_16x16x32_bf16 v[204:207], v[84:87], a[76:79], v[204:207]
 ds_read_b64_tr_b16 v[68:69], v13 offset:27776
 s_waitcnt lgkmcnt(14)
 ds_read_b64_tr_b16 v[70:71], v13 offset:30080
 s_waitcnt lgkmcnt(4)
 v_mfma_f32_16x16x32_bf16 v[208:211], v[88:91], a[64:67], v[208:211]
 s_barrier
 v_mfma_f32_16x16x32_bf16 v[212:215], v[88:91], a[68:71], v[212:215]
 v_mfma_f32_16x16x32_bf16 v[216:219], v[88:91], a[72:75], v[216:219]
 v_mfma_f32_16x16x32_bf16 v[220:223], v[88:91], a[76:79], v[220:223]
 s_lshl_b32 s87, s36, 3
 ds_read_b64_tr_b16 v[72:73], v13 offset:27808
 v_mfma_f32_16x16x32_bf16 v[224:227], v[92:95], a[64:67], v[224:227]
 ds_read_b64_tr_b16 v[74:75], v13 offset:30112
 v_mfma_f32_16x16x32_bf16 v[228:231], v[92:95], a[68:71], v[228:231]
 s_lshr_b32 s87, 0xf0e, s87
 v_mfma_f32_16x16x32_bf16 v[232:235], v[92:95], a[72:75], v[232:235]
 v_mfma_f32_16x16x32_bf16 v[236:239], v[92:95], a[76:79], v[236:239]
 ds_read_b64_tr_b16 v[76:77], v13 offset:27840
 ds_read_b64_tr_b16 v[78:79], v13 offset:30144
 v_mfma_f32_16x16x32_bf16 v[240:243], v[96:99], a[64:67], v[240:243]
 s_and_b32 s87, s87, 0xff
 v_mfma_f32_16x16x32_bf16 v[244:247], v[96:99], a[68:71], v[244:247]
 v_mfma_f32_16x16x32_bf16 v[248:251], v[96:99], a[72:75], v[248:251]
 v_mfma_f32_16x16x32_bf16 v[252:255], v[96:99], a[76:79], v[252:255]
 s_sub_u32 s87, s87, s36
 ds_read_b64_tr_b16 v[80:81], v13 offset:27872
 v_mfma_f32_16x16x32_bf16 v[112:115], v[100:103], a[80:83], v[112:115]
 ds_read_b64_tr_b16 v[82:83], v13 offset:30176
 v_mfma_f32_16x16x32_bf16 v[116:119], v[100:103], a[84:87], v[116:119]
 s_mul_i32 s87, s87, 0x9000
 v_mfma_f32_16x16x32_bf16 v[120:123], v[100:103], a[88:91], v[120:123]
 v_mfma_f32_16x16x32_bf16 v[124:127], v[100:103], a[92:95], v[124:127]
 ds_read_b64_tr_b16 v[84:85], v13 offset:27904
 ds_read_b64_tr_b16 v[86:87], v13 offset:30208
 v_mfma_f32_16x16x32_bf16 v[128:131], v[104:107], a[80:83], v[128:131]
 s_add_u32 s87, s87, s41
 v_mfma_f32_16x16x32_bf16 v[132:135], v[104:107], a[84:87], v[132:135]
 v_mfma_f32_16x16x32_bf16 v[136:139], v[104:107], a[88:91], v[136:139]
 s_cmp_lt_u32 s36, 2
 s_cselect_b32 s87, s87, 0x7000000
 v_mfma_f32_16x16x32_bf16 v[140:143], v[104:107], a[92:95], v[140:143]
 ds_read_b64_tr_b16 v[88:89], v13 offset:36864
 ds_read_b64_tr_b16 v[90:91], v13 offset:39168
 v_mfma_f32_16x16x32_bf16 v[144:147], v[108:111], a[80:83], v[144:147]
 v_mfma_f32_16x16x32_bf16 v[148:151], v[108:111], a[84:87], v[148:151]
 s_add_u32 m0, s44, 0x9000
 v_mfma_f32_16x16x32_bf16 v[152:155], v[108:111], a[88:91], v[152:155]
 v_mfma_f32_16x16x32_bf16 v[156:159], v[108:111], a[92:95], v[156:159]
 buffer_load_dwordx4 v2, s[8:11], s87 offen lds
 s_waitcnt lgkmcnt(2)
 v_mfma_f32_16x16x32_bf16 v[160:163], v[64:67], a[80:83], v[160:163]
 ds_read_b64_tr_b16 v[92:93], v13 offset:36896
 ds_read_b64_tr_b16 v[94:95], v13 offset:39200
 v_mfma_f32_16x16x32_bf16 v[164:167], v[64:67], a[84:87], v[164:167]
 v_mfma_f32_16x16x32_bf16 v[168:171], v[64:67], a[88:91], v[168:171]
 buffer_load_dwordx4 v3, s[8:11], s87 offen offset:1024 lds
 v_mfma_f32_16x16x32_bf16 v[172:175], v[64:67], a[92:95], v[172:175]
 ds_read_b64_tr_b16 v[96:97], v13 offset:36928
 ds_read_b64_tr_b16 v[98:99], v13 offset:39232
 v_mfma_f32_16x16x32_bf16 v[176:179], v[68:71], a[80:83], v[176:179]
 v_mfma_f32_16x16x32_bf16 v[180:183], v[68:71], a[84:87], v[180:183]
 buffer_load_dwordx4 v4, s[8:11], s87 offen offset:2048 lds
 v_mfma_f32_16x16x32_bf16 v[184:187], v[68:71], a[88:91], v[184:187]
 v_mfma_f32_16x16x32_bf16 v[188:191], v[68:71], a[92:95], v[188:191]
 buffer_load_dwordx4 v5, s[8:11], s87 offen offset:3072 lds
 v_mfma_f32_16x16x32_bf16 v[192:195], v[72:75], a[80:83], v[192:195]
 ds_read_b64_tr_b16 v[100:101], v13 offset:36960
 ds_read_b64_tr_b16 v[102:103], v13 offset:39264
 v_mfma_f32_16x16x32_bf16 v[196:199], v[72:75], a[84:87], v[196:199]
 v_mfma_f32_16x16x32_bf16 v[200:203], v[72:75], a[88:91], v[200:203]
 s_add_u32 m0, s44, 0xa000
 v_mfma_f32_16x16x32_bf16 v[204:207], v[72:75], a[92:95], v[204:207]
 ds_read_b64_tr_b16 v[104:105], v13 offset:36992
 ds_read_b64_tr_b16 v[106:107], v13 offset:39296
 v_mfma_f32_16x16x32_bf16 v[208:211], v[76:79], a[80:83], v[208:211]
 buffer_load_dwordx4 v6, s[8:11], s87 offen lds
 v_mfma_f32_16x16x32_bf16 v[212:215], v[76:79], a[84:87], v[212:215]
 v_mfma_f32_16x16x32_bf16 v[216:219], v[76:79], a[88:91], v[216:219]
 v_mfma_f32_16x16x32_bf16 v[220:223], v[76:79], a[92:95], v[220:223]
 buffer_load_dwordx4 v7, s[8:11], s87 offen offset:1024 lds
 v_mfma_f32_16x16x32_bf16 v[224:227], v[80:83], a[80:83], v[224:227]
 ds_read_b64_tr_b16 v[108:109], v13 offset:37024
 ds_read_b64_tr_b16 v[110:111], v13 offset:39328
 v_mfma_f32_16x16x32_bf16 v[228:231], v[80:83], a[84:87], v[228:231]
 buffer_load_dwordx4 v8, s[8:11], s87 offen offset:2048 lds
 v_mfma_f32_16x16x32_bf16 v[232:235], v[80:83], a[88:91], v[232:235]
 v_mfma_f32_16x16x32_bf16 v[236:239], v[80:83], a[92:95], v[236:239]
 ds_read_b64_tr_b16 v[64:65], v13 offset:37056
 ds_read_b64_tr_b16 v[66:67], v13 offset:39360
 v_mfma_f32_16x16x32_bf16 v[240:243], v[84:87], a[80:83], v[240:243]
 buffer_load_dwordx4 v9, s[8:11], s87 offen offset:3072 lds
 v_mfma_f32_16x16x32_bf16 v[244:247], v[84:87], a[84:87], v[244:247]
 v_mfma_f32_16x16x32_bf16 v[248:251], v[84:87], a[88:91], v[248:251]
 v_mfma_f32_16x16x32_bf16 v[252:255], v[84:87], a[92:95], v[252:255]
 s_add_u32 m0, s44, 0xb000
 ds_read_b64_tr_b16 v[68:69], v13 offset:37088
 s_waitcnt lgkmcnt(3)
 v_mfma_f32_16x16x32_bf16 v[112:115], v[88:91], a[96:99], v[112:115]
 ds_read_b64_tr_b16 v[70:71], v13 offset:39392
 v_mfma_f32_16x16x32_bf16 v[116:119], v[88:91], a[100:103], v[116:119]
 buffer_load_dwordx4 v10, s[8:11], s87 offen lds
 v_mfma_f32_16x16x32_bf16 v[120:123], v[88:91], a[104:107], v[120:123]
 v_mfma_f32_16x16x32_bf16 v[124:127], v[88:91], a[108:111], v[124:127]
 ds_read_b64_tr_b16 v[72:73], v13 offset:37120
 ds_read_b64_tr_b16 v[74:75], v13 offset:39424
 v_mfma_f32_16x16x32_bf16 v[128:131], v[92:95], a[96:99], v[128:131]
 s_add_u32 s88, s42, 0x7000
 v_mfma_f32_16x16x32_bf16 v[132:135], v[92:95], a[100:103], v[132:135]
 v_mfma_f32_16x16x32_bf16 v[136:139], v[92:95], a[104:107], v[136:139]
 s_add_u32 s89, s43, 0x7000
 v_mfma_f32_16x16x32_bf16 v[140:143], v[92:95], a[108:111], v[140:143]
 ds_read_b64_tr_b16 v[76:77], v13 offset:46080
 ds_read_b64_tr_b16 v[78:79], v13 offset:48384
 v_mfma_f32_16x16x32_bf16 v[144:147], v[96:99], a[96:99], v[144:147]
 v_mfma_f32_16x16x32_bf16 v[148:151], v[96:99], a[100:103], v[148:151]
 buffer_load_dwordx4 v[32:35], v11, s[4:7], s88 offen sc1
 v_mfma_f32_16x16x32_bf16 v[152:155], v[96:99], a[104:107], v[152:155]
 v_mfma_f32_16x16x32_bf16 v[156:159], v[96:99], a[108:111], v[156:159]
 buffer_load_dwordx4 v[36:39], v11, s[4:7], s88 offen offset:256 sc1
 v_mfma_f32_16x16x32_bf16 v[160:163], v[100:103], a[96:99], v[160:163]
 ds_read_b64_tr_b16 v[80:81], v13 offset:46112
 ds_read_b64_tr_b16 v[82:83], v13 offset:48416
 v_mfma_f32_16x16x32_bf16 v[164:167], v[100:103], a[100:103], v[164:167]
 v_mfma_f32_16x16x32_bf16 v[168:171], v[100:103], a[104:107], v[168:171]
 buffer_load_dwordx4 v[40:43], v11, s[4:7], s89 offen sc1
 v_mfma_f32_16x16x32_bf16 v[172:175], v[100:103], a[108:111], v[172:175]
 ds_read_b64_tr_b16 v[84:85], v13 offset:46144
 ds_read_b64_tr_b16 v[86:87], v13 offset:48448
 v_mfma_f32_16x16x32_bf16 v[176:179], v[104:107], a[96:99], v[176:179]
 v_mfma_f32_16x16x32_bf16 v[180:183], v[104:107], a[100:103], v[180:183]
 buffer_load_dwordx4 v[44:47], v11, s[4:7], s89 offen offset:256 sc1
 v_mfma_f32_16x16x32_bf16 v[184:187], v[104:107], a[104:107], v[184:187]
 v_mfma_f32_16x16x32_bf16 v[188:191], v[104:107], a[108:111], v[188:191]
 s_add_u32 s88, s42, 0x7800
 ds_read_b64_tr_b16 v[88:89], v13 offset:46176
 v_mfma_f32_16x16x32_bf16 v[192:195], v[108:111], a[96:99], v[192:195]
 ds_read_b64_tr_b16 v[90:91], v13 offset:48480
 v_mfma_f32_16x16x32_bf16 v[196:199], v[108:111], a[100:103], v[196:199]
 v_mfma_f32_16x16x32_bf16 v[200:203], v[108:111], a[104:107], v[200:203]
 s_add_u32 s89, s43, 0x7800
 v_mfma_f32_16x16x32_bf16 v[204:207], v[108:111], a[108:111], v[204:207]
 ds_read_b64_tr_b16 v[92:93], v13 offset:46208
 s_waitcnt lgkmcnt(14)
 ds_read_b64_tr_b16 v[94:95], v13 offset:48512
 s_waitcnt lgkmcnt(4)
 v_mfma_f32_16x16x32_bf16 v[208:211], v[64:67], a[96:99], v[208:211]
 buffer_load_dwordx4 v[48:51], v11, s[4:7], s88 offen sc1
 v_mfma_f32_16x16x32_bf16 v[212:215], v[64:67], a[100:103], v[212:215]
 v_mfma_f32_16x16x32_bf16 v[216:219], v[64:67], a[104:107], v[216:219]
 v_mfma_f32_16x16x32_bf16 v[220:223], v[64:67], a[108:111], v[220:223]
 buffer_load_dwordx4 v[52:55], v11, s[4:7], s88 offen offset:256 sc1
 v_mfma_f32_16x16x32_bf16 v[224:227], v[68:71], a[96:99], v[224:227]
 ds_read_b64_tr_b16 v[96:97], v13 offset:46240
 ds_read_b64_tr_b16 v[98:99], v13 offset:48544
 v_mfma_f32_16x16x32_bf16 v[228:231], v[68:71], a[100:103], v[228:231]
 buffer_load_dwordx4 v[56:59], v11, s[4:7], s89 offen sc1
 v_mfma_f32_16x16x32_bf16 v[232:235], v[68:71], a[104:107], v[232:235]
 v_mfma_f32_16x16x32_bf16 v[236:239], v[68:71], a[108:111], v[236:239]
 ds_read_b64_tr_b16 v[100:101], v13 offset:46272
 ds_read_b64_tr_b16 v[102:103], v13 offset:48576
 v_mfma_f32_16x16x32_bf16 v[240:243], v[72:75], a[96:99], v[240:243]
 buffer_load_dwordx4 v[60:63], v11, s[4:7], s89 offen offset:256 sc1
 v_mfma_f32_16x16x32_bf16 v[244:247], v[72:75], a[100:103], v[244:247]
 v_mfma_f32_16x16x32_bf16 v[248:251], v[72:75], a[104:107], v[248:251]
 v_mfma_f32_16x16x32_bf16 v[252:255], v[72:75], a[108:111], v[252:255]
 ds_read_b64_tr_b16 v[104:105], v13 offset:46304
 ds_read_b64_tr_b16 v[106:107], v13 offset:48608
 v_mfma_f32_16x16x32_bf16 v[112:115], v[76:79], a[112:115], v[112:115]
 v_mfma_f32_16x16x32_bf16 v[116:119], v[76:79], a[116:119], v[116:119]
 v_mfma_f32_16x16x32_bf16 v[120:123], v[76:79], a[120:123], v[120:123]
 v_mfma_f32_16x16x32_bf16 v[124:127], v[76:79], a[124:127], v[124:127]
 ds_read_b64_tr_b16 v[108:109], v13 offset:46336
 ds_read_b64_tr_b16 v[110:111], v13 offset:48640
 v_mfma_f32_16x16x32_bf16 v[128:131], v[80:83], a[112:115], v[128:131]
 v_mfma_f32_16x16x32_bf16 v[132:135], v[80:83], a[116:119], v[132:135]
 s_barrier
 v_mfma_f32_16x16x32_bf16 v[136:139], v[80:83], a[120:123], v[136:139]
 v_mfma_f32_16x16x32_bf16 v[140:143], v[80:83], a[124:127], v[140:143]
 ds_read_b64_tr_b16 v[64:65], v14
 ds_read_b64_tr_b16 v[66:67], v14 offset:2304
 v_mfma_f32_16x16x32_bf16 v[144:147], v[84:87], a[112:115], v[144:147]
 v_mfma_f32_16x16x32_bf16 v[148:151], v[84:87], a[116:119], v[148:151]
 v_mfma_f32_16x16x32_bf16 v[152:155], v[84:87], a[120:123], v[152:155]
 v_mfma_f32_16x16x32_bf16 v[156:159], v[84:87], a[124:127], v[156:159]
 ds_read_b64_tr_b16 v[68:69], v14 offset:9216
 s_waitcnt lgkmcnt(14)
 ds_read_b64_tr_b16 v[70:71], v14 offset:11520
 s_waitcnt lgkmcnt(4)
 v_mfma_f32_16x16x32_bf16 v[160:163], v[88:91], a[112:115], v[160:163]
 v_mfma_f32_16x16x32_bf16 v[164:167], v[88:91], a[116:119], v[164:167]
 v_mfma_f32_16x16x32_bf16 v[168:171], v[88:91], a[120:123], v[168:171]
 v_mfma_f32_16x16x32_bf16 v[172:175], v[88:91], a[124:127], v[172:175]
 v_lshlrev_b32 v18, 4, v17
 v_min_u32 v19, 0xbf0, v18
 v_mfma_f32_16x16x32_bf16 v[176:179], v[92:95], a[112:115], v[176:179]
 v_add_u32 v19, 0x24000, v19
 ds_read_b64_tr_b16 v[72:73], v14 offset:18432
 v_mfma_f32_16x16x32_bf16 v[180:183], v[92:95], a[116:119], v[180:183]
 ds_read_b64_tr_b16 v[74:75], v14 offset:20736
 v_mfma_f32_16x16x32_bf16 v[184:187], v[92:95], a[120:123], v[184:187]
 v_mfma_f32_16x16x32_bf16 v[188:191], v[92:95], a[124:127], v[188:191]
 ds_read_b64_tr_b16 v[76:77], v14 offset:27648
 ds_read_b64_tr_b16 v[78:79], v14 offset:29952
 v_mfma_f32_16x16x32_bf16 v[192:195], v[96:99], a[112:115], v[192:195]
 v_mfma_f32_16x16x32_bf16 v[196:199], v[96:99], a[116:119], v[196:199]
 v_mfma_f32_16x16x32_bf16 v[200:203], v[96:99], a[120:123], v[200:203]
 v_mfma_f32_16x16x32_bf16 v[204:207], v[96:99], a[124:127], v[204:207]
 ds_read_b64_tr_b16 v[80:81], v12
 ds_read_b64_tr_b16 v[82:83], v12 offset:2304
 v_mfma_f32_16x16x32_bf16 v[208:211], v[100:103], a[112:115], v[208:211]
 v_mfma_f32_16x16x32_bf16 v[212:215], v[100:103], a[116:119], v[212:215]
 s_mov_b32 s90, 0x2d00
 v_mfma_f32_16x16x32_bf16 v[216:219], v[100:103], a[120:123], v[216:219]
 buffer_load_dwordx4 v[20:23], v18, s[12:15], s90 offen
 v_mfma_f32_16x16x32_bf16 v[220:223], v[100:103], a[124:127], v[220:223]
 s_mov_b32 s90, 0x6300
 v_mfma_f32_16x16x32_bf16 v[224:227], v[104:107], a[112:115], v[224:227]
 buffer_load_dwordx4 v[24:27], v18, s[12:15], s90 offen
 v_mfma_f32_16x16x32_bf16 v[228:231], v[104:107], a[116:119], v[228:231]
 s_mov_b32 s90, 0x9900
 v_mfma_f32_16x16x32_bf16 v[232:235], v[104:107], a[120:123], v[232:235]
 buffer_load_dwordx4 v[28:31], v18, s[12:15], s90 offen
 v_mfma_f32_16x16x32_bf16 v[236:239], v[104:107], a[124:127], v[236:239]
 ds_read_b64_tr_b16 v[84:85], v12 offset:9216
 ds_read_b64_tr_b16 v[86:87], v12 offset:11520
 v_mfma_f32_16x16x32_bf16 v[240:243], v[108:111], a[112:115], v[240:243]
 ds_read_b64_tr_b16 v[88:89], v12 offset:18432
 ds_read_b64_tr_b16 v[90:91], v12 offset:20736
 v_mfma_f32_16x16x32_bf16 v[244:247], v[108:111], a[116:119], v[244:247]
 v_mfma_f32_16x16x32_bf16 v[248:251], v[108:111], a[120:123], v[248:251]
 v_mfma_f32_16x16x32_bf16 v[252:255], v[108:111], a[124:127], v[252:255]
 ds_read_b64_tr_b16 v[92:93], v12 offset:27648
 s_waitcnt lgkmcnt(14)
 ds_read_b64_tr_b16 v[94:95], v12 offset:29952
 s_waitcnt vmcnt(51) lgkmcnt(6)
 v_mfma_f32_16x16x32_bf16 v[112:115], v[64:67], a[128:131], v[112:115]
 s_waitcnt vmcnt(50)
 v_mfma_f32_16x16x32_bf16 v[116:119], v[64:67], a[132:135], v[116:119]
 s_waitcnt vmcnt(49)
 v_mfma_f32_16x16x32_bf16 v[120:123], v[64:67], a[136:139], v[120:123]
 s_waitcnt vmcnt(48)
 v_mfma_f32_16x16x32_bf16 v[124:127], v[64:67], a[140:143], v[124:127]
 s_lshl_b32 s40, s37, 2
 s_add_u32 s40, s40, s39
 s_lshl_b32 s84, s38, 2
 s_lshr_b32 s86, s40, 3
 s_add_u32 s84, s84, s86
 s_lshl_b32 s93, s84, 7
 s_add_u32 s93, s93, 0x28000
 s_lshl_b32 s84, s84, 2
 s_add_u32 s84, s84, s36
 s_mul_i32 s99, s84, 0x180
 s_add_u32 s99, s99, 0xc000
 v_and_b32 v11, 7, v0
 s_mul_i32 s84, s36, 18
 v_lshrrev_b32 v8, 3, v0
 v_min_u32 v8, 5, v8
 v_add_u32 v8, 0, v8
 v_add_u32 v8, s84, v8
 v_lshlrev_b32 v2, 9, v8
 v_lshl_add_u32 v2, v11, 4, v2
 v_mul_u32_u24 v5, 0x480, v11
 v_lshl_add_u32 v5, v8, 4, v5
 v_lshlrev_b32 v8, 5, v8
 v_add_u32 v8, 0x24000, v8
 v_lshrrev_b32 v9, 3, v0
 v_min_u32 v9, 5, v9
 v_add_u32 v9, 6, v9
 v_add_u32 v9, s84, v9
 v_lshlrev_b32 v3, 9, v9
 v_lshl_add_u32 v3, v11, 4, v3
 v_mul_u32_u24 v6, 0x480, v11
 v_lshl_add_u32 v6, v9, 4, v6
 v_lshlrev_b32 v9, 5, v9
 v_add_u32 v9, 0x24000, v9
 v_lshrrev_b32 v10, 3, v0
 v_min_u32 v10, 5, v10
 v_add_u32 v10, 12, v10
 v_add_u32 v10, s84, v10
 v_lshlrev_b32 v4, 9, v10
 v_lshl_add_u32 v4, v11, 4, v4
 v_mul_u32_u24 v7, 0x480, v11
 v_lshl_add_u32 v7, v10, 4, v7
 v_lshlrev_b32 v10, 5, v10
 v_add_u32 v10, 0x24000, v10
 s_lshl_b32 s84, s38, 3
 s_lshr_b32 s86, s40, 2
 s_add_u32 s84, s84, s86
 s_mul_i32 s98, s84, 0x9000
 s_and_b32 s86, s40, 3
 s_lshl_b32 s86, s86, 7
 s_add_u32 s98, s98, s86
 s_lshl_b32 s84, s38, 5
 s_add_u32 s84, s84, s40
 s_mul_i32 s97, s84, 0x2400
 s_waitcnt vmcnt(47)
 v_mfma_f32_16x16x32_bf16 v[112:115], v[68:71], a[144:147], v[112:115]
 s_waitcnt vmcnt(46)
 v_mfma_f32_16x16x32_bf16 v[116:119], v[68:71], a[148:151], v[116:119]
 s_waitcnt vmcnt(45)
 v_mfma_f32_16x16x32_bf16 v[120:123], v[68:71], a[152:155], v[120:123]
 s_waitcnt vmcnt(44)
 v_mfma_f32_16x16x32_bf16 v[124:127], v[68:71], a[156:159], v[124:127]
 s_waitcnt vmcnt(11)
 s_barrier
 v_mfma_f32_16x16x32_bf16 v[112:115], v[72:75], a[160:163], v[112:115]
 ds_read_b64_tr_b16 v[96:97], v12 offset:36864
 ds_read_b64_tr_b16 v[98:99], v12 offset:39168
 v_mfma_f32_16x16x32_bf16 v[116:119], v[72:75], a[164:167], v[116:119]
 ds_read_b64_tr_b16 v[100:101], v12 offset:46080
 ds_read_b64_tr_b16 v[102:103], v12 offset:48384
 v_mfma_f32_16x16x32_bf16 v[120:123], v[72:75], a[168:171], v[120:123]
 v_mfma_f32_16x16x32_bf16 v[124:127], v[72:75], a[172:175], v[124:127]
 ds_read_b64_tr_b16 v[104:105], v14 offset:32
 ds_read_b64_tr_b16 v[106:107], v14 offset:2336
 v_mfma_f32_16x16x32_bf16 v[112:115], v[76:79], a[176:179], v[112:115]
 v_mfma_f32_16x16x32_bf16 v[116:119], v[76:79], a[180:183], v[116:119]
 v_mfma_f32_16x16x32_bf16 v[120:123], v[76:79], a[184:187], v[120:123]
 v_mfma_f32_16x16x32_bf16 v[124:127], v[76:79], a[188:191], v[124:127]
 ds_read_b64_tr_b16 v[108:109], v14 offset:9248
 ds_read_b64_tr_b16 v[110:111], v14 offset:11552
 v_mfma_f32_16x16x32_bf16 v[112:115], v[80:83], a[192:195], v[112:115]
 v_mfma_f32_16x16x32_bf16 v[116:119], v[80:83], a[196:199], v[116:119]
 v_mfma_f32_16x16x32_bf16 v[120:123], v[80:83], a[200:203], v[120:123]
 v_mfma_f32_16x16x32_bf16 v[124:127], v[80:83], a[204:207], v[124:127]
 ds_read_b64_tr_b16 v[64:65], v14 offset:18464
 s_waitcnt lgkmcnt(14)
 ds_read_b64_tr_b16 v[66:67], v14 offset:20768
 s_waitcnt lgkmcnt(4)
 v_mfma_f32_16x16x32_bf16 v[112:115], v[84:87], a[208:211], v[112:115]
 v_mfma_f32_16x16x32_bf16 v[116:119], v[84:87], a[212:215], v[116:119]
 v_mfma_f32_16x16x32_bf16 v[120:123], v[84:87], a[216:219], v[120:123]
 v_mfma_f32_16x16x32_bf16 v[124:127], v[84:87], a[220:223], v[124:127]
 ds_read_b64_tr_b16 v[68:69], v14 offset:27680
 ds_read_b64_tr_b16 v[70:71], v14 offset:29984
 v_mfma_f32_16x16x32_bf16 v[112:115], v[88:91], a[224:227], v[112:115]
 v_mfma_f32_16x16x32_bf16 v[116:119], v[88:91], a[228:231], v[116:119]
 v_mfma_f32_16x16x32_bf16 v[120:123], v[88:91], a[232:235], v[120:123]
 v_mfma_f32_16x16x32_bf16 v[124:127], v[88:91], a[236:239], v[124:127]
 ds_read_b64_tr_b16 v[72:73], v12 offset:32
 ds_read_b64_tr_b16 v[74:75], v12 offset:2336
 v_mfma_f32_16x16x32_bf16 v[112:115], v[92:95], a[240:243], v[112:115]
 v_mfma_f32_16x16x32_bf16 v[116:119], v[92:95], a[244:247], v[116:119]
 s_waitcnt vmcnt(1)
 v_add_f32 v20, v20, v24
 s_waitcnt vmcnt(0)
 v_add_f32 v20, v20, v28
 v_mfma_f32_16x16x32_bf16 v[120:123], v[92:95], a[248:251], v[120:123]
 v_cvt_pk_bf16_f32 v20, v20, v20
 v_and_b32 v20, 0xffff0000, v20
 v_mfma_f32_16x16x32_bf16 v[124:127], v[92:95], a[252:255], v[124:127]
 ds_read_b64_tr_b16 v[76:77], v12 offset:9248
 ds_read_b64_tr_b16 v[78:79], v12 offset:11552
 v_mfma_f32_16x16x32_bf16 v[112:115], v[96:99], v[32:35], v[112:115]
 v_add_f32 v21, v21, v25
 v_add_f32 v21, v21, v29
 v_mfma_f32_16x16x32_bf16 v[116:119], v[96:99], v[36:39], v[116:119]
 v_cvt_pk_bf16_f32 v21, v21, v21
 v_and_b32 v21, 0xffff0000, v21
 v_mfma_f32_16x16x32_bf16 v[120:123], v[96:99], v[40:43], v[120:123]
 v_add_f32 v22, v22, v26
 v_add_f32 v22, v22, v30
 v_mfma_f32_16x16x32_bf16 v[124:127], v[96:99], v[44:47], v[124:127]
 ds_read_b64_tr_b16 v[80:81], v12 offset:18464
 ds_read_b64_tr_b16 v[82:83], v12 offset:20768
 v_mfma_f32_16x16x32_bf16 v[112:115], v[100:103], v[48:51], v[112:115]
 v_cvt_pk_bf16_f32 v22, v22, v22
 v_and_b32 v22, 0xffff0000, v22
 v_mfma_f32_16x16x32_bf16 v[116:119], v[100:103], v[52:55], v[116:119]
 v_add_f32 v23, v23, v27
 v_add_f32 v23, v23, v31
 v_mfma_f32_16x16x32_bf16 v[120:123], v[100:103], v[56:59], v[120:123]
 v_cvt_pk_bf16_f32 v23, v23, v23
 v_and_b32 v23, 0xffff0000, v23
 v_mfma_f32_16x16x32_bf16 v[124:127], v[100:103], v[60:63], v[124:127]
 ds_read_b64_tr_b16 v[84:85], v12 offset:27680
 ds_read_b64_tr_b16 v[86:87], v12 offset:29984
 v_mfma_f32_16x16x32_bf16 v[128:131], v[104:107], a[128:131], v[128:131]
 ds_write_b128 v19, v[20:23]
 v_mfma_f32_16x16x32_bf16 v[132:135], v[104:107], a[132:135], v[132:135]
 v_mfma_f32_16x16x32_bf16 v[136:139], v[104:107], a[136:139], v[136:139]
 v_cvt_pk_bf16_f32 v112, v112, v113
 v_cvt_pk_bf16_f32 v113, v114, v115
 v_mfma_f32_16x16x32_bf16 v[140:143], v[104:107], a[140:143], v[140:143]
 s_waitcnt lgkmcnt(14)
 ds_read_b64_tr_b16 v[88:89], v12 offset:36896
 s_waitcnt lgkmcnt(14)
 ds_read_b64_tr_b16 v[90:91], v12 offset:39200
 v_mfma_f32_16x16x32_bf16 v[128:131], v[108:111], a[144:147], v[128:131]
 v_cvt_pk_bf16_f32 v114, v116, v117
 v_cvt_pk_bf16_f32 v115, v118, v119
 v_mfma_f32_16x16x32_bf16 v[132:135], v[108:111], a[148:151], v[132:135]
 v_permlane16_swap_b32 v112, v114
 v_permlane16_swap_b32 v113, v115
 v_mfma_f32_16x16x32_bf16 v[136:139], v[108:111], a[152:155], v[136:139]
 buffer_store_dwordx4 v[112:115], v1, s[16:19], s45 offen sc1
 v_mfma_f32_16x16x32_bf16 v[140:143], v[108:111], a[156:159], v[140:143]
 s_waitcnt lgkmcnt(14)
 ds_read_b64_tr_b16 v[92:93], v12 offset:46112
 s_waitcnt lgkmcnt(14)
 ds_read_b64_tr_b16 v[94:95], v12 offset:48416
 v_mfma_f32_16x16x32_bf16 v[128:131], v[64:67], a[160:163], v[128:131]
 v_cvt_pk_bf16_f32 v120, v120, v121
 v_cvt_pk_bf16_f32 v121, v122, v123
 v_mfma_f32_16x16x32_bf16 v[132:135], v[64:67], a[164:167], v[132:135]
 v_cvt_pk_bf16_f32 v122, v124, v125
 v_cvt_pk_bf16_f32 v123, v126, v127
 v_mfma_f32_16x16x32_bf16 v[136:139], v[64:67], a[168:171], v[136:139]
 v_permlane16_swap_b32 v120, v122
 v_permlane16_swap_b32 v121, v123
 v_mfma_f32_16x16x32_bf16 v[140:143], v[64:67], a[172:175], v[140:143]
 s_waitcnt lgkmcnt(14)
 ds_read_b64_tr_b16 v[96:97], v14 offset:64
 s_waitcnt lgkmcnt(14)
 ds_read_b64_tr_b16 v[98:99], v14 offset:2368
 v_mfma_f32_16x16x32_bf16 v[128:131], v[68:71], a[176:179], v[128:131]
 buffer_store_dwordx4 v[120:123], v1, s[16:19], s46 offen sc1
 v_mfma_f32_16x16x32_bf16 v[132:135], v[68:71], a[180:183], v[132:135]
 v_mfma_f32_16x16x32_bf16 v[136:139], v[68:71], a[184:187], v[136:139]
 v_mfma_f32_16x16x32_bf16 v[140:143], v[68:71], a[188:191], v[140:143]
 s_waitcnt lgkmcnt(14)
 ds_read_b64_tr_b16 v[100:101], v14 offset:9280
 s_waitcnt lgkmcnt(14)
 ds_read_b64_tr_b16 v[102:103], v14 offset:11584
 v_mfma_f32_16x16x32_bf16 v[128:131], v[72:75], a[192:195], v[128:131]
 v_mfma_f32_16x16x32_bf16 v[132:135], v[72:75], a[196:199], v[132:135]
 v_mfma_f32_16x16x32_bf16 v[136:139], v[72:75], a[200:203], v[136:139]
 v_mfma_f32_16x16x32_bf16 v[140:143], v[72:75], a[204:207], v[140:143]
 s_waitcnt lgkmcnt(14)
 ds_read_b64_tr_b16 v[104:105], v14 offset:18496
 s_waitcnt lgkmcnt(14)
 ds_read_b64_tr_b16 v[106:107], v14 offset:20800
 v_mfma_f32_16x16x32_bf16 v[128:131], v[76:79], a[208:211], v[128:131]
 v_mfma_f32_16x16x32_bf16 v[132:135], v[76:79], a[212:215], v[132:135]
 v_mfma_f32_16x16x32_bf16 v[136:139], v[76:79], a[216:219], v[136:139]
 v_mfma_f32_16x16x32_bf16 v[140:143], v[76:79], a[220:223], v[140:143]
 s_waitcnt lgkmcnt(14)
 ds_read_b64_tr_b16 v[108:109], v14 offset:27712
 s_waitcnt lgkmcnt(14)
 ds_read_b64_tr_b16 v[110:111], v14 offset:30016
 v_mfma_f32_16x16x32_bf16 v[128:131], v[80:83], a[224:227], v[128:131]
 v_mfma_f32_16x16x32_bf16 v[132:135], v[80:83], a[228:231], v[132:135]
 v_mfma_f32_16x16x32_bf16 v[136:139], v[80:83], a[232:235], v[136:139]
 v_mfma_f32_16x16x32_bf16 v[140:143], v[80:83], a[236:239], v[140:143]
 s_waitcnt lgkmcnt(14)
 ds_read_b64_tr_b16 v[64:65], v12 offset:64
 s_waitcnt lgkmcnt(14)
 ds_read_b64_tr_b16 v[66:67], v12 offset:2368
 v_mfma_f32_16x16x32_bf16 v[128:131], v[84:87], a[240:243], v[128:131]
 v_mfma_f32_16x16x32_bf16 v[132:135], v[84:87], a[244:247], v[132:135]
 v_mfma_f32_16x16x32_bf16 v[136:139], v[84:87], a[248:251], v[136:139]
 v_mfma_f32_16x16x32_bf16 v[140:143], v[84:87], a[252:255], v[140:143]
 s_waitcnt lgkmcnt(14)
 ds_read_b64_tr_b16 v[68:69], v12 offset:9280
 s_waitcnt lgkmcnt(14)
 ds_read_b64_tr_b16 v[70:71], v12 offset:11584
 s_waitcnt lgkmcnt(4)
 v_mfma_f32_16x16x32_bf16 v[128:131], v[88:91], v[32:35], v[128:131]
 v_mfma_f32_16x16x32_bf16 v[132:135], v[88:91], v[36:39], v[132:135]
 v_mfma_f32_16x16x32_bf16 v[136:139], v[88:91], v[40:43], v[136:139]
 v_mfma_f32_16x16x32_bf16 v[140:143], v[88:91], v[44:47], v[140:143]
 ds_read_b64_tr_b16 v[72:73], v12 offset:18496
 ds_read_b64_tr_b16 v[74:75], v12 offset:20800
 v_mfma_f32_16x16x32_bf16 v[128:131], v[92:95], v[48:51], v[128:131]
 v_mfma_f32_16x16x32_bf16 v[132:135], v[92:95], v[52:55], v[132:135]
 v_mfma_f32_16x16x32_bf16 v[136:139], v[92:95], v[56:59], v[136:139]
 v_mfma_f32_16x16x32_bf16 v[140:143], v[92:95], v[60:63], v[140:143]
 ds_read_b64_tr_b16 v[76:77], v12 offset:27712
 ds_read_b64_tr_b16 v[78:79], v12 offset:30016
 v_mfma_f32_16x16x32_bf16 v[144:147], v[96:99], a[128:131], v[144:147]
 v_mfma_f32_16x16x32_bf16 v[148:151], v[96:99], a[132:135], v[148:151]
 v_mfma_f32_16x16x32_bf16 v[152:155], v[96:99], a[136:139], v[152:155]
 v_cvt_pk_bf16_f32 v128, v128, v129
 v_cvt_pk_bf16_f32 v129, v130, v131
 v_mfma_f32_16x16x32_bf16 v[156:159], v[96:99], a[140:143], v[156:159]
 ds_read_b64_tr_b16 v[80:81], v12 offset:36928
 ds_read_b64_tr_b16 v[82:83], v12 offset:39232
 v_mfma_f32_16x16x32_bf16 v[144:147], v[100:103], a[144:147], v[144:147]
 v_cvt_pk_bf16_f32 v130, v132, v133
 v_cvt_pk_bf16_f32 v131, v134, v135
 v_mfma_f32_16x16x32_bf16 v[148:151], v[100:103], a[148:151], v[148:151]
 v_permlane16_swap_b32 v128, v130
 v_permlane16_swap_b32 v129, v131
 v_mfma_f32_16x16x32_bf16 v[152:155], v[100:103], a[152:155], v[152:155]
 buffer_store_dwordx4 v[128:131], v1, s[16:19], s45 offen offset:1024 sc1
 v_mfma_f32_16x16x32_bf16 v[156:159], v[100:103], a[156:159], v[156:159]
 ds_read_b64_tr_b16 v[84:85], v12 offset:46144
 ds_read_b64_tr_b16 v[86:87], v12 offset:48448
 v_mfma_f32_16x16x32_bf16 v[144:147], v[104:107], a[160:163], v[144:147]
 v_cvt_pk_bf16_f32 v136, v136, v137
 v_cvt_pk_bf16_f32 v137, v138, v139
 v_mfma_f32_16x16x32_bf16 v[148:151], v[104:107], a[164:167], v[148:151]
 v_cvt_pk_bf16_f32 v138, v140, v141
 v_cvt_pk_bf16_f32 v139, v142, v143
 v_mfma_f32_16x16x32_bf16 v[152:155], v[104:107], a[168:171], v[152:155]
 v_permlane16_swap_b32 v136, v138
 v_permlane16_swap_b32 v137, v139
 v_mfma_f32_16x16x32_bf16 v[156:159], v[104:107], a[172:175], v[156:159]
 ds_read_b64_tr_b16 v[88:89], v14 offset:96
 ds_read_b64_tr_b16 v[90:91], v14 offset:2400
 v_mfma_f32_16x16x32_bf16 v[144:147], v[108:111], a[176:179], v[144:147]
 buffer_store_dwordx4 v[136:139], v1, s[16:19], s46 offen offset:1024 sc1
 v_mfma_f32_16x16x32_bf16 v[148:151], v[108:111], a[180:183], v[148:151]
 v_mfma_f32_16x16x32_bf16 v[152:155], v[108:111], a[184:187], v[152:155]
 v_mfma_f32_16x16x32_bf16 v[156:159], v[108:111], a[188:191], v[156:159]
 ds_read_b64_tr_b16 v[92:93], v14 offset:9312
 s_waitcnt lgkmcnt(14)
 ds_read_b64_tr_b16 v[94:95], v14 offset:11616
 s_waitcnt lgkmcnt(4)
 v_mfma_f32_16x16x32_bf16 v[144:147], v[64:67], a[192:195], v[144:147]
 v_mfma_f32_16x16x32_bf16 v[148:151], v[64:67], a[196:199], v[148:151]
 v_mfma_f32_16x16x32_bf16 v[152:155], v[64:67], a[200:203], v[152:155]
 v_mfma_f32_16x16x32_bf16 v[156:159], v[64:67], a[204:207], v[156:159]
 ds_read_b64_tr_b16 v[96:97], v14 offset:18528
 ds_read_b64_tr_b16 v[98:99], v14 offset:20832
 v_mfma_f32_16x16x32_bf16 v[144:147], v[68:71], a[208:211], v[144:147]
 v_mfma_f32_16x16x32_bf16 v[148:151], v[68:71], a[212:215], v[148:151]
 v_mfma_f32_16x16x32_bf16 v[152:155], v[68:71], a[216:219], v[152:155]
 v_mfma_f32_16x16x32_bf16 v[156:159], v[68:71], a[220:223], v[156:159]
 ds_read_b64_tr_b16 v[100:101], v14 offset:27744
 ds_read_b64_tr_b16 v[102:103], v14 offset:30048
 v_mfma_f32_16x16x32_bf16 v[144:147], v[72:75], a[224:227], v[144:147]
 v_mfma_f32_16x16x32_bf16 v[148:151], v[72:75], a[228:231], v[148:151]
 v_mfma_f32_16x16x32_bf16 v[152:155], v[72:75], a[232:235], v[152:155]
 v_mfma_f32_16x16x32_bf16 v[156:159], v[72:75], a[236:239], v[156:159]
 ds_read_b64_tr_b16 v[104:105], v12 offset:96
 ds_read_b64_tr_b16 v[106:107], v12 offset:2400
 v_mfma_f32_16x16x32_bf16 v[144:147], v[76:79], a[240:243], v[144:147]
 v_mfma_f32_16x16x32_bf16 v[148:151], v[76:79], a[244:247], v[148:151]
 v_mfma_f32_16x16x32_bf16 v[152:155], v[76:79], a[248:251], v[152:155]
 v_mfma_f32_16x16x32_bf16 v[156:159], v[76:79], a[252:255], v[156:159]
 ds_read_b64_tr_b16 v[108:109], v12 offset:9312
 ds_read_b64_tr_b16 v[110:111], v12 offset:11616
 v_mfma_f32_16x16x32_bf16 v[144:147], v[80:83], v[32:35], v[144:147]
 v_mfma_f32_16x16x32_bf16 v[148:151], v[80:83], v[36:39], v[148:151]
 v_mfma_f32_16x16x32_bf16 v[152:155], v[80:83], v[40:43], v[152:155]
 v_mfma_f32_16x16x32_bf16 v[156:159], v[80:83], v[44:47], v[156:159]
 ds_read_b64_tr_b16 v[64:65], v12 offset:18528
 ds_read_b64_tr_b16 v[66:67], v12 offset:20832
 v_mfma_f32_16x16x32_bf16 v[144:147], v[84:87], v[48:51], v[144:147]
 v_mfma_f32_16x16x32_bf16 v[148:151], v[84:87], v[52:55], v[148:151]
 v_mfma_f32_16x16x32_bf16 v[152:155], v[84:87], v[56:59], v[152:155]
 v_mfma_f32_16x16x32_bf16 v[156:159], v[84:87], v[60:63], v[156:159]
 ds_read_b64_tr_b16 v[68:69], v12 offset:27744
 s_waitcnt lgkmcnt(14)
 ds_read_b64_tr_b16 v[70:71], v12 offset:30048
 s_waitcnt lgkmcnt(4)
 v_mfma_f32_16x16x32_bf16 v[160:163], v[88:91], a[128:131], v[160:163]
 v_mfma_f32_16x16x32_bf16 v[164:167], v[88:91], a[132:135], v[164:167]
 v_mfma_f32_16x16x32_bf16 v[168:171], v[88:91], a[136:139], v[168:171]
 v_cvt_pk_bf16_f32 v144, v144, v145
 v_cvt_pk_bf16_f32 v145, v146, v147
 v_mfma_f32_16x16x32_bf16 v[172:175], v[88:91], a[140:143], v[172:175]
 ds_read_b64_tr_b16 v[72:73], v12 offset:36960
 ds_read_b64_tr_b16 v[74:75], v12 offset:39264
 v_mfma_f32_16x16x32_bf16 v[160:163], v[92:95], a[144:147], v[160:163]
 v_cvt_pk_bf16_f32 v146, v148, v149
 v_cvt_pk_bf16_f32 v147, v150, v151
 v_mfma_f32_16x16x32_bf16 v[164:167], v[92:95], a[148:151], v[164:167]
 v_permlane16_swap_b32 v144, v146
 v_permlane16_swap_b32 v145, v147
 v_mfma_f32_16x16x32_bf16 v[168:171], v[92:95], a[152:155], v[168:171]
 buffer_store_dwordx4 v[144:147], v1, s[16:19], s45 offen offset:2048 sc1
 v_mfma_f32_16x16x32_bf16 v[172:175], v[92:95], a[156:159], v[172:175]
 ds_read_b64_tr_b16 v[76:77], v12 offset:46176
 ds_read_b64_tr_b16 v[78:79], v12 offset:48480
 v_mfma_f32_16x16x32_bf16 v[160:163], v[96:99], a[160:163], v[160:163]
 v_cvt_pk_bf16_f32 v152, v152, v153
 v_cvt_pk_bf16_f32 v153, v154, v155
 v_mfma_f32_16x16x32_bf16 v[164:167], v[96:99], a[164:167], v[164:167]
 v_cvt_pk_bf16_f32 v154, v156, v157
 v_cvt_pk_bf16_f32 v155, v158, v159
 v_mfma_f32_16x16x32_bf16 v[168:171], v[96:99], a[168:171], v[168:171]
 v_permlane16_swap_b32 v152, v154
 v_permlane16_swap_b32 v153, v155
 v_mfma_f32_16x16x32_bf16 v[172:175], v[96:99], a[172:175], v[172:175]
 ds_read_b64_tr_b16 v[80:81], v14 offset:128
 ds_read_b64_tr_b16 v[82:83], v14 offset:2432
 v_mfma_f32_16x16x32_bf16 v[160:163], v[100:103], a[176:179], v[160:163]
 buffer_store_dwordx4 v[152:155], v1, s[16:19], s46 offen offset:2048 sc1
 v_mfma_f32_16x16x32_bf16 v[164:167], v[100:103], a[180:183], v[164:167]
 v_mfma_f32_16x16x32_bf16 v[168:171], v[100:103], a[184:187], v[168:171]
 v_mfma_f32_16x16x32_bf16 v[172:175], v[100:103], a[188:191], v[172:175]
 ds_read_b64_tr_b16 v[84:85], v14 offset:9344
 ds_read_b64_tr_b16 v[86:87], v14 offset:11648
 v_mfma_f32_16x16x32_bf16 v[160:163], v[104:107], a[192:195], v[160:163]
 v_mfma_f32_16x16x32_bf16 v[164:167], v[104:107], a[196:199], v[164:167]
 v_mfma_f32_16x16x32_bf16 v[168:171], v[104:107], a[200:203], v[168:171]
 v_mfma_f32_16x16x32_bf16 v[172:175], v[104:107], a[204:207], v[172:175]
 ds_read_b64_tr_b16 v[88:89], v14 offset:18560
 ds_read_b64_tr_b16 v[90:91], v14 offset:20864
 v_mfma_f32_16x16x32_bf16 v[160:163], v[108:111], a[208:211], v[160:163]
 v_mfma_f32_16x16x32_bf16 v[164:167], v[108:111], a[212:215], v[164:167]
 v_mfma_f32_16x16x32_bf16 v[168:171], v[108:111], a[216:219], v[168:171]
 v_mfma_f32_16x16x32_bf16 v[172:175], v[108:111], a[220:223], v[172:175]
 ds_read_b64_tr_b16 v[92:93], v14 offset:27776
 s_waitcnt lgkmcnt(14)
 ds_read_b64_tr_b16 v[94:95], v14 offset:30080
 s_waitcnt lgkmcnt(4)
 v_mfma_f32_16x16x32_bf16 v[160:163], v[64:67], a[224:227], v[160:163]
 v_mfma_f32_16x16x32_bf16 v[164:167], v[64:67], a[228:231], v[164:167]
 v_mfma_f32_16x16x32_bf16 v[168:171], v[64:67], a[232:235], v[168:171]
 v_mfma_f32_16x16x32_bf16 v[172:175], v[64:67], a[236:239], v[172:175]
 ds_read_b64_tr_b16 v[96:97], v12 offset:128
 ds_read_b64_tr_b16 v[98:99], v12 offset:2432
 v_mfma_f32_16x16x32_bf16 v[160:163], v[68:71], a[240:243], v[160:163]
 v_mfma_f32_16x16x32_bf16 v[164:167], v[68:71], a[244:247], v[164:167]
 v_mfma_f32_16x16x32_bf16 v[168:171], v[68:71], a[248:251], v[168:171]
 v_mfma_f32_16x16x32_bf16 v[172:175], v[68:71], a[252:255], v[172:175]
 ds_read_b64_tr_b16 v[100:101], v12 offset:9344
 ds_read_b64_tr_b16 v[102:103], v12 offset:11648
 v_mfma_f32_16x16x32_bf16 v[160:163], v[72:75], v[32:35], v[160:163]
 v_mfma_f32_16x16x32_bf16 v[164:167], v[72:75], v[36:39], v[164:167]
 v_mfma_f32_16x16x32_bf16 v[168:171], v[72:75], v[40:43], v[168:171]
 v_mfma_f32_16x16x32_bf16 v[172:175], v[72:75], v[44:47], v[172:175]
 ds_read_b64_tr_b16 v[104:105], v12 offset:18560
 ds_read_b64_tr_b16 v[106:107], v12 offset:20864
 v_mfma_f32_16x16x32_bf16 v[160:163], v[76:79], v[48:51], v[160:163]
 v_mfma_f32_16x16x32_bf16 v[164:167], v[76:79], v[52:55], v[164:167]
 v_mfma_f32_16x16x32_bf16 v[168:171], v[76:79], v[56:59], v[168:171]
 v_mfma_f32_16x16x32_bf16 v[172:175], v[76:79], v[60:63], v[172:175]
 ds_read_b64_tr_b16 v[108:109], v12 offset:27776
 ds_read_b64_tr_b16 v[110:111], v12 offset:30080
 v_mfma_f32_16x16x32_bf16 v[176:179], v[80:83], a[128:131], v[176:179]
 v_mfma_f32_16x16x32_bf16 v[180:183], v[80:83], a[132:135], v[180:183]
 v_mfma_f32_16x16x32_bf16 v[184:187], v[80:83], a[136:139], v[184:187]
 v_cvt_pk_bf16_f32 v160, v160, v161
 v_cvt_pk_bf16_f32 v161, v162, v163
 v_mfma_f32_16x16x32_bf16 v[188:191], v[80:83], a[140:143], v[188:191]
 ds_read_b64_tr_b16 v[64:65], v12 offset:36992
 ds_read_b64_tr_b16 v[66:67], v12 offset:39296
 v_mfma_f32_16x16x32_bf16 v[176:179], v[84:87], a[144:147], v[176:179]
 v_cvt_pk_bf16_f32 v162, v164, v165
 v_cvt_pk_bf16_f32 v163, v166, v167
 v_mfma_f32_16x16x32_bf16 v[180:183], v[84:87], a[148:151], v[180:183]
 v_permlane16_swap_b32 v160, v162
 v_permlane16_swap_b32 v161, v163
 v_mfma_f32_16x16x32_bf16 v[184:187], v[84:87], a[152:155], v[184:187]
 buffer_store_dwordx4 v[160:163], v1, s[16:19], s45 offen offset:3072 sc1
 v_mfma_f32_16x16x32_bf16 v[188:191], v[84:87], a[156:159], v[188:191]
 ds_read_b64_tr_b16 v[68:69], v12 offset:46208
 s_waitcnt lgkmcnt(14)
 ds_read_b64_tr_b16 v[70:71], v12 offset:48512
 s_waitcnt lgkmcnt(4)
 v_mfma_f32_16x16x32_bf16 v[176:179], v[88:91], a[160:163], v[176:179]
 v_cvt_pk_bf16_f32 v168, v168, v169
 v_cvt_pk_bf16_f32 v169, v170, v171
 v_mfma_f32_16x16x32_bf16 v[180:183], v[88:91], a[164:167], v[180:183]
 v_cvt_pk_bf16_f32 v170, v172, v173
 v_cvt_pk_bf16_f32 v171, v174, v175
 v_mfma_f32_16x16x32_bf16 v[184:187], v[88:91], a[168:171], v[184:187]
 v_permlane16_swap_b32 v168, v170
 v_permlane16_swap_b32 v169, v171
 v_mfma_f32_16x16x32_bf16 v[188:191], v[88:91], a[172:175], v[188:191]
 ds_read_b64_tr_b16 v[72:73], v14 offset:160
 ds_read_b64_tr_b16 v[74:75], v14 offset:2464
 v_mfma_f32_16x16x32_bf16 v[176:179], v[92:95], a[176:179], v[176:179]
 buffer_store_dwordx4 v[168:171], v1, s[16:19], s46 offen offset:3072 sc1
 v_mfma_f32_16x16x32_bf16 v[180:183], v[92:95], a[180:183], v[180:183]
 v_mfma_f32_16x16x32_bf16 v[184:187], v[92:95], a[184:187], v[184:187]
 v_mfma_f32_16x16x32_bf16 v[188:191], v[92:95], a[188:191], v[188:191]
 ds_read_b64_tr_b16 v[76:77], v14 offset:9376
 ds_read_b64_tr_b16 v[78:79], v14 offset:11680
 v_mfma_f32_16x16x32_bf16 v[176:179], v[96:99], a[192:195], v[176:179]
 v_mfma_f32_16x16x32_bf16 v[180:183], v[96:99], a[196:199], v[180:183]
 v_mfma_f32_16x16x32_bf16 v[184:187], v[96:99], a[200:203], v[184:187]
 v_mfma_f32_16x16x32_bf16 v[188:191], v[96:99], a[204:207], v[188:191]
 ds_read_b64_tr_b16 v[80:81], v14 offset:18592
 ds_read_b64_tr_b16 v[82:83], v14 offset:20896
 v_mfma_f32_16x16x32_bf16 v[176:179], v[100:103], a[208:211], v[176:179]
 v_mfma_f32_16x16x32_bf16 v[180:183], v[100:103], a[212:215], v[180:183]
 v_mfma_f32_16x16x32_bf16 v[184:187], v[100:103], a[216:219], v[184:187]
 v_mfma_f32_16x16x32_bf16 v[188:191], v[100:103], a[220:223], v[188:191]
 ds_read_b64_tr_b16 v[84:85], v14 offset:27808
 ds_read_b64_tr_b16 v[86:87], v14 offset:30112
 v_mfma_f32_16x16x32_bf16 v[176:179], v[104:107], a[224:227], v[176:179]
 v_mfma_f32_16x16x32_bf16 v[180:183], v[104:107], a[228:231], v[180:183]
 v_mfma_f32_16x16x32_bf16 v[184:187], v[104:107], a[232:235], v[184:187]
 v_mfma_f32_16x16x32_bf16 v[188:191], v[104:107], a[236:239], v[188:191]
 ds_read_b64_tr_b16 v[88:89], v12 offset:160
 ds_read_b64_tr_b16 v[90:91], v12 offset:2464
 v_mfma_f32_16x16x32_bf16 v[176:179], v[108:111], a[240:243], v[176:179]
 v_mfma_f32_16x16x32_bf16 v[180:183], v[108:111], a[244:247], v[180:183]
 v_mfma_f32_16x16x32_bf16 v[184:187], v[108:111], a[248:251], v[184:187]
 v_mfma_f32_16x16x32_bf16 v[188:191], v[108:111], a[252:255], v[188:191]
 ds_read_b64_tr_b16 v[92:93], v12 offset:9376
 s_waitcnt lgkmcnt(14)
 ds_read_b64_tr_b16 v[94:95], v12 offset:11680
 s_waitcnt lgkmcnt(4)
 v_mfma_f32_16x16x32_bf16 v[176:179], v[64:67], v[32:35], v[176:179]
 v_mfma_f32_16x16x32_bf16 v[180:183], v[64:67], v[36:39], v[180:183]
 v_mfma_f32_16x16x32_bf16 v[184:187], v[64:67], v[40:43], v[184:187]
 v_mfma_f32_16x16x32_bf16 v[188:191], v[64:67], v[44:47], v[188:191]
 ds_read_b64_tr_b16 v[96:97], v12 offset:18592
 ds_read_b64_tr_b16 v[98:99], v12 offset:20896
 v_mfma_f32_16x16x32_bf16 v[176:179], v[68:71], v[48:51], v[176:179]
 v_mfma_f32_16x16x32_bf16 v[180:183], v[68:71], v[52:55], v[180:183]
 v_mfma_f32_16x16x32_bf16 v[184:187], v[68:71], v[56:59], v[184:187]
 v_mfma_f32_16x16x32_bf16 v[188:191], v[68:71], v[60:63], v[188:191]
 ds_read_b64_tr_b16 v[100:101], v12 offset:27808
 ds_read_b64_tr_b16 v[102:103], v12 offset:30112
 v_mfma_f32_16x16x32_bf16 v[192:195], v[72:75], a[128:131], v[192:195]
 v_mfma_f32_16x16x32_bf16 v[196:199], v[72:75], a[132:135], v[196:199]
 v_mfma_f32_16x16x32_bf16 v[200:203], v[72:75], a[136:139], v[200:203]
 v_cvt_pk_bf16_f32 v176, v176, v177
 v_cvt_pk_bf16_f32 v177, v178, v179
 v_mfma_f32_16x16x32_bf16 v[204:207], v[72:75], a[140:143], v[204:207]
 ds_read_b64_tr_b16 v[104:105], v12 offset:37024
 ds_read_b64_tr_b16 v[106:107], v12 offset:39328
 v_mfma_f32_16x16x32_bf16 v[192:195], v[76:79], a[144:147], v[192:195]
 v_cvt_pk_bf16_f32 v178, v180, v181
 v_cvt_pk_bf16_f32 v179, v182, v183
 v_mfma_f32_16x16x32_bf16 v[196:199], v[76:79], a[148:151], v[196:199]
 v_permlane16_swap_b32 v176, v178
 v_permlane16_swap_b32 v177, v179
 v_mfma_f32_16x16x32_bf16 v[200:203], v[76:79], a[152:155], v[200:203]
 s_add_u32 s91, s45, 0x1000
 v_mfma_f32_16x16x32_bf16 v[204:207], v[76:79], a[156:159], v[204:207]
 ds_read_b64_tr_b16 v[108:109], v12 offset:46240
 ds_read_b64_tr_b16 v[110:111], v12 offset:48544
 v_mfma_f32_16x16x32_bf16 v[192:195], v[80:83], a[160:163], v[192:195]
 buffer_store_dwordx4 v[176:179], v1, s[16:19], s91 offen sc1
 v_mfma_f32_16x16x32_bf16 v[196:199], v[80:83], a[164:167], v[196:199]
 v_cvt_pk_bf16_f32 v184, v184, v185
 v_cvt_pk_bf16_f32 v185, v186, v187
 v_mfma_f32_16x16x32_bf16 v[200:203], v[80:83], a[168:171], v[200:203]
 v_cvt_pk_bf16_f32 v186, v188, v189
 v_cvt_pk_bf16_f32 v187, v190, v191
 v_mfma_f32_16x16x32_bf16 v[204:207], v[80:83], a[172:175], v[204:207]
 ds_read_b64_tr_b16 v[64:65], v14 offset:192
 ds_read_b64_tr_b16 v[66:67], v14 offset:2496
 v_mfma_f32_16x16x32_bf16 v[192:195], v[84:87], a[176:179], v[192:195]
 v_permlane16_swap_b32 v184, v186
 v_permlane16_swap_b32 v185, v187
 v_mfma_f32_16x16x32_bf16 v[196:199], v[84:87], a[180:183], v[196:199]
 s_add_u32 s91, s46, 0x1000
 v_mfma_f32_16x16x32_bf16 v[200:203], v[84:87], a[184:187], v[200:203]
 buffer_store_dwordx4 v[184:187], v1, s[16:19], s91 offen sc1
 v_mfma_f32_16x16x32_bf16 v[204:207], v[84:87], a[188:191], v[204:207]
 ds_read_b64_tr_b16 v[68:69], v14 offset:9408
 s_waitcnt lgkmcnt(14)
 ds_read_b64_tr_b16 v[70:71], v14 offset:11712
 s_waitcnt lgkmcnt(4)
 v_mfma_f32_16x16x32_bf16 v[192:195], v[88:91], a[192:195], v[192:195]
 s_waitcnt vmcnt(4)
 v_mfma_f32_16x16x32_bf16 v[196:199], v[88:91], a[196:199], v[196:199]
 buffer_atomic_add v16, v15, s[20:23], s92 offen sc1
 v_mfma_f32_16x16x32_bf16 v[200:203], v[88:91], a[200:203], v[200:203]
 v_mfma_f32_16x16x32_bf16 v[204:207], v[88:91], a[204:207], v[204:207]
 ds_read_b64_tr_b16 v[72:73], v14 offset:18624
 ds_read_b64_tr_b16 v[74:75], v14 offset:20928
 v_mfma_f32_16x16x32_bf16 v[192:195], v[92:95], a[208:211], v[192:195]
 v_mfma_f32_16x16x32_bf16 v[196:199], v[92:95], a[212:215], v[196:199]
 v_mfma_f32_16x16x32_bf16 v[200:203], v[92:95], a[216:219], v[200:203]
 v_mfma_f32_16x16x32_bf16 v[204:207], v[92:95], a[220:223], v[204:207]
 ds_read_b64_tr_b16 v[76:77], v14 offset:27840
 ds_read_b64_tr_b16 v[78:79], v14 offset:30144
 v_mfma_f32_16x16x32_bf16 v[192:195], v[96:99], a[224:227], v[192:195]
 v_mfma_f32_16x16x32_bf16 v[196:199], v[96:99], a[228:231], v[196:199]
 v_mfma_f32_16x16x32_bf16 v[200:203], v[96:99], a[232:235], v[200:203]
 v_mfma_f32_16x16x32_bf16 v[204:207], v[96:99], a[236:239], v[204:207]
 ds_read_b64_tr_b16 v[80:81], v12 offset:192
 ds_read_b64_tr_b16 v[82:83], v12 offset:2496
 v_mfma_f32_16x16x32_bf16 v[192:195], v[100:103], a[240:243], v[192:195]
 v_mfma_f32_16x16x32_bf16 v[196:199], v[100:103], a[244:247], v[196:199]
 v_mfma_f32_16x16x32_bf16 v[200:203], v[100:103], a[248:251], v[200:203]
 v_mfma_f32_16x16x32_bf16 v[204:207], v[100:103], a[252:255], v[204:207]
 ds_read_b64_tr_b16 v[84:85], v12 offset:9408
 ds_read_b64_tr_b16 v[86:87], v12 offset:11712
 v_mfma_f32_16x16x32_bf16 v[192:195], v[104:107], v[32:35], v[192:195]
 v_mfma_f32_16x16x32_bf16 v[196:199], v[104:107], v[36:39], v[196:199]
 v_mfma_f32_16x16x32_bf16 v[200:203], v[104:107], v[40:43], v[200:203]
 v_mfma_f32_16x16x32_bf16 v[204:207], v[104:107], v[44:47], v[204:207]
 ds_read_b64_tr_b16 v[88:89], v12 offset:18624
 ds_read_b64_tr_b16 v[90:91], v12 offset:20928
 v_mfma_f32_16x16x32_bf16 v[192:195], v[108:111], v[48:51], v[192:195]
 v_mfma_f32_16x16x32_bf16 v[196:199], v[108:111], v[52:55], v[196:199]
 v_mfma_f32_16x16x32_bf16 v[200:203], v[108:111], v[56:59], v[200:203]
 v_mfma_f32_16x16x32_bf16 v[204:207], v[108:111], v[60:63], v[204:207]
 ds_read_b64_tr_b16 v[92:93], v12 offset:27840
 s_waitcnt lgkmcnt(14)
 ds_read_b64_tr_b16 v[94:95], v12 offset:30144
 s_waitcnt lgkmcnt(4)
 v_mfma_f32_16x16x32_bf16 v[208:211], v[64:67], a[128:131], v[208:211]
 v_mfma_f32_16x16x32_bf16 v[212:215], v[64:67], a[132:135], v[212:215]
 v_mfma_f32_16x16x32_bf16 v[216:219], v[64:67], a[136:139], v[216:219]
 v_cvt_pk_bf16_f32 v192, v192, v193
 v_cvt_pk_bf16_f32 v193, v194, v195
 v_mfma_f32_16x16x32_bf16 v[220:223], v[64:67], a[140:143], v[220:223]
 ds_read_b64_tr_b16 v[96:97], v12 offset:37056
 ds_read_b64_tr_b16 v[98:99], v12 offset:39360
 v_mfma_f32_16x16x32_bf16 v[208:211], v[68:71], a[144:147], v[208:211]
 v_cvt_pk_bf16_f32 v194, v196, v197
 v_cvt_pk_bf16_f32 v195, v198, v199
 v_mfma_f32_16x16x32_bf16 v[212:215], v[68:71], a[148:151], v[212:215]
 v_permlane16_swap_b32 v192, v194
 v_permlane16_swap_b32 v193, v195
 v_mfma_f32_16x16x32_bf16 v[216:219], v[68:71], a[152:155], v[216:219]
 s_add_u32 s91, s45, 0x1000
 v_mfma_f32_16x16x32_bf16 v[220:223], v[68:71], a[156:159], v[220:223]
 ds_read_b64_tr_b16 v[100:101], v12 offset:46272
 ds_read_b64_tr_b16 v[102:103], v12 offset:48576
 v_mfma_f32_16x16x32_bf16 v[208:211], v[72:75], a[160:163], v[208:211]
 buffer_store_dwordx4 v[192:195], v1, s[16:19], s91 offen offset:1024 sc1
 v_mfma_f32_16x16x32_bf16 v[212:215], v[72:75], a[164:167], v[212:215]
 v_cvt_pk_bf16_f32 v200, v200, v201
 v_cvt_pk_bf16_f32 v201, v202, v203
 v_mfma_f32_16x16x32_bf16 v[216:219], v[72:75], a[168:171], v[216:219]
 v_cvt_pk_bf16_f32 v202, v204, v205
 v_cvt_pk_bf16_f32 v203, v206, v207
 v_mfma_f32_16x16x32_bf16 v[220:223], v[72:75], a[172:175], v[220:223]
 ds_read_b64_tr_b16 v[104:105], v14 offset:224
 ds_read_b64_tr_b16 v[106:107], v14 offset:2528
 v_mfma_f32_16x16x32_bf16 v[208:211], v[76:79], a[176:179], v[208:211]
 v_permlane16_swap_b32 v200, v202
 v_permlane16_swap_b32 v201, v203
 v_mfma_f32_16x16x32_bf16 v[212:215], v[76:79], a[180:183], v[212:215]
 s_add_u32 s91, s46, 0x1000
 v_mfma_f32_16x16x32_bf16 v[216:219], v[76:79], a[184:187], v[216:219]
 buffer_store_dwordx4 v[200:203], v1, s[16:19], s91 offen offset:1024 sc1
 v_mfma_f32_16x16x32_bf16 v[220:223], v[76:79], a[188:191], v[220:223]
 ds_read_b64_tr_b16 v[108:109], v14 offset:9440
 ds_read_b64_tr_b16 v[110:111], v14 offset:11744
 v_mfma_f32_16x16x32_bf16 v[208:211], v[80:83], a[192:195], v[208:211]
 v_mfma_f32_16x16x32_bf16 v[212:215], v[80:83], a[196:199], v[212:215]
 v_mfma_f32_16x16x32_bf16 v[216:219], v[80:83], a[200:203], v[216:219]
 v_mfma_f32_16x16x32_bf16 v[220:223], v[80:83], a[204:207], v[220:223]
 ds_read_b64_tr_b16 v[64:65], v14 offset:18656
 ds_read_b64_tr_b16 v[66:67], v14 offset:20960
 v_mfma_f32_16x16x32_bf16 v[208:211], v[84:87], a[208:211], v[208:211]
 v_mfma_f32_16x16x32_bf16 v[212:215], v[84:87], a[212:215], v[212:215]
 v_mfma_f32_16x16x32_bf16 v[216:219], v[84:87], a[216:219], v[216:219]
 v_mfma_f32_16x16x32_bf16 v[220:223], v[84:87], a[220:223], v[220:223]
 ds_read_b64_tr_b16 v[68:69], v14 offset:27872
 s_waitcnt lgkmcnt(14)
 ds_read_b64_tr_b16 v[70:71], v14 offset:30176
 s_waitcnt lgkmcnt(4)
 v_mfma_f32_16x16x32_bf16 v[208:211], v[88:91], a[224:227], v[208:211]
 v_mfma_f32_16x16x32_bf16 v[212:215], v[88:91], a[228:231], v[212:215]
 v_mfma_f32_16x16x32_bf16 v[216:219], v[88:91], a[232:235], v[216:219]
 v_mfma_f32_16x16x32_bf16 v[220:223], v[88:91], a[236:239], v[220:223]
 ds_read_b64_tr_b16 v[72:73], v12 offset:224
 ds_read_b64_tr_b16 v[74:75], v12 offset:2528
 v_mfma_f32_16x16x32_bf16 v[208:211], v[92:95], a[240:243], v[208:211]
 v_mfma_f32_16x16x32_bf16 v[212:215], v[92:95], a[244:247], v[212:215]
 v_mfma_f32_16x16x32_bf16 v[216:219], v[92:95], a[248:251], v[216:219]
 v_mfma_f32_16x16x32_bf16 v[220:223], v[92:95], a[252:255], v[220:223]
 ds_read_b64_tr_b16 v[76:77], v12 offset:9440
 ds_read_b64_tr_b16 v[78:79], v12 offset:11744
 v_mfma_f32_16x16x32_bf16 v[208:211], v[96:99], v[32:35], v[208:211]
 v_mfma_f32_16x16x32_bf16 v[212:215], v[96:99], v[36:39], v[212:215]
 v_mfma_f32_16x16x32_bf16 v[216:219], v[96:99], v[40:43], v[216:219]
 v_mfma_f32_16x16x32_bf16 v[220:223], v[96:99], v[44:47], v[220:223]
 ds_read_b64_tr_b16 v[80:81], v12 offset:18656
 ds_read_b64_tr_b16 v[82:83], v12 offset:20960
 v_mfma_f32_16x16x32_bf16 v[208:211], v[100:103], v[48:51], v[208:211]
 v_mfma_f32_16x16x32_bf16 v[212:215], v[100:103], v[52:55], v[212:215]
 v_mfma_f32_16x16x32_bf16 v[216:219], v[100:103], v[56:59], v[216:219]
 v_mfma_f32_16x16x32_bf16 v[220:223], v[100:103], v[60:63], v[220:223]
 ds_read_b64_tr_b16 v[84:85], v12 offset:27872
 ds_read_b64_tr_b16 v[86:87], v12 offset:30176
 v_mfma_f32_16x16x32_bf16 v[224:227], v[104:107], a[128:131], v[224:227]
 v_mfma_f32_16x16x32_bf16 v[228:231], v[104:107], a[132:135], v[228:231]
 v_mfma_f32_16x16x32_bf16 v[232:235], v[104:107], a[136:139], v[232:235]
 v_cvt_pk_bf16_f32 v208, v208, v209
 v_cvt_pk_bf16_f32 v209, v210, v211
 v_mfma_f32_16x16x32_bf16 v[236:239], v[104:107], a[140:143], v[236:239]
 ds_read_b64_tr_b16 v[88:89], v12 offset:37088
 ds_read_b64_tr_b16 v[90:91], v12 offset:39392
 v_mfma_f32_16x16x32_bf16 v[224:227], v[108:111], a[144:147], v[224:227]
 v_cvt_pk_bf16_f32 v210, v212, v213
 v_cvt_pk_bf16_f32 v211, v214, v215
 v_mfma_f32_16x16x32_bf16 v[228:231], v[108:111], a[148:151], v[228:231]
 v_permlane16_swap_b32 v208, v210
 v_permlane16_swap_b32 v209, v211
 v_mfma_f32_16x16x32_bf16 v[232:235], v[108:111], a[152:155], v[232:235]
 s_add_u32 s91, s45, 0x1000
 v_mfma_f32_16x16x32_bf16 v[236:239], v[108:111], a[156:159], v[236:239]
 ds_read_b64_tr_b16 v[92:93], v12 offset:46304
 s_waitcnt lgkmcnt(14)
 ds_read_b64_tr_b16 v[94:95], v12 offset:48608
 s_waitcnt lgkmcnt(4)
 v_mfma_f32_16x16x32_bf16 v[224:227], v[64:67], a[160:163], v[224:227]
 buffer_store_dwordx4 v[208:211], v1, s[16:19], s91 offen offset:2048 sc1
 v_mfma_f32_16x16x32_bf16 v[228:231], v[64:67], a[164:167], v[228:231]
 v_cvt_pk_bf16_f32 v216, v216, v217
 v_cvt_pk_bf16_f32 v217, v218, v219
 v_mfma_f32_16x16x32_bf16 v[232:235], v[64:67], a[168:171], v[232:235]
 v_cvt_pk_bf16_f32 v218, v220, v221
 v_cvt_pk_bf16_f32 v219, v222, v223
 v_mfma_f32_16x16x32_bf16 v[236:239], v[64:67], a[172:175], v[236:239]
 ds_read_b64_tr_b16 v[96:97], v14 offset:256
 ds_read_b64_tr_b16 v[98:99], v14 offset:2560
 v_mfma_f32_16x16x32_bf16 v[224:227], v[68:71], a[176:179], v[224:227]
 v_permlane16_swap_b32 v216, v218
 v_permlane16_swap_b32 v217, v219
 v_mfma_f32_16x16x32_bf16 v[228:231], v[68:71], a[180:183], v[228:231]
 s_add_u32 s91, s46, 0x1000
 v_mfma_f32_16x16x32_bf16 v[232:235], v[68:71], a[184:187], v[232:235]
 buffer_store_dwordx4 v[216:219], v1, s[16:19], s91 offen offset:2048 sc1
 v_mfma_f32_16x16x32_bf16 v[236:239], v[68:71], a[188:191], v[236:239]
 ds_read_b64_tr_b16 v[100:101], v14 offset:9472
 ds_read_b64_tr_b16 v[102:103], v14 offset:11776
 v_mfma_f32_16x16x32_bf16 v[224:227], v[72:75], a[192:195], v[224:227]
 buffer_load_dword v17, off, s[20:23], s99 sc1
 v_mfma_f32_16x16x32_bf16 v[228:231], v[72:75], a[196:199], v[228:231]
 v_mfma_f32_16x16x32_bf16 v[232:235], v[72:75], a[200:203], v[232:235]
 v_mfma_f32_16x16x32_bf16 v[236:239], v[72:75], a[204:207], v[236:239]
 ds_read_b64_tr_b16 v[104:105], v14 offset:18688
 ds_read_b64_tr_b16 v[106:107], v14 offset:20992
 v_mfma_f32_16x16x32_bf16 v[224:227], v[76:79], a[208:211], v[224:227]
 v_mfma_f32_16x16x32_bf16 v[228:231], v[76:79], a[212:215], v[228:231]
 v_mfma_f32_16x16x32_bf16 v[232:235], v[76:79], a[216:219], v[232:235]
 v_mfma_f32_16x16x32_bf16 v[236:239], v[76:79], a[220:223], v[236:239]
 ds_read_b64_tr_b16 v[108:109], v14 offset:27904
 ds_read_b64_tr_b16 v[110:111], v14 offset:30208
 v_mfma_f32_16x16x32_bf16 v[224:227], v[80:83], a[224:227], v[224:227]
 v_mfma_f32_16x16x32_bf16 v[228:231], v[80:83], a[228:231], v[228:231]
 v_mfma_f32_16x16x32_bf16 v[232:235], v[80:83], a[232:235], v[232:235]
 v_mfma_f32_16x16x32_bf16 v[236:239], v[80:83], a[236:239], v[236:239]
 ds_read_b64_tr_b16 v[64:65], v12 offset:256
 ds_read_b64_tr_b16 v[66:67], v12 offset:2560
 v_mfma_f32_16x16x32_bf16 v[224:227], v[84:87], a[240:243], v[224:227]
 v_mfma_f32_16x16x32_bf16 v[228:231], v[84:87], a[244:247], v[228:231]
 v_mfma_f32_16x16x32_bf16 v[232:235], v[84:87], a[248:251], v[232:235]
 v_mfma_f32_16x16x32_bf16 v[236:239], v[84:87], a[252:255], v[236:239]
 ds_read_b64_tr_b16 v[68:69], v12 offset:9472
 s_waitcnt lgkmcnt(14)
 ds_read_b64_tr_b16 v[70:71], v12 offset:11776
 s_waitcnt lgkmcnt(4)
 v_mfma_f32_16x16x32_bf16 v[224:227], v[88:91], v[32:35], v[224:227]
 v_mfma_f32_16x16x32_bf16 v[228:231], v[88:91], v[36:39], v[228:231]
 v_mfma_f32_16x16x32_bf16 v[232:235], v[88:91], v[40:43], v[232:235]
 v_mfma_f32_16x16x32_bf16 v[236:239], v[88:91], v[44:47], v[236:239]
 ds_read_b64_tr_b16 v[72:73], v12 offset:18688
 ds_read_b64_tr_b16 v[74:75], v12 offset:20992
 v_mfma_f32_16x16x32_bf16 v[224:227], v[92:95], v[48:51], v[224:227]
 v_mfma_f32_16x16x32_bf16 v[228:231], v[92:95], v[52:55], v[228:231]
 v_mfma_f32_16x16x32_bf16 v[232:235], v[92:95], v[56:59], v[232:235]
 v_mfma_f32_16x16x32_bf16 v[236:239], v[92:95], v[60:63], v[236:239]
 ds_read_b64_tr_b16 v[76:77], v12 offset:27904
 ds_read_b64_tr_b16 v[78:79], v12 offset:30208
 v_mfma_f32_16x16x32_bf16 v[240:243], v[96:99], a[128:131], v[240:243]
 v_mfma_f32_16x16x32_bf16 v[244:247], v[96:99], a[132:135], v[244:247]
 v_mfma_f32_16x16x32_bf16 v[248:251], v[96:99], a[136:139], v[248:251]
 v_cvt_pk_bf16_f32 v224, v224, v225
 v_cvt_pk_bf16_f32 v225, v226, v227
 v_mfma_f32_16x16x32_bf16 v[252:255], v[96:99], a[140:143], v[252:255]
 ds_read_b64_tr_b16 v[80:81], v12 offset:37120
 ds_read_b64_tr_b16 v[82:83], v12 offset:39424
 v_mfma_f32_16x16x32_bf16 v[240:243], v[100:103], a[144:147], v[240:243]
 v_cvt_pk_bf16_f32 v226, v228, v229
 v_cvt_pk_bf16_f32 v227, v230, v231
 v_mfma_f32_16x16x32_bf16 v[244:247], v[100:103], a[148:151], v[244:247]
 v_permlane16_swap_b32 v224, v226
 v_permlane16_swap_b32 v225, v227
 v_mfma_f32_16x16x32_bf16 v[248:251], v[100:103], a[152:155], v[248:251]
 s_add_u32 s91, s45, 0x1000
 v_mfma_f32_16x16x32_bf16 v[252:255], v[100:103], a[156:159], v[252:255]
 ds_read_b64_tr_b16 v[84:85], v12 offset:46336
 ds_read_b64_tr_b16 v[86:87], v12 offset:48640
 v_mfma_f32_16x16x32_bf16 v[240:243], v[104:107], a[160:163], v[240:243]
 buffer_store_dwordx4 v[224:227], v1, s[16:19], s91 offen offset:3072 sc1
 v_mfma_f32_16x16x32_bf16 v[244:247], v[104:107], a[164:167], v[244:247]
 v_cvt_pk_bf16_f32 v232, v232, v233
 v_cvt_pk_bf16_f32 v233, v234, v235
 v_mfma_f32_16x16x32_bf16 v[248:251], v[104:107], a[168:171], v[248:251]
 v_cvt_pk_bf16_f32 v234, v236, v237
 v_cvt_pk_bf16_f32 v235, v238, v239
 v_mfma_f32_16x16x32_bf16 v[252:255], v[104:107], a[172:175], v[252:255]
 v_permlane16_swap_b32 v232, v234
 v_permlane16_swap_b32 v233, v235
 v_mfma_f32_16x16x32_bf16 v[240:243], v[108:111], a[176:179], v[240:243]
 s_add_u32 s91, s46, 0x1000
 v_mfma_f32_16x16x32_bf16 v[244:247], v[108:111], a[180:183], v[244:247]
 buffer_store_dwordx4 v[232:235], v1, s[16:19], s91 offen offset:3072 sc1
 v_mfma_f32_16x16x32_bf16 v[248:251], v[108:111], a[184:187], v[248:251]
 s_waitcnt vmcnt(4)
 v_mfma_f32_16x16x32_bf16 v[252:255], v[108:111], a[188:191], v[252:255]
 buffer_atomic_add v16, v15, s[20:23], s92 offen offset:128 sc1
 s_waitcnt vmcnt(3)
 v_cmp_ne_u32 vcc, 8, v17
 s_nop 1
 s_cbranch_vccz down_e0_ok
 s_mov_b32 s47, 0
down_e0:
 s_sleep 4
 buffer_load_dword v17, off, s[20:23], s99 sc1
 s_waitcnt vmcnt(0)
 v_cmp_ne_u32 vcc, 8, v17
 s_add_u32 s47, s47, 1
 s_cmp_ge_u32 s47, 0x100000
 s_cbranch_scc1 down_e0_ok
 s_cbranch_vccnz down_e0
down_e0_ok:
 s_mov_b32 s96, s98
 buffer_load_dwordx4 v[112:115], v2, s[16:19], s96 offen sc1
 s_add_u32 s96, s96, 0x240000
 buffer_load_dwordx4 v[116:119], v2, s[16:19], s96 offen sc1
 s_add_u32 s96, s96, 0x240000
 buffer_load_dwordx4 v[120:123], v2, s[16:19], s96 offen sc1
 s_add_u32 s96, s96, 0x240000
 buffer_load_dwordx4 v[124:127], v2, s[16:19], s96 offen sc1
 s_add_u32 s96, s96, 0x240000
 buffer_load_dwordx4 v[128:131], v2, s[16:19], s96 offen sc1
 s_add_u32 s96, s96, 0x240000
 buffer_load_dwordx4 v[132:135], v2, s[16:19], s96 offen sc1
 s_add_u32 s96, s96, 0x240000
 buffer_load_dwordx4 v[136:139], v2, s[16:19], s96 offen sc1
 s_add_u32 s96, s96, 0x240000
 buffer_load_dwordx4 v[140:143], v2, s[16:19], s96 offen sc1
 s_waitcnt lgkmcnt(0)
 v_mfma_f32_16x16x32_bf16 v[240:243], v[64:67], a[192:195], v[240:243]
 v_mfma_f32_16x16x32_bf16 v[244:247], v[64:67], a[196:199], v[244:247]
 v_mfma_f32_16x16x32_bf16 v[248:251], v[64:67], a[200:203], v[248:251]
 v_mfma_f32_16x16x32_bf16 v[252:255], v[64:67], a[204:207], v[252:255]
 v_mfma_f32_16x16x32_bf16 v[240:243], v[68:71], a[208:211], v[240:243]
 v_mfma_f32_16x16x32_bf16 v[244:247], v[68:71], a[212:215], v[244:247]
 v_mfma_f32_16x16x32_bf16 v[248:251], v[68:71], a[216:219], v[248:251]
 v_mfma_f32_16x16x32_bf16 v[252:255], v[68:71], a[220:223], v[252:255]
 v_mfma_f32_16x16x32_bf16 v[240:243], v[72:75], a[224:227], v[240:243]
 v_mfma_f32_16x16x32_bf16 v[244:247], v[72:75], a[228:231], v[244:247]
 v_mfma_f32_16x16x32_bf16 v[248:251], v[72:75], a[232:235], v[248:251]
 v_mfma_f32_16x16x32_bf16 v[252:255], v[72:75], a[236:239], v[252:255]
 v_mfma_f32_16x16x32_bf16 v[240:243], v[76:79], a[240:243], v[240:243]
 v_mfma_f32_16x16x32_bf16 v[244:247], v[76:79], a[244:247], v[244:247]
 v_mfma_f32_16x16x32_bf16 v[248:251], v[76:79], a[248:251], v[248:251]
 v_mfma_f32_16x16x32_bf16 v[252:255], v[76:79], a[252:255], v[252:255]
 v_mfma_f32_16x16x32_bf16 v[240:243], v[80:83], v[32:35], v[240:243]
 v_mfma_f32_16x16x32_bf16 v[244:247], v[80:83], v[36:39], v[244:247]
 v_mfma_f32_16x16x32_bf16 v[248:251], v[80:83], v[40:43], v[248:251]
 v_mfma_f32_16x16x32_bf16 v[252:255], v[80:83], v[44:47], v[252:255]
 v_mfma_f32_16x16x32_bf16 v[240:243], v[84:87], v[48:51], v[240:243]
 v_mfma_f32_16x16x32_bf16 v[244:247], v[84:87], v[52:55], v[244:247]
 v_mfma_f32_16x16x32_bf16 v[248:251], v[84:87], v[56:59], v[248:251]
 v_mfma_f32_16x16x32_bf16 v[252:255], v[84:87], v[60:63], v[252:255]
 s_nop 4
 v_cvt_pk_bf16_f32 v240, v240, v241
 v_cvt_pk_bf16_f32 v241, v242, v243
 v_cvt_pk_bf16_f32 v242, v244, v245
 v_cvt_pk_bf16_f32 v243, v246, v247
 s_nop 0
 v_permlane16_swap_b32 v240, v242
 v_permlane16_swap_b32 v241, v243
 s_add_u32 s91, s45, 0x2000
 buffer_store_dwordx4 v[240:243], v1, s[16:19], s91 offen sc1
 v_cvt_pk_bf16_f32 v248, v248, v249
 v_cvt_pk_bf16_f32 v249, v250, v251
 v_cvt_pk_bf16_f32 v250, v252, v253
 v_cvt_pk_bf16_f32 v251, v254, v255
 s_nop 0
 v_permlane16_swap_b32 v248, v250
 v_permlane16_swap_b32 v249, v251
 s_add_u32 s91, s46, 0x2000
 buffer_store_dwordx4 v[248:251], v1, s[16:19], s91 offen sc1
 v_and_b32 v30, 1, v0
 v_lshlrev_b32 v30, 7, v30
 s_barrier
 s_mov_b32 s47, 0
down_pa:
 buffer_load_dword v31, v30, s[20:23], s99 offen sc1
 s_waitcnt vmcnt(0)
 v_cmp_ne_u32 vcc, 8, v31
 s_add_u32 s47, s47, 1
 s_cmp_ge_u32 s47, 0x100000
 s_cbranch_scc1 down_pa_done
 s_cbranch_vccz down_pa_done
 s_sleep 4
 s_branch down_pa
down_pa_done:
 s_nop 3
 buffer_atomic_add v16, v15, s[20:23], s92 offen offset:256 sc1
 s_mov_b32 s96, s98
 buffer_load_dwordx4 v[144:147], v3, s[16:19], s96 offen sc1
 s_add_u32 s96, s96, 0x240000
 buffer_load_dwordx4 v[148:151], v3, s[16:19], s96 offen sc1
 s_add_u32 s96, s96, 0x240000
 buffer_load_dwordx4 v[152:155], v3, s[16:19], s96 offen sc1
 s_add_u32 s96, s96, 0x240000
 buffer_load_dwordx4 v[156:159], v3, s[16:19], s96 offen sc1
 s_add_u32 s96, s96, 0x240000
 buffer_load_dwordx4 v[160:163], v3, s[16:19], s96 offen sc1
 s_add_u32 s96, s96, 0x240000
 buffer_load_dwordx4 v[164:167], v3, s[16:19], s96 offen sc1
 s_add_u32 s96, s96, 0x240000
 buffer_load_dwordx4 v[168:171], v3, s[16:19], s96 offen sc1
 s_add_u32 s96, s96, 0x240000
 buffer_load_dwordx4 v[172:175], v3, s[16:19], s96 offen sc1
 buffer_load_dwordx4 v[64:67], v2, s[24:27], s98 offen sc1
 buffer_load_dwordx4 v[68:71], v3, s[24:27], s98 offen sc1
 buffer_load_dwordx4 v[72:75], v4, s[24:27], s98 offen sc1
 ds_read_b128 v[208:211], v8
 ds_read_b128 v[212:215], v8 offset:16
 ds_read_b128 v[216:219], v9
 ds_read_b128 v[220:223], v9 offset:16
 ds_read_b128 v[224:227], v10
 ds_read_b128 v[228:231], v10 offset:16
 v_mov_b32 v30, 0x100
 s_mov_b32 s47, 0
down_pb:
 buffer_load_dword v31, v30, s[20:23], s99 offen sc1
 s_waitcnt vmcnt(0)
 v_cmp_ne_u32 vcc, 8, v31
 s_add_u32 s47, s47, 1
 s_cmp_ge_u32 s47, 0x100000
 s_cbranch_scc1 down_pb_done
 s_cbranch_vccz down_pb_done
 s_sleep 4
 s_branch down_pb
down_pb_done:
 s_nop 3
 s_mov_b32 s96, s98
 buffer_load_dwordx4 v[176:179], v4, s[16:19], s96 offen sc1
 s_add_u32 s96, s96, 0x240000
 buffer_load_dwordx4 v[180:183], v4, s[16:19], s96 offen sc1
 s_add_u32 s96, s96, 0x240000
 buffer_load_dwordx4 v[184:187], v4, s[16:19], s96 offen sc1
 s_add_u32 s96, s96, 0x240000
 buffer_load_dwordx4 v[188:191], v4, s[16:19], s96 offen sc1
 s_add_u32 s96, s96, 0x240000
 buffer_load_dwordx4 v[192:195], v4, s[16:19], s96 offen sc1
 s_add_u32 s96, s96, 0x240000
 buffer_load_dwordx4 v[196:199], v4, s[16:19], s96 offen sc1
 s_add_u32 s96, s96, 0x240000
 buffer_load_dwordx4 v[200:203], v4, s[16:19], s96 offen sc1
 s_add_u32 s96, s96, 0x240000
 buffer_load_dwordx4 v[204:207], v4, s[16:19], s96 offen sc1
 v_lshlrev_b32 v76, 16, v112
 v_and_b32 v77, 0xffff0000, v112
 v_lshlrev_b32 v78, 16, v113
 v_and_b32 v79, 0xffff0000, v113
 v_lshlrev_b32 v80, 16, v114
 v_and_b32 v81, 0xffff0000, v114
 v_lshlrev_b32 v82, 16, v115
 v_and_b32 v83, 0xffff0000, v115
 v_lshlrev_b32 v84, 16, v144
 v_and_b32 v85, 0xffff0000, v144
 v_lshlrev_b32 v86, 16, v145
 v_and_b32 v87, 0xffff0000, v145
 v_lshlrev_b32 v88, 16, v146
 v_and_b32 v89, 0xffff0000, v146
 v_lshlrev_b32 v90, 16, v147
 v_and_b32 v91, 0xffff0000, v147
 v_lshlrev_b32 v100, 16, v116
 v_and_b32 v101, 0xffff0000, v116
 v_pk_add_f32 v[76:77], v[76:77], v[100:101]
 v_lshlrev_b32 v100, 16, v117
 v_and_b32 v101, 0xffff0000, v117
 v_pk_add_f32 v[78:79], v[78:79], v[100:101]
 v_lshlrev_b32 v100, 16, v118
 v_and_b32 v101, 0xffff0000, v118
 v_pk_add_f32 v[80:81], v[80:81], v[100:101]
 v_lshlrev_b32 v100, 16, v119
 v_and_b32 v101, 0xffff0000, v119
 v_pk_add_f32 v[82:83], v[82:83], v[100:101]
 v_lshlrev_b32 v100, 16, v148
 v_and_b32 v101, 0xffff0000, v148
 v_pk_add_f32 v[84:85], v[84:85], v[100:101]
 v_lshlrev_b32 v100, 16, v149
 v_and_b32 v101, 0xffff0000, v149
 v_pk_add_f32 v[86:87], v[86:87], v[100:101]
 v_lshlrev_b32 v100, 16, v150
 v_and_b32 v101, 0xffff0000, v150
 v_pk_add_f32 v[88:89], v[88:89], v[100:101]
 v_lshlrev_b32 v100, 16, v151
 v_and_b32 v101, 0xffff0000, v151
 v_pk_add_f32 v[90:91], v[90:91], v[100:101]
 v_lshlrev_b32 v100, 16, v120
 v_and_b32 v101, 0xffff0000, v120
 v_pk_add_f32 v[76:77], v[76:77], v[100:101]
 v_lshlrev_b32 v100, 16, v121
 v_and_b32 v101, 0xffff0000, v121
 v_pk_add_f32 v[78:79], v[78:79], v[100:101]
 v_lshlrev_b32 v100, 16, v122
 v_and_b32 v101, 0xffff0000, v122
 v_pk_add_f32 v[80:81], v[80:81], v[100:101]
 v_lshlrev_b32 v100, 16, v123
 v_and_b32 v101, 0xffff0000, v123
 v_pk_add_f32 v[82:83], v[82:83], v[100:101]
 v_lshlrev_b32 v100, 16, v152
 v_and_b32 v101, 0xffff0000, v152
 v_pk_add_f32 v[84:85], v[84:85], v[100:101]
 v_lshlrev_b32 v100, 16, v153
 v_and_b32 v101, 0xffff0000, v153
 v_pk_add_f32 v[86:87], v[86:87], v[100:101]
 v_lshlrev_b32 v100, 16, v154
 v_and_b32 v101, 0xffff0000, v154
 v_pk_add_f32 v[88:89], v[88:89], v[100:101]
 v_lshlrev_b32 v100, 16, v155
 v_and_b32 v101, 0xffff0000, v155
 v_pk_add_f32 v[90:91], v[90:91], v[100:101]
 v_lshlrev_b32 v100, 16, v124
 v_and_b32 v101, 0xffff0000, v124
 v_pk_add_f32 v[76:77], v[76:77], v[100:101]
 v_lshlrev_b32 v100, 16, v125
 v_and_b32 v101, 0xffff0000, v125
 v_pk_add_f32 v[78:79], v[78:79], v[100:101]
 v_lshlrev_b32 v100, 16, v126
 v_and_b32 v101, 0xffff0000, v126
 v_pk_add_f32 v[80:81], v[80:81], v[100:101]
 v_lshlrev_b32 v100, 16, v127
 v_and_b32 v101, 0xffff0000, v127
 v_pk_add_f32 v[82:83], v[82:83], v[100:101]
 v_lshlrev_b32 v100, 16, v156
 v_and_b32 v101, 0xffff0000, v156
 v_pk_add_f32 v[84:85], v[84:85], v[100:101]
 v_lshlrev_b32 v100, 16, v157
 v_and_b32 v101, 0xffff0000, v157
 v_pk_add_f32 v[86:87], v[86:87], v[100:101]
 v_lshlrev_b32 v100, 16, v158
 v_and_b32 v101, 0xffff0000, v158
 v_pk_add_f32 v[88:89], v[88:89], v[100:101]
 v_lshlrev_b32 v100, 16, v159
 v_and_b32 v101, 0xffff0000, v159
 v_pk_add_f32 v[90:91], v[90:91], v[100:101]
 v_lshlrev_b32 v100, 16, v128
 v_and_b32 v101, 0xffff0000, v128
 v_pk_add_f32 v[76:77], v[76:77], v[100:101]
 v_lshlrev_b32 v100, 16, v129
 v_and_b32 v101, 0xffff0000, v129
 v_pk_add_f32 v[78:79], v[78:79], v[100:101]
 v_lshlrev_b32 v100, 16, v130
 v_and_b32 v101, 0xffff0000, v130
 v_pk_add_f32 v[80:81], v[80:81], v[100:101]
 v_lshlrev_b32 v100, 16, v131
 v_and_b32 v101, 0xffff0000, v131
 v_pk_add_f32 v[82:83], v[82:83], v[100:101]
 v_lshlrev_b32 v100, 16, v160
 v_and_b32 v101, 0xffff0000, v160
 v_pk_add_f32 v[84:85], v[84:85], v[100:101]
 v_lshlrev_b32 v100, 16, v161
 v_and_b32 v101, 0xffff0000, v161
 v_pk_add_f32 v[86:87], v[86:87], v[100:101]
 v_lshlrev_b32 v100, 16, v162
 v_and_b32 v101, 0xffff0000, v162
 v_pk_add_f32 v[88:89], v[88:89], v[100:101]
 v_lshlrev_b32 v100, 16, v163
 v_and_b32 v101, 0xffff0000, v163
 v_pk_add_f32 v[90:91], v[90:91], v[100:101]
 v_lshlrev_b32 v100, 16, v132
 v_and_b32 v101, 0xffff0000, v132
 v_pk_add_f32 v[76:77], v[76:77], v[100:101]
 v_lshlrev_b32 v100, 16, v133
 v_and_b32 v101, 0xffff0000, v133
 v_pk_add_f32 v[78:79], v[78:79], v[100:101]
 v_lshlrev_b32 v100, 16, v134
 v_and_b32 v101, 0xffff0000, v134
 v_pk_add_f32 v[80:81], v[80:81], v[100:101]
 v_lshlrev_b32 v100, 16, v135
 v_and_b32 v101, 0xffff0000, v135
 v_pk_add_f32 v[82:83], v[82:83], v[100:101]
 v_lshlrev_b32 v100, 16, v164
 v_and_b32 v101, 0xffff0000, v164
 v_pk_add_f32 v[84:85], v[84:85], v[100:101]
 v_lshlrev_b32 v100, 16, v165
 v_and_b32 v101, 0xffff0000, v165
 v_pk_add_f32 v[86:87], v[86:87], v[100:101]
 v_lshlrev_b32 v100, 16, v166
 v_and_b32 v101, 0xffff0000, v166
 v_pk_add_f32 v[88:89], v[88:89], v[100:101]
 v_lshlrev_b32 v100, 16, v167
 v_and_b32 v101, 0xffff0000, v167
 v_pk_add_f32 v[90:91], v[90:91], v[100:101]
 v_lshlrev_b32 v100, 16, v136
 v_and_b32 v101, 0xffff0000, v136
 v_pk_add_f32 v[76:77], v[76:77], v[100:101]
 v_lshlrev_b32 v100, 16, v137
 v_and_b32 v101, 0xffff0000, v137
 v_pk_add_f32 v[78:79], v[78:79], v[100:101]
 v_lshlrev_b32 v100, 16, v138
 v_and_b32 v101, 0xffff0000, v138
 v_pk_add_f32 v[80:81], v[80:81], v[100:101]
 v_lshlrev_b32 v100, 16, v139
 v_and_b32 v101, 0xffff0000, v139
 v_pk_add_f32 v[82:83], v[82:83], v[100:101]
 v_lshlrev_b32 v100, 16, v168
 v_and_b32 v101, 0xffff0000, v168
 v_pk_add_f32 v[84:85], v[84:85], v[100:101]
 v_lshlrev_b32 v100, 16, v169
 v_and_b32 v101, 0xffff0000, v169
 v_pk_add_f32 v[86:87], v[86:87], v[100:101]
 v_lshlrev_b32 v100, 16, v170
 v_and_b32 v101, 0xffff0000, v170
 v_pk_add_f32 v[88:89], v[88:89], v[100:101]
 v_lshlrev_b32 v100, 16, v171
 v_and_b32 v101, 0xffff0000, v171
 v_pk_add_f32 v[90:91], v[90:91], v[100:101]
 v_lshlrev_b32 v100, 16, v140
 v_and_b32 v101, 0xffff0000, v140
 v_pk_add_f32 v[76:77], v[76:77], v[100:101]
 v_lshlrev_b32 v100, 16, v141
 v_and_b32 v101, 0xffff0000, v141
 v_pk_add_f32 v[78:79], v[78:79], v[100:101]
 v_lshlrev_b32 v100, 16, v142
 v_and_b32 v101, 0xffff0000, v142
 v_pk_add_f32 v[80:81], v[80:81], v[100:101]
 v_lshlrev_b32 v100, 16, v143
 v_and_b32 v101, 0xffff0000, v143
 v_pk_add_f32 v[82:83], v[82:83], v[100:101]
 v_lshlrev_b32 v100, 16, v172
 v_and_b32 v101, 0xffff0000, v172
 v_pk_add_f32 v[84:85], v[84:85], v[100:101]
 v_lshlrev_b32 v100, 16, v173
 v_and_b32 v101, 0xffff0000, v173
 v_pk_add_f32 v[86:87], v[86:87], v[100:101]
 v_lshlrev_b32 v100, 16, v174
 v_and_b32 v101, 0xffff0000, v174
 v_pk_add_f32 v[88:89], v[88:89], v[100:101]
 v_lshlrev_b32 v100, 16, v175
 v_and_b32 v101, 0xffff0000, v175
 v_pk_add_f32 v[90:91], v[90:91], v[100:101]
 v_cvt_pk_bf16_f32 v232, v76, v77
 v_lshlrev_b32 v76, 16, v232
 v_and_b32 v77, 0xffff0000, v232
 s_waitcnt lgkmcnt(0)
 v_pk_mul_f32 v[76:77], v[76:77], v[208:209]
 v_cvt_pk_bf16_f32 v232, v76, v77
 v_lshlrev_b32 v76, 16, v232
 v_and_b32 v77, 0xffff0000, v232
 v_lshlrev_b32 v100, 16, v64
 v_and_b32 v101, 0xffff0000, v64
 v_pk_add_f32 v[76:77], v[76:77], v[100:101]
 v_cvt_pk_bf16_f32 v232, v76, v77
 v_cvt_pk_bf16_f32 v233, v78, v79
 v_lshlrev_b32 v78, 16, v233
 v_and_b32 v79, 0xffff0000, v233
 v_pk_mul_f32 v[78:79], v[78:79], v[210:211]
 v_cvt_pk_bf16_f32 v233, v78, v79
 v_lshlrev_b32 v78, 16, v233
 v_and_b32 v79, 0xffff0000, v233
 v_lshlrev_b32 v100, 16, v65
 v_and_b32 v101, 0xffff0000, v65
 v_pk_add_f32 v[78:79], v[78:79], v[100:101]
 v_cvt_pk_bf16_f32 v233, v78, v79
 v_cvt_pk_bf16_f32 v234, v80, v81
 v_lshlrev_b32 v80, 16, v234
 v_and_b32 v81, 0xffff0000, v234
 v_pk_mul_f32 v[80:81], v[80:81], v[212:213]
 v_cvt_pk_bf16_f32 v234, v80, v81
 v_lshlrev_b32 v80, 16, v234
 v_and_b32 v81, 0xffff0000, v234
 v_lshlrev_b32 v100, 16, v66
 v_and_b32 v101, 0xffff0000, v66
 v_pk_add_f32 v[80:81], v[80:81], v[100:101]
 v_cvt_pk_bf16_f32 v234, v80, v81
 v_cvt_pk_bf16_f32 v235, v82, v83
 v_lshlrev_b32 v82, 16, v235
 v_and_b32 v83, 0xffff0000, v235
 v_pk_mul_f32 v[82:83], v[82:83], v[214:215]
 v_cvt_pk_bf16_f32 v235, v82, v83
 v_lshlrev_b32 v82, 16, v235
 v_and_b32 v83, 0xffff0000, v235
 v_lshlrev_b32 v100, 16, v67
 v_and_b32 v101, 0xffff0000, v67
 v_pk_add_f32 v[82:83], v[82:83], v[100:101]
 v_cvt_pk_bf16_f32 v235, v82, v83
 buffer_store_dwordx4 v[232:235], v5, s[28:31], s97 offen sc1
 v_cvt_pk_bf16_f32 v236, v84, v85
 v_lshlrev_b32 v84, 16, v236
 v_and_b32 v85, 0xffff0000, v236
 v_pk_mul_f32 v[84:85], v[84:85], v[216:217]
 v_cvt_pk_bf16_f32 v236, v84, v85
 v_lshlrev_b32 v84, 16, v236
 v_and_b32 v85, 0xffff0000, v236
 v_lshlrev_b32 v100, 16, v68
 v_and_b32 v101, 0xffff0000, v68
 v_pk_add_f32 v[84:85], v[84:85], v[100:101]
 v_cvt_pk_bf16_f32 v236, v84, v85
 v_cvt_pk_bf16_f32 v237, v86, v87
 v_lshlrev_b32 v86, 16, v237
 v_and_b32 v87, 0xffff0000, v237
 v_pk_mul_f32 v[86:87], v[86:87], v[218:219]
 v_cvt_pk_bf16_f32 v237, v86, v87
 v_lshlrev_b32 v86, 16, v237
 v_and_b32 v87, 0xffff0000, v237
 v_lshlrev_b32 v100, 16, v69
 v_and_b32 v101, 0xffff0000, v69
 v_pk_add_f32 v[86:87], v[86:87], v[100:101]
 v_cvt_pk_bf16_f32 v237, v86, v87
 v_cvt_pk_bf16_f32 v238, v88, v89
 v_lshlrev_b32 v88, 16, v238
 v_and_b32 v89, 0xffff0000, v238
 v_pk_mul_f32 v[88:89], v[88:89], v[220:221]
 v_cvt_pk_bf16_f32 v238, v88, v89
 v_lshlrev_b32 v88, 16, v238
 v_and_b32 v89, 0xffff0000, v238
 v_lshlrev_b32 v100, 16, v70
 v_and_b32 v101, 0xffff0000, v70
 v_pk_add_f32 v[88:89], v[88:89], v[100:101]
 v_cvt_pk_bf16_f32 v238, v88, v89
 v_cvt_pk_bf16_f32 v239, v90, v91
 v_lshlrev_b32 v90, 16, v239
 v_and_b32 v91, 0xffff0000, v239
 v_pk_mul_f32 v[90:91], v[90:91], v[222:223]
 v_cvt_pk_bf16_f32 v239, v90, v91
 v_lshlrev_b32 v90, 16, v239
 v_and_b32 v91, 0xffff0000, v239
 v_lshlrev_b32 v100, 16, v71
 v_and_b32 v101, 0xffff0000, v71
 v_pk_add_f32 v[90:91], v[90:91], v[100:101]
 v_cvt_pk_bf16_f32 v239, v90, v91
 buffer_store_dwordx4 v[236:239], v6, s[28:31], s97 offen sc1
 s_waitcnt vmcnt(9)
 v_lshlrev_b32 v92, 16, v176
 v_and_b32 v93, 0xffff0000, v176
 v_lshlrev_b32 v94, 16, v177
 v_and_b32 v95, 0xffff0000, v177
 v_lshlrev_b32 v96, 16, v178
 v_and_b32 v97, 0xffff0000, v178
 v_lshlrev_b32 v98, 16, v179
 v_and_b32 v99, 0xffff0000, v179
 s_waitcnt vmcnt(8)
 v_lshlrev_b32 v100, 16, v180
 v_and_b32 v101, 0xffff0000, v180
 v_pk_add_f32 v[92:93], v[92:93], v[100:101]
 v_lshlrev_b32 v100, 16, v181
 v_and_b32 v101, 0xffff0000, v181
 v_pk_add_f32 v[94:95], v[94:95], v[100:101]
 v_lshlrev_b32 v100, 16, v182
 v_and_b32 v101, 0xffff0000, v182
 v_pk_add_f32 v[96:97], v[96:97], v[100:101]
 v_lshlrev_b32 v100, 16, v183
 v_and_b32 v101, 0xffff0000, v183
 v_pk_add_f32 v[98:99], v[98:99], v[100:101]
 s_waitcnt vmcnt(7)
 v_lshlrev_b32 v100, 16, v184
 v_and_b32 v101, 0xffff0000, v184
 v_pk_add_f32 v[92:93], v[92:93], v[100:101]
 v_lshlrev_b32 v100, 16, v185
 v_and_b32 v101, 0xffff0000, v185
 v_pk_add_f32 v[94:95], v[94:95], v[100:101]
 v_lshlrev_b32 v100, 16, v186
 v_and_b32 v101, 0xffff0000, v186
 v_pk_add_f32 v[96:97], v[96:97], v[100:101]
 v_lshlrev_b32 v100, 16, v187
 v_and_b32 v101, 0xffff0000, v187
 v_pk_add_f32 v[98:99], v[98:99], v[100:101]
 s_waitcnt vmcnt(6)
 v_lshlrev_b32 v100, 16, v188
 v_and_b32 v101, 0xffff0000, v188
 v_pk_add_f32 v[92:93], v[92:93], v[100:101]
 v_lshlrev_b32 v100, 16, v189
 v_and_b32 v101, 0xffff0000, v189
 v_pk_add_f32 v[94:95], v[94:95], v[100:101]
 v_lshlrev_b32 v100, 16, v190
 v_and_b32 v101, 0xffff0000, v190
 v_pk_add_f32 v[96:97], v[96:97], v[100:101]
 v_lshlrev_b32 v100, 16, v191
 v_and_b32 v101, 0xffff0000, v191
 v_pk_add_f32 v[98:99], v[98:99], v[100:101]
 s_waitcnt vmcnt(5)
 v_lshlrev_b32 v100, 16, v192
 v_and_b32 v101, 0xffff0000, v192
 v_pk_add_f32 v[92:93], v[92:93], v[100:101]
 v_lshlrev_b32 v100, 16, v193
 v_and_b32 v101, 0xffff0000, v193
 v_pk_add_f32 v[94:95], v[94:95], v[100:101]
 v_lshlrev_b32 v100, 16, v194
 v_and_b32 v101, 0xffff0000, v194
 v_pk_add_f32 v[96:97], v[96:97], v[100:101]
 v_lshlrev_b32 v100, 16, v195
 v_and_b32 v101, 0xffff0000, v195
 v_pk_add_f32 v[98:99], v[98:99], v[100:101]
 s_waitcnt vmcnt(4)
 v_lshlrev_b32 v100, 16, v196
 v_and_b32 v101, 0xffff0000, v196
 v_pk_add_f32 v[92:93], v[92:93], v[100:101]
 v_lshlrev_b32 v100, 16, v197
 v_and_b32 v101, 0xffff0000, v197
 v_pk_add_f32 v[94:95], v[94:95], v[100:101]
 v_lshlrev_b32 v100, 16, v198
 v_and_b32 v101, 0xffff0000, v198
 v_pk_add_f32 v[96:97], v[96:97], v[100:101]
 v_lshlrev_b32 v100, 16, v199
 v_and_b32 v101, 0xffff0000, v199
 v_pk_add_f32 v[98:99], v[98:99], v[100:101]
 s_waitcnt vmcnt(3)
 v_lshlrev_b32 v100, 16, v200
 v_and_b32 v101, 0xffff0000, v200
 v_pk_add_f32 v[92:93], v[92:93], v[100:101]
 v_lshlrev_b32 v100, 16, v201
 v_and_b32 v101, 0xffff0000, v201
 v_pk_add_f32 v[94:95], v[94:95], v[100:101]
 v_lshlrev_b32 v100, 16, v202
 v_and_b32 v101, 0xffff0000, v202
 v_pk_add_f32 v[96:97], v[96:97], v[100:101]
 v_lshlrev_b32 v100, 16, v203
 v_and_b32 v101, 0xffff0000, v203
 v_pk_add_f32 v[98:99], v[98:99], v[100:101]
 s_waitcnt vmcnt(2)
 v_lshlrev_b32 v100, 16, v204
 v_and_b32 v101, 0xffff0000, v204
 v_pk_add_f32 v[92:93], v[92:93], v[100:101]
 v_lshlrev_b32 v100, 16, v205
 v_and_b32 v101, 0xffff0000, v205
 v_pk_add_f32 v[94:95], v[94:95], v[100:101]
 v_lshlrev_b32 v100, 16, v206
 v_and_b32 v101, 0xffff0000, v206
 v_pk_add_f32 v[96:97], v[96:97], v[100:101]
 v_lshlrev_b32 v100, 16, v207
 v_and_b32 v101, 0xffff0000, v207
 v_pk_add_f32 v[98:99], v[98:99], v[100:101]
 v_cvt_pk_bf16_f32 v240, v92, v93
 v_lshlrev_b32 v92, 16, v240
 v_and_b32 v93, 0xffff0000, v240
 v_pk_mul_f32 v[92:93], v[92:93], v[224:225]
 v_cvt_pk_bf16_f32 v240, v92, v93
 v_lshlrev_b32 v92, 16, v240
 v_and_b32 v93, 0xffff0000, v240
 v_lshlrev_b32 v100, 16, v72
 v_and_b32 v101, 0xffff0000, v72
 v_pk_add_f32 v[92:93], v[92:93], v[100:101]
 v_cvt_pk_bf16_f32 v240, v92, v93
 v_cvt_pk_bf16_f32 v241, v94, v95
 v_lshlrev_b32 v94, 16, v241
 v_and_b32 v95, 0xffff0000, v241
 v_pk_mul_f32 v[94:95], v[94:95], v[226:227]
 v_cvt_pk_bf16_f32 v241, v94, v95
 v_lshlrev_b32 v94, 16, v241
 v_and_b32 v95, 0xffff0000, v241
 v_lshlrev_b32 v100, 16, v73
 v_and_b32 v101, 0xffff0000, v73
 v_pk_add_f32 v[94:95], v[94:95], v[100:101]
 v_cvt_pk_bf16_f32 v241, v94, v95
 v_cvt_pk_bf16_f32 v242, v96, v97
 v_lshlrev_b32 v96, 16, v242
 v_and_b32 v97, 0xffff0000, v242
 v_pk_mul_f32 v[96:97], v[96:97], v[228:229]
 v_cvt_pk_bf16_f32 v242, v96, v97
 v_lshlrev_b32 v96, 16, v242
 v_and_b32 v97, 0xffff0000, v242
 v_lshlrev_b32 v100, 16, v74
 v_and_b32 v101, 0xffff0000, v74
 v_pk_add_f32 v[96:97], v[96:97], v[100:101]
 v_cvt_pk_bf16_f32 v242, v96, v97
 v_cvt_pk_bf16_f32 v243, v98, v99
 v_lshlrev_b32 v98, 16, v243
 v_and_b32 v99, 0xffff0000, v243
 v_pk_mul_f32 v[98:99], v[98:99], v[230:231]
 v_cvt_pk_bf16_f32 v243, v98, v99
 v_lshlrev_b32 v98, 16, v243
 v_and_b32 v99, 0xffff0000, v243
 v_lshlrev_b32 v100, 16, v75
 v_and_b32 v101, 0xffff0000, v75
 v_pk_add_f32 v[98:99], v[98:99], v[100:101]
 v_cvt_pk_bf16_f32 v243, v98, v99
 buffer_store_dwordx4 v[240:243], v7, s[28:31], s97 offen sc1
main_kernel_end:
 s_endpgm
 s_waitcnt vmcnt(0)
attn_slow:
 s_waitcnt vmcnt(0) lgkmcnt(0)
 v_mov_b32 v15, 0xff800000
 v_mov_b32 v16, 0xff800000
 s_mov_b32 s40, s32
 s_mov_b32 s41, 0
attn_p1:
 s_barrier
 s_add_u32 m0, s35, 0x20000
 s_nop 0
 buffer_load_dwordx4 v6, s[16:19], s40 offen lds
 buffer_load_dwordx4 v7, s[16:19], s40 offen offset:1024 lds
 buffer_load_dwordx4 v8, s[16:19], s40 offen offset:2048 lds
 buffer_load_dwordx4 v9, s[16:19], s40 offen offset:3072 lds
 s_waitcnt vmcnt(0)
 s_barrier
 ds_read_b128 a[192:195], v76 offset:49152
 ds_read_b128 a[196:199], v77 offset:49152
 ds_read_b128 a[200:203], v78 offset:49152
 ds_read_b128 a[204:207], v79 offset:49152
 ds_read_b128 a[208:211], v80 offset:49152
 ds_read_b128 a[212:215], v81 offset:49152
 ds_read_b128 a[216:219], v82 offset:49152
 ds_read_b128 a[220:223], v83 offset:49152
 ds_read_b128 a[224:227], v76 offset:57344
 ds_read_b128 a[228:231], v77 offset:57344
 ds_read_b128 a[232:235], v78 offset:57344
 ds_read_b128 a[236:239], v79 offset:57344
 ds_read_b128 a[240:243], v80 offset:57344
 ds_read_b128 a[244:247], v81 offset:57344
 ds_read_b128 a[248:251], v82 offset:57344
 s_waitcnt lgkmcnt(14)
 ds_read_b128 a[252:255], v83 offset:57344
 v_mfma_f32_32x32x16_bf16 v[128:143], a[192:195], a[128:131], 0
 v_mfma_f32_32x32x16_bf16 v[144:159], a[192:195], a[160:163], 0
 s_waitcnt lgkmcnt(8)
 v_mfma_f32_32x32x16_bf16 v[128:143], a[196:199], a[132:135], v[128:143]
 v_mfma_f32_32x32x16_bf16 v[144:159], a[196:199], a[164:167], v[144:159]
 v_mfma_f32_32x32x16_bf16 v[128:143], a[200:203], a[136:139], v[128:143]
 v_mfma_f32_32x32x16_bf16 v[144:159], a[200:203], a[168:171], v[144:159]
 v_mfma_f32_32x32x16_bf16 v[128:143], a[204:207], a[140:143], v[128:143]
 v_mfma_f32_32x32x16_bf16 v[144:159], a[204:207], a[172:175], v[144:159]
 v_mfma_f32_32x32x16_bf16 v[128:143], a[208:211], a[144:147], v[128:143]
 v_mfma_f32_32x32x16_bf16 v[144:159], a[208:211], a[176:179], v[144:159]
 v_mfma_f32_32x32x16_bf16 v[128:143], a[212:215], a[148:151], v[128:143]
 v_mfma_f32_32x32x16_bf16 v[144:159], a[212:215], a[180:183], v[144:159]
 v_mfma_f32_32x32x16_bf16 v[128:143], a[216:219], a[152:155], v[128:143]
 v_mfma_f32_32x32x16_bf16 v[144:159], a[216:219], a[184:187], v[144:159]
 v_mfma_f32_32x32x16_bf16 v[128:143], a[220:223], a[156:159], v[128:143]
 v_mfma_f32_32x32x16_bf16 v[144:159], a[220:223], a[188:191], v[144:159]
 s_waitcnt lgkmcnt(0)
 v_mfma_f32_32x32x16_bf16 v[160:175], a[224:227], a[128:131], 0
 v_mfma_f32_32x32x16_bf16 v[176:191], a[224:227], a[160:163], 0
 v_mfma_f32_32x32x16_bf16 v[160:175], a[228:231], a[132:135], v[160:175]
 v_mfma_f32_32x32x16_bf16 v[176:191], a[228:231], a[164:167], v[176:191]
 v_mfma_f32_32x32x16_bf16 v[160:175], a[232:235], a[136:139], v[160:175]
 v_mfma_f32_32x32x16_bf16 v[176:191], a[232:235], a[168:171], v[176:191]
 v_mfma_f32_32x32x16_bf16 v[160:175], a[236:239], a[140:143], v[160:175]
 v_mfma_f32_32x32x16_bf16 v[176:191], a[236:239], a[172:175], v[176:191]
 v_mfma_f32_32x32x16_bf16 v[160:175], a[240:243], a[144:147], v[160:175]
 v_mfma_f32_32x32x16_bf16 v[176:191], a[240:243], a[176:179], v[176:191]
 v_mfma_f32_32x32x16_bf16 v[160:175], a[244:247], a[148:151], v[160:175]
 v_mfma_f32_32x32x16_bf16 v[176:191], a[244:247], a[180:183], v[176:191]
 v_mfma_f32_32x32x16_bf16 v[160:175], a[248:251], a[152:155], v[160:175]
 v_mfma_f32_32x32x16_bf16 v[176:191], a[248:251], a[184:187], v[176:191]
 v_mfma_f32_32x32x16_bf16 v[160:175], a[252:255], a[156:159], v[160:175]
 v_mfma_f32_32x32x16_bf16 v[176:191], a[252:255], a[188:191], v[176:191]
 v_max3_f32 v15, v15, v128, v129
 v_max3_f32 v15, v15, v130, v131
 v_max3_f32 v15, v15, v132, v133
 v_max3_f32 v15, v15, v134, v135
 v_max3_f32 v15, v15, v136, v137
 v_max3_f32 v15, v15, v138, v139
 v_max3_f32 v15, v15, v140, v141
 v_max3_f32 v15, v15, v142, v143
 v_max3_f32 v16, v16, v144, v145
 v_max3_f32 v16, v16, v146, v147
 v_max3_f32 v16, v16, v148, v149
 v_max3_f32 v16, v16, v150, v151
 v_max3_f32 v16, v16, v152, v153
 v_max3_f32 v16, v16, v154, v155
 v_max3_f32 v16, v16, v156, v157
 v_max3_f32 v16, v16, v158, v159
 v_max3_f32 v15, v15, v160, v161
 v_max3_f32 v15, v15, v162, v163
 v_max3_f32 v15, v15, v164, v165
 v_max3_f32 v15, v15, v166, v167
 v_max3_f32 v15, v15, v168, v169
 v_max3_f32 v15, v15, v170, v171
 v_max3_f32 v15, v15, v172, v173
 v_max3_f32 v15, v15, v174, v175
 v_max3_f32 v16, v16, v176, v177
 v_max3_f32 v16, v16, v178, v179
 v_max3_f32 v16, v16, v180, v181
 v_max3_f32 v16, v16, v182, v183
 v_max3_f32 v16, v16, v184, v185
 v_max3_f32 v16, v16, v186, v187
 v_max3_f32 v16, v16, v188, v189
 v_max3_f32 v16, v16, v190, v191
 s_add_u32 s40, s40, 0x4000
 s_add_u32 s41, s41, 1
 s_cmp_lt_u32 s41, 8
 s_nop 15
 s_nop 15
 s_cbranch_scc1 attn_p1
 v_mov_b32 v17, v15
 s_nop 1
 v_permlane32_swap_b32 v15, v17
 v_min_f32 v15, -v15, -v17
 v_mov_b32 v192, v15
 v_mov_b32 v193, v15
 v_mov_b32 v194, v15
 v_mov_b32 v195, v15
 v_mov_b32 v196, v15
 v_mov_b32 v197, v15
 v_mov_b32 v198, v15
 v_mov_b32 v199, v15
 v_mov_b32 v200, v15
 v_mov_b32 v201, v15
 v_mov_b32 v202, v15
 v_mov_b32 v203, v15
 v_mov_b32 v204, v15
 v_mov_b32 v205, v15
 v_mov_b32 v206, v15
 v_mov_b32 v207, v15
 v_mov_b32 v11, 0
 v_mov_b32 v18, v16
 s_nop 1
 v_permlane32_swap_b32 v16, v18
 v_min_f32 v16, -v16, -v18
 v_mov_b32 v208, v16
 v_mov_b32 v209, v16
 v_mov_b32 v210, v16
 v_mov_b32 v211, v16
 v_mov_b32 v212, v16
 v_mov_b32 v213, v16
 v_mov_b32 v214, v16
 v_mov_b32 v215, v16
 v_mov_b32 v216, v16
 v_mov_b32 v217, v16
 v_mov_b32 v218, v16
 v_mov_b32 v219, v16
 v_mov_b32 v220, v16
 v_mov_b32 v221, v16
 v_mov_b32 v222, v16
 v_mov_b32 v223, v16
 v_mov_b32 v12, 0
 v_accvgpr_write_b32 a0, 0
 v_accvgpr_write_b32 a1, 0
 v_accvgpr_write_b32 a2, 0
 v_accvgpr_write_b32 a3, 0
 v_accvgpr_write_b32 a4, 0
 v_accvgpr_write_b32 a5, 0
 v_accvgpr_write_b32 a6, 0
 v_accvgpr_write_b32 a7, 0
 v_accvgpr_write_b32 a8, 0
 v_accvgpr_write_b32 a9, 0
 v_accvgpr_write_b32 a10, 0
 v_accvgpr_write_b32 a11, 0
 v_accvgpr_write_b32 a12, 0
 v_accvgpr_write_b32 a13, 0
 v_accvgpr_write_b32 a14, 0
 v_accvgpr_write_b32 a15, 0
 v_accvgpr_write_b32 a16, 0
 v_accvgpr_write_b32 a17, 0
 v_accvgpr_write_b32 a18, 0
 v_accvgpr_write_b32 a19, 0
 v_accvgpr_write_b32 a20, 0
 v_accvgpr_write_b32 a21, 0
 v_accvgpr_write_b32 a22, 0
 v_accvgpr_write_b32 a23, 0
 v_accvgpr_write_b32 a24, 0
 v_accvgpr_write_b32 a25, 0
 v_accvgpr_write_b32 a26, 0
 v_accvgpr_write_b32 a27, 0
 v_accvgpr_write_b32 a28, 0
 v_accvgpr_write_b32 a29, 0
 v_accvgpr_write_b32 a30, 0
 v_accvgpr_write_b32 a31, 0
 v_accvgpr_write_b32 a32, 0
 v_accvgpr_write_b32 a33, 0
 v_accvgpr_write_b32 a34, 0
 v_accvgpr_write_b32 a35, 0
 v_accvgpr_write_b32 a36, 0
 v_accvgpr_write_b32 a37, 0
 v_accvgpr_write_b32 a38, 0
 v_accvgpr_write_b32 a39, 0
 v_accvgpr_write_b32 a40, 0
 v_accvgpr_write_b32 a41, 0
 v_accvgpr_write_b32 a42, 0
 v_accvgpr_write_b32 a43, 0
 v_accvgpr_write_b32 a44, 0
 v_accvgpr_write_b32 a45, 0
 v_accvgpr_write_b32 a46, 0
 v_accvgpr_write_b32 a47, 0
 v_accvgpr_write_b32 a48, 0
 v_accvgpr_write_b32 a49, 0
 v_accvgpr_write_b32 a50, 0
 v_accvgpr_write_b32 a51, 0
 v_accvgpr_write_b32 a52, 0
 v_accvgpr_write_b32 a53, 0
 v_accvgpr_write_b32 a54, 0
 v_accvgpr_write_b32 a55, 0
 v_accvgpr_write_b32 a56, 0
 v_accvgpr_write_b32 a57, 0
 v_accvgpr_write_b32 a58, 0
 v_accvgpr_write_b32 a59, 0
 v_accvgpr_write_b32 a60, 0
 v_accvgpr_write_b32 a61, 0
 v_accvgpr_write_b32 a62, 0
 v_accvgpr_write_b32 a63, 0
 v_accvgpr_write_b32 a64, 0
 v_accvgpr_write_b32 a65, 0
 v_accvgpr_write_b32 a66, 0
 v_accvgpr_write_b32 a67, 0
 v_accvgpr_write_b32 a68, 0
 v_accvgpr_write_b32 a69, 0
 v_accvgpr_write_b32 a70, 0
 v_accvgpr_write_b32 a71, 0
 v_accvgpr_write_b32 a72, 0
 v_accvgpr_write_b32 a73, 0
 v_accvgpr_write_b32 a74, 0
 v_accvgpr_write_b32 a75, 0
 v_accvgpr_write_b32 a76, 0
 v_accvgpr_write_b32 a77, 0
 v_accvgpr_write_b32 a78, 0
 v_accvgpr_write_b32 a79, 0
 v_accvgpr_write_b32 a80, 0
 v_accvgpr_write_b32 a81, 0
 v_accvgpr_write_b32 a82, 0
 v_accvgpr_write_b32 a83, 0
 v_accvgpr_write_b32 a84, 0
 v_accvgpr_write_b32 a85, 0
 v_accvgpr_write_b32 a86, 0
 v_accvgpr_write_b32 a87, 0
 v_accvgpr_write_b32 a88, 0
 v_accvgpr_write_b32 a89, 0
 v_accvgpr_write_b32 a90, 0
 v_accvgpr_write_b32 a91, 0
 v_accvgpr_write_b32 a92, 0
 v_accvgpr_write_b32 a93, 0
 v_accvgpr_write_b32 a94, 0
 v_accvgpr_write_b32 a95, 0
 v_accvgpr_write_b32 a96, 0
 v_accvgpr_write_b32 a97, 0
 v_accvgpr_write_b32 a98, 0
 v_accvgpr_write_b32 a99, 0
 v_accvgpr_write_b32 a100, 0
 v_accvgpr_write_b32 a101, 0
 v_accvgpr_write_b32 a102, 0
 v_accvgpr_write_b32 a103, 0
 v_accvgpr_write_b32 a104, 0
 v_accvgpr_write_b32 a105, 0
 v_accvgpr_write_b32 a106, 0
 v_accvgpr_write_b32 a107, 0
 v_accvgpr_write_b32 a108, 0
 v_accvgpr_write_b32 a109, 0
 v_accvgpr_write_b32 a110, 0
 v_accvgpr_write_b32 a111, 0
 v_accvgpr_write_b32 a112, 0
 v_accvgpr_write_b32 a113, 0
 v_accvgpr_write_b32 a114, 0
 v_accvgpr_write_b32 a115, 0
 v_accvgpr_write_b32 a116, 0
 v_accvgpr_write_b32 a117, 0
 v_accvgpr_write_b32 a118, 0
 v_accvgpr_write_b32 a119, 0
 v_accvgpr_write_b32 a120, 0
 v_accvgpr_write_b32 a121, 0
 v_accvgpr_write_b32 a122, 0
 v_accvgpr_write_b32 a123, 0
 v_accvgpr_write_b32 a124, 0
 v_accvgpr_write_b32 a125, 0
 v_accvgpr_write_b32 a126, 0
 v_accvgpr_write_b32 a127, 0
 s_mov_b32 s40, s32
 s_mov_b32 s41, 0
attn_p2:
 s_barrier
 s_add_u32 m0, s35, 0x20000
 s_nop 0
 buffer_load_dwordx4 v6, s[16:19], s40 offen lds
 buffer_load_dwordx4 v7, s[16:19], s40 offen offset:1024 lds
 buffer_load_dwordx4 v8, s[16:19], s40 offen offset:2048 lds
 buffer_load_dwordx4 v9, s[16:19], s40 offen offset:3072 lds
 s_add_u32 m0, s35, 0x24000
 s_nop 0
 buffer_load_dwordx4 v10, s[20:23], s40 offen lds
 buffer_load_dwordx4 v10, s[20:23], s40 offen offset:1024 lds
 buffer_load_dwordx4 v10, s[20:23], s40 offen offset:2048 lds
 buffer_load_dwordx4 v10, s[20:23], s40 offen offset:3072 lds
 s_waitcnt vmcnt(0)
 s_barrier
 ds_read_b128 a[192:195], v76 offset:49152
 ds_read_b128 a[196:199], v77 offset:49152
 ds_read_b128 a[200:203], v78 offset:49152
 ds_read_b128 a[204:207], v79 offset:49152
 ds_read_b128 a[208:211], v80 offset:49152
 ds_read_b128 a[212:215], v81 offset:49152
 ds_read_b128 a[216:219], v82 offset:49152
 ds_read_b128 a[220:223], v83 offset:49152
 ds_read_b128 a[224:227], v76 offset:57344
 ds_read_b128 a[228:231], v77 offset:57344
 ds_read_b128 a[232:235], v78 offset:57344
 ds_read_b128 a[236:239], v79 offset:57344
 ds_read_b128 a[240:243], v80 offset:57344
 ds_read_b128 a[244:247], v81 offset:57344
 ds_read_b128 a[248:251], v82 offset:57344
 s_waitcnt lgkmcnt(14)
 ds_read_b128 a[252:255], v83 offset:57344
 v_mfma_f32_32x32x16_bf16 v[128:143], a[192:195], a[128:131], v[192:207]
 v_mfma_f32_32x32x16_bf16 v[144:159], a[192:195], a[160:163], v[208:223]
 s_waitcnt lgkmcnt(8)
 v_mfma_f32_32x32x16_bf16 v[128:143], a[196:199], a[132:135], v[128:143]
 v_mfma_f32_32x32x16_bf16 v[144:159], a[196:199], a[164:167], v[144:159]
 v_mfma_f32_32x32x16_bf16 v[128:143], a[200:203], a[136:139], v[128:143]
 v_mfma_f32_32x32x16_bf16 v[144:159], a[200:203], a[168:171], v[144:159]
 v_mfma_f32_32x32x16_bf16 v[128:143], a[204:207], a[140:143], v[128:143]
 v_mfma_f32_32x32x16_bf16 v[144:159], a[204:207], a[172:175], v[144:159]
 v_mfma_f32_32x32x16_bf16 v[128:143], a[208:211], a[144:147], v[128:143]
 v_mfma_f32_32x32x16_bf16 v[144:159], a[208:211], a[176:179], v[144:159]
 v_mfma_f32_32x32x16_bf16 v[128:143], a[212:215], a[148:151], v[128:143]
 v_mfma_f32_32x32x16_bf16 v[144:159], a[212:215], a[180:183], v[144:159]
 v_mfma_f32_32x32x16_bf16 v[128:143], a[216:219], a[152:155], v[128:143]
 v_mfma_f32_32x32x16_bf16 v[144:159], a[216:219], a[184:187], v[144:159]
 v_mfma_f32_32x32x16_bf16 v[128:143], a[220:223], a[156:159], v[128:143]
 v_mfma_f32_32x32x16_bf16 v[144:159], a[220:223], a[188:191], v[144:159]
 s_waitcnt lgkmcnt(0)
 v_mfma_f32_32x32x16_bf16 v[160:175], a[224:227], a[128:131], v[192:207]
 v_mfma_f32_32x32x16_bf16 v[176:191], a[224:227], a[160:163], v[208:223]
 v_mfma_f32_32x32x16_bf16 v[160:175], a[228:231], a[132:135], v[160:175]
 v_mfma_f32_32x32x16_bf16 v[176:191], a[228:231], a[164:167], v[176:191]
 v_mfma_f32_32x32x16_bf16 v[160:175], a[232:235], a[136:139], v[160:175]
 v_mfma_f32_32x32x16_bf16 v[176:191], a[232:235], a[168:171], v[176:191]
 v_mfma_f32_32x32x16_bf16 v[160:175], a[236:239], a[140:143], v[160:175]
 v_mfma_f32_32x32x16_bf16 v[176:191], a[236:239], a[172:175], v[176:191]
 v_mfma_f32_32x32x16_bf16 v[160:175], a[240:243], a[144:147], v[160:175]
 v_mfma_f32_32x32x16_bf16 v[176:191], a[240:243], a[176:179], v[176:191]
 v_mfma_f32_32x32x16_bf16 v[160:175], a[244:247], a[148:151], v[160:175]
 v_mfma_f32_32x32x16_bf16 v[176:191], a[244:247], a[180:183], v[176:191]
 v_mfma_f32_32x32x16_bf16 v[160:175], a[248:251], a[152:155], v[160:175]
 v_mfma_f32_32x32x16_bf16 v[176:191], a[248:251], a[184:187], v[176:191]
 v_mfma_f32_32x32x16_bf16 v[160:175], a[252:255], a[156:159], v[160:175]
 v_mfma_f32_32x32x16_bf16 v[176:191], a[252:255], a[188:191], v[176:191]
 ds_read_b64_tr_b16 a[192:193], v72
 ds_read_b64_tr_b16 a[194:195], v72 offset:1024
 ds_read_b64_tr_b16 a[196:197], v73
 ds_read_b64_tr_b16 a[198:199], v73 offset:1024
 ds_read_b64_tr_b16 a[200:201], v74
 ds_read_b64_tr_b16 a[202:203], v74 offset:1024
 ds_read_b64_tr_b16 a[204:205], v75
 ds_read_b64_tr_b16 a[206:207], v75 offset:1024
 ds_read_b64_tr_b16 a[208:209], v72 offset:4096
 ds_read_b64_tr_b16 a[210:211], v72 offset:5120
 ds_read_b64_tr_b16 a[212:213], v73 offset:4096
 ds_read_b64_tr_b16 a[214:215], v73 offset:5120
 ds_read_b64_tr_b16 a[216:217], v74 offset:4096
 ds_read_b64_tr_b16 a[218:219], v74 offset:5120
 ds_read_b64_tr_b16 a[220:221], v75 offset:4096
 s_waitcnt lgkmcnt(14)
 ds_read_b64_tr_b16 a[222:223], v75 offset:5120
 s_waitcnt lgkmcnt(14)
 ds_read_b64_tr_b16 a[224:225], v72 offset:8192
 s_waitcnt lgkmcnt(14)
 ds_read_b64_tr_b16 a[226:227], v72 offset:9216
 s_waitcnt lgkmcnt(14)
 ds_read_b64_tr_b16 a[228:229], v73 offset:8192
 s_waitcnt lgkmcnt(14)
 ds_read_b64_tr_b16 a[230:231], v73 offset:9216
 s_waitcnt lgkmcnt(14)
 ds_read_b64_tr_b16 a[232:233], v74 offset:8192
 s_waitcnt lgkmcnt(14)
 ds_read_b64_tr_b16 a[234:235], v74 offset:9216
 s_waitcnt lgkmcnt(14)
 ds_read_b64_tr_b16 a[236:237], v75 offset:8192
 s_waitcnt lgkmcnt(14)
 ds_read_b64_tr_b16 a[238:239], v75 offset:9216
 s_waitcnt lgkmcnt(14)
 ds_read_b64_tr_b16 a[240:241], v72 offset:12288
 s_waitcnt lgkmcnt(14)
 ds_read_b64_tr_b16 a[242:243], v72 offset:13312
 s_waitcnt lgkmcnt(14)
 ds_read_b64_tr_b16 a[244:245], v73 offset:12288
 s_waitcnt lgkmcnt(14)
 ds_read_b64_tr_b16 a[246:247], v73 offset:13312
 s_waitcnt lgkmcnt(14)
 ds_read_b64_tr_b16 a[248:249], v74 offset:12288
 s_waitcnt lgkmcnt(14)
 ds_read_b64_tr_b16 a[250:251], v74 offset:13312
 s_waitcnt lgkmcnt(14)
 ds_read_b64_tr_b16 a[252:253], v75 offset:12288
 s_waitcnt lgkmcnt(14)
 ds_read_b64_tr_b16 a[254:255], v75 offset:13312
 v_exp_f32 v128, v128
 v_exp_f32 v129, v129
 v_exp_f32 v130, v130
 v_exp_f32 v131, v131
 v_exp_f32 v132, v132
 v_exp_f32 v133, v133
 v_exp_f32 v134, v134
 v_exp_f32 v135, v135
 v_exp_f32 v136, v136
 v_exp_f32 v137, v137
 v_exp_f32 v138, v138
 v_exp_f32 v139, v139
 v_exp_f32 v140, v140
 v_exp_f32 v141, v141
 v_exp_f32 v142, v142
 v_exp_f32 v143, v143
 v_add_f32 v11, v11, v128
 v_add_f32 v11, v11, v129
 v_add_f32 v11, v11, v130
 v_add_f32 v11, v11, v131
 v_add_f32 v11, v11, v132
 v_add_f32 v11, v11, v133
 v_add_f32 v11, v11, v134
 v_add_f32 v11, v11, v135
 v_add_f32 v11, v11, v136
 v_add_f32 v11, v11, v137
 v_add_f32 v11, v11, v138
 v_add_f32 v11, v11, v139
 v_add_f32 v11, v11, v140
 v_add_f32 v11, v11, v141
 v_add_f32 v11, v11, v142
 v_add_f32 v11, v11, v143
 v_cvt_pk_bf16_f32 v128, v128, v129
 v_cvt_pk_bf16_f32 v129, v130, v131
 v_cvt_pk_bf16_f32 v130, v132, v133
 v_cvt_pk_bf16_f32 v131, v134, v135
 v_cvt_pk_bf16_f32 v136, v136, v137
 v_cvt_pk_bf16_f32 v137, v138, v139
 v_cvt_pk_bf16_f32 v138, v140, v141
 v_cvt_pk_bf16_f32 v139, v142, v143
 v_exp_f32 v144, v144
 v_exp_f32 v145, v145
 v_exp_f32 v146, v146
 v_exp_f32 v147, v147
 v_exp_f32 v148, v148
 v_exp_f32 v149, v149
 v_exp_f32 v150, v150
 v_exp_f32 v151, v151
 v_exp_f32 v152, v152
 v_exp_f32 v153, v153
 v_exp_f32 v154, v154
 v_exp_f32 v155, v155
 v_exp_f32 v156, v156
 v_exp_f32 v157, v157
 v_exp_f32 v158, v158
 v_exp_f32 v159, v159
 v_add_f32 v12, v12, v144
 v_add_f32 v12, v12, v145
 v_add_f32 v12, v12, v146
 v_add_f32 v12, v12, v147
 v_add_f32 v12, v12, v148
 v_add_f32 v12, v12, v149
 v_add_f32 v12, v12, v150
 v_add_f32 v12, v12, v151
 v_add_f32 v12, v12, v152
 v_add_f32 v12, v12, v153
 v_add_f32 v12, v12, v154
 v_add_f32 v12, v12, v155
 v_add_f32 v12, v12, v156
 v_add_f32 v12, v12, v157
 v_add_f32 v12, v12, v158
 v_add_f32 v12, v12, v159
 v_cvt_pk_bf16_f32 v144, v144, v145
 v_cvt_pk_bf16_f32 v145, v146, v147
 v_cvt_pk_bf16_f32 v146, v148, v149
 v_cvt_pk_bf16_f32 v147, v150, v151
 v_cvt_pk_bf16_f32 v152, v152, v153
 v_cvt_pk_bf16_f32 v153, v154, v155
 v_cvt_pk_bf16_f32 v154, v156, v157
 v_cvt_pk_bf16_f32 v155, v158, v159
 v_exp_f32 v160, v160
 v_exp_f32 v161, v161
 v_exp_f32 v162, v162
 v_exp_f32 v163, v163
 v_exp_f32 v164, v164
 v_exp_f32 v165, v165
 v_exp_f32 v166, v166
 v_exp_f32 v167, v167
 v_exp_f32 v168, v168
 v_exp_f32 v169, v169
 v_exp_f32 v170, v170
 v_exp_f32 v171, v171
 v_exp_f32 v172, v172
 v_exp_f32 v173, v173
 v_exp_f32 v174, v174
 v_exp_f32 v175, v175
 v_add_f32 v11, v11, v160
 v_add_f32 v11, v11, v161
 v_add_f32 v11, v11, v162
 v_add_f32 v11, v11, v163
 v_add_f32 v11, v11, v164
 v_add_f32 v11, v11, v165
 v_add_f32 v11, v11, v166
 v_add_f32 v11, v11, v167
 v_add_f32 v11, v11, v168
 v_add_f32 v11, v11, v169
 v_add_f32 v11, v11, v170
 v_add_f32 v11, v11, v171
 v_add_f32 v11, v11, v172
 v_add_f32 v11, v11, v173
 v_add_f32 v11, v11, v174
 v_add_f32 v11, v11, v175
 v_cvt_pk_bf16_f32 v160, v160, v161
 v_cvt_pk_bf16_f32 v161, v162, v163
 v_cvt_pk_bf16_f32 v162, v164, v165
 v_cvt_pk_bf16_f32 v163, v166, v167
 v_cvt_pk_bf16_f32 v168, v168, v169
 v_cvt_pk_bf16_f32 v169, v170, v171
 v_cvt_pk_bf16_f32 v170, v172, v173
 v_cvt_pk_bf16_f32 v171, v174, v175
 v_exp_f32 v176, v176
 v_exp_f32 v177, v177
 v_exp_f32 v178, v178
 v_exp_f32 v179, v179
 v_exp_f32 v180, v180
 v_exp_f32 v181, v181
 v_exp_f32 v182, v182
 v_exp_f32 v183, v183
 v_exp_f32 v184, v184
 v_exp_f32 v185, v185
 v_exp_f32 v186, v186
 v_exp_f32 v187, v187
 v_exp_f32 v188, v188
 v_exp_f32 v189, v189
 v_exp_f32 v190, v190
 v_exp_f32 v191, v191
 v_add_f32 v12, v12, v176
 v_add_f32 v12, v12, v177
 v_add_f32 v12, v12, v178
 v_add_f32 v12, v12, v179
 v_add_f32 v12, v12, v180
 v_add_f32 v12, v12, v181
 v_add_f32 v12, v12, v182
 v_add_f32 v12, v12, v183
 v_add_f32 v12, v12, v184
 v_add_f32 v12, v12, v185
 v_add_f32 v12, v12, v186
 v_add_f32 v12, v12, v187
 v_add_f32 v12, v12, v188
 v_add_f32 v12, v12, v189
 v_add_f32 v12, v12, v190
 v_add_f32 v12, v12, v191
 v_cvt_pk_bf16_f32 v176, v176, v177
 v_cvt_pk_bf16_f32 v177, v178, v179
 v_cvt_pk_bf16_f32 v178, v180, v181
 v_cvt_pk_bf16_f32 v179, v182, v183
 v_cvt_pk_bf16_f32 v184, v184, v185
 v_cvt_pk_bf16_f32 v185, v186, v187
 v_cvt_pk_bf16_f32 v186, v188, v189
 v_cvt_pk_bf16_f32 v187, v190, v191
 v_mfma_f32_32x32x16_bf16 a[0:15], a[192:195], v[128:131], a[0:15]
 v_mfma_f32_32x32x16_bf16 a[16:31], a[192:195], v[144:147], a[16:31]
 v_mfma_f32_32x32x16_bf16 a[32:47], a[196:199], v[128:131], a[32:47]
 v_mfma_f32_32x32x16_bf16 a[48:63], a[196:199], v[144:147], a[48:63]
 v_mfma_f32_32x32x16_bf16 a[64:79], a[200:203], v[128:131], a[64:79]
 v_mfma_f32_32x32x16_bf16 a[80:95], a[200:203], v[144:147], a[80:95]
 v_mfma_f32_32x32x16_bf16 a[96:111], a[204:207], v[128:131], a[96:111]
 v_mfma_f32_32x32x16_bf16 a[112:127], a[204:207], v[144:147], a[112:127]
 v_mfma_f32_32x32x16_bf16 a[0:15], a[208:211], v[136:139], a[0:15]
 v_mfma_f32_32x32x16_bf16 a[16:31], a[208:211], v[152:155], a[16:31]
 v_mfma_f32_32x32x16_bf16 a[32:47], a[212:215], v[136:139], a[32:47]
 v_mfma_f32_32x32x16_bf16 a[48:63], a[212:215], v[152:155], a[48:63]
 v_mfma_f32_32x32x16_bf16 a[64:79], a[216:219], v[136:139], a[64:79]
 v_mfma_f32_32x32x16_bf16 a[80:95], a[216:219], v[152:155], a[80:95]
 v_mfma_f32_32x32x16_bf16 a[96:111], a[220:223], v[136:139], a[96:111]
 v_mfma_f32_32x32x16_bf16 a[112:127], a[220:223], v[152:155], a[112:127]
 s_waitcnt lgkmcnt(0)
 v_mfma_f32_32x32x16_bf16 a[0:15], a[224:227], v[160:163], a[0:15]
 v_mfma_f32_32x32x16_bf16 a[16:31], a[224:227], v[176:179], a[16:31]
 v_mfma_f32_32x32x16_bf16 a[32:47], a[228:231], v[160:163], a[32:47]
 v_mfma_f32_32x32x16_bf16 a[48:63], a[228:231], v[176:179], a[48:63]
 v_mfma_f32_32x32x16_bf16 a[64:79], a[232:235], v[160:163], a[64:79]
 v_mfma_f32_32x32x16_bf16 a[80:95], a[232:235], v[176:179], a[80:95]
 v_mfma_f32_32x32x16_bf16 a[96:111], a[236:239], v[160:163], a[96:111]
 v_mfma_f32_32x32x16_bf16 a[112:127], a[236:239], v[176:179], a[112:127]
 v_mfma_f32_32x32x16_bf16 a[0:15], a[240:243], v[168:171], a[0:15]
 v_mfma_f32_32x32x16_bf16 a[16:31], a[240:243], v[184:187], a[16:31]
 v_mfma_f32_32x32x16_bf16 a[32:47], a[244:247], v[168:171], a[32:47]
 v_mfma_f32_32x32x16_bf16 a[48:63], a[244:247], v[184:187], a[48:63]
 v_mfma_f32_32x32x16_bf16 a[64:79], a[248:251], v[168:171], a[64:79]
 v_mfma_f32_32x32x16_bf16 a[80:95], a[248:251], v[184:187], a[80:95]
 v_mfma_f32_32x32x16_bf16 a[96:111], a[252:255], v[168:171], a[96:111]
 v_mfma_f32_32x32x16_bf16 a[112:127], a[252:255], v[184:187], a[112:127]
 s_add_u32 s40, s40, 0x4000
 s_add_u32 s41, s41, 1
 s_cmp_lt_u32 s41, 8
 s_nop 15
 s_nop 15
 s_cbranch_scc1 attn_p2
 v_mov_b32 v17, v11
 s_nop 1
 v_permlane32_swap_b32 v17, v11
 v_add_f32 v11, v17, v11
 v_rcp_f32 v13, v11
 v_mov_b32 v18, v12
 s_nop 1
 v_permlane32_swap_b32 v18, v12
 v_add_f32 v12, v18, v12
 v_rcp_f32 v14, v12
 v_mov_b32 v122, 0
 v_mov_b32 v120, 0
 v_accvgpr_read_b32 v24, a0
 v_accvgpr_read_b32 v25, a1
 v_accvgpr_read_b32 v26, a2
 v_accvgpr_read_b32 v27, a3
 v_accvgpr_read_b32 v28, a4
 v_accvgpr_read_b32 v29, a5
 v_accvgpr_read_b32 v30, a6
 v_accvgpr_read_b32 v31, a7
 v_mul_f32 v24, v24, v13
 v_mul_f32 v25, v25, v13
 v_mul_f32 v26, v26, v13
 v_mul_f32 v27, v27, v13
 v_mul_f32 v28, v28, v13
 v_mul_f32 v29, v29, v13
 v_mul_f32 v30, v30, v13
 v_mul_f32 v31, v31, v13
 v_cvt_pk_bf16_f32 v32, v24, v25
 v_cvt_pk_bf16_f32 v33, v26, v27
 v_cvt_pk_bf16_f32 v34, v28, v29
 v_cvt_pk_bf16_f32 v35, v30, v31
 buffer_store_dwordx4 v[32:35], v1, s[24:27], s36 offen sc1
 v_dot2c_f32_bf16 v122, v32, v120
 v_dot2c_f32_bf16 v122, v33, v120
 v_dot2c_f32_bf16 v122, v34, v120
 v_dot2c_f32_bf16 v122, v35, v120
 v_accvgpr_read_b32 v36, a8
 v_accvgpr_read_b32 v37, a9
 v_accvgpr_read_b32 v38, a10
 v_accvgpr_read_b32 v39, a11
 v_accvgpr_read_b32 v40, a12
 v_accvgpr_read_b32 v41, a13
 v_accvgpr_read_b32 v42, a14
 v_accvgpr_read_b32 v43, a15
 v_mul_f32 v36, v36, v13
 v_mul_f32 v37, v37, v13
 v_mul_f32 v38, v38, v13
 v_mul_f32 v39, v39, v13
 v_mul_f32 v40, v40, v13
 v_mul_f32 v41, v41, v13
 v_mul_f32 v42, v42, v13
 v_mul_f32 v43, v43, v13
 v_cvt_pk_bf16_f32 v44, v36, v37
 v_cvt_pk_bf16_f32 v45, v38, v39
 v_cvt_pk_bf16_f32 v46, v40, v41
 v_cvt_pk_bf16_f32 v47, v42, v43
 buffer_store_dwordx4 v[44:47], v1, s[24:27], s36 offen offset:1024 sc1
 v_dot2c_f32_bf16 v122, v44, v120
 v_dot2c_f32_bf16 v122, v45, v120
 v_dot2c_f32_bf16 v122, v46, v120
 v_dot2c_f32_bf16 v122, v47, v120
 v_permlane32_swap_b32 v32, v44
 v_permlane32_swap_b32 v33, v45
 v_permlane32_swap_b32 v34, v46
 v_permlane32_swap_b32 v35, v47
 v_permlane16_swap_b32 v32, v44
 v_permlane16_swap_b32 v33, v45
 v_permlane16_swap_b32 v34, v46
 v_permlane16_swap_b32 v35, v47
 v_accvgpr_write_b32 a0, v32
 v_accvgpr_write_b32 a4, v44
 v_accvgpr_write_b32 a1, v33
 v_accvgpr_write_b32 a5, v45
 v_accvgpr_write_b32 a2, v34
 v_accvgpr_write_b32 a6, v46
 v_accvgpr_write_b32 a3, v35
 v_accvgpr_write_b32 a7, v47
 v_accvgpr_read_b32 v24, a16
 v_accvgpr_read_b32 v25, a17
 v_accvgpr_read_b32 v26, a18
 v_accvgpr_read_b32 v27, a19
 v_accvgpr_read_b32 v28, a20
 v_accvgpr_read_b32 v29, a21
 v_accvgpr_read_b32 v30, a22
 v_accvgpr_read_b32 v31, a23
 v_mul_f32 v24, v24, v14
 v_mul_f32 v25, v25, v14
 v_mul_f32 v26, v26, v14
 v_mul_f32 v27, v27, v14
 v_mul_f32 v28, v28, v14
 v_mul_f32 v29, v29, v14
 v_mul_f32 v30, v30, v14
 v_mul_f32 v31, v31, v14
 v_cvt_pk_bf16_f32 v32, v24, v25
 v_cvt_pk_bf16_f32 v33, v26, v27
 v_cvt_pk_bf16_f32 v34, v28, v29
 v_cvt_pk_bf16_f32 v35, v30, v31
 buffer_store_dwordx4 v[32:35], v1, s[24:27], s37 offen sc1
 v_dot2c_f32_bf16 v122, v32, v120
 v_dot2c_f32_bf16 v122, v33, v120
 v_dot2c_f32_bf16 v122, v34, v120
 v_dot2c_f32_bf16 v122, v35, v120
 v_accvgpr_read_b32 v36, a24
 v_accvgpr_read_b32 v37, a25
 v_accvgpr_read_b32 v38, a26
 v_accvgpr_read_b32 v39, a27
 v_accvgpr_read_b32 v40, a28
 v_accvgpr_read_b32 v41, a29
 v_accvgpr_read_b32 v42, a30
 v_accvgpr_read_b32 v43, a31
 v_mul_f32 v36, v36, v14
 v_mul_f32 v37, v37, v14
 v_mul_f32 v38, v38, v14
 v_mul_f32 v39, v39, v14
 v_mul_f32 v40, v40, v14
 v_mul_f32 v41, v41, v14
 v_mul_f32 v42, v42, v14
 v_mul_f32 v43, v43, v14
 v_cvt_pk_bf16_f32 v44, v36, v37
 v_cvt_pk_bf16_f32 v45, v38, v39
 v_cvt_pk_bf16_f32 v46, v40, v41
 v_cvt_pk_bf16_f32 v47, v42, v43
 buffer_store_dwordx4 v[44:47], v1, s[24:27], s37 offen offset:1024 sc1
 v_dot2c_f32_bf16 v122, v44, v120
 v_dot2c_f32_bf16 v122, v45, v120
 v_dot2c_f32_bf16 v122, v46, v120
 v_dot2c_f32_bf16 v122, v47, v120
 v_permlane32_swap_b32 v32, v44
 v_permlane32_swap_b32 v33, v45
 v_permlane32_swap_b32 v34, v46
 v_permlane32_swap_b32 v35, v47
 v_permlane16_swap_b32 v32, v44
 v_permlane16_swap_b32 v33, v45
 v_permlane16_swap_b32 v34, v46
 v_permlane16_swap_b32 v35, v47
 v_accvgpr_write_b32 a8, v32
 v_accvgpr_write_b32 a12, v44
 v_accvgpr_write_b32 a9, v33
 v_accvgpr_write_b32 a13, v45
 v_accvgpr_write_b32 a10, v34
 v_accvgpr_write_b32 a14, v46
 v_accvgpr_write_b32 a11, v35
 v_accvgpr_write_b32 a15, v47
 v_accvgpr_read_b32 v24, a32
 v_accvgpr_read_b32 v25, a33
 v_accvgpr_read_b32 v26, a34
 v_accvgpr_read_b32 v27, a35
 v_accvgpr_read_b32 v28, a36
 v_accvgpr_read_b32 v29, a37
 v_accvgpr_read_b32 v30, a38
 v_accvgpr_read_b32 v31, a39
 v_mul_f32 v24, v24, v13
 v_mul_f32 v25, v25, v13
 v_mul_f32 v26, v26, v13
 v_mul_f32 v27, v27, v13
 v_mul_f32 v28, v28, v13
 v_mul_f32 v29, v29, v13
 v_mul_f32 v30, v30, v13
 v_mul_f32 v31, v31, v13
 v_cvt_pk_bf16_f32 v32, v24, v25
 v_cvt_pk_bf16_f32 v33, v26, v27
 v_cvt_pk_bf16_f32 v34, v28, v29
 v_cvt_pk_bf16_f32 v35, v30, v31
 buffer_store_dwordx4 v[32:35], v1, s[24:27], s36 offen offset:2048 sc1
 v_dot2c_f32_bf16 v122, v32, v120
 v_dot2c_f32_bf16 v122, v33, v120
 v_dot2c_f32_bf16 v122, v34, v120
 v_dot2c_f32_bf16 v122, v35, v120
 v_accvgpr_read_b32 v36, a40
 v_accvgpr_read_b32 v37, a41
 v_accvgpr_read_b32 v38, a42
 v_accvgpr_read_b32 v39, a43
 v_accvgpr_read_b32 v40, a44
 v_accvgpr_read_b32 v41, a45
 v_accvgpr_read_b32 v42, a46
 v_accvgpr_read_b32 v43, a47
 v_mul_f32 v36, v36, v13
 v_mul_f32 v37, v37, v13
 v_mul_f32 v38, v38, v13
 v_mul_f32 v39, v39, v13
 v_mul_f32 v40, v40, v13
 v_mul_f32 v41, v41, v13
 v_mul_f32 v42, v42, v13
 v_mul_f32 v43, v43, v13
 v_cvt_pk_bf16_f32 v44, v36, v37
 v_cvt_pk_bf16_f32 v45, v38, v39
 v_cvt_pk_bf16_f32 v46, v40, v41
 v_cvt_pk_bf16_f32 v47, v42, v43
 buffer_store_dwordx4 v[44:47], v1, s[24:27], s36 offen offset:3072 sc1
 v_dot2c_f32_bf16 v122, v44, v120
 v_dot2c_f32_bf16 v122, v45, v120
 v_dot2c_f32_bf16 v122, v46, v120
 v_dot2c_f32_bf16 v122, v47, v120
 v_permlane32_swap_b32 v32, v44
 v_permlane32_swap_b32 v33, v45
 v_permlane32_swap_b32 v34, v46
 v_permlane32_swap_b32 v35, v47
 v_permlane16_swap_b32 v32, v44
 v_permlane16_swap_b32 v33, v45
 v_permlane16_swap_b32 v34, v46
 v_permlane16_swap_b32 v35, v47
 v_accvgpr_write_b32 a16, v32
 v_accvgpr_write_b32 a20, v44
 v_accvgpr_write_b32 a17, v33
 v_accvgpr_write_b32 a21, v45
 v_accvgpr_write_b32 a18, v34
 v_accvgpr_write_b32 a22, v46
 v_accvgpr_write_b32 a19, v35
 v_accvgpr_write_b32 a23, v47
 v_accvgpr_read_b32 v24, a48
 v_accvgpr_read_b32 v25, a49
 v_accvgpr_read_b32 v26, a50
 v_accvgpr_read_b32 v27, a51
 v_accvgpr_read_b32 v28, a52
 v_accvgpr_read_b32 v29, a53
 v_accvgpr_read_b32 v30, a54
 v_accvgpr_read_b32 v31, a55
 v_mul_f32 v24, v24, v14
 v_mul_f32 v25, v25, v14
 v_mul_f32 v26, v26, v14
 v_mul_f32 v27, v27, v14
 v_mul_f32 v28, v28, v14
 v_mul_f32 v29, v29, v14
 v_mul_f32 v30, v30, v14
 v_mul_f32 v31, v31, v14
 v_cvt_pk_bf16_f32 v32, v24, v25
 v_cvt_pk_bf16_f32 v33, v26, v27
 v_cvt_pk_bf16_f32 v34, v28, v29
 v_cvt_pk_bf16_f32 v35, v30, v31
 buffer_store_dwordx4 v[32:35], v1, s[24:27], s37 offen offset:2048 sc1
 v_dot2c_f32_bf16 v122, v32, v120
 v_dot2c_f32_bf16 v122, v33, v120
 v_dot2c_f32_bf16 v122, v34, v120
 v_dot2c_f32_bf16 v122, v35, v120
 v_accvgpr_read_b32 v36, a56
 v_accvgpr_read_b32 v37, a57
 v_accvgpr_read_b32 v38, a58
 v_accvgpr_read_b32 v39, a59
 v_accvgpr_read_b32 v40, a60
 v_accvgpr_read_b32 v41, a61
 v_accvgpr_read_b32 v42, a62
 v_accvgpr_read_b32 v43, a63
 v_mul_f32 v36, v36, v14
 v_mul_f32 v37, v37, v14
 v_mul_f32 v38, v38, v14
 v_mul_f32 v39, v39, v14
 v_mul_f32 v40, v40, v14
 v_mul_f32 v41, v41, v14
 v_mul_f32 v42, v42, v14
 v_mul_f32 v43, v43, v14
 v_cvt_pk_bf16_f32 v44, v36, v37
 v_cvt_pk_bf16_f32 v45, v38, v39
 v_cvt_pk_bf16_f32 v46, v40, v41
 v_cvt_pk_bf16_f32 v47, v42, v43
 buffer_store_dwordx4 v[44:47], v1, s[24:27], s37 offen offset:3072 sc1
 v_dot2c_f32_bf16 v122, v44, v120
 v_dot2c_f32_bf16 v122, v45, v120
 v_dot2c_f32_bf16 v122, v46, v120
 v_dot2c_f32_bf16 v122, v47, v120
 v_permlane32_swap_b32 v32, v44
 v_permlane32_swap_b32 v33, v45
 v_permlane32_swap_b32 v34, v46
 v_permlane32_swap_b32 v35, v47
 v_permlane16_swap_b32 v32, v44
 v_permlane16_swap_b32 v33, v45
 v_permlane16_swap_b32 v34, v46
 v_permlane16_swap_b32 v35, v47
 v_accvgpr_write_b32 a24, v32
 v_accvgpr_write_b32 a28, v44
 v_accvgpr_write_b32 a25, v33
 v_accvgpr_write_b32 a29, v45
 v_accvgpr_write_b32 a26, v34
 v_accvgpr_write_b32 a30, v46
 v_accvgpr_write_b32 a27, v35
 v_accvgpr_write_b32 a31, v47
 v_accvgpr_read_b32 v24, a64
 v_accvgpr_read_b32 v25, a65
 v_accvgpr_read_b32 v26, a66
 v_accvgpr_read_b32 v27, a67
 v_accvgpr_read_b32 v28, a68
 v_accvgpr_read_b32 v29, a69
 v_accvgpr_read_b32 v30, a70
 v_accvgpr_read_b32 v31, a71
 v_mul_f32 v24, v24, v13
 v_mul_f32 v25, v25, v13
 v_mul_f32 v26, v26, v13
 v_mul_f32 v27, v27, v13
 v_mul_f32 v28, v28, v13
 v_mul_f32 v29, v29, v13
 v_mul_f32 v30, v30, v13
 v_mul_f32 v31, v31, v13
 v_cvt_pk_bf16_f32 v32, v24, v25
 v_cvt_pk_bf16_f32 v33, v26, v27
 v_cvt_pk_bf16_f32 v34, v28, v29
 v_cvt_pk_bf16_f32 v35, v30, v31
 s_add_u32 s47, s36, 0x1000
 buffer_store_dwordx4 v[32:35], v1, s[24:27], s47 offen sc1
 v_dot2c_f32_bf16 v122, v32, v120
 v_dot2c_f32_bf16 v122, v33, v120
 v_dot2c_f32_bf16 v122, v34, v120
 v_dot2c_f32_bf16 v122, v35, v120
 v_accvgpr_read_b32 v36, a72
 v_accvgpr_read_b32 v37, a73
 v_accvgpr_read_b32 v38, a74
 v_accvgpr_read_b32 v39, a75
 v_accvgpr_read_b32 v40, a76
 v_accvgpr_read_b32 v41, a77
 v_accvgpr_read_b32 v42, a78
 v_accvgpr_read_b32 v43, a79
 v_mul_f32 v36, v36, v13
 v_mul_f32 v37, v37, v13
 v_mul_f32 v38, v38, v13
 v_mul_f32 v39, v39, v13
 v_mul_f32 v40, v40, v13
 v_mul_f32 v41, v41, v13
 v_mul_f32 v42, v42, v13
 v_mul_f32 v43, v43, v13
 v_cvt_pk_bf16_f32 v44, v36, v37
 v_cvt_pk_bf16_f32 v45, v38, v39
 v_cvt_pk_bf16_f32 v46, v40, v41
 v_cvt_pk_bf16_f32 v47, v42, v43
 s_add_u32 s47, s36, 0x1000
 buffer_store_dwordx4 v[44:47], v1, s[24:27], s47 offen offset:1024 sc1
 v_dot2c_f32_bf16 v122, v44, v120
 v_dot2c_f32_bf16 v122, v45, v120
 v_dot2c_f32_bf16 v122, v46, v120
 v_dot2c_f32_bf16 v122, v47, v120
 v_permlane32_swap_b32 v32, v44
 v_permlane32_swap_b32 v33, v45
 v_permlane32_swap_b32 v34, v46
 v_permlane32_swap_b32 v35, v47
 v_permlane16_swap_b32 v32, v44
 v_permlane16_swap_b32 v33, v45
 v_permlane16_swap_b32 v34, v46
 v_permlane16_swap_b32 v35, v47
 v_accvgpr_write_b32 a32, v32
 v_accvgpr_write_b32 a36, v44
 v_accvgpr_write_b32 a33, v33
 v_accvgpr_write_b32 a37, v45
 v_accvgpr_write_b32 a34, v34
 v_accvgpr_write_b32 a38, v46
 v_accvgpr_write_b32 a35, v35
 v_accvgpr_write_b32 a39, v47
 v_accvgpr_read_b32 v24, a80
 v_accvgpr_read_b32 v25, a81
 v_accvgpr_read_b32 v26, a82
 v_accvgpr_read_b32 v27, a83
 v_accvgpr_read_b32 v28, a84
 v_accvgpr_read_b32 v29, a85
 v_accvgpr_read_b32 v30, a86
 v_accvgpr_read_b32 v31, a87
 v_mul_f32 v24, v24, v14
 v_mul_f32 v25, v25, v14
 v_mul_f32 v26, v26, v14
 v_mul_f32 v27, v27, v14
 v_mul_f32 v28, v28, v14
 v_mul_f32 v29, v29, v14
 v_mul_f32 v30, v30, v14
 v_mul_f32 v31, v31, v14
 v_cvt_pk_bf16_f32 v32, v24, v25
 v_cvt_pk_bf16_f32 v33, v26, v27
 v_cvt_pk_bf16_f32 v34, v28, v29
 v_cvt_pk_bf16_f32 v35, v30, v31
 s_add_u32 s47, s37, 0x1000
 buffer_store_dwordx4 v[32:35], v1, s[24:27], s47 offen sc1
 v_dot2c_f32_bf16 v122, v32, v120
 v_dot2c_f32_bf16 v122, v33, v120
 v_dot2c_f32_bf16 v122, v34, v120
 v_dot2c_f32_bf16 v122, v35, v120
 v_accvgpr_read_b32 v36, a88
 v_accvgpr_read_b32 v37, a89
 v_accvgpr_read_b32 v38, a90
 v_accvgpr_read_b32 v39, a91
 v_accvgpr_read_b32 v40, a92
 v_accvgpr_read_b32 v41, a93
 v_accvgpr_read_b32 v42, a94
 v_accvgpr_read_b32 v43, a95
 v_mul_f32 v36, v36, v14
 v_mul_f32 v37, v37, v14
 v_mul_f32 v38, v38, v14
 v_mul_f32 v39, v39, v14
 v_mul_f32 v40, v40, v14
 v_mul_f32 v41, v41, v14
 v_mul_f32 v42, v42, v14
 v_mul_f32 v43, v43, v14
 v_cvt_pk_bf16_f32 v44, v36, v37
 v_cvt_pk_bf16_f32 v45, v38, v39
 v_cvt_pk_bf16_f32 v46, v40, v41
 v_cvt_pk_bf16_f32 v47, v42, v43
 s_add_u32 s47, s37, 0x1000
 buffer_store_dwordx4 v[44:47], v1, s[24:27], s47 offen offset:1024 sc1
 v_dot2c_f32_bf16 v122, v44, v120
 v_dot2c_f32_bf16 v122, v45, v120
 v_dot2c_f32_bf16 v122, v46, v120
 v_dot2c_f32_bf16 v122, v47, v120
 v_permlane32_swap_b32 v32, v44
 v_permlane32_swap_b32 v33, v45
 v_permlane32_swap_b32 v34, v46
 v_permlane32_swap_b32 v35, v47
 v_permlane16_swap_b32 v32, v44
 v_permlane16_swap_b32 v33, v45
 v_permlane16_swap_b32 v34, v46
 v_permlane16_swap_b32 v35, v47
 v_accvgpr_write_b32 a40, v32
 v_accvgpr_write_b32 a44, v44
 v_accvgpr_write_b32 a41, v33
 v_accvgpr_write_b32 a45, v45
 v_accvgpr_write_b32 a42, v34
 v_accvgpr_write_b32 a46, v46
 v_accvgpr_write_b32 a43, v35
 v_accvgpr_write_b32 a47, v47
 v_accvgpr_read_b32 v24, a96
 v_accvgpr_read_b32 v25, a97
 v_accvgpr_read_b32 v26, a98
 v_accvgpr_read_b32 v27, a99
 v_accvgpr_read_b32 v28, a100
 v_accvgpr_read_b32 v29, a101
 v_accvgpr_read_b32 v30, a102
 v_accvgpr_read_b32 v31, a103
 v_mul_f32 v24, v24, v13
 v_mul_f32 v25, v25, v13
 v_mul_f32 v26, v26, v13
 v_mul_f32 v27, v27, v13
 v_mul_f32 v28, v28, v13
 v_mul_f32 v29, v29, v13
 v_mul_f32 v30, v30, v13
 v_mul_f32 v31, v31, v13
 v_cvt_pk_bf16_f32 v32, v24, v25
 v_cvt_pk_bf16_f32 v33, v26, v27
 v_cvt_pk_bf16_f32 v34, v28, v29
 v_cvt_pk_bf16_f32 v35, v30, v31
 s_add_u32 s47, s36, 0x1000
 buffer_store_dwordx4 v[32:35], v1, s[24:27], s47 offen offset:2048 sc1
 v_dot2c_f32_bf16 v122, v32, v120
 v_dot2c_f32_bf16 v122, v33, v120
 v_dot2c_f32_bf16 v122, v34, v120
 v_dot2c_f32_bf16 v122, v35, v120
 v_accvgpr_read_b32 v36, a104
 v_accvgpr_read_b32 v37, a105
 v_accvgpr_read_b32 v38, a106
 v_accvgpr_read_b32 v39, a107
 v_accvgpr_read_b32 v40, a108
 v_accvgpr_read_b32 v41, a109
 v_accvgpr_read_b32 v42, a110
 v_accvgpr_read_b32 v43, a111
 v_mul_f32 v36, v36, v13
 v_mul_f32 v37, v37, v13
 v_mul_f32 v38, v38, v13
 v_mul_f32 v39, v39, v13
 v_mul_f32 v40, v40, v13
 v_mul_f32 v41, v41, v13
 v_mul_f32 v42, v42, v13
 v_mul_f32 v43, v43, v13
 v_cvt_pk_bf16_f32 v44, v36, v37
 v_cvt_pk_bf16_f32 v45, v38, v39
 v_cvt_pk_bf16_f32 v46, v40, v41
 v_cvt_pk_bf16_f32 v47, v42, v43
 s_add_u32 s47, s36, 0x1000
 buffer_store_dwordx4 v[44:47], v1, s[24:27], s47 offen offset:3072 sc1
 v_dot2c_f32_bf16 v122, v44, v120
 v_dot2c_f32_bf16 v122, v45, v120
 v_dot2c_f32_bf16 v122, v46, v120
 v_dot2c_f32_bf16 v122, v47, v120
 v_permlane32_swap_b32 v32, v44
 v_permlane32_swap_b32 v33, v45
 v_permlane32_swap_b32 v34, v46
 v_permlane32_swap_b32 v35, v47
 v_permlane16_swap_b32 v32, v44
 v_permlane16_swap_b32 v33, v45
 v_permlane16_swap_b32 v34, v46
 v_permlane16_swap_b32 v35, v47
 v_accvgpr_write_b32 a48, v32
 v_accvgpr_write_b32 a52, v44
 v_accvgpr_write_b32 a49, v33
 v_accvgpr_write_b32 a53, v45
 v_accvgpr_write_b32 a50, v34
 v_accvgpr_write_b32 a54, v46
 v_accvgpr_write_b32 a51, v35
 v_accvgpr_write_b32 a55, v47
 v_accvgpr_read_b32 v24, a112
 v_accvgpr_read_b32 v25, a113
 v_accvgpr_read_b32 v26, a114
 v_accvgpr_read_b32 v27, a115
 v_accvgpr_read_b32 v28, a116
 v_accvgpr_read_b32 v29, a117
 v_accvgpr_read_b32 v30, a118
 v_accvgpr_read_b32 v31, a119
 v_mul_f32 v24, v24, v14
 v_mul_f32 v25, v25, v14
 v_mul_f32 v26, v26, v14
 v_mul_f32 v27, v27, v14
 v_mul_f32 v28, v28, v14
 v_mul_f32 v29, v29, v14
 v_mul_f32 v30, v30, v14
 v_mul_f32 v31, v31, v14
 v_cvt_pk_bf16_f32 v32, v24, v25
 v_cvt_pk_bf16_f32 v33, v26, v27
 v_cvt_pk_bf16_f32 v34, v28, v29
 v_cvt_pk_bf16_f32 v35, v30, v31
 s_add_u32 s47, s37, 0x1000
 buffer_store_dwordx4 v[32:35], v1, s[24:27], s47 offen offset:2048 sc1
 v_dot2c_f32_bf16 v122, v32, v120
 v_dot2c_f32_bf16 v122, v33, v120
 v_dot2c_f32_bf16 v122, v34, v120
 v_dot2c_f32_bf16 v122, v35, v120
 v_accvgpr_read_b32 v36, a120
 v_accvgpr_read_b32 v37, a121
 v_accvgpr_read_b32 v38, a122
 v_accvgpr_read_b32 v39, a123
 v_accvgpr_read_b32 v40, a124
 v_accvgpr_read_b32 v41, a125
 v_accvgpr_read_b32 v42, a126
 v_accvgpr_read_b32 v43, a127
 v_mul_f32 v36, v36, v14
 v_mul_f32 v37, v37, v14
 v_mul_f32 v38, v38, v14
 v_mul_f32 v39, v39, v14
 v_mul_f32 v40, v40, v14
 v_mul_f32 v41, v41, v14
 v_mul_f32 v42, v42, v14
 v_mul_f32 v43, v43, v14
 v_cvt_pk_bf16_f32 v44, v36, v37
 v_cvt_pk_bf16_f32 v45, v38, v39
 v_cvt_pk_bf16_f32 v46, v40, v41
 v_cvt_pk_bf16_f32 v47, v42, v43
 s_add_u32 s47, s37, 0x1000
 buffer_store_dwordx4 v[44:47], v1, s[24:27], s47 offen offset:3072 sc1
 v_dot2c_f32_bf16 v122, v44, v120
 v_dot2c_f32_bf16 v122, v45, v120
 v_dot2c_f32_bf16 v122, v46, v120
 v_dot2c_f32_bf16 v122, v47, v120
 v_permlane32_swap_b32 v32, v44
 v_permlane32_swap_b32 v33, v45
 v_permlane32_swap_b32 v34, v46
 v_permlane32_swap_b32 v35, v47
 v_permlane16_swap_b32 v32, v44
 v_permlane16_swap_b32 v33, v45
 v_permlane16_swap_b32 v34, v46
 v_permlane16_swap_b32 v35, v47
 v_accvgpr_write_b32 a56, v32
 v_accvgpr_write_b32 a60, v44
 v_accvgpr_write_b32 a57, v33
 v_accvgpr_write_b32 a61, v45
 v_accvgpr_write_b32 a58, v34
 v_accvgpr_write_b32 a62, v46
 v_accvgpr_write_b32 a59, v35
 v_accvgpr_write_b32 a63, v47
 s_waitcnt vmcnt(0) lgkmcnt(0)
 s_barrier
 s_waitcnt vmcnt(0)
 s_branch attn_cont
code_end:
 s_endpgm
.section .rodata,"a"
.p2align 6
.amdhsa_kernel pre_kernel
  .amdhsa_next_free_vgpr 136
  .amdhsa_next_free_sgpr 24
  .amdhsa_accum_offset 136
  .amdhsa_group_segment_fixed_size 0
  .amdhsa_kernarg_size 112
  .amdhsa_user_sgpr_count 2
  .amdhsa_user_sgpr_kernarg_segment_ptr 1
  .amdhsa_system_sgpr_workgroup_id_x 1
  .amdhsa_float_denorm_mode_32 3
  .amdhsa_float_denorm_mode_16_64 3
.end_amdhsa_kernel
.p2align 6
.amdhsa_kernel main_kernel
  .amdhsa_next_free_vgpr 512
  .amdhsa_next_free_sgpr 101
  .amdhsa_accum_offset 256
  .amdhsa_group_segment_fixed_size 0
  .amdhsa_kernarg_size 112
  .amdhsa_user_sgpr_count 2
  .amdhsa_user_sgpr_kernarg_segment_ptr 1
  .amdhsa_system_sgpr_workgroup_id_x 1
  .amdhsa_float_denorm_mode_32 3
  .amdhsa_float_denorm_mode_16_64 3
.end_amdhsa_kernel
```
